```python
import torch

def _softmax(x, axis=-1):
    return torch.softmax(x, dim=axis)

def _gelu(x):
    return torch.nn.functional.gelu(x, approximate='tanh')

def _silu(x):
    return torch.nn.functional.silu(x)

def _sigmoid(x):
    return torch.sigmoid(x)

def _layernorm(x, axis=-1, eps=1e-05):
    m = x.mean(dim=axis, keepdim=True)
    v = x.var(dim=axis, keepdim=True, unbiased=False)
    return (x - m) / torch.sqrt(v + eps)

def _scatter_add(tgt, idx, src, axis=0):
    return tgt.clone().index_add_(axis, idx, src)

def _segment_sum(src, seg, n):
    out = torch.zeros((n,) + src.shape[1:], dtype=src.dtype)
    return out.index_add_(0, seg, src)

def _pad(x, pw):
    flat = tuple((v for pair in reversed(pw) for v in pair))
    return torch.nn.functional.pad(x, flat)
kernel_name = 'adaLN_cond__mha_block_cached__swiglu_ffn__prompt'

def setup_inputs():

    _w = lambda a: (lambda t: t.to(torch.bfloat16) if t.is_floating_point() else t)(torch.as_tensor(a))

    def _A_setup():
        B, Sq, D = (1, 2048, 1024)
        H, Sk, Dh = (32, 2048, 128)
        return {'x': _w((lambda *s: torch.randn(*s, dtype=torch.bfloat16) * 0.05)(B, Sq, D)), 'k_cache': _w((lambda *s: torch.randn(*s, dtype=torch.bfloat16) * 3.2)(B, H, Sk, Dh)), 'v_cache': _w((lambda *s: torch.randn(*s, dtype=torch.bfloat16) * 0.4)(B, H, Sk, Dh)), 'wq': _w((lambda *s: torch.randn(*s, dtype=torch.bfloat16) * 3.2)(D, H * Dh) * D ** (-0.5)), 'wo': _w((lambda *s: torch.randn(*s, dtype=torch.bfloat16) * 0.4)(H * Dh, D) * (H * Dh) ** (-0.5))}
    _A_in = _A_setup()

    def _B_setup():
        B, S, D, F = (1, 2048, 1024, 3584)
        return {'x': _w((lambda *s: torch.randn(*s, dtype=torch.bfloat16) * 0.05)(B, S, D)), 'w_gate': _w((lambda *s: torch.randn(*s, dtype=torch.bfloat16) * 0.05)(D, F)), 'w_up': _w((lambda *s: torch.randn(*s, dtype=torch.bfloat16) * 0.05)(D, F)), 'w_down': _w((lambda *s: torch.randn(*s, dtype=torch.bfloat16) * 0.05)(F, D))}
    _B_in = _B_setup()
    return {'A_x': _A_in['x'], 'A_k_cache': _A_in['k_cache'], 'A_v_cache': _A_in['v_cache'], 'A_wq': _A_in['wq'], 'A_wo': _A_in['wo'], 'B_x': _B_in['x'], 'B_w_gate': _B_in['w_gate'], 'B_w_up': _B_in['w_up'], 'B_w_down': _B_in['w_down'], 'c': _w((lambda *s: torch.randn(*s, dtype=torch.bfloat16) * 0.1)(1, 1024) * 8.0), 'w_mod': _w((lambda *s: torch.randn(*s, dtype=torch.bfloat16) * 0.1)(1024, 6 * 1024) * 1024 ** (-0.5) * 8.0)}

def reference(A_x, A_k_cache, A_v_cache, A_wq, A_wo, B_x, B_w_gate, B_w_up, B_w_down, c, w_mod):

    def _A_ref(x, k_cache, v_cache, wq, wo):
        B, Sq, D = x.shape
        H, Dh = (32, 128)
        q = (lambda x, *d: x.permute(*d))((x @ wq).reshape(B, Sq, H, Dh), 0, 2, 1, 3)
        scores = torch.einsum('bhqd,bhkd->bhqk', q, k_cache) * Dh ** (-0.5)
        p = _softmax(scores, axis=-1)
        o = torch.einsum('bhqk,bhkd->bhqd', p, v_cache)
        return (lambda x, *d: x.permute(*d))(o, 0, 2, 1, 3).reshape(B, Sq, H * Dh) @ wo

    def _B_ref(x, w_gate, w_up, w_down):
        g = _silu(x @ w_gate)
        u = x @ w_up
        return g * u @ w_down
    x = A_x
    mod = (_silu(c) @ w_mod).reshape(c.shape[0], 6, 1, -1)
    sa, ca, ga, sb, cb, gb = (mod[:, 0].clone(), mod[:, 1].clone(), mod[:, 2].clone(), mod[:, 3].clone(), mod[:, 4].clone(), mod[:, 5].clone())
    h = _layernorm(x, axis=-1) * (1 + ca) + sa
    x = x + ga * _A_ref(h, A_k_cache, A_v_cache, A_wq, A_wo)
    h = _layernorm(x, axis=-1) * (1 + cb) + sb
    x = x + gb * _B_ref(h, B_w_gate, B_w_up, B_w_down)
    return x
```

```asm
; @launch kernel=gemv_kernel grid=(128,1,1) block=(1024,1,1) lds=4096
; @launch kernel=main_kernel grid=(256,1,1) block=(256,1,1) lds=163840
.amdgcn_target "amdgcn-amd-amdhsa--gfx950"
.text
.globl gemv_kernel
.p2align 8
.type gemv_kernel,@function
gemv_kernel:
    s_cmp_ge_u32 s2, 128
    s_cbranch_scc1 L_gemv_kernel_done
    s_load_dwordx2 s[4:5], s[0:1], 72
    s_load_dwordx2 s[6:7], s[0:1], 80
    s_load_dwordx2 s[8:9], s[0:1], 104
    v_lshrrev_b32 v3, 6, v0
    s_nop 0
    v_readfirstlane_b32 s36, v3
    s_nop 0
    s_cmp_lg_u32 s36, 0
    s_cbranch_scc1 L_gemv_kernel_noclr
    s_waitcnt lgkmcnt(0)
    s_add_u32 s12, s8, 0x60000
    s_addc_u32 s13, s9, 0
    s_mov_b32 s14, 0x6800
    s_mov_b32 s15, 0x20000
    s_mul_i32 s3, s2, 208
    v_lshlrev_b32 v4, 2, v0
    v_add_u32 v5, s3, v4
    v_cmp_gt_u32 vcc, 208, v4
    v_mov_b32 v6, 0x7f000000
    s_nop 0
    v_cndmask_b32 v5, v6, v5, vcc
    v_mov_b32 v6, 0
    buffer_store_dword v6, v5, s[12:15], 0 offen
L_gemv_kernel_noclr:
    s_cmp_ge_u32 s2, 128
    s_cbranch_scc1 L_gemv_kernel_done
    s_lshr_b32 s37, s2, 5
    s_and_b32 s39, s2, 31
    s_lshl_b32 s39, s39, 6
    s_lshl_b32 s42, s37, 8
    s_lshl_b32 s43, s36, 4
    s_add_u32 s38, s42, s43
    v_bfe_u32 v2, v0, 3, 3
    v_add_u32 v1, s38, v2
    v_and_b32 v2, 7, v0
    v_lshlrev_b32 v3, 1, v1
    v_mul_u32_u24 v4, 0x3000, v1
    v_lshl_add_u32 v4, v2, 4, v4
    s_lshl_b32 s42, s39, 1
    v_add_u32 v4, s42, v4
    s_mov_b32 s24, 0
    s_mov_b32 s25, 98304
    s_mov_b32 s26, 196608
    s_mov_b32 s27, 294912
    s_mov_b32 s28, 32
    s_mov_b32 s29, 48
    s_waitcnt lgkmcnt(0)
    s_mov_b32 s12, s4
    s_mov_b32 s13, s5
    s_mov_b32 s14, 0x800
    s_mov_b32 s15, 0x20000
    s_mov_b32 s16, s6
    s_mov_b32 s17, s7
    s_mov_b32 s18, 0xc00000
    s_mov_b32 s19, 0x20000
    s_mov_b32 s20, s8
    s_mov_b32 s21, s9
    s_mov_b32 s22, 0x40000
    s_mov_b32 s23, 0x20000
    buffer_load_dwordx4 v[16:19], v4, s[16:19], s24 offen
    buffer_load_dwordx4 v[20:23], v4, s[16:19], s25 offen
    buffer_load_ushort v8, v3, s[12:15], 0 offen
    buffer_load_ushort v9, v3, s[12:15], 0 offen offset:16
    s_cmp_lg_u32 s36, 15
    s_cbranch_scc1 L_gemv_kernel_nocode
    s_getpc_b64 s[42:43]
L_gemv_kernel_pc:
    s_bfe_u32 s44, s2, 0x40003
    s_lshl_b32 s44, s44, 6
    v_and_b32 v42, 63, v0
    v_add_u32 v42, s44, v42
    v_lshlrev_b32 v42, 7, v42
    v_min_u32 v42, L_code_end-L_gemv_kernel_pc-4, v42
    v_mov_b32 v43, s43
    v_add_co_u32 v42, vcc, s42, v42
    s_nop 1
    v_addc_co_u32 v43, vcc, 0, v43, vcc
    global_load_dword v44, v[42:43], off
L_gemv_kernel_nocode:
    s_waitcnt vmcnt(0)
    v_lshlrev_b32 v8, 16, v8
    v_lshlrev_b32 v9, 16, v9
    v_lshlrev_b32 v10, 16, v10
    v_lshlrev_b32 v11, 16, v11
    v_mul_f32 v12, 0xbfb8aa3b, v8
    v_mul_f32 v13, 0xbfb8aa3b, v9
    v_mul_f32 v14, 0xbfb8aa3b, v10
    v_mul_f32 v15, 0xbfb8aa3b, v11
    v_exp_f32 v12, v12
    v_exp_f32 v13, v13
    v_exp_f32 v14, v14
    v_exp_f32 v15, v15
    v_add_f32 v12, 1.0, v12
    v_add_f32 v13, 1.0, v13
    v_add_f32 v14, 1.0, v14
    v_add_f32 v15, 1.0, v15
    v_rcp_f32 v12, v12
    v_rcp_f32 v13, v13
    v_rcp_f32 v14, v14
    v_rcp_f32 v15, v15
    v_mul_f32 v8, v8, v12
    v_mul_f32 v9, v9, v13
    v_mul_f32 v10, v10, v14
    v_mul_f32 v11, v11, v15
    v_cvt_pk_bf16_f32 v8, v8, v8
    v_cvt_pk_bf16_f32 v9, v9, v9
    v_cvt_pk_bf16_f32 v10, v10, v10
    v_cvt_pk_bf16_f32 v11, v11, v11
    v_lshlrev_b32 v8, 16, v8
    v_lshlrev_b32 v9, 16, v9
    v_lshlrev_b32 v10, 16, v10
    v_lshlrev_b32 v11, 16, v11
    v_lshlrev_b32 v40, 16, v16
    v_and_b32 v41, 0xffff0000, v16
    v_mul_f32 v32, v8, v40
    v_mul_f32 v33, v8, v41
    v_lshlrev_b32 v40, 16, v17
    v_and_b32 v41, 0xffff0000, v17
    v_mul_f32 v34, v8, v40
    v_mul_f32 v35, v8, v41
    v_lshlrev_b32 v40, 16, v18
    v_and_b32 v41, 0xffff0000, v18
    v_mul_f32 v36, v8, v40
    v_mul_f32 v37, v8, v41
    v_lshlrev_b32 v40, 16, v19
    v_and_b32 v41, 0xffff0000, v19
    v_mul_f32 v38, v8, v40
    v_mul_f32 v39, v8, v41
    v_lshlrev_b32 v40, 16, v20
    v_and_b32 v41, 0xffff0000, v20
    v_fmac_f32 v32, v9, v40
    v_fmac_f32 v33, v9, v41
    v_lshlrev_b32 v40, 16, v21
    v_and_b32 v41, 0xffff0000, v21
    v_fmac_f32 v34, v9, v40
    v_fmac_f32 v35, v9, v41
    v_lshlrev_b32 v40, 16, v22
    v_and_b32 v41, 0xffff0000, v22
    v_fmac_f32 v36, v9, v40
    v_fmac_f32 v37, v9, v41
    v_lshlrev_b32 v40, 16, v23
    v_and_b32 v41, 0xffff0000, v23
    v_fmac_f32 v38, v9, v40
    v_fmac_f32 v39, v9, v41
L_gemv_kernel_fdone:
    v_add_f32_dpp v32, v32, v32 row_ror:8 row_mask:0xf bank_mask:0xf
    v_add_f32_dpp v33, v33, v33 row_ror:8 row_mask:0xf bank_mask:0xf
    v_add_f32_dpp v34, v34, v34 row_ror:8 row_mask:0xf bank_mask:0xf
    v_add_f32_dpp v35, v35, v35 row_ror:8 row_mask:0xf bank_mask:0xf
    v_add_f32_dpp v36, v36, v36 row_ror:8 row_mask:0xf bank_mask:0xf
    v_add_f32_dpp v37, v37, v37 row_ror:8 row_mask:0xf bank_mask:0xf
    v_add_f32_dpp v38, v38, v38 row_ror:8 row_mask:0xf bank_mask:0xf
    v_add_f32_dpp v39, v39, v39 row_ror:8 row_mask:0xf bank_mask:0xf
    v_mov_b32 v16, v32
    v_mov_b32 v17, v33
    v_mov_b32 v18, v34
    v_mov_b32 v19, v35
    v_mov_b32 v20, v36
    v_mov_b32 v21, v37
    v_mov_b32 v22, v38
    v_mov_b32 v23, v39
    v_permlane16_swap_b32 v32, v16
    v_permlane16_swap_b32 v33, v17
    v_permlane16_swap_b32 v34, v18
    v_permlane16_swap_b32 v35, v19
    v_permlane16_swap_b32 v36, v20
    v_permlane16_swap_b32 v37, v21
    v_permlane16_swap_b32 v38, v22
    v_permlane16_swap_b32 v39, v23
    v_add_f32 v32, v32, v16
    v_add_f32 v33, v33, v17
    v_add_f32 v34, v34, v18
    v_add_f32 v35, v35, v19
    v_add_f32 v36, v36, v20
    v_add_f32 v37, v37, v21
    v_add_f32 v38, v38, v22
    v_add_f32 v39, v39, v23
    v_mov_b32 v16, v32
    v_mov_b32 v17, v33
    v_mov_b32 v18, v34
    v_mov_b32 v19, v35
    v_mov_b32 v20, v36
    v_mov_b32 v21, v37
    v_mov_b32 v22, v38
    v_mov_b32 v23, v39
    v_permlane32_swap_b32 v32, v16
    v_permlane32_swap_b32 v33, v17
    v_permlane32_swap_b32 v34, v18
    v_permlane32_swap_b32 v35, v19
    v_permlane32_swap_b32 v36, v20
    v_permlane32_swap_b32 v37, v21
    v_permlane32_swap_b32 v38, v22
    v_permlane32_swap_b32 v39, v23
    v_add_f32 v32, v32, v16
    v_add_f32 v33, v33, v17
    v_add_f32 v34, v34, v18
    v_add_f32 v35, v35, v19
    v_add_f32 v36, v36, v20
    v_add_f32 v37, v37, v21
    v_add_f32 v38, v38, v22
    v_add_f32 v39, v39, v23
    s_lshl_b32 s3, s36, 8
    v_lshl_add_u32 v5, v2, 5, s3
    v_and_b32 v6, 63, v0
    v_cmp_gt_u32 vcc, 8, v6
    s_nop 0
    s_and_saveexec_b64 s[30:31], vcc
    ds_write_b128 v5, v[32:35]
    ds_write_b128 v5, v[36:39] offset:16
    s_mov_b64 exec, s[30:31]
    s_waitcnt lgkmcnt(0)
    s_barrier
    s_cmp_lg_u32 s36, 0
    s_cbranch_scc1 L_gemv_kernel_done
    v_lshlrev_b32 v5, 2, v0
    ds_read_b32 v8, v5 offset:0
    ds_read_b32 v9, v5 offset:256
    ds_read_b32 v10, v5 offset:512
    ds_read_b32 v11, v5 offset:768
    ds_read_b32 v12, v5 offset:1024
    ds_read_b32 v13, v5 offset:1280
    ds_read_b32 v14, v5 offset:1536
    ds_read_b32 v15, v5 offset:1792
    ds_read_b32 v16, v5 offset:2048
    ds_read_b32 v17, v5 offset:2304
    ds_read_b32 v18, v5 offset:2560
    ds_read_b32 v19, v5 offset:2816
    ds_read_b32 v20, v5 offset:3072
    ds_read_b32 v21, v5 offset:3328
    ds_read_b32 v22, v5 offset:3584
    ds_read_b32 v23, v5 offset:3840
    s_waitcnt lgkmcnt(0)
    v_add_f32 v8, v8, v9
    v_add_f32 v10, v10, v11
    v_add_f32 v12, v12, v13
    v_add_f32 v14, v14, v15
    v_add_f32 v16, v16, v17
    v_add_f32 v18, v18, v19
    v_add_f32 v20, v20, v21
    v_add_f32 v22, v22, v23
    v_add_f32 v8, v8, v10
    v_add_f32 v12, v12, v14
    v_add_f32 v16, v16, v18
    v_add_f32 v20, v20, v22
    v_add_f32 v8, v8, v12
    v_add_f32 v16, v16, v20
    v_add_f32 v8, v8, v16
    s_lshl_b32 s3, s37, 13
    s_lshl_b32 s42, s39, 2
    s_add_u32 s3, s3, s42
    s_add_u32 s3, s3, 0x30000
    v_add_u32 v5, s3, v5
    buffer_store_dword v8, v5, s[20:23], 0 offen
L_gemv_kernel_done:
    s_endpgm
.section .rodata,"a"
.p2align 6
.amdhsa_kernel gemv_kernel
  .amdhsa_next_free_vgpr 128
  .amdhsa_next_free_sgpr 100
  .amdhsa_accum_offset 128
  .amdhsa_group_segment_fixed_size 0
  .amdhsa_kernarg_size 112
  .amdhsa_user_sgpr_count 2
  .amdhsa_user_sgpr_kernarg_segment_ptr 1
  .amdhsa_system_sgpr_workgroup_id_x 1
  .amdhsa_float_denorm_mode_32 3
.end_amdhsa_kernel
.text
.globl main_kernel
.p2align 8
.type main_kernel,@function
main_kernel:
    s_cmp_ge_u32 s2, 256
    s_cbranch_scc1 L_main_done
    v_readfirstlane_b32 s94, v0
    s_nop 0
    s_and_b32 s94, s94, 0x3c0
    s_load_dwordx2 s[4:5], s[0:1], 104
    s_load_dwordx2 s[8:9], s[0:1], 0
    s_load_dwordx2 s[10:11], s[0:1], 24
    s_lshr_b32 s36, s94, 6
    v_and_b32 v212, 63, v0
    v_and_b32 v1, 7, v212
    v_lshrrev_b32 v2, 3, v212
    s_lshl_b32 s50, s2, 3
    v_add_u32 v3, s50, v1
    s_lshl_b32 s42, s36, 5
    v_add_u32 v2, s42, v2
    v_lshlrev_b32 v4, 11, v3
    v_lshl_add_u32 v5, v2, 4, v4
    v_lshlrev_b32 v6, 5, v0
    s_mov_b32 s42, 24576
    s_waitcnt lgkmcnt(0)
    s_mov_b32 s12, s8
    s_mov_b32 s13, s9
    s_mov_b32 s14, 0x400000
    s_mov_b32 s15, 0x20000
    s_add_u32 s20, s4, 0x30000
    s_addc_u32 s21, s5, 0
    s_mov_b32 s22, 0xc000
    s_mov_b32 s23, 0x20000
    s_add_u32 s32, s4, 0x100000
    s_addc_u32 s33, s5, 0
    s_mov_b32 s34, 0x400000
    s_mov_b32 s35, 0x20000
    buffer_load_dwordx4 v[16:19], v5, s[12:15], 0 offen offset:0
    buffer_load_dwordx4 v[20:23], v5, s[12:15], 0 offen offset:128
    buffer_load_dwordx4 v[24:27], v5, s[12:15], 0 offen offset:256
    buffer_load_dwordx4 v[28:31], v5, s[12:15], 0 offen offset:384
    s_mov_b32 s42, 0
    buffer_load_dwordx4 v[32:35], v6, s[20:23], s42 offen
    buffer_load_dwordx4 v[36:39], v6, s[20:23], s42 offen offset:16
    s_mov_b32 s42, 8192
    buffer_load_dwordx4 v[40:43], v6, s[20:23], s42 offen
    buffer_load_dwordx4 v[44:47], v6, s[20:23], s42 offen offset:16
    s_mov_b32 s42, 16384
    buffer_load_dwordx4 v[48:51], v6, s[20:23], s42 offen
    buffer_load_dwordx4 v[52:55], v6, s[20:23], s42 offen offset:16
    s_mov_b32 s42, 24576
    buffer_load_dwordx4 v[56:59], v6, s[20:23], s42 offen
    buffer_load_dwordx4 v[60:63], v6, s[20:23], s42 offen offset:16
    s_waitcnt vmcnt(0)
    v_add_f32 v32, v32, v48
    v_add_f32 v40, v40, v56
    v_add_f32 v33, v33, v49
    v_add_f32 v41, v41, v57
    v_add_f32 v34, v34, v50
    v_add_f32 v42, v42, v58
    v_add_f32 v35, v35, v51
    v_add_f32 v43, v43, v59
    v_add_f32 v36, v36, v52
    v_add_f32 v44, v44, v60
    v_add_f32 v37, v37, v53
    v_add_f32 v45, v45, v61
    v_add_f32 v38, v38, v54
    v_add_f32 v46, v46, v62
    v_add_f32 v39, v39, v55
    v_add_f32 v47, v47, v63
    v_add_f32 v32, v32, v40
    v_add_f32 v33, v33, v41
    v_add_f32 v34, v34, v42
    v_add_f32 v35, v35, v43
    v_add_f32 v36, v36, v44
    v_add_f32 v37, v37, v45
    v_add_f32 v38, v38, v46
    v_add_f32 v39, v39, v47
    v_cvt_pk_bf16_f32 v64, v32, v33
    v_lshlrev_b32 v32, 16, v64
    v_and_b32 v33, 0xffff0000, v64
    v_cvt_pk_bf16_f32 v65, v34, v35
    v_lshlrev_b32 v34, 16, v65
    v_and_b32 v35, 0xffff0000, v65
    v_cvt_pk_bf16_f32 v64, v36, v37
    v_lshlrev_b32 v36, 16, v64
    v_and_b32 v37, 0xffff0000, v64
    v_cvt_pk_bf16_f32 v65, v38, v39
    v_lshlrev_b32 v38, 16, v65
    v_and_b32 v39, 0xffff0000, v65
    v_add_f32 v40, 1.0, v32
    v_add_f32 v41, 1.0, v33
    v_add_f32 v42, 1.0, v34
    v_add_f32 v43, 1.0, v35
    v_add_f32 v44, 1.0, v36
    v_add_f32 v45, 1.0, v37
    v_add_f32 v46, 1.0, v38
    v_add_f32 v47, 1.0, v39
    v_cvt_pk_bf16_f32 v64, v40, v41
    v_lshlrev_b32 v40, 16, v64
    v_and_b32 v41, 0xffff0000, v64
    v_cvt_pk_bf16_f32 v65, v42, v43
    v_lshlrev_b32 v42, 16, v65
    v_and_b32 v43, 0xffff0000, v65
    v_cvt_pk_bf16_f32 v64, v44, v45
    v_lshlrev_b32 v44, 16, v64
    v_and_b32 v45, 0xffff0000, v64
    v_cvt_pk_bf16_f32 v65, v46, v47
    v_lshlrev_b32 v46, 16, v65
    v_and_b32 v47, 0xffff0000, v65
    v_cmp_le_u32 vcc, 128, v0
    s_nop 1
    v_cndmask_b32 v32, v32, v40, vcc
    v_cndmask_b32 v33, v33, v41, vcc
    v_cndmask_b32 v34, v34, v42, vcc
    v_cndmask_b32 v35, v35, v43, vcc
    v_cndmask_b32 v36, v36, v44, vcc
    v_cndmask_b32 v37, v37, v45, vcc
    v_cndmask_b32 v38, v38, v46, vcc
    v_cndmask_b32 v39, v39, v47, vcc
    ds_write_b128 v6, v[32:35] offset:1024
    ds_write_b128 v6, v[36:39] offset:1040
    v_lshlrev_b32 v96, 16, v16
    v_and_b32 v97, 0xffff0000, v16
    v_lshlrev_b32 v98, 16, v17
    v_and_b32 v99, 0xffff0000, v17
    v_lshlrev_b32 v100, 16, v18
    v_and_b32 v101, 0xffff0000, v18
    v_lshlrev_b32 v102, 16, v19
    v_and_b32 v103, 0xffff0000, v19
    v_lshlrev_b32 v104, 16, v20
    v_and_b32 v105, 0xffff0000, v20
    v_lshlrev_b32 v106, 16, v21
    v_and_b32 v107, 0xffff0000, v21
    v_lshlrev_b32 v108, 16, v22
    v_and_b32 v109, 0xffff0000, v22
    v_lshlrev_b32 v110, 16, v23
    v_and_b32 v111, 0xffff0000, v23
    v_lshlrev_b32 v112, 16, v24
    v_and_b32 v113, 0xffff0000, v24
    v_lshlrev_b32 v114, 16, v25
    v_and_b32 v115, 0xffff0000, v25
    v_lshlrev_b32 v116, 16, v26
    v_and_b32 v117, 0xffff0000, v26
    v_lshlrev_b32 v118, 16, v27
    v_and_b32 v119, 0xffff0000, v27
    v_lshlrev_b32 v120, 16, v28
    v_and_b32 v121, 0xffff0000, v28
    v_lshlrev_b32 v122, 16, v29
    v_and_b32 v123, 0xffff0000, v29
    v_lshlrev_b32 v124, 16, v30
    v_and_b32 v125, 0xffff0000, v30
    v_lshlrev_b32 v126, 16, v31
    v_and_b32 v127, 0xffff0000, v31
    v_pk_add_f32 v[14:15], v[96:97], v[98:99]
    v_pk_add_f32 v[14:15], v[14:15], v[100:101]
    v_pk_add_f32 v[14:15], v[14:15], v[102:103]
    v_pk_add_f32 v[14:15], v[14:15], v[104:105]
    v_pk_add_f32 v[14:15], v[14:15], v[106:107]
    v_pk_add_f32 v[14:15], v[14:15], v[108:109]
    v_pk_add_f32 v[14:15], v[14:15], v[110:111]
    v_pk_add_f32 v[14:15], v[14:15], v[112:113]
    v_pk_add_f32 v[14:15], v[14:15], v[114:115]
    v_pk_add_f32 v[14:15], v[14:15], v[116:117]
    v_pk_add_f32 v[14:15], v[14:15], v[118:119]
    v_pk_add_f32 v[14:15], v[14:15], v[120:121]
    v_pk_add_f32 v[14:15], v[14:15], v[122:123]
    v_pk_add_f32 v[14:15], v[14:15], v[124:125]
    v_pk_add_f32 v[14:15], v[14:15], v[126:127]
    v_add_f32 v14, v14, v15
    s_nop 1
    v_add_f32_dpp v14, v14, v14 row_ror:8 row_mask:0xf bank_mask:0xf
    v_mov_b32 v13, v14
    s_nop 1
    v_permlane16_swap_b32 v14, v13
    v_add_f32 v14, v14, v13
    v_mov_b32 v13, v14
    s_nop 1
    v_permlane32_swap_b32 v14, v13
    v_add_f32 v14, v14, v13
    v_cmp_gt_u32 vcc, 8, v212
    v_lshlrev_b32 v13, 4, v1
    s_lshl_b32 s42, s36, 2
    v_add_u32 v13, s42, v13
    s_and_saveexec_b64 s[52:53], vcc
    ds_write_b32 v13, v14 offset:0
    s_mov_b64 exec, s[52:53]
    s_waitcnt lgkmcnt(0)
    s_barrier
    v_lshlrev_b32 v13, 4, v1
    ds_read_b128 v[128:131], v13 offset:0
    s_waitcnt lgkmcnt(0)
    v_add_f32 v128, v128, v129
    v_add_f32 v130, v130, v131
    v_add_f32 v14, v128, v130
    v_mul_f32 v14, 0x3a800000, v14
    v_pk_add_f32 v[96:97], v[96:97], v[14:15] op_sel_hi:[1,0] neg_lo:[0,1] neg_hi:[0,1]
    v_pk_add_f32 v[98:99], v[98:99], v[14:15] op_sel_hi:[1,0] neg_lo:[0,1] neg_hi:[0,1]
    v_pk_add_f32 v[100:101], v[100:101], v[14:15] op_sel_hi:[1,0] neg_lo:[0,1] neg_hi:[0,1]
    v_pk_add_f32 v[102:103], v[102:103], v[14:15] op_sel_hi:[1,0] neg_lo:[0,1] neg_hi:[0,1]
    v_pk_add_f32 v[104:105], v[104:105], v[14:15] op_sel_hi:[1,0] neg_lo:[0,1] neg_hi:[0,1]
    v_pk_add_f32 v[106:107], v[106:107], v[14:15] op_sel_hi:[1,0] neg_lo:[0,1] neg_hi:[0,1]
    v_pk_add_f32 v[108:109], v[108:109], v[14:15] op_sel_hi:[1,0] neg_lo:[0,1] neg_hi:[0,1]
    v_pk_add_f32 v[110:111], v[110:111], v[14:15] op_sel_hi:[1,0] neg_lo:[0,1] neg_hi:[0,1]
    v_pk_add_f32 v[112:113], v[112:113], v[14:15] op_sel_hi:[1,0] neg_lo:[0,1] neg_hi:[0,1]
    v_pk_add_f32 v[114:115], v[114:115], v[14:15] op_sel_hi:[1,0] neg_lo:[0,1] neg_hi:[0,1]
    v_pk_add_f32 v[116:117], v[116:117], v[14:15] op_sel_hi:[1,0] neg_lo:[0,1] neg_hi:[0,1]
    v_pk_add_f32 v[118:119], v[118:119], v[14:15] op_sel_hi:[1,0] neg_lo:[0,1] neg_hi:[0,1]
    v_pk_add_f32 v[120:121], v[120:121], v[14:15] op_sel_hi:[1,0] neg_lo:[0,1] neg_hi:[0,1]
    v_pk_add_f32 v[122:123], v[122:123], v[14:15] op_sel_hi:[1,0] neg_lo:[0,1] neg_hi:[0,1]
    v_pk_add_f32 v[124:125], v[124:125], v[14:15] op_sel_hi:[1,0] neg_lo:[0,1] neg_hi:[0,1]
    v_pk_add_f32 v[126:127], v[126:127], v[14:15] op_sel_hi:[1,0] neg_lo:[0,1] neg_hi:[0,1]
    v_pk_mul_f32 v[14:15], v[96:97], v[96:97]
    v_pk_fma_f32 v[14:15], v[98:99], v[98:99], v[14:15]
    v_pk_fma_f32 v[14:15], v[100:101], v[100:101], v[14:15]
    v_pk_fma_f32 v[14:15], v[102:103], v[102:103], v[14:15]
    v_pk_fma_f32 v[14:15], v[104:105], v[104:105], v[14:15]
    v_pk_fma_f32 v[14:15], v[106:107], v[106:107], v[14:15]
    v_pk_fma_f32 v[14:15], v[108:109], v[108:109], v[14:15]
    v_pk_fma_f32 v[14:15], v[110:111], v[110:111], v[14:15]
    v_pk_fma_f32 v[14:15], v[112:113], v[112:113], v[14:15]
    v_pk_fma_f32 v[14:15], v[114:115], v[114:115], v[14:15]
    v_pk_fma_f32 v[14:15], v[116:117], v[116:117], v[14:15]
    v_pk_fma_f32 v[14:15], v[118:119], v[118:119], v[14:15]
    v_pk_fma_f32 v[14:15], v[120:121], v[120:121], v[14:15]
    v_pk_fma_f32 v[14:15], v[122:123], v[122:123], v[14:15]
    v_pk_fma_f32 v[14:15], v[124:125], v[124:125], v[14:15]
    v_pk_fma_f32 v[14:15], v[126:127], v[126:127], v[14:15]
    v_add_f32 v14, v14, v15
    s_nop 1
    v_add_f32_dpp v14, v14, v14 row_ror:8 row_mask:0xf bank_mask:0xf
    v_mov_b32 v13, v14
    s_nop 1
    v_permlane16_swap_b32 v14, v13
    v_add_f32 v14, v14, v13
    v_mov_b32 v13, v14
    s_nop 1
    v_permlane32_swap_b32 v14, v13
    v_add_f32 v14, v14, v13
    v_cmp_gt_u32 vcc, 8, v212
    v_lshlrev_b32 v13, 4, v1
    s_lshl_b32 s42, s36, 2
    v_add_u32 v13, s42, v13
    s_and_saveexec_b64 s[52:53], vcc
    ds_write_b32 v13, v14 offset:256
    s_mov_b64 exec, s[52:53]
    s_waitcnt lgkmcnt(0)
    s_barrier
    v_lshlrev_b32 v13, 4, v1
    ds_read_b128 v[128:131], v13 offset:256
    s_waitcnt lgkmcnt(0)
    v_add_f32 v128, v128, v129
    v_add_f32 v130, v130, v131
    v_add_f32 v14, v128, v130
    v_mov_b32 v15, 0x3727c5ac
    v_fmac_f32 v15, 0x3a800000, v14
    v_rsq_f32 v160, v15
    v_lshrrev_b32 v13, 5, v3
    v_lshlrev_b32 v13, 16, v13
    v_lshl_add_u32 v13, v2, 9, v13
    v_and_b32 v14, 31, v3
    v_lshl_add_u32 v13, v14, 4, v13
    v_lshlrev_b32 v9, 5, v2
    ds_read_b128 v[128:131], v9 offset:1024
    ds_read_b128 v[132:135], v9 offset:1040
    ds_read_b128 v[136:139], v9 offset:5120
    ds_read_b128 v[140:143], v9 offset:5136
    v_pk_mul_f32 v[96:97], v[96:97], v[160:161] op_sel_hi:[1,0]
    v_pk_mul_f32 v[98:99], v[98:99], v[160:161] op_sel_hi:[1,0]
    v_pk_mul_f32 v[100:101], v[100:101], v[160:161] op_sel_hi:[1,0]
    v_pk_mul_f32 v[102:103], v[102:103], v[160:161] op_sel_hi:[1,0]
    s_waitcnt lgkmcnt(0)
    v_pk_fma_f32 v[96:97], v[96:97], v[136:137], v[128:129]
    v_pk_fma_f32 v[98:99], v[98:99], v[138:139], v[130:131]
    v_pk_fma_f32 v[100:101], v[100:101], v[140:141], v[132:133]
    v_pk_fma_f32 v[102:103], v[102:103], v[142:143], v[134:135]
    v_cvt_pk_bf16_f32 v152, v96, v97
    v_cvt_pk_bf16_f32 v153, v98, v99
    v_cvt_pk_bf16_f32 v154, v100, v101
    v_cvt_pk_bf16_f32 v155, v102, v103
    s_mov_b32 s42, 0
    buffer_store_dwordx4 v[152:155], v13, s[32:35], s42 offen sc1
    ds_read_b128 v[128:131], v9 offset:1280
    ds_read_b128 v[132:135], v9 offset:1296
    ds_read_b128 v[136:139], v9 offset:5376
    ds_read_b128 v[140:143], v9 offset:5392
    v_pk_mul_f32 v[104:105], v[104:105], v[160:161] op_sel_hi:[1,0]
    v_pk_mul_f32 v[106:107], v[106:107], v[160:161] op_sel_hi:[1,0]
    v_pk_mul_f32 v[108:109], v[108:109], v[160:161] op_sel_hi:[1,0]
    v_pk_mul_f32 v[110:111], v[110:111], v[160:161] op_sel_hi:[1,0]
    s_waitcnt lgkmcnt(0)
    v_pk_fma_f32 v[104:105], v[104:105], v[136:137], v[128:129]
    v_pk_fma_f32 v[106:107], v[106:107], v[138:139], v[130:131]
    v_pk_fma_f32 v[108:109], v[108:109], v[140:141], v[132:133]
    v_pk_fma_f32 v[110:111], v[110:111], v[142:143], v[134:135]
    v_cvt_pk_bf16_f32 v156, v104, v105
    v_cvt_pk_bf16_f32 v157, v106, v107
    v_cvt_pk_bf16_f32 v158, v108, v109
    v_cvt_pk_bf16_f32 v159, v110, v111
    s_mov_b32 s42, 4096
    buffer_store_dwordx4 v[156:159], v13, s[32:35], s42 offen sc1
    ds_read_b128 v[128:131], v9 offset:1536
    ds_read_b128 v[132:135], v9 offset:1552
    ds_read_b128 v[136:139], v9 offset:5632
    ds_read_b128 v[140:143], v9 offset:5648
    v_pk_mul_f32 v[112:113], v[112:113], v[160:161] op_sel_hi:[1,0]
    v_pk_mul_f32 v[114:115], v[114:115], v[160:161] op_sel_hi:[1,0]
    v_pk_mul_f32 v[116:117], v[116:117], v[160:161] op_sel_hi:[1,0]
    v_pk_mul_f32 v[118:119], v[118:119], v[160:161] op_sel_hi:[1,0]
    s_waitcnt lgkmcnt(0)
    v_pk_fma_f32 v[112:113], v[112:113], v[136:137], v[128:129]
    v_pk_fma_f32 v[114:115], v[114:115], v[138:139], v[130:131]
    v_pk_fma_f32 v[116:117], v[116:117], v[140:141], v[132:133]
    v_pk_fma_f32 v[118:119], v[118:119], v[142:143], v[134:135]
    v_cvt_pk_bf16_f32 v152, v112, v113
    v_cvt_pk_bf16_f32 v153, v114, v115
    v_cvt_pk_bf16_f32 v154, v116, v117
    v_cvt_pk_bf16_f32 v155, v118, v119
    s_mov_b32 s42, 8192
    buffer_store_dwordx4 v[152:155], v13, s[32:35], s42 offen sc1
    ds_read_b128 v[128:131], v9 offset:1792
    ds_read_b128 v[132:135], v9 offset:1808
    ds_read_b128 v[136:139], v9 offset:5888
    ds_read_b128 v[140:143], v9 offset:5904
    v_pk_mul_f32 v[120:121], v[120:121], v[160:161] op_sel_hi:[1,0]
    v_pk_mul_f32 v[122:123], v[122:123], v[160:161] op_sel_hi:[1,0]
    v_pk_mul_f32 v[124:125], v[124:125], v[160:161] op_sel_hi:[1,0]
    v_pk_mul_f32 v[126:127], v[126:127], v[160:161] op_sel_hi:[1,0]
    s_waitcnt lgkmcnt(0)
    v_pk_fma_f32 v[120:121], v[120:121], v[136:137], v[128:129]
    v_pk_fma_f32 v[122:123], v[122:123], v[138:139], v[130:131]
    v_pk_fma_f32 v[124:125], v[124:125], v[140:141], v[132:133]
    v_pk_fma_f32 v[126:127], v[126:127], v[142:143], v[134:135]
    v_cvt_pk_bf16_f32 v156, v120, v121
    v_cvt_pk_bf16_f32 v157, v122, v123
    v_cvt_pk_bf16_f32 v158, v124, v125
    v_cvt_pk_bf16_f32 v159, v126, v127
    s_mov_b32 s42, 12288
    buffer_store_dwordx4 v[156:159], v13, s[32:35], s42 offen sc1
    s_lshr_b32 s42, s2, 5
    s_add_u32 s42, s42, 16
    s_waitcnt vmcnt(0)
    s_barrier
    s_cmp_lg_u32 s94, 0
    s_cbranch_scc1 L_ln1_nosig
    s_add_u32 s88, s4, 0x60000
    s_addc_u32 s89, s5, 0
    s_mov_b32 s90, 0x6800
    s_mov_b32 s91, 0x20000
    s_lshl_b32 s92, s42, 7
    v_mov_b32 v252, s92
    v_mov_b32 v253, 1
    s_mov_b64 s[92:93], exec
    s_mov_b64 exec, 1
    buffer_atomic_add v253, v252, s[88:91], 0 offen
    s_mov_b64 exec, s[92:93]
L_ln1_nosig:
    s_mov_b64 exec, -1
    v_mbcnt_lo_u32_b32 v0, -1, 0
    v_mbcnt_hi_u32_b32 v0, -1, v0
    v_add_u32 v0, s94, v0
    s_load_dwordx2 s[4:5], s[0:1], 104
    s_load_dwordx4 s[8:11], s[0:1], 8
    s_load_dwordx2 s[6:7], s[0:1], 24
    v_mov_b32 v174, v0
    v_lshrrev_b32 v1, 6, v0
    s_nop 0
    v_readfirstlane_b32 s36, v1
    s_and_b32 s42, s2, 3
    s_lshl_b32 s42, s42, 3
    s_bfe_u32 s60, s2, 0x30003
    s_add_u32 s37, s42, s60
    s_bfe_u32 s42, s2, 0x10002
    s_lshl_b32 s42, s42, 2
    s_lshr_b32 s61, s2, 6
    s_add_u32 s38, s42, s61
    v_and_b32 v154, 63, v174
    v_lshlrev_b32 v153, 4, v154
    v_lshrrev_b32 v155, 4, v154
    v_and_b32 v156, 15, v154
    s_lshl_b32 s42, s36, 4
    v_lshlrev_b32 v158, 2, v155
    v_xor_b32 v158, v158, v156
    v_add_u32 v159, s42, v155
    v_lshlrev_b32 v157, 13, v159
    v_lshl_add_u32 v149, v158, 4, v157
    v_add_u32 v150, 31744, v149
    v_add_u32 v151, 63488, v149
    v_add_u32 v152, 95232, v149
    v_lshlrev_b32 v157, 8, v159
    v_add_u32 v158, 0, v155
    v_lshlrev_b32 v158, 1, v158
    v_xor_b32 v158, v158, v156
    v_lshl_add_u32 v148, v158, 4, v157
    v_add_u32 v158, 4, v155
    v_lshlrev_b32 v158, 1, v158
    v_xor_b32 v158, v158, v156
    v_lshl_add_u32 v197, v158, 4, v157
    v_add_u32 v158, 0, v155
    v_xor_b32 v158, v158, v156
    v_lshl_add_u32 v144, v158, 4, v157
    v_add_u32 v158, 4, v155
    v_xor_b32 v158, v158, v156
    v_lshl_add_u32 v145, v158, 4, v157
    v_add_u32 v158, 8, v155
    v_xor_b32 v158, v158, v156
    v_lshl_add_u32 v146, v158, 4, v157
    v_add_u32 v158, 12, v155
    v_xor_b32 v158, v158, v156
    v_lshl_add_u32 v147, v158, 4, v157
    s_lshl_b32 s44, s36, 12
    s_add_u32 s44, s44, 0
    s_add_u32 s48, s44, 65536
    s_lshl_b32 s45, s36, 12
    s_add_u32 s45, s45, 16384
    s_add_u32 s49, s45, 65536
    s_lshl_b32 s46, s36, 12
    s_add_u32 s46, s46, 32768
    s_add_u32 s50, s46, 65536
    s_lshl_b32 s47, s36, 12
    s_add_u32 s47, s47, 49152
    s_add_u32 s51, s47, 65536
    s_lshl_b32 s42, s61, 0
    s_add_u32 s62, s60, s42
    s_waitcnt lgkmcnt(0)
    s_lshl_b32 s42, s38, 3
    s_lshl_b32 s43, s36, 1
    s_add_u32 s57, s42, s43
    s_lshl_b32 s43, s57, 16
    s_add_u32 s43, s43, 0x100000
    s_add_u32 s24, s4, s43
    s_addc_u32 s25, s5, 0
    s_mov_b32 s26, 0x10000
    s_mov_b32 s27, 0x20000
    s_add_u32 s43, s43, 65536
    s_add_u32 s28, s4, s43
    s_addc_u32 s29, s5, 0
    s_mov_b32 s30, 0x10000
    s_mov_b32 s31, 0x20000
    s_lshl_b32 s42, s37, 8
    s_add_u32 s20, s6, s42
    s_addc_u32 s21, s7, 0
    s_mov_b32 s22, 0x0
    s_mov_b32 s23, 0x20000
    s_sub_u32 s22, 8388608, s42
    s_lshl_b32 s42, s37, 19
    s_add_u32 s12, s8, s42
    s_addc_u32 s13, s9, 0
    s_mov_b32 s14, 0x80000
    s_mov_b32 s15, 0x20000
    s_add_u32 s16, s10, s42
    s_addc_u32 s17, s11, 0
    s_mov_b32 s18, 0x80000
    s_mov_b32 s19, 0x20000
    s_add_u32 s32, s4, 0x2000000
    s_addc_u32 s33, s5, 0
    s_mov_b32 s34, 0x1000000
    s_mov_b32 s35, 0x20000
    s_load_dwordx2 s[84:85], s[0:1], 32
    s_load_dwordx4 s[8:11], s[0:1], 48
    s_load_dwordx2 s[6:7], s[0:1], 64
    s_waitcnt lgkmcnt(0)
    s_mov_b32 s63, 0
    s_mov_b32 s65, 0
    s_mov_b32 s66, 0
    s_mov_b32 s52, 0
    s_mov_b32 s53, 0
    s_mov_b32 s69, s63
    s_add_u32 s64, s63, s62
    s_and_b32 s64, s64, 3
    s_andn2_b32 s67, s63, 3
    s_or_b32 s64, s64, s67
    s_add_u32 s63, s63, 1
    s_lshl_b32 s39, s64, 12
    s_lshl_b32 s40, s64, 19
    s_mov_b32 m0, s48
    s_nop 0
    buffer_load_dwordx4 v149, s[20:23], s40 offen offset:0 lds
    buffer_load_dwordx4 v150, s[20:23], s40 offen offset:1024 lds
    buffer_load_dwordx4 v151, s[20:23], s40 offen offset:2048 lds
    buffer_load_dwordx4 v152, s[20:23], s40 offen offset:3072 lds
    s_add_u32 s64, s63, s62
    s_and_b32 s64, s64, 3
    s_andn2_b32 s67, s63, 3
    s_or_b32 s64, s64, s67
    s_add_u32 s63, s63, 1
    s_lshl_b32 s39, s64, 12
    s_lshl_b32 s40, s64, 19
    s_mov_b32 m0, s49
    s_nop 0
    buffer_load_dwordx4 v149, s[20:23], s40 offen offset:0 lds
    buffer_load_dwordx4 v150, s[20:23], s40 offen offset:1024 lds
    buffer_load_dwordx4 v151, s[20:23], s40 offen offset:2048 lds
    buffer_load_dwordx4 v152, s[20:23], s40 offen offset:3072 lds
    s_add_u32 s42, s38, 16
    s_cmp_lg_u32 s94, 0
    s_cbranch_scc1 L_attn_wgo
    s_add_u32 s88, s4, 0x60000
    s_addc_u32 s89, s5, 0
    s_mov_b32 s90, 0x6800
    s_mov_b32 s91, 0x20000
    s_lshl_b32 s92, s42, 7
    v_mov_b32 v252, s92
    s_mov_b64 s[92:93], exec
    s_mov_b64 exec, 1
    s_mov_b32 s3, 0x40000
L_attn_wpoll:
    buffer_load_dword v253, v252, s[88:91], 0 offen sc1
    s_waitcnt vmcnt(0)
    v_cmp_ne_u32 vcc, 32, v253
    s_cbranch_vccz L_attn_wdone
    s_sleep 1
    s_sub_u32 s3, s3, 1
    s_cmp_lg_u32 s3, 0
    s_cbranch_scc1 L_attn_wpoll
L_attn_wdone:
    s_mov_b64 exec, s[92:93]
L_attn_wgo:
    s_barrier
    v_mov_b32 v252, 0x7f000000
    s_mov_b32 s63, s69
    s_add_u32 s64, s63, s62
    s_and_b32 s64, s64, 3
    s_andn2_b32 s67, s63, 3
    s_or_b32 s64, s64, s67
    s_add_u32 s63, s63, 1
    s_lshl_b32 s39, s64, 12
    s_lshl_b32 s40, s64, 19
    buffer_load_dwordx4 a[0:3], v153, s[24:27], s39 offen offset:0 sc1
    buffer_load_dwordx4 a[4:7], v153, s[28:31], s39 offen offset:0 sc1
    buffer_load_dwordx4 a[8:11], v153, s[24:27], s39 offen offset:1024 sc1
    buffer_load_dwordx4 a[12:15], v153, s[28:31], s39 offen offset:1024 sc1
    buffer_load_dwordx4 a[16:19], v153, s[24:27], s39 offen offset:2048 sc1
    buffer_load_dwordx4 a[20:23], v153, s[28:31], s39 offen offset:2048 sc1
    buffer_load_dwordx4 a[24:27], v153, s[24:27], s39 offen offset:3072 sc1
    buffer_load_dwordx4 a[28:31], v153, s[28:31], s39 offen offset:3072 sc1
    s_add_u32 s64, s63, s62
    s_and_b32 s64, s64, 3
    s_andn2_b32 s67, s63, 3
    s_or_b32 s64, s64, s67
    s_add_u32 s63, s63, 1
    s_lshl_b32 s39, s64, 12
    s_lshl_b32 s40, s64, 19
    buffer_load_dwordx4 a[32:35], v153, s[24:27], s39 offen offset:0 sc1
    buffer_load_dwordx4 a[36:39], v153, s[28:31], s39 offen offset:0 sc1
    buffer_load_dwordx4 a[40:43], v153, s[24:27], s39 offen offset:1024 sc1
    buffer_load_dwordx4 a[44:47], v153, s[28:31], s39 offen offset:1024 sc1
    buffer_load_dwordx4 a[48:51], v153, s[24:27], s39 offen offset:2048 sc1
    buffer_load_dwordx4 a[52:55], v153, s[28:31], s39 offen offset:2048 sc1
    buffer_load_dwordx4 a[56:59], v153, s[24:27], s39 offen offset:3072 sc1
    buffer_load_dwordx4 a[60:63], v153, s[28:31], s39 offen offset:3072 sc1
    buffer_load_dword v253, v252, s[20:23], 0 offen
    buffer_load_dword v253, v252, s[20:23], 0 offen
    buffer_load_dword v253, v252, s[20:23], 0 offen
    buffer_load_dword v253, v252, s[20:23], 0 offen
    buffer_load_dword v253, v252, s[20:23], 0 offen
    buffer_load_dword v253, v252, s[20:23], 0 offen
    s_add_u32 s64, s63, s62
    s_and_b32 s64, s64, 3
    s_andn2_b32 s67, s63, 3
    s_or_b32 s64, s64, s67
    s_add_u32 s63, s63, 1
    s_lshl_b32 s39, s64, 12
    s_lshl_b32 s40, s64, 19
    v_and_b32 v155, 15, v154
    v_lshrrev_b32 v156, 4, v154
    v_xor_b32 v157, v155, v156
    v_lshlrev_b32 v158, 8, v155
    v_lshl_add_u32 v128, v157, 4, v158
    v_xor_b32 v129, 64, v128
    v_xor_b32 v130, 128, v128
    v_xor_b32 v131, 192, v128
    s_lshl_b32 s42, s36, 13
    s_add_u32 s42, s42, 131072
    v_add_u32 v199, s42, v128
    v_and_b32 v157, 31, v154
    v_lshrrev_b32 v158, 5, v154
    v_xor_b32 v158, v158, v155
    v_lshlrev_b32 v157, 8, v157
    v_lshl_add_u32 v157, v158, 4, v157
    v_add_u32 v198, s42, v157
    v_lshrrev_b32 v157, 2, v154
    v_lshlrev_b32 v158, 8, v157
    v_and_b32 v157, 7, v157
    v_lshl_add_u32 v158, v157, 5, v158
    v_and_b32 v157, 3, v154
    v_lshl_add_u32 v158, v157, 3, v158
    v_add_u32 v132, 65536, v158
    v_xor_b32 v133, 32, v132
    v_xor_b32 v134, 64, v132
    v_xor_b32 v135, 96, v132
    v_xor_b32 v136, 128, v132
    v_xor_b32 v137, 160, v132
    v_xor_b32 v138, 192, v132
    v_xor_b32 v139, 224, v132
    v_bfe_u32 v155, v154, 2, 2
    v_lshrrev_b32 v156, 5, v154
    v_bfe_u32 v157, v154, 4, 1
    v_and_b32 v158, 3, v154
    v_lshl_add_u32 v159, v156, 3, v155
    v_lshlrev_b32 v159, 8, v159
    v_lshl_add_u32 v159, v155, 6, v159
    v_lshl_add_u32 v159, v157, 5, v159
    v_and_b32 v160, 1, v158
    v_lshl_add_u32 v159, v160, 4, v159
    v_lshrrev_b32 v160, 1, v158
    v_lshl_add_u32 v159, v160, 3, v159
    v_add_u32 v140, 65536, v159
    v_xor_b32 v141, 64, v140
    v_xor_b32 v142, 128, v140
    v_xor_b32 v143, 192, v140
    s_lshl_b32 s42, s57, 18
    s_lshl_b32 s43, s37, 12
    s_add_u32 s42, s42, s43
    v_add_u32 v175, s42, v153
    s_lshr_b32 s42, s2, 7
    s_lshl_b32 s42, s42, 9
    s_lshl_b32 s43, s36, 7
    s_add_u32 s42, s42, s43
    v_and_b32 v244, 63, v174
    v_lshrrev_b32 v245, 2, v244
    v_add_u32 v245, s42, v245
    v_and_b32 v244, 3, v244
    v_mul_u32_u24 v246, 0x3000, v245
    v_lshl_add_u32 v246, v244, 4, v246
    s_and_b32 s42, s2, 127
    s_lshl_b32 s42, s42, 6
    s_add_u32 s42, s42, 4096
    v_add_u32 v246, s42, v246
    v_lshlrev_b32 v245, 1, v245
    v_mov_b32 v0, 0
    v_mov_b32 v1, 0
    v_mov_b32 v2, 0
    v_mov_b32 v3, 0
    v_mov_b32 v4, 0
    v_mov_b32 v5, 0
    v_mov_b32 v6, 0
    v_mov_b32 v7, 0
    v_mov_b32 v8, 0
    v_mov_b32 v9, 0
    v_mov_b32 v10, 0
    v_mov_b32 v11, 0
    v_mov_b32 v12, 0
    v_mov_b32 v13, 0
    v_mov_b32 v14, 0
    v_mov_b32 v15, 0
    v_mov_b32 v16, 0
    v_mov_b32 v17, 0
    v_mov_b32 v18, 0
    v_mov_b32 v19, 0
    v_mov_b32 v20, 0
    v_mov_b32 v21, 0
    v_mov_b32 v22, 0
    v_mov_b32 v23, 0
    v_mov_b32 v24, 0
    v_mov_b32 v25, 0
    v_mov_b32 v26, 0
    v_mov_b32 v27, 0
    v_mov_b32 v28, 0
    v_mov_b32 v29, 0
    v_mov_b32 v30, 0
    v_mov_b32 v31, 0
    v_mov_b32 v32, 0
    v_mov_b32 v33, 0
    v_mov_b32 v34, 0
    v_mov_b32 v35, 0
    v_mov_b32 v36, 0
    v_mov_b32 v37, 0
    v_mov_b32 v38, 0
    v_mov_b32 v39, 0
    v_mov_b32 v40, 0
    v_mov_b32 v41, 0
    v_mov_b32 v42, 0
    v_mov_b32 v43, 0
    v_mov_b32 v44, 0
    v_mov_b32 v45, 0
    v_mov_b32 v46, 0
    v_mov_b32 v47, 0
    v_mov_b32 v48, 0
    v_mov_b32 v49, 0
    v_mov_b32 v50, 0
    v_mov_b32 v51, 0
    v_mov_b32 v52, 0
    v_mov_b32 v53, 0
    v_mov_b32 v54, 0
    v_mov_b32 v55, 0
    v_mov_b32 v56, 0
    v_mov_b32 v57, 0
    v_mov_b32 v58, 0
    v_mov_b32 v59, 0
    v_mov_b32 v60, 0
    v_mov_b32 v61, 0
    v_mov_b32 v62, 0
    v_mov_b32 v63, 0
    v_mov_b32 v64, 0
    v_mov_b32 v65, 0
    v_mov_b32 v66, 0
    v_mov_b32 v67, 0
    v_mov_b32 v68, 0
    v_mov_b32 v69, 0
    v_mov_b32 v70, 0
    v_mov_b32 v71, 0
    v_mov_b32 v72, 0
    v_mov_b32 v73, 0
    v_mov_b32 v74, 0
    v_mov_b32 v75, 0
    v_mov_b32 v76, 0
    v_mov_b32 v77, 0
    v_mov_b32 v78, 0
    v_mov_b32 v79, 0
    v_mov_b32 v80, 0
    v_mov_b32 v81, 0
    v_mov_b32 v82, 0
    v_mov_b32 v83, 0
    v_mov_b32 v84, 0
    v_mov_b32 v85, 0
    v_mov_b32 v86, 0
    v_mov_b32 v87, 0
    v_mov_b32 v88, 0
    v_mov_b32 v89, 0
    v_mov_b32 v90, 0
    v_mov_b32 v91, 0
    v_mov_b32 v92, 0
    v_mov_b32 v93, 0
    v_mov_b32 v94, 0
    v_mov_b32 v95, 0
    v_mov_b32 v96, 0
    v_mov_b32 v97, 0
    v_mov_b32 v98, 0
    v_mov_b32 v99, 0
    v_mov_b32 v100, 0
    v_mov_b32 v101, 0
    v_mov_b32 v102, 0
    v_mov_b32 v103, 0
    v_mov_b32 v104, 0
    v_mov_b32 v105, 0
    v_mov_b32 v106, 0
    v_mov_b32 v107, 0
    v_mov_b32 v108, 0
    v_mov_b32 v109, 0
    v_mov_b32 v110, 0
    v_mov_b32 v111, 0
    v_mov_b32 v112, 0
    v_mov_b32 v113, 0
    v_mov_b32 v114, 0
    v_mov_b32 v115, 0
    v_mov_b32 v116, 0
    v_mov_b32 v117, 0
    v_mov_b32 v118, 0
    v_mov_b32 v119, 0
    v_mov_b32 v120, 0
    v_mov_b32 v121, 0
    v_mov_b32 v122, 0
    v_mov_b32 v123, 0
    v_mov_b32 v124, 0
    v_mov_b32 v125, 0
    v_mov_b32 v126, 0
    v_mov_b32 v127, 0
    s_waitcnt vmcnt(26)
    s_barrier
    ds_read_b64_tr_b16 a[192:193], v140 offset:0
    ds_read_b64_tr_b16 a[194:195], v140 offset:1024
    ds_read_b64_tr_b16 a[196:197], v141 offset:0
    ds_read_b64_tr_b16 a[198:199], v141 offset:1024
    ds_read_b64_tr_b16 a[200:201], v142 offset:0
    ds_read_b64_tr_b16 a[202:203], v142 offset:1024
    ds_read_b64_tr_b16 a[204:205], v143 offset:0
    ds_read_b64_tr_b16 a[206:207], v143 offset:1024
    ds_read_b64_tr_b16 a[208:209], v140 offset:4096
    ds_read_b64_tr_b16 a[210:211], v140 offset:5120
    ds_read_b64_tr_b16 a[212:213], v141 offset:4096
    ds_read_b64_tr_b16 a[214:215], v141 offset:5120
    ds_read_b64_tr_b16 a[216:217], v142 offset:4096
    ds_read_b64_tr_b16 a[218:219], v142 offset:5120
    ds_read_b64_tr_b16 a[220:221], v143 offset:4096
    ds_read_b64_tr_b16 a[222:223], v143 offset:5120
    s_mov_b32 s41, 3
L_attn_qloop:
    s_waitcnt vmcnt(20)
    s_waitcnt lgkmcnt(8)
    v_mfma_f32_32x32x16_bf16 v[0:15], a[192:195], a[0:3], v[0:15]
    ds_read_b64_tr_b16 a[224:225], v140 offset:8192
    s_mov_b32 m0, s50
    s_nop 0
    buffer_load_dwordx4 v149, s[20:23], s40 offen offset:0 lds
    v_mfma_f32_32x32x16_bf16 v[64:79], a[192:195], a[4:7], v[64:79]
    ds_read_b64_tr_b16 a[226:227], v140 offset:9216
    v_mfma_f32_32x32x16_bf16 v[16:31], a[196:199], a[0:3], v[16:31]
    ds_read_b64_tr_b16 a[228:229], v141 offset:8192
    buffer_load_dwordx4 a[64:67], v153, s[24:27], s39 offen offset:0 sc1
    v_mfma_f32_32x32x16_bf16 v[80:95], a[196:199], a[4:7], v[80:95]
    ds_read_b64_tr_b16 a[230:231], v141 offset:9216
    v_mfma_f32_32x32x16_bf16 v[32:47], a[200:203], a[0:3], v[32:47]
    ds_read_b64_tr_b16 a[232:233], v142 offset:8192
    buffer_load_dwordx4 v150, s[20:23], s40 offen offset:1024 lds
    v_mfma_f32_32x32x16_bf16 v[96:111], a[200:203], a[4:7], v[96:111]
    ds_read_b64_tr_b16 a[234:235], v142 offset:9216
    v_mfma_f32_32x32x16_bf16 v[48:63], a[204:207], a[0:3], v[48:63]
    ds_read_b64_tr_b16 a[236:237], v143 offset:8192
    buffer_load_dwordx4 a[68:71], v153, s[28:31], s39 offen offset:0 sc1
    v_mfma_f32_32x32x16_bf16 v[112:127], a[204:207], a[4:7], v[112:127]
    ds_read_b64_tr_b16 a[238:239], v143 offset:9216
    s_waitcnt vmcnt(20)
    s_waitcnt lgkmcnt(8)
    v_mfma_f32_32x32x16_bf16 v[0:15], a[208:211], a[8:11], v[0:15]
    ds_read_b64_tr_b16 a[240:241], v140 offset:12288
    buffer_load_dwordx4 v151, s[20:23], s40 offen offset:2048 lds
    v_mfma_f32_32x32x16_bf16 v[64:79], a[208:211], a[12:15], v[64:79]
    ds_read_b64_tr_b16 a[242:243], v140 offset:13312
    v_mfma_f32_32x32x16_bf16 v[16:31], a[212:215], a[8:11], v[16:31]
    ds_read_b64_tr_b16 a[244:245], v141 offset:12288
    buffer_load_dwordx4 a[72:75], v153, s[24:27], s39 offen offset:1024 sc1
    v_mfma_f32_32x32x16_bf16 v[80:95], a[212:215], a[12:15], v[80:95]
    ds_read_b64_tr_b16 a[246:247], v141 offset:13312
    v_mfma_f32_32x32x16_bf16 v[32:47], a[216:219], a[8:11], v[32:47]
    ds_read_b64_tr_b16 a[248:249], v142 offset:12288
    buffer_load_dwordx4 v152, s[20:23], s40 offen offset:3072 lds
    v_mfma_f32_32x32x16_bf16 v[96:111], a[216:219], a[12:15], v[96:111]
    ds_read_b64_tr_b16 a[250:251], v142 offset:13312
    v_mfma_f32_32x32x16_bf16 v[48:63], a[220:223], a[8:11], v[48:63]
    ds_read_b64_tr_b16 a[252:253], v143 offset:12288
    buffer_load_dwordx4 a[76:79], v153, s[28:31], s39 offen offset:1024 sc1
    v_mfma_f32_32x32x16_bf16 v[112:127], a[220:223], a[12:15], v[112:127]
    ds_read_b64_tr_b16 a[254:255], v143 offset:13312
    s_waitcnt vmcnt(22)
    s_waitcnt lgkmcnt(8)
    s_waitcnt vmcnt(13)
    s_barrier
    v_mfma_f32_32x32x16_bf16 v[0:15], a[224:227], a[16:19], v[0:15]
    ds_read_b64_tr_b16 a[192:193], v140 offset:16384
    buffer_load_dwordx4 a[80:83], v153, s[24:27], s39 offen offset:2048 sc1
    v_mfma_f32_32x32x16_bf16 v[64:79], a[224:227], a[20:23], v[64:79]
    ds_read_b64_tr_b16 a[194:195], v140 offset:17408
    v_mfma_f32_32x32x16_bf16 v[16:31], a[228:231], a[16:19], v[16:31]
    ds_read_b64_tr_b16 a[196:197], v141 offset:16384
    buffer_load_dwordx4 a[84:87], v153, s[28:31], s39 offen offset:2048 sc1
    v_mfma_f32_32x32x16_bf16 v[80:95], a[228:231], a[20:23], v[80:95]
    ds_read_b64_tr_b16 a[198:199], v141 offset:17408
    v_mfma_f32_32x32x16_bf16 v[32:47], a[232:235], a[16:19], v[32:47]
    ds_read_b64_tr_b16 a[200:201], v142 offset:16384
    buffer_load_dwordx4 a[88:91], v153, s[24:27], s39 offen offset:3072 sc1
    v_mfma_f32_32x32x16_bf16 v[96:111], a[232:235], a[20:23], v[96:111]
    ds_read_b64_tr_b16 a[202:203], v142 offset:17408
    v_mfma_f32_32x32x16_bf16 v[48:63], a[236:239], a[16:19], v[48:63]
    ds_read_b64_tr_b16 a[204:205], v143 offset:16384
    buffer_load_dwordx4 a[92:95], v153, s[28:31], s39 offen offset:3072 sc1
    v_mfma_f32_32x32x16_bf16 v[112:127], a[236:239], a[20:23], v[112:127]
    ds_read_b64_tr_b16 a[206:207], v143 offset:17408
    s_waitcnt vmcnt(26)
    s_waitcnt lgkmcnt(8)
    v_mfma_f32_32x32x16_bf16 v[0:15], a[240:243], a[24:27], v[0:15]
    ds_read_b64_tr_b16 a[208:209], v140 offset:20480
    s_add_u32 s64, s63, s62
    v_mfma_f32_32x32x16_bf16 v[64:79], a[240:243], a[28:31], v[64:79]
    ds_read_b64_tr_b16 a[210:211], v140 offset:21504
    s_and_b32 s64, s64, 3
    v_mfma_f32_32x32x16_bf16 v[16:31], a[244:247], a[24:27], v[16:31]
    ds_read_b64_tr_b16 a[212:213], v141 offset:20480
    s_andn2_b32 s67, s63, 3
    v_mfma_f32_32x32x16_bf16 v[80:95], a[244:247], a[28:31], v[80:95]
    ds_read_b64_tr_b16 a[214:215], v141 offset:21504
    s_or_b32 s64, s64, s67
    v_mfma_f32_32x32x16_bf16 v[32:47], a[248:251], a[24:27], v[32:47]
    ds_read_b64_tr_b16 a[216:217], v142 offset:20480
    s_add_u32 s63, s63, 1
    v_mfma_f32_32x32x16_bf16 v[96:111], a[248:251], a[28:31], v[96:111]
    ds_read_b64_tr_b16 a[218:219], v142 offset:21504
    s_lshl_b32 s39, s64, 12
    v_mfma_f32_32x32x16_bf16 v[48:63], a[252:255], a[24:27], v[48:63]
    ds_read_b64_tr_b16 a[220:221], v143 offset:20480
    s_lshl_b32 s40, s64, 19
    v_mfma_f32_32x32x16_bf16 v[112:127], a[252:255], a[28:31], v[112:127]
    ds_read_b64_tr_b16 a[222:223], v143 offset:21504
    s_waitcnt vmcnt(24)
    s_waitcnt lgkmcnt(8)
    v_mfma_f32_32x32x16_bf16 v[0:15], a[192:195], a[32:35], v[0:15]
    ds_read_b64_tr_b16 a[224:225], v140 offset:24576
    s_mov_b32 m0, s51
    s_nop 0
    buffer_load_dwordx4 v149, s[20:23], s40 offen offset:0 lds
    v_mfma_f32_32x32x16_bf16 v[64:79], a[192:195], a[36:39], v[64:79]
    ds_read_b64_tr_b16 a[226:227], v140 offset:25600
    v_mfma_f32_32x32x16_bf16 v[16:31], a[196:199], a[32:35], v[16:31]
    ds_read_b64_tr_b16 a[228:229], v141 offset:24576
    buffer_load_dwordx4 a[96:99], v153, s[24:27], s39 offen offset:0 sc1
    v_mfma_f32_32x32x16_bf16 v[80:95], a[196:199], a[36:39], v[80:95]
    ds_read_b64_tr_b16 a[230:231], v141 offset:25600
    v_mfma_f32_32x32x16_bf16 v[32:47], a[200:203], a[32:35], v[32:47]
    ds_read_b64_tr_b16 a[232:233], v142 offset:24576
    buffer_load_dwordx4 v150, s[20:23], s40 offen offset:1024 lds
    v_mfma_f32_32x32x16_bf16 v[96:111], a[200:203], a[36:39], v[96:111]
    ds_read_b64_tr_b16 a[234:235], v142 offset:25600
    v_mfma_f32_32x32x16_bf16 v[48:63], a[204:207], a[32:35], v[48:63]
    ds_read_b64_tr_b16 a[236:237], v143 offset:24576
    buffer_load_dwordx4 a[100:103], v153, s[28:31], s39 offen offset:0 sc1
    v_mfma_f32_32x32x16_bf16 v[112:127], a[204:207], a[36:39], v[112:127]
    ds_read_b64_tr_b16 a[238:239], v143 offset:25600
    s_waitcnt vmcnt(20)
    s_waitcnt lgkmcnt(8)
    v_mfma_f32_32x32x16_bf16 v[0:15], a[208:211], a[40:43], v[0:15]
    ds_read_b64_tr_b16 a[240:241], v140 offset:28672
    buffer_load_dwordx4 v151, s[20:23], s40 offen offset:2048 lds
    v_mfma_f32_32x32x16_bf16 v[64:79], a[208:211], a[44:47], v[64:79]
    ds_read_b64_tr_b16 a[242:243], v140 offset:29696
    v_mfma_f32_32x32x16_bf16 v[16:31], a[212:215], a[40:43], v[16:31]
    ds_read_b64_tr_b16 a[244:245], v141 offset:28672
    buffer_load_dwordx4 a[104:107], v153, s[24:27], s39 offen offset:1024 sc1
    v_mfma_f32_32x32x16_bf16 v[80:95], a[212:215], a[44:47], v[80:95]
    ds_read_b64_tr_b16 a[246:247], v141 offset:29696
    v_mfma_f32_32x32x16_bf16 v[32:47], a[216:219], a[40:43], v[32:47]
    ds_read_b64_tr_b16 a[248:249], v142 offset:28672
    buffer_load_dwordx4 v152, s[20:23], s40 offen offset:3072 lds
    v_mfma_f32_32x32x16_bf16 v[96:111], a[216:219], a[44:47], v[96:111]
    ds_read_b64_tr_b16 a[250:251], v142 offset:29696
    v_mfma_f32_32x32x16_bf16 v[48:63], a[220:223], a[40:43], v[48:63]
    ds_read_b64_tr_b16 a[252:253], v143 offset:28672
    buffer_load_dwordx4 a[108:111], v153, s[28:31], s39 offen offset:1024 sc1
    v_mfma_f32_32x32x16_bf16 v[112:127], a[220:223], a[44:47], v[112:127]
    ds_read_b64_tr_b16 a[254:255], v143 offset:29696
    s_waitcnt vmcnt(22)
    s_waitcnt lgkmcnt(8)
    s_waitcnt vmcnt(13)
    s_barrier
    v_mfma_f32_32x32x16_bf16 v[0:15], a[224:227], a[48:51], v[0:15]
    ds_read_b64_tr_b16 a[192:193], v140 offset:32768
    buffer_load_dwordx4 a[112:115], v153, s[24:27], s39 offen offset:2048 sc1
    v_mfma_f32_32x32x16_bf16 v[64:79], a[224:227], a[52:55], v[64:79]
    ds_read_b64_tr_b16 a[194:195], v140 offset:33792
    v_mfma_f32_32x32x16_bf16 v[16:31], a[228:231], a[48:51], v[16:31]
    ds_read_b64_tr_b16 a[196:197], v141 offset:32768
    buffer_load_dwordx4 a[116:119], v153, s[28:31], s39 offen offset:2048 sc1
    v_mfma_f32_32x32x16_bf16 v[80:95], a[228:231], a[52:55], v[80:95]
    ds_read_b64_tr_b16 a[198:199], v141 offset:33792
    v_mfma_f32_32x32x16_bf16 v[32:47], a[232:235], a[48:51], v[32:47]
    ds_read_b64_tr_b16 a[200:201], v142 offset:32768
    buffer_load_dwordx4 a[120:123], v153, s[24:27], s39 offen offset:3072 sc1
    v_mfma_f32_32x32x16_bf16 v[96:111], a[232:235], a[52:55], v[96:111]
    ds_read_b64_tr_b16 a[202:203], v142 offset:33792
    v_mfma_f32_32x32x16_bf16 v[48:63], a[236:239], a[48:51], v[48:63]
    ds_read_b64_tr_b16 a[204:205], v143 offset:32768
    buffer_load_dwordx4 a[124:127], v153, s[28:31], s39 offen offset:3072 sc1
    v_mfma_f32_32x32x16_bf16 v[112:127], a[236:239], a[52:55], v[112:127]
    ds_read_b64_tr_b16 a[206:207], v143 offset:33792
    s_waitcnt lgkmcnt(8)
    v_mfma_f32_32x32x16_bf16 v[0:15], a[240:243], a[56:59], v[0:15]
    ds_read_b64_tr_b16 a[208:209], v140 offset:36864
    s_add_u32 s64, s63, s62
    v_mfma_f32_32x32x16_bf16 v[64:79], a[240:243], a[60:63], v[64:79]
    ds_read_b64_tr_b16 a[210:211], v140 offset:37888
    s_and_b32 s64, s64, 3
    v_mfma_f32_32x32x16_bf16 v[16:31], a[244:247], a[56:59], v[16:31]
    ds_read_b64_tr_b16 a[212:213], v141 offset:36864
    s_andn2_b32 s67, s63, 3
    v_mfma_f32_32x32x16_bf16 v[80:95], a[244:247], a[60:63], v[80:95]
    ds_read_b64_tr_b16 a[214:215], v141 offset:37888
    s_or_b32 s64, s64, s67
    v_mfma_f32_32x32x16_bf16 v[32:47], a[248:251], a[56:59], v[32:47]
    ds_read_b64_tr_b16 a[216:217], v142 offset:36864
    s_add_u32 s63, s63, 1
    v_mfma_f32_32x32x16_bf16 v[96:111], a[248:251], a[60:63], v[96:111]
    ds_read_b64_tr_b16 a[218:219], v142 offset:37888
    s_lshl_b32 s39, s64, 12
    v_mfma_f32_32x32x16_bf16 v[48:63], a[252:255], a[56:59], v[48:63]
    ds_read_b64_tr_b16 a[220:221], v143 offset:36864
    s_lshl_b32 s40, s64, 19
    v_mfma_f32_32x32x16_bf16 v[112:127], a[252:255], a[60:63], v[112:127]
    ds_read_b64_tr_b16 a[222:223], v143 offset:37888
    s_waitcnt lgkmcnt(8)
    v_mfma_f32_32x32x16_bf16 v[0:15], a[192:195], a[64:67], v[0:15]
    ds_read_b64_tr_b16 a[224:225], v140 offset:40960
    s_mov_b32 m0, s48
    s_nop 0
    buffer_load_dwordx4 v149, s[20:23], s40 offen offset:0 lds
    v_mfma_f32_32x32x16_bf16 v[64:79], a[192:195], a[68:71], v[64:79]
    ds_read_b64_tr_b16 a[226:227], v140 offset:41984
    v_mfma_f32_32x32x16_bf16 v[16:31], a[196:199], a[64:67], v[16:31]
    ds_read_b64_tr_b16 a[228:229], v141 offset:40960
    buffer_load_dwordx4 a[0:3], v153, s[24:27], s39 offen offset:0 sc1
    v_mfma_f32_32x32x16_bf16 v[80:95], a[196:199], a[68:71], v[80:95]
    ds_read_b64_tr_b16 a[230:231], v141 offset:41984
    v_mfma_f32_32x32x16_bf16 v[32:47], a[200:203], a[64:67], v[32:47]
    ds_read_b64_tr_b16 a[232:233], v142 offset:40960
    buffer_load_dwordx4 v150, s[20:23], s40 offen offset:1024 lds
    v_mfma_f32_32x32x16_bf16 v[96:111], a[200:203], a[68:71], v[96:111]
    ds_read_b64_tr_b16 a[234:235], v142 offset:41984
    v_mfma_f32_32x32x16_bf16 v[48:63], a[204:207], a[64:67], v[48:63]
    ds_read_b64_tr_b16 a[236:237], v143 offset:40960
    buffer_load_dwordx4 a[4:7], v153, s[28:31], s39 offen offset:0 sc1
    v_mfma_f32_32x32x16_bf16 v[112:127], a[204:207], a[68:71], v[112:127]
    ds_read_b64_tr_b16 a[238:239], v143 offset:41984
    s_waitcnt vmcnt(20)
    s_waitcnt lgkmcnt(8)
    v_mfma_f32_32x32x16_bf16 v[0:15], a[208:211], a[72:75], v[0:15]
    ds_read_b64_tr_b16 a[240:241], v140 offset:45056
    buffer_load_dwordx4 v151, s[20:23], s40 offen offset:2048 lds
    v_mfma_f32_32x32x16_bf16 v[64:79], a[208:211], a[76:79], v[64:79]
    ds_read_b64_tr_b16 a[242:243], v140 offset:46080
    v_mfma_f32_32x32x16_bf16 v[16:31], a[212:215], a[72:75], v[16:31]
    ds_read_b64_tr_b16 a[244:245], v141 offset:45056
    buffer_load_dwordx4 a[8:11], v153, s[24:27], s39 offen offset:1024 sc1
    v_mfma_f32_32x32x16_bf16 v[80:95], a[212:215], a[76:79], v[80:95]
    ds_read_b64_tr_b16 a[246:247], v141 offset:46080
    v_mfma_f32_32x32x16_bf16 v[32:47], a[216:219], a[72:75], v[32:47]
    ds_read_b64_tr_b16 a[248:249], v142 offset:45056
    buffer_load_dwordx4 v152, s[20:23], s40 offen offset:3072 lds
    v_mfma_f32_32x32x16_bf16 v[96:111], a[216:219], a[76:79], v[96:111]
    ds_read_b64_tr_b16 a[250:251], v142 offset:46080
    v_mfma_f32_32x32x16_bf16 v[48:63], a[220:223], a[72:75], v[48:63]
    ds_read_b64_tr_b16 a[252:253], v143 offset:45056
    buffer_load_dwordx4 a[12:15], v153, s[28:31], s39 offen offset:1024 sc1
    v_mfma_f32_32x32x16_bf16 v[112:127], a[220:223], a[76:79], v[112:127]
    ds_read_b64_tr_b16 a[254:255], v143 offset:46080
    s_waitcnt vmcnt(22)
    s_waitcnt lgkmcnt(8)
    s_waitcnt vmcnt(13)
    s_barrier
    v_mfma_f32_32x32x16_bf16 v[0:15], a[224:227], a[80:83], v[0:15]
    ds_read_b64_tr_b16 a[192:193], v140 offset:49152
    buffer_load_dwordx4 a[16:19], v153, s[24:27], s39 offen offset:2048 sc1
    v_mfma_f32_32x32x16_bf16 v[64:79], a[224:227], a[84:87], v[64:79]
    ds_read_b64_tr_b16 a[194:195], v140 offset:50176
    v_mfma_f32_32x32x16_bf16 v[16:31], a[228:231], a[80:83], v[16:31]
    ds_read_b64_tr_b16 a[196:197], v141 offset:49152
    buffer_load_dwordx4 a[20:23], v153, s[28:31], s39 offen offset:2048 sc1
    v_mfma_f32_32x32x16_bf16 v[80:95], a[228:231], a[84:87], v[80:95]
    ds_read_b64_tr_b16 a[198:199], v141 offset:50176
    v_mfma_f32_32x32x16_bf16 v[32:47], a[232:235], a[80:83], v[32:47]
    ds_read_b64_tr_b16 a[200:201], v142 offset:49152
    buffer_load_dwordx4 a[24:27], v153, s[24:27], s39 offen offset:3072 sc1
    v_mfma_f32_32x32x16_bf16 v[96:111], a[232:235], a[84:87], v[96:111]
    ds_read_b64_tr_b16 a[202:203], v142 offset:50176
    v_mfma_f32_32x32x16_bf16 v[48:63], a[236:239], a[80:83], v[48:63]
    ds_read_b64_tr_b16 a[204:205], v143 offset:49152
    buffer_load_dwordx4 a[28:31], v153, s[28:31], s39 offen offset:3072 sc1
    v_mfma_f32_32x32x16_bf16 v[112:127], a[236:239], a[84:87], v[112:127]
    ds_read_b64_tr_b16 a[206:207], v143 offset:50176
    s_waitcnt lgkmcnt(8)
    v_mfma_f32_32x32x16_bf16 v[0:15], a[240:243], a[88:91], v[0:15]
    ds_read_b64_tr_b16 a[208:209], v140 offset:53248
    s_add_u32 s64, s63, s62
    v_mfma_f32_32x32x16_bf16 v[64:79], a[240:243], a[92:95], v[64:79]
    ds_read_b64_tr_b16 a[210:211], v140 offset:54272
    s_and_b32 s64, s64, 3
    v_mfma_f32_32x32x16_bf16 v[16:31], a[244:247], a[88:91], v[16:31]
    ds_read_b64_tr_b16 a[212:213], v141 offset:53248
    s_andn2_b32 s67, s63, 3
    v_mfma_f32_32x32x16_bf16 v[80:95], a[244:247], a[92:95], v[80:95]
    ds_read_b64_tr_b16 a[214:215], v141 offset:54272
    s_or_b32 s64, s64, s67
    v_mfma_f32_32x32x16_bf16 v[32:47], a[248:251], a[88:91], v[32:47]
    ds_read_b64_tr_b16 a[216:217], v142 offset:53248
    s_add_u32 s63, s63, 1
    v_mfma_f32_32x32x16_bf16 v[96:111], a[248:251], a[92:95], v[96:111]
    ds_read_b64_tr_b16 a[218:219], v142 offset:54272
    s_lshl_b32 s39, s64, 12
    v_mfma_f32_32x32x16_bf16 v[48:63], a[252:255], a[88:91], v[48:63]
    ds_read_b64_tr_b16 a[220:221], v143 offset:53248
    s_lshl_b32 s40, s64, 19
    v_mfma_f32_32x32x16_bf16 v[112:127], a[252:255], a[92:95], v[112:127]
    ds_read_b64_tr_b16 a[222:223], v143 offset:54272
    s_waitcnt lgkmcnt(8)
    v_mfma_f32_32x32x16_bf16 v[0:15], a[192:195], a[96:99], v[0:15]
    ds_read_b64_tr_b16 a[224:225], v140 offset:57344
    s_mov_b32 m0, s49
    s_nop 0
    buffer_load_dwordx4 v149, s[20:23], s40 offen offset:0 lds
    v_mfma_f32_32x32x16_bf16 v[64:79], a[192:195], a[100:103], v[64:79]
    ds_read_b64_tr_b16 a[226:227], v140 offset:58368
    v_mfma_f32_32x32x16_bf16 v[16:31], a[196:199], a[96:99], v[16:31]
    ds_read_b64_tr_b16 a[228:229], v141 offset:57344
    buffer_load_dwordx4 a[32:35], v153, s[24:27], s39 offen offset:0 sc1
    v_mfma_f32_32x32x16_bf16 v[80:95], a[196:199], a[100:103], v[80:95]
    ds_read_b64_tr_b16 a[230:231], v141 offset:58368
    v_mfma_f32_32x32x16_bf16 v[32:47], a[200:203], a[96:99], v[32:47]
    ds_read_b64_tr_b16 a[232:233], v142 offset:57344
    buffer_load_dwordx4 v150, s[20:23], s40 offen offset:1024 lds
    v_mfma_f32_32x32x16_bf16 v[96:111], a[200:203], a[100:103], v[96:111]
    ds_read_b64_tr_b16 a[234:235], v142 offset:58368
    v_mfma_f32_32x32x16_bf16 v[48:63], a[204:207], a[96:99], v[48:63]
    ds_read_b64_tr_b16 a[236:237], v143 offset:57344
    buffer_load_dwordx4 a[36:39], v153, s[28:31], s39 offen offset:0 sc1
    v_mfma_f32_32x32x16_bf16 v[112:127], a[204:207], a[100:103], v[112:127]
    ds_read_b64_tr_b16 a[238:239], v143 offset:58368
    s_waitcnt vmcnt(20)
    s_waitcnt lgkmcnt(8)
    v_mfma_f32_32x32x16_bf16 v[0:15], a[208:211], a[104:107], v[0:15]
    ds_read_b64_tr_b16 a[240:241], v140 offset:61440
    buffer_load_dwordx4 v151, s[20:23], s40 offen offset:2048 lds
    v_mfma_f32_32x32x16_bf16 v[64:79], a[208:211], a[108:111], v[64:79]
    ds_read_b64_tr_b16 a[242:243], v140 offset:62464
    v_mfma_f32_32x32x16_bf16 v[16:31], a[212:215], a[104:107], v[16:31]
    ds_read_b64_tr_b16 a[244:245], v141 offset:61440
    buffer_load_dwordx4 a[40:43], v153, s[24:27], s39 offen offset:1024 sc1
    v_mfma_f32_32x32x16_bf16 v[80:95], a[212:215], a[108:111], v[80:95]
    ds_read_b64_tr_b16 a[246:247], v141 offset:62464
    v_mfma_f32_32x32x16_bf16 v[32:47], a[216:219], a[104:107], v[32:47]
    ds_read_b64_tr_b16 a[248:249], v142 offset:61440
    buffer_load_dwordx4 v152, s[20:23], s40 offen offset:3072 lds
    v_mfma_f32_32x32x16_bf16 v[96:111], a[216:219], a[108:111], v[96:111]
    ds_read_b64_tr_b16 a[250:251], v142 offset:62464
    v_mfma_f32_32x32x16_bf16 v[48:63], a[220:223], a[104:107], v[48:63]
    ds_read_b64_tr_b16 a[252:253], v143 offset:61440
    buffer_load_dwordx4 a[44:47], v153, s[28:31], s39 offen offset:1024 sc1
    v_mfma_f32_32x32x16_bf16 v[112:127], a[220:223], a[108:111], v[112:127]
    ds_read_b64_tr_b16 a[254:255], v143 offset:62464
    s_waitcnt vmcnt(22)
    s_waitcnt lgkmcnt(8)
    s_waitcnt vmcnt(13)
    s_barrier
    v_mfma_f32_32x32x16_bf16 v[0:15], a[224:227], a[112:115], v[0:15]
    ds_read_b64_tr_b16 a[192:193], v140 offset:0
    buffer_load_dwordx4 a[48:51], v153, s[24:27], s39 offen offset:2048 sc1
    v_mfma_f32_32x32x16_bf16 v[64:79], a[224:227], a[116:119], v[64:79]
    ds_read_b64_tr_b16 a[194:195], v140 offset:1024
    v_mfma_f32_32x32x16_bf16 v[16:31], a[228:231], a[112:115], v[16:31]
    ds_read_b64_tr_b16 a[196:197], v141 offset:0
    buffer_load_dwordx4 a[52:55], v153, s[28:31], s39 offen offset:2048 sc1
    v_mfma_f32_32x32x16_bf16 v[80:95], a[228:231], a[116:119], v[80:95]
    ds_read_b64_tr_b16 a[198:199], v141 offset:1024
    v_mfma_f32_32x32x16_bf16 v[32:47], a[232:235], a[112:115], v[32:47]
    ds_read_b64_tr_b16 a[200:201], v142 offset:0
    buffer_load_dwordx4 a[56:59], v153, s[24:27], s39 offen offset:3072 sc1
    v_mfma_f32_32x32x16_bf16 v[96:111], a[232:235], a[116:119], v[96:111]
    ds_read_b64_tr_b16 a[202:203], v142 offset:1024
    v_mfma_f32_32x32x16_bf16 v[48:63], a[236:239], a[112:115], v[48:63]
    ds_read_b64_tr_b16 a[204:205], v143 offset:0
    buffer_load_dwordx4 a[60:63], v153, s[28:31], s39 offen offset:3072 sc1
    v_mfma_f32_32x32x16_bf16 v[112:127], a[236:239], a[116:119], v[112:127]
    ds_read_b64_tr_b16 a[206:207], v143 offset:1024
    s_waitcnt lgkmcnt(8)
    v_mfma_f32_32x32x16_bf16 v[0:15], a[240:243], a[120:123], v[0:15]
    ds_read_b64_tr_b16 a[208:209], v140 offset:4096
    s_add_u32 s64, s63, s62
    v_mfma_f32_32x32x16_bf16 v[64:79], a[240:243], a[124:127], v[64:79]
    ds_read_b64_tr_b16 a[210:211], v140 offset:5120
    s_and_b32 s64, s64, 3
    v_mfma_f32_32x32x16_bf16 v[16:31], a[244:247], a[120:123], v[16:31]
    ds_read_b64_tr_b16 a[212:213], v141 offset:4096
    s_andn2_b32 s67, s63, 3
    v_mfma_f32_32x32x16_bf16 v[80:95], a[244:247], a[124:127], v[80:95]
    ds_read_b64_tr_b16 a[214:215], v141 offset:5120
    s_or_b32 s64, s64, s67
    v_mfma_f32_32x32x16_bf16 v[32:47], a[248:251], a[120:123], v[32:47]
    ds_read_b64_tr_b16 a[216:217], v142 offset:4096
    s_add_u32 s63, s63, 1
    v_mfma_f32_32x32x16_bf16 v[96:111], a[248:251], a[124:127], v[96:111]
    ds_read_b64_tr_b16 a[218:219], v142 offset:5120
    s_lshl_b32 s39, s64, 12
    v_mfma_f32_32x32x16_bf16 v[48:63], a[252:255], a[120:123], v[48:63]
    ds_read_b64_tr_b16 a[220:221], v143 offset:4096
    s_lshl_b32 s40, s64, 19
    v_mfma_f32_32x32x16_bf16 v[112:127], a[252:255], a[124:127], v[112:127]
    ds_read_b64_tr_b16 a[222:223], v143 offset:5120
    s_sub_u32 s41, s41, 1
    s_cmp_lg_u32 s41, 0
    s_cbranch_scc1 L_attn_qloop
    s_waitcnt lgkmcnt(8)
    v_mfma_f32_32x32x16_bf16 v[0:15], a[192:195], a[0:3], v[0:15]
    ds_read_b64_tr_b16 a[224:225], v140 offset:8192
    s_mov_b32 m0, s50
    s_nop 0
    buffer_load_dwordx4 v149, s[20:23], s40 offen offset:0 lds
    v_mfma_f32_32x32x16_bf16 v[64:79], a[192:195], a[4:7], v[64:79]
    ds_read_b64_tr_b16 a[226:227], v140 offset:9216
    v_mfma_f32_32x32x16_bf16 v[16:31], a[196:199], a[0:3], v[16:31]
    ds_read_b64_tr_b16 a[228:229], v141 offset:8192
    buffer_load_dwordx4 a[64:67], v153, s[24:27], s39 offen offset:0 sc1
    v_mfma_f32_32x32x16_bf16 v[80:95], a[196:199], a[4:7], v[80:95]
    ds_read_b64_tr_b16 a[230:231], v141 offset:9216
    v_mfma_f32_32x32x16_bf16 v[32:47], a[200:203], a[0:3], v[32:47]
    ds_read_b64_tr_b16 a[232:233], v142 offset:8192
    buffer_load_dwordx4 v150, s[20:23], s40 offen offset:1024 lds
    v_mfma_f32_32x32x16_bf16 v[96:111], a[200:203], a[4:7], v[96:111]
    ds_read_b64_tr_b16 a[234:235], v142 offset:9216
    v_mfma_f32_32x32x16_bf16 v[48:63], a[204:207], a[0:3], v[48:63]
    ds_read_b64_tr_b16 a[236:237], v143 offset:8192
    buffer_load_dwordx4 a[68:71], v153, s[28:31], s39 offen offset:0 sc1
    v_mfma_f32_32x32x16_bf16 v[112:127], a[204:207], a[4:7], v[112:127]
    ds_read_b64_tr_b16 a[238:239], v143 offset:9216
    s_waitcnt vmcnt(20)
    s_waitcnt lgkmcnt(8)
    v_mfma_f32_32x32x16_bf16 v[0:15], a[208:211], a[8:11], v[0:15]
    ds_read_b64_tr_b16 a[240:241], v140 offset:12288
    buffer_load_dwordx4 v151, s[20:23], s40 offen offset:2048 lds
    v_mfma_f32_32x32x16_bf16 v[64:79], a[208:211], a[12:15], v[64:79]
    ds_read_b64_tr_b16 a[242:243], v140 offset:13312
    v_mfma_f32_32x32x16_bf16 v[16:31], a[212:215], a[8:11], v[16:31]
    ds_read_b64_tr_b16 a[244:245], v141 offset:12288
    buffer_load_dwordx4 a[72:75], v153, s[24:27], s39 offen offset:1024 sc1
    v_mfma_f32_32x32x16_bf16 v[80:95], a[212:215], a[12:15], v[80:95]
    ds_read_b64_tr_b16 a[246:247], v141 offset:13312
    v_mfma_f32_32x32x16_bf16 v[32:47], a[216:219], a[8:11], v[32:47]
    ds_read_b64_tr_b16 a[248:249], v142 offset:12288
    buffer_load_dwordx4 v152, s[20:23], s40 offen offset:3072 lds
    v_mfma_f32_32x32x16_bf16 v[96:111], a[216:219], a[12:15], v[96:111]
    ds_read_b64_tr_b16 a[250:251], v142 offset:13312
    v_mfma_f32_32x32x16_bf16 v[48:63], a[220:223], a[8:11], v[48:63]
    ds_read_b64_tr_b16 a[252:253], v143 offset:12288
    buffer_load_dwordx4 a[76:79], v153, s[28:31], s39 offen offset:1024 sc1
    v_mfma_f32_32x32x16_bf16 v[112:127], a[220:223], a[12:15], v[112:127]
    ds_read_b64_tr_b16 a[254:255], v143 offset:13312
    s_waitcnt vmcnt(22)
    s_waitcnt lgkmcnt(8)
    s_waitcnt vmcnt(13)
    s_barrier
    v_mfma_f32_32x32x16_bf16 v[0:15], a[224:227], a[16:19], v[0:15]
    ds_read_b64_tr_b16 a[192:193], v140 offset:16384
    buffer_load_dwordx4 a[80:83], v153, s[24:27], s39 offen offset:2048 sc1
    v_mfma_f32_32x32x16_bf16 v[64:79], a[224:227], a[20:23], v[64:79]
    ds_read_b64_tr_b16 a[194:195], v140 offset:17408
    v_mfma_f32_32x32x16_bf16 v[16:31], a[228:231], a[16:19], v[16:31]
    ds_read_b64_tr_b16 a[196:197], v141 offset:16384
    buffer_load_dwordx4 a[84:87], v153, s[28:31], s39 offen offset:2048 sc1
    v_mfma_f32_32x32x16_bf16 v[80:95], a[228:231], a[20:23], v[80:95]
    ds_read_b64_tr_b16 a[198:199], v141 offset:17408
    v_mfma_f32_32x32x16_bf16 v[32:47], a[232:235], a[16:19], v[32:47]
    ds_read_b64_tr_b16 a[200:201], v142 offset:16384
    buffer_load_dwordx4 a[88:91], v153, s[24:27], s39 offen offset:3072 sc1
    v_mfma_f32_32x32x16_bf16 v[96:111], a[232:235], a[20:23], v[96:111]
    ds_read_b64_tr_b16 a[202:203], v142 offset:17408
    v_mfma_f32_32x32x16_bf16 v[48:63], a[236:239], a[16:19], v[48:63]
    ds_read_b64_tr_b16 a[204:205], v143 offset:16384
    buffer_load_dwordx4 a[92:95], v153, s[28:31], s39 offen offset:3072 sc1
    v_mfma_f32_32x32x16_bf16 v[112:127], a[236:239], a[20:23], v[112:127]
    ds_read_b64_tr_b16 a[206:207], v143 offset:17408
    s_waitcnt lgkmcnt(8)
    v_mfma_f32_32x32x16_bf16 v[0:15], a[240:243], a[24:27], v[0:15]
    ds_read_b64_tr_b16 a[208:209], v140 offset:20480
    s_add_u32 s64, s63, s62
    v_mfma_f32_32x32x16_bf16 v[64:79], a[240:243], a[28:31], v[64:79]
    ds_read_b64_tr_b16 a[210:211], v140 offset:21504
    s_and_b32 s64, s64, 3
    v_mfma_f32_32x32x16_bf16 v[16:31], a[244:247], a[24:27], v[16:31]
    ds_read_b64_tr_b16 a[212:213], v141 offset:20480
    s_andn2_b32 s67, s63, 3
    v_mfma_f32_32x32x16_bf16 v[80:95], a[244:247], a[28:31], v[80:95]
    ds_read_b64_tr_b16 a[214:215], v141 offset:21504
    s_or_b32 s64, s64, s67
    v_mfma_f32_32x32x16_bf16 v[32:47], a[248:251], a[24:27], v[32:47]
    ds_read_b64_tr_b16 a[216:217], v142 offset:20480
    s_add_u32 s63, s63, 1
    v_mfma_f32_32x32x16_bf16 v[96:111], a[248:251], a[28:31], v[96:111]
    ds_read_b64_tr_b16 a[218:219], v142 offset:21504
    s_lshl_b32 s39, s64, 12
    v_mfma_f32_32x32x16_bf16 v[48:63], a[252:255], a[24:27], v[48:63]
    ds_read_b64_tr_b16 a[220:221], v143 offset:20480
    s_lshl_b32 s40, s64, 19
    v_mfma_f32_32x32x16_bf16 v[112:127], a[252:255], a[28:31], v[112:127]
    ds_read_b64_tr_b16 a[222:223], v143 offset:21504
    s_waitcnt lgkmcnt(8)
    v_mfma_f32_32x32x16_bf16 v[0:15], a[192:195], a[32:35], v[0:15]
    ds_read_b64_tr_b16 a[224:225], v140 offset:24576
    s_mov_b32 m0, s51
    s_nop 0
    buffer_load_dwordx4 v149, s[20:23], s40 offen offset:0 lds
    v_mfma_f32_32x32x16_bf16 v[64:79], a[192:195], a[36:39], v[64:79]
    ds_read_b64_tr_b16 a[226:227], v140 offset:25600
    v_mfma_f32_32x32x16_bf16 v[16:31], a[196:199], a[32:35], v[16:31]
    ds_read_b64_tr_b16 a[228:229], v141 offset:24576
    buffer_load_dwordx4 a[96:99], v153, s[24:27], s39 offen offset:0 sc1
    v_mfma_f32_32x32x16_bf16 v[80:95], a[196:199], a[36:39], v[80:95]
    ds_read_b64_tr_b16 a[230:231], v141 offset:25600
    v_mfma_f32_32x32x16_bf16 v[32:47], a[200:203], a[32:35], v[32:47]
    ds_read_b64_tr_b16 a[232:233], v142 offset:24576
    buffer_load_dwordx4 v150, s[20:23], s40 offen offset:1024 lds
    v_mfma_f32_32x32x16_bf16 v[96:111], a[200:203], a[36:39], v[96:111]
    ds_read_b64_tr_b16 a[234:235], v142 offset:25600
    v_mfma_f32_32x32x16_bf16 v[48:63], a[204:207], a[32:35], v[48:63]
    ds_read_b64_tr_b16 a[236:237], v143 offset:24576
    buffer_load_dwordx4 a[100:103], v153, s[28:31], s39 offen offset:0 sc1
    v_mfma_f32_32x32x16_bf16 v[112:127], a[204:207], a[36:39], v[112:127]
    ds_read_b64_tr_b16 a[238:239], v143 offset:25600
    s_waitcnt vmcnt(20)
    s_waitcnt lgkmcnt(8)
    v_mfma_f32_32x32x16_bf16 v[0:15], a[208:211], a[40:43], v[0:15]
    ds_read_b64_tr_b16 a[240:241], v140 offset:28672
    buffer_load_dwordx4 v151, s[20:23], s40 offen offset:2048 lds
    v_mfma_f32_32x32x16_bf16 v[64:79], a[208:211], a[44:47], v[64:79]
    ds_read_b64_tr_b16 a[242:243], v140 offset:29696
    v_mfma_f32_32x32x16_bf16 v[16:31], a[212:215], a[40:43], v[16:31]
    ds_read_b64_tr_b16 a[244:245], v141 offset:28672
    buffer_load_dwordx4 a[104:107], v153, s[24:27], s39 offen offset:1024 sc1
    v_mfma_f32_32x32x16_bf16 v[80:95], a[212:215], a[44:47], v[80:95]
    ds_read_b64_tr_b16 a[246:247], v141 offset:29696
    v_mfma_f32_32x32x16_bf16 v[32:47], a[216:219], a[40:43], v[32:47]
    ds_read_b64_tr_b16 a[248:249], v142 offset:28672
    buffer_load_dwordx4 v152, s[20:23], s40 offen offset:3072 lds
    v_mfma_f32_32x32x16_bf16 v[96:111], a[216:219], a[44:47], v[96:111]
    ds_read_b64_tr_b16 a[250:251], v142 offset:29696
    v_mfma_f32_32x32x16_bf16 v[48:63], a[220:223], a[40:43], v[48:63]
    ds_read_b64_tr_b16 a[252:253], v143 offset:28672
    buffer_load_dwordx4 a[108:111], v153, s[28:31], s39 offen offset:1024 sc1
    v_mfma_f32_32x32x16_bf16 v[112:127], a[220:223], a[44:47], v[112:127]
    ds_read_b64_tr_b16 a[254:255], v143 offset:29696
    s_waitcnt vmcnt(22)
    s_waitcnt lgkmcnt(8)
    s_waitcnt vmcnt(13)
    s_barrier
    v_mfma_f32_32x32x16_bf16 v[0:15], a[224:227], a[48:51], v[0:15]
    ds_read_b64_tr_b16 a[192:193], v140 offset:32768
    buffer_load_dwordx4 a[112:115], v153, s[24:27], s39 offen offset:2048 sc1
    v_mfma_f32_32x32x16_bf16 v[64:79], a[224:227], a[52:55], v[64:79]
    ds_read_b64_tr_b16 a[194:195], v140 offset:33792
    v_mfma_f32_32x32x16_bf16 v[16:31], a[228:231], a[48:51], v[16:31]
    ds_read_b64_tr_b16 a[196:197], v141 offset:32768
    buffer_load_dwordx4 a[116:119], v153, s[28:31], s39 offen offset:2048 sc1
    v_mfma_f32_32x32x16_bf16 v[80:95], a[228:231], a[52:55], v[80:95]
    ds_read_b64_tr_b16 a[198:199], v141 offset:33792
    v_mfma_f32_32x32x16_bf16 v[32:47], a[232:235], a[48:51], v[32:47]
    ds_read_b64_tr_b16 a[200:201], v142 offset:32768
    buffer_load_dwordx4 a[120:123], v153, s[24:27], s39 offen offset:3072 sc1
    v_mfma_f32_32x32x16_bf16 v[96:111], a[232:235], a[52:55], v[96:111]
    ds_read_b64_tr_b16 a[202:203], v142 offset:33792
    v_mfma_f32_32x32x16_bf16 v[48:63], a[236:239], a[48:51], v[48:63]
    ds_read_b64_tr_b16 a[204:205], v143 offset:32768
    buffer_load_dwordx4 a[124:127], v153, s[28:31], s39 offen offset:3072 sc1
    v_mfma_f32_32x32x16_bf16 v[112:127], a[236:239], a[52:55], v[112:127]
    ds_read_b64_tr_b16 a[206:207], v143 offset:33792
    s_waitcnt lgkmcnt(8)
    v_mfma_f32_32x32x16_bf16 v[0:15], a[240:243], a[56:59], v[0:15]
    ds_read_b64_tr_b16 a[208:209], v140 offset:36864
    v_mfma_f32_32x32x16_bf16 v[64:79], a[240:243], a[60:63], v[64:79]
    ds_read_b64_tr_b16 a[210:211], v140 offset:37888
    v_mfma_f32_32x32x16_bf16 v[16:31], a[244:247], a[56:59], v[16:31]
    ds_read_b64_tr_b16 a[212:213], v141 offset:36864
    v_mfma_f32_32x32x16_bf16 v[80:95], a[244:247], a[60:63], v[80:95]
    ds_read_b64_tr_b16 a[214:215], v141 offset:37888
    v_mfma_f32_32x32x16_bf16 v[32:47], a[248:251], a[56:59], v[32:47]
    ds_read_b64_tr_b16 a[216:217], v142 offset:36864
    v_mfma_f32_32x32x16_bf16 v[96:111], a[248:251], a[60:63], v[96:111]
    ds_read_b64_tr_b16 a[218:219], v142 offset:37888
    v_mfma_f32_32x32x16_bf16 v[48:63], a[252:255], a[56:59], v[48:63]
    ds_read_b64_tr_b16 a[220:221], v143 offset:36864
    v_mfma_f32_32x32x16_bf16 v[112:127], a[252:255], a[60:63], v[112:127]
    ds_read_b64_tr_b16 a[222:223], v143 offset:37888
    s_waitcnt lgkmcnt(8)
    v_mfma_f32_32x32x16_bf16 v[0:15], a[192:195], a[64:67], v[0:15]
    ds_read_b64_tr_b16 a[224:225], v140 offset:40960
    s_mov_b32 m0, s44
    s_add_u32 s64, s65, s61
    s_and_b32 s64, s64, 3
    s_andn2_b32 s67, s65, 3
    s_or_b32 s64, s64, s67
    s_add_u32 s65, s65, 1
    s_lshl_b32 s52, s64, 14
    buffer_load_dwordx4 v144, s[12:15], s52 offen offset:0 lds
    v_mfma_f32_32x32x16_bf16 v[64:79], a[192:195], a[68:71], v[64:79]
    ds_read_b64_tr_b16 a[226:227], v140 offset:41984
    v_mfma_f32_32x32x16_bf16 v[16:31], a[196:199], a[64:67], v[16:31]
    ds_read_b64_tr_b16 a[228:229], v141 offset:40960
    buffer_load_dwordx4 v145, s[12:15], s52 offen offset:1024 lds
    v_mfma_f32_32x32x16_bf16 v[80:95], a[196:199], a[68:71], v[80:95]
    ds_read_b64_tr_b16 a[230:231], v141 offset:41984
    v_mfma_f32_32x32x16_bf16 v[32:47], a[200:203], a[64:67], v[32:47]
    ds_read_b64_tr_b16 a[232:233], v142 offset:40960
    buffer_load_dwordx4 v146, s[12:15], s52 offen offset:2048 lds
    v_mfma_f32_32x32x16_bf16 v[96:111], a[200:203], a[68:71], v[96:111]
    ds_read_b64_tr_b16 a[234:235], v142 offset:41984
    v_mfma_f32_32x32x16_bf16 v[48:63], a[204:207], a[64:67], v[48:63]
    ds_read_b64_tr_b16 a[236:237], v143 offset:40960
    buffer_load_dwordx4 v147, s[12:15], s52 offen offset:3072 lds
    v_mfma_f32_32x32x16_bf16 v[112:127], a[204:207], a[68:71], v[112:127]
    ds_read_b64_tr_b16 a[238:239], v143 offset:41984
    s_waitcnt vmcnt(20)
    s_waitcnt lgkmcnt(8)
    v_mfma_f32_32x32x16_bf16 v[0:15], a[208:211], a[72:75], v[0:15]
    ds_read_b64_tr_b16 a[240:241], v140 offset:45056
    s_mov_b32 m0, s48
    s_add_u32 s64, s66, s61
    s_and_b32 s64, s64, 3
    s_andn2_b32 s67, s66, 3
    s_or_b32 s64, s64, s67
    s_add_u32 s66, s66, 1
    s_lshl_b32 s53, s64, 14
    buffer_load_dwordx4 v148, s[16:19], s53 offen offset:0 lds
    v_mfma_f32_32x32x16_bf16 v[64:79], a[208:211], a[76:79], v[64:79]
    ds_read_b64_tr_b16 a[242:243], v140 offset:46080
    v_mfma_f32_32x32x16_bf16 v[16:31], a[212:215], a[72:75], v[16:31]
    ds_read_b64_tr_b16 a[244:245], v141 offset:45056
    buffer_load_dwordx4 v197, s[16:19], s53 offen offset:1024 lds
    v_mfma_f32_32x32x16_bf16 v[80:95], a[212:215], a[76:79], v[80:95]
    ds_read_b64_tr_b16 a[246:247], v141 offset:46080
    v_mfma_f32_32x32x16_bf16 v[32:47], a[216:219], a[72:75], v[32:47]
    ds_read_b64_tr_b16 a[248:249], v142 offset:45056
    buffer_load_dwordx4 v148, s[16:19], s53 offen offset:2048 lds
    v_mfma_f32_32x32x16_bf16 v[96:111], a[216:219], a[76:79], v[96:111]
    ds_read_b64_tr_b16 a[250:251], v142 offset:46080
    v_mfma_f32_32x32x16_bf16 v[48:63], a[220:223], a[72:75], v[48:63]
    ds_read_b64_tr_b16 a[252:253], v143 offset:45056
    buffer_load_dwordx4 v197, s[16:19], s53 offen offset:3072 lds
    v_mfma_f32_32x32x16_bf16 v[112:127], a[220:223], a[76:79], v[112:127]
    ds_read_b64_tr_b16 a[254:255], v143 offset:46080
    s_waitcnt vmcnt(22)
    s_waitcnt lgkmcnt(8)
    s_waitcnt vmcnt(13)
    s_barrier
    v_mfma_f32_32x32x16_bf16 v[0:15], a[224:227], a[80:83], v[0:15]
    ds_read_b64_tr_b16 a[192:193], v140 offset:49152
    s_mov_b32 m0, s45
    s_add_u32 s64, s65, s61
    s_and_b32 s64, s64, 3
    s_andn2_b32 s67, s65, 3
    s_or_b32 s64, s64, s67
    s_add_u32 s65, s65, 1
    s_lshl_b32 s52, s64, 14
    buffer_load_dwordx4 v144, s[12:15], s52 offen offset:0 lds
    v_mfma_f32_32x32x16_bf16 v[64:79], a[224:227], a[84:87], v[64:79]
    ds_read_b64_tr_b16 a[194:195], v140 offset:50176
    v_mfma_f32_32x32x16_bf16 v[16:31], a[228:231], a[80:83], v[16:31]
    ds_read_b64_tr_b16 a[196:197], v141 offset:49152
    buffer_load_dwordx4 v145, s[12:15], s52 offen offset:1024 lds
    v_mfma_f32_32x32x16_bf16 v[80:95], a[228:231], a[84:87], v[80:95]
    ds_read_b64_tr_b16 a[198:199], v141 offset:50176
    v_mfma_f32_32x32x16_bf16 v[32:47], a[232:235], a[80:83], v[32:47]
    ds_read_b64_tr_b16 a[200:201], v142 offset:49152
    buffer_load_dwordx4 v146, s[12:15], s52 offen offset:2048 lds
    v_mfma_f32_32x32x16_bf16 v[96:111], a[232:235], a[84:87], v[96:111]
    ds_read_b64_tr_b16 a[202:203], v142 offset:50176
    v_mfma_f32_32x32x16_bf16 v[48:63], a[236:239], a[80:83], v[48:63]
    ds_read_b64_tr_b16 a[204:205], v143 offset:49152
    buffer_load_dwordx4 v147, s[12:15], s52 offen offset:3072 lds
    v_mfma_f32_32x32x16_bf16 v[112:127], a[236:239], a[84:87], v[112:127]
    ds_read_b64_tr_b16 a[206:207], v143 offset:50176
    s_waitcnt lgkmcnt(8)
    v_mfma_f32_32x32x16_bf16 v[0:15], a[240:243], a[88:91], v[0:15]
    ds_read_b64_tr_b16 a[208:209], v140 offset:53248
    v_mfma_f32_32x32x16_bf16 v[64:79], a[240:243], a[92:95], v[64:79]
    ds_read_b64_tr_b16 a[210:211], v140 offset:54272
    v_mfma_f32_32x32x16_bf16 v[16:31], a[244:247], a[88:91], v[16:31]
    ds_read_b64_tr_b16 a[212:213], v141 offset:53248
    v_mfma_f32_32x32x16_bf16 v[80:95], a[244:247], a[92:95], v[80:95]
    ds_read_b64_tr_b16 a[214:215], v141 offset:54272
    v_mfma_f32_32x32x16_bf16 v[32:47], a[248:251], a[88:91], v[32:47]
    ds_read_b64_tr_b16 a[216:217], v142 offset:53248
    v_mfma_f32_32x32x16_bf16 v[96:111], a[248:251], a[92:95], v[96:111]
    ds_read_b64_tr_b16 a[218:219], v142 offset:54272
    v_mfma_f32_32x32x16_bf16 v[48:63], a[252:255], a[88:91], v[48:63]
    ds_read_b64_tr_b16 a[220:221], v143 offset:53248
    v_mfma_f32_32x32x16_bf16 v[112:127], a[252:255], a[92:95], v[112:127]
    ds_read_b64_tr_b16 a[222:223], v143 offset:54272
    s_waitcnt lgkmcnt(8)
    v_mfma_f32_32x32x16_bf16 v[0:15], a[192:195], a[96:99], v[0:15]
    ds_read_b64_tr_b16 a[224:225], v140 offset:57344
    s_mov_b32 m0, s49
    s_add_u32 s64, s66, s61
    s_and_b32 s64, s64, 3
    s_andn2_b32 s67, s66, 3
    s_or_b32 s64, s64, s67
    s_add_u32 s66, s66, 1
    s_lshl_b32 s53, s64, 14
    buffer_load_dwordx4 v148, s[16:19], s53 offen offset:0 lds
    v_mfma_f32_32x32x16_bf16 v[64:79], a[192:195], a[100:103], v[64:79]
    ds_read_b64_tr_b16 a[226:227], v140 offset:58368
    v_mfma_f32_32x32x16_bf16 v[16:31], a[196:199], a[96:99], v[16:31]
    ds_read_b64_tr_b16 a[228:229], v141 offset:57344
    buffer_load_dwordx4 v197, s[16:19], s53 offen offset:1024 lds
    v_mfma_f32_32x32x16_bf16 v[80:95], a[196:199], a[100:103], v[80:95]
    ds_read_b64_tr_b16 a[230:231], v141 offset:58368
    v_mfma_f32_32x32x16_bf16 v[32:47], a[200:203], a[96:99], v[32:47]
    ds_read_b64_tr_b16 a[232:233], v142 offset:57344
    buffer_load_dwordx4 v148, s[16:19], s53 offen offset:2048 lds
    v_mfma_f32_32x32x16_bf16 v[96:111], a[200:203], a[100:103], v[96:111]
    ds_read_b64_tr_b16 a[234:235], v142 offset:58368
    v_mfma_f32_32x32x16_bf16 v[48:63], a[204:207], a[96:99], v[48:63]
    ds_read_b64_tr_b16 a[236:237], v143 offset:57344
    buffer_load_dwordx4 v197, s[16:19], s53 offen offset:3072 lds
    v_mfma_f32_32x32x16_bf16 v[112:127], a[204:207], a[100:103], v[112:127]
    ds_read_b64_tr_b16 a[238:239], v143 offset:58368
    s_waitcnt vmcnt(20)
    s_waitcnt lgkmcnt(8)
    v_mfma_f32_32x32x16_bf16 v[0:15], a[208:211], a[104:107], v[0:15]
    ds_read_b64_tr_b16 a[240:241], v140 offset:61440
    s_mov_b32 m0, s46
    s_add_u32 s64, s65, s61
    s_and_b32 s64, s64, 3
    s_andn2_b32 s67, s65, 3
    s_or_b32 s64, s64, s67
    s_add_u32 s65, s65, 1
    s_lshl_b32 s52, s64, 14
    buffer_load_dwordx4 v144, s[12:15], s52 offen offset:0 lds
    v_mfma_f32_32x32x16_bf16 v[64:79], a[208:211], a[108:111], v[64:79]
    ds_read_b64_tr_b16 a[242:243], v140 offset:62464
    v_mfma_f32_32x32x16_bf16 v[16:31], a[212:215], a[104:107], v[16:31]
    ds_read_b64_tr_b16 a[244:245], v141 offset:61440
    buffer_load_dwordx4 v145, s[12:15], s52 offen offset:1024 lds
    v_mfma_f32_32x32x16_bf16 v[80:95], a[212:215], a[108:111], v[80:95]
    ds_read_b64_tr_b16 a[246:247], v141 offset:62464
    v_mfma_f32_32x32x16_bf16 v[32:47], a[216:219], a[104:107], v[32:47]
    ds_read_b64_tr_b16 a[248:249], v142 offset:61440
    buffer_load_dwordx4 v146, s[12:15], s52 offen offset:2048 lds
    v_mfma_f32_32x32x16_bf16 v[96:111], a[216:219], a[108:111], v[96:111]
    ds_read_b64_tr_b16 a[250:251], v142 offset:62464
    v_mfma_f32_32x32x16_bf16 v[48:63], a[220:223], a[104:107], v[48:63]
    ds_read_b64_tr_b16 a[252:253], v143 offset:61440
    buffer_load_dwordx4 v147, s[12:15], s52 offen offset:3072 lds
    v_mfma_f32_32x32x16_bf16 v[112:127], a[220:223], a[108:111], v[112:127]
    ds_read_b64_tr_b16 a[254:255], v143 offset:62464
    s_waitcnt vmcnt(22)
    s_waitcnt lgkmcnt(8)
    v_mfma_f32_32x32x16_bf16 v[0:15], a[224:227], a[112:115], v[0:15]
    v_mfma_f32_32x32x16_bf16 v[64:79], a[224:227], a[116:119], v[64:79]
    v_mfma_f32_32x32x16_bf16 v[16:31], a[228:231], a[112:115], v[16:31]
    v_mfma_f32_32x32x16_bf16 v[80:95], a[228:231], a[116:119], v[80:95]
    v_mfma_f32_32x32x16_bf16 v[32:47], a[232:235], a[112:115], v[32:47]
    v_mfma_f32_32x32x16_bf16 v[96:111], a[232:235], a[116:119], v[96:111]
    v_mfma_f32_32x32x16_bf16 v[48:63], a[236:239], a[112:115], v[48:63]
    v_mfma_f32_32x32x16_bf16 v[112:127], a[236:239], a[116:119], v[112:127]
    s_waitcnt vmcnt(20)
    s_waitcnt lgkmcnt(0)
    v_mfma_f32_32x32x16_bf16 v[0:15], a[240:243], a[120:123], v[0:15]
    v_mfma_f32_32x32x16_bf16 v[64:79], a[240:243], a[124:127], v[64:79]
    v_mfma_f32_32x32x16_bf16 v[16:31], a[244:247], a[120:123], v[16:31]
    v_mfma_f32_32x32x16_bf16 v[80:95], a[244:247], a[124:127], v[80:95]
    v_mfma_f32_32x32x16_bf16 v[32:47], a[248:251], a[120:123], v[32:47]
    v_mfma_f32_32x32x16_bf16 v[96:111], a[248:251], a[124:127], v[96:111]
    v_mfma_f32_32x32x16_bf16 v[48:63], a[252:255], a[120:123], v[48:63]
    v_mfma_f32_32x32x16_bf16 v[112:127], a[252:255], a[124:127], v[112:127]
    s_nop 7
    s_barrier
    s_mov_b32 m0, s50
    s_add_u32 s64, s66, s61
    s_and_b32 s64, s64, 3
    s_andn2_b32 s67, s66, 3
    s_or_b32 s64, s64, s67
    s_add_u32 s66, s66, 1
    s_lshl_b32 s53, s64, 14
    buffer_load_dwordx4 v148, s[16:19], s53 offen offset:0 lds
    buffer_load_dwordx4 v197, s[16:19], s53 offen offset:1024 lds
    buffer_load_dwordx4 v148, s[16:19], s53 offen offset:2048 lds
    buffer_load_dwordx4 v197, s[16:19], s53 offen offset:3072 lds
    s_load_dwordx2 s[24:25], s[0:1], 72
    s_load_dwordx2 s[26:27], s[0:1], 80
    s_waitcnt lgkmcnt(0)
    s_mov_b32 s88, s24
    s_mov_b32 s89, s25
    s_mov_b32 s90, 0x800
    s_mov_b32 s91, 0x20000
    buffer_load_ushort v236, v245, s[88:91], 0 offen offset:0
    buffer_load_ushort v237, v245, s[88:91], 0 offen offset:32
    buffer_load_ushort v238, v245, s[88:91], 0 offen offset:64
    buffer_load_ushort v239, v245, s[88:91], 0 offen offset:96
    buffer_load_ushort v240, v245, s[88:91], 0 offen offset:128
    buffer_load_ushort v241, v245, s[88:91], 0 offen offset:160
    buffer_load_ushort v242, v245, s[88:91], 0 offen offset:192
    buffer_load_ushort v243, v245, s[88:91], 0 offen offset:224
    s_nop 4
    s_mov_b32 s88, s26
    s_mov_b32 s89, s27
    s_mov_b32 s90, 0xc00000
    s_mov_b32 s91, 0x20000
    s_mov_b32 s42, 0
    buffer_load_dwordx4 v[204:207], v246, s[88:91], s42 offen
    s_mov_b32 s42, 196608
    buffer_load_dwordx4 v[208:211], v246, s[88:91], s42 offen
    s_mov_b32 s42, 393216
    buffer_load_dwordx4 v[212:215], v246, s[88:91], s42 offen
    s_mov_b32 s42, 589824
    buffer_load_dwordx4 v[216:219], v246, s[88:91], s42 offen
    s_mov_b32 s42, 786432
    buffer_load_dwordx4 v[220:223], v246, s[88:91], s42 offen
    s_mov_b32 s42, 983040
    buffer_load_dwordx4 v[224:227], v246, s[88:91], s42 offen
    s_mov_b32 s42, 1179648
    buffer_load_dwordx4 v[228:231], v246, s[88:91], s42 offen
    s_mov_b32 s42, 1376256
    buffer_load_dwordx4 v[232:235], v246, s[88:91], s42 offen
    s_mov_b32 s54, 0x3e0293ee
    v_pk_mul_f32 v[0:1], v[0:1], s[54:55] op_sel_hi:[1,0]
    v_pk_mul_f32 v[2:3], v[2:3], s[54:55] op_sel_hi:[1,0]
    v_pk_mul_f32 v[4:5], v[4:5], s[54:55] op_sel_hi:[1,0]
    v_pk_mul_f32 v[6:7], v[6:7], s[54:55] op_sel_hi:[1,0]
    v_cvt_pk_bf16_f32 v154, v0, v1
    v_cvt_pk_bf16_f32 v155, v2, v3
    v_cvt_pk_bf16_f32 v156, v4, v5
    v_cvt_pk_bf16_f32 v157, v6, v7
    v_xor_b32 v162, 0, v198
    ds_write_b128 v162, v[154:157]
    v_pk_mul_f32 v[8:9], v[8:9], s[54:55] op_sel_hi:[1,0]
    v_pk_mul_f32 v[10:11], v[10:11], s[54:55] op_sel_hi:[1,0]
    v_pk_mul_f32 v[12:13], v[12:13], s[54:55] op_sel_hi:[1,0]
    v_pk_mul_f32 v[14:15], v[14:15], s[54:55] op_sel_hi:[1,0]
    v_cvt_pk_bf16_f32 v158, v8, v9
    v_cvt_pk_bf16_f32 v159, v10, v11
    v_cvt_pk_bf16_f32 v160, v12, v13
    v_cvt_pk_bf16_f32 v161, v14, v15
    v_xor_b32 v163, 32, v198
    ds_write_b128 v163, v[158:161]
    v_pk_mul_f32 v[16:17], v[16:17], s[54:55] op_sel_hi:[1,0]
    v_pk_mul_f32 v[18:19], v[18:19], s[54:55] op_sel_hi:[1,0]
    v_pk_mul_f32 v[20:21], v[20:21], s[54:55] op_sel_hi:[1,0]
    v_pk_mul_f32 v[22:23], v[22:23], s[54:55] op_sel_hi:[1,0]
    v_cvt_pk_bf16_f32 v154, v16, v17
    v_cvt_pk_bf16_f32 v155, v18, v19
    v_cvt_pk_bf16_f32 v156, v20, v21
    v_cvt_pk_bf16_f32 v157, v22, v23
    v_xor_b32 v162, 64, v198
    ds_write_b128 v162, v[154:157]
    v_pk_mul_f32 v[24:25], v[24:25], s[54:55] op_sel_hi:[1,0]
    v_pk_mul_f32 v[26:27], v[26:27], s[54:55] op_sel_hi:[1,0]
    v_pk_mul_f32 v[28:29], v[28:29], s[54:55] op_sel_hi:[1,0]
    v_pk_mul_f32 v[30:31], v[30:31], s[54:55] op_sel_hi:[1,0]
    v_cvt_pk_bf16_f32 v158, v24, v25
    v_cvt_pk_bf16_f32 v159, v26, v27
    v_cvt_pk_bf16_f32 v160, v28, v29
    v_cvt_pk_bf16_f32 v161, v30, v31
    v_xor_b32 v163, 96, v198
    ds_write_b128 v163, v[158:161]
    v_pk_mul_f32 v[32:33], v[32:33], s[54:55] op_sel_hi:[1,0]
    v_pk_mul_f32 v[34:35], v[34:35], s[54:55] op_sel_hi:[1,0]
    v_pk_mul_f32 v[36:37], v[36:37], s[54:55] op_sel_hi:[1,0]
    v_pk_mul_f32 v[38:39], v[38:39], s[54:55] op_sel_hi:[1,0]
    v_cvt_pk_bf16_f32 v154, v32, v33
    v_cvt_pk_bf16_f32 v155, v34, v35
    v_cvt_pk_bf16_f32 v156, v36, v37
    v_cvt_pk_bf16_f32 v157, v38, v39
    v_xor_b32 v162, 128, v198
    ds_write_b128 v162, v[154:157]
    v_pk_mul_f32 v[40:41], v[40:41], s[54:55] op_sel_hi:[1,0]
    v_pk_mul_f32 v[42:43], v[42:43], s[54:55] op_sel_hi:[1,0]
    v_pk_mul_f32 v[44:45], v[44:45], s[54:55] op_sel_hi:[1,0]
    v_pk_mul_f32 v[46:47], v[46:47], s[54:55] op_sel_hi:[1,0]
    v_cvt_pk_bf16_f32 v158, v40, v41
    v_cvt_pk_bf16_f32 v159, v42, v43
    v_cvt_pk_bf16_f32 v160, v44, v45
    v_cvt_pk_bf16_f32 v161, v46, v47
    v_xor_b32 v163, 160, v198
    ds_write_b128 v163, v[158:161]
    v_pk_mul_f32 v[48:49], v[48:49], s[54:55] op_sel_hi:[1,0]
    v_pk_mul_f32 v[50:51], v[50:51], s[54:55] op_sel_hi:[1,0]
    v_pk_mul_f32 v[52:53], v[52:53], s[54:55] op_sel_hi:[1,0]
    v_pk_mul_f32 v[54:55], v[54:55], s[54:55] op_sel_hi:[1,0]
    v_cvt_pk_bf16_f32 v154, v48, v49
    v_cvt_pk_bf16_f32 v155, v50, v51
    v_cvt_pk_bf16_f32 v156, v52, v53
    v_cvt_pk_bf16_f32 v157, v54, v55
    v_xor_b32 v162, 192, v198
    ds_write_b128 v162, v[154:157]
    v_pk_mul_f32 v[56:57], v[56:57], s[54:55] op_sel_hi:[1,0]
    v_pk_mul_f32 v[58:59], v[58:59], s[54:55] op_sel_hi:[1,0]
    v_pk_mul_f32 v[60:61], v[60:61], s[54:55] op_sel_hi:[1,0]
    v_pk_mul_f32 v[62:63], v[62:63], s[54:55] op_sel_hi:[1,0]
    v_cvt_pk_bf16_f32 v158, v56, v57
    v_cvt_pk_bf16_f32 v159, v58, v59
    v_cvt_pk_bf16_f32 v160, v60, v61
    v_cvt_pk_bf16_f32 v161, v62, v63
    v_xor_b32 v163, 224, v198
    ds_write_b128 v163, v[158:161]
    v_xor_b32 v164, 0, v199
    ds_read_b128 a[128:131], v164 offset:0
    ds_read_b128 a[144:147], v164 offset:4096
    v_xor_b32 v164, 64, v199
    ds_read_b128 a[132:135], v164 offset:0
    ds_read_b128 a[148:151], v164 offset:4096
    v_xor_b32 v164, 128, v199
    ds_read_b128 a[136:139], v164 offset:0
    ds_read_b128 a[152:155], v164 offset:4096
    v_xor_b32 v164, 192, v199
    ds_read_b128 a[140:143], v164 offset:0
    ds_read_b128 a[156:159], v164 offset:4096
    v_pk_mul_f32 v[64:65], v[64:65], s[54:55] op_sel_hi:[1,0]
    v_pk_mul_f32 v[66:67], v[66:67], s[54:55] op_sel_hi:[1,0]
    v_pk_mul_f32 v[68:69], v[68:69], s[54:55] op_sel_hi:[1,0]
    v_pk_mul_f32 v[70:71], v[70:71], s[54:55] op_sel_hi:[1,0]
    v_cvt_pk_bf16_f32 v154, v64, v65
    v_cvt_pk_bf16_f32 v155, v66, v67
    v_cvt_pk_bf16_f32 v156, v68, v69
    v_cvt_pk_bf16_f32 v157, v70, v71
    v_xor_b32 v162, 0, v198
    ds_write_b128 v162, v[154:157]
    v_pk_mul_f32 v[72:73], v[72:73], s[54:55] op_sel_hi:[1,0]
    v_pk_mul_f32 v[74:75], v[74:75], s[54:55] op_sel_hi:[1,0]
    v_pk_mul_f32 v[76:77], v[76:77], s[54:55] op_sel_hi:[1,0]
    v_pk_mul_f32 v[78:79], v[78:79], s[54:55] op_sel_hi:[1,0]
    v_cvt_pk_bf16_f32 v158, v72, v73
    v_cvt_pk_bf16_f32 v159, v74, v75
    v_cvt_pk_bf16_f32 v160, v76, v77
    v_cvt_pk_bf16_f32 v161, v78, v79
    v_xor_b32 v163, 32, v198
    ds_write_b128 v163, v[158:161]
    v_pk_mul_f32 v[80:81], v[80:81], s[54:55] op_sel_hi:[1,0]
    v_pk_mul_f32 v[82:83], v[82:83], s[54:55] op_sel_hi:[1,0]
    v_pk_mul_f32 v[84:85], v[84:85], s[54:55] op_sel_hi:[1,0]
    v_pk_mul_f32 v[86:87], v[86:87], s[54:55] op_sel_hi:[1,0]
    v_cvt_pk_bf16_f32 v154, v80, v81
    v_cvt_pk_bf16_f32 v155, v82, v83
    v_cvt_pk_bf16_f32 v156, v84, v85
    v_cvt_pk_bf16_f32 v157, v86, v87
    v_xor_b32 v162, 64, v198
    ds_write_b128 v162, v[154:157]
    v_pk_mul_f32 v[88:89], v[88:89], s[54:55] op_sel_hi:[1,0]
    v_pk_mul_f32 v[90:91], v[90:91], s[54:55] op_sel_hi:[1,0]
    v_pk_mul_f32 v[92:93], v[92:93], s[54:55] op_sel_hi:[1,0]
    v_pk_mul_f32 v[94:95], v[94:95], s[54:55] op_sel_hi:[1,0]
    v_cvt_pk_bf16_f32 v158, v88, v89
    v_cvt_pk_bf16_f32 v159, v90, v91
    v_cvt_pk_bf16_f32 v160, v92, v93
    v_cvt_pk_bf16_f32 v161, v94, v95
    v_xor_b32 v163, 96, v198
    ds_write_b128 v163, v[158:161]
    v_pk_mul_f32 v[96:97], v[96:97], s[54:55] op_sel_hi:[1,0]
    v_pk_mul_f32 v[98:99], v[98:99], s[54:55] op_sel_hi:[1,0]
    v_pk_mul_f32 v[100:101], v[100:101], s[54:55] op_sel_hi:[1,0]
    v_pk_mul_f32 v[102:103], v[102:103], s[54:55] op_sel_hi:[1,0]
    v_cvt_pk_bf16_f32 v154, v96, v97
    v_cvt_pk_bf16_f32 v155, v98, v99
    v_cvt_pk_bf16_f32 v156, v100, v101
    v_cvt_pk_bf16_f32 v157, v102, v103
    v_xor_b32 v162, 128, v198
    ds_write_b128 v162, v[154:157]
    v_pk_mul_f32 v[104:105], v[104:105], s[54:55] op_sel_hi:[1,0]
    v_pk_mul_f32 v[106:107], v[106:107], s[54:55] op_sel_hi:[1,0]
    v_pk_mul_f32 v[108:109], v[108:109], s[54:55] op_sel_hi:[1,0]
    v_pk_mul_f32 v[110:111], v[110:111], s[54:55] op_sel_hi:[1,0]
    v_cvt_pk_bf16_f32 v158, v104, v105
    v_cvt_pk_bf16_f32 v159, v106, v107
    v_cvt_pk_bf16_f32 v160, v108, v109
    v_cvt_pk_bf16_f32 v161, v110, v111
    v_xor_b32 v163, 160, v198
    ds_write_b128 v163, v[158:161]
    v_pk_mul_f32 v[112:113], v[112:113], s[54:55] op_sel_hi:[1,0]
    v_pk_mul_f32 v[114:115], v[114:115], s[54:55] op_sel_hi:[1,0]
    v_pk_mul_f32 v[116:117], v[116:117], s[54:55] op_sel_hi:[1,0]
    v_pk_mul_f32 v[118:119], v[118:119], s[54:55] op_sel_hi:[1,0]
    v_cvt_pk_bf16_f32 v154, v112, v113
    v_cvt_pk_bf16_f32 v155, v114, v115
    v_cvt_pk_bf16_f32 v156, v116, v117
    v_cvt_pk_bf16_f32 v157, v118, v119
    v_xor_b32 v162, 192, v198
    ds_write_b128 v162, v[154:157]
    v_pk_mul_f32 v[120:121], v[120:121], s[54:55] op_sel_hi:[1,0]
    v_pk_mul_f32 v[122:123], v[122:123], s[54:55] op_sel_hi:[1,0]
    v_pk_mul_f32 v[124:125], v[124:125], s[54:55] op_sel_hi:[1,0]
    v_pk_mul_f32 v[126:127], v[126:127], s[54:55] op_sel_hi:[1,0]
    v_cvt_pk_bf16_f32 v158, v120, v121
    v_cvt_pk_bf16_f32 v159, v122, v123
    v_cvt_pk_bf16_f32 v160, v124, v125
    v_cvt_pk_bf16_f32 v161, v126, v127
    v_xor_b32 v163, 224, v198
    ds_write_b128 v163, v[158:161]
    v_xor_b32 v164, 0, v199
    ds_read_b128 a[160:163], v164 offset:0
    ds_read_b128 a[176:179], v164 offset:4096
    v_xor_b32 v164, 64, v199
    ds_read_b128 a[164:167], v164 offset:0
    ds_read_b128 a[180:183], v164 offset:4096
    v_xor_b32 v164, 128, v199
    ds_read_b128 a[168:171], v164 offset:0
    ds_read_b128 a[184:187], v164 offset:4096
    v_xor_b32 v164, 192, v199
    ds_read_b128 a[172:175], v164 offset:0
    ds_read_b128 a[188:191], v164 offset:4096
    s_waitcnt lgkmcnt(0)
    v_mov_b32 v116, 0
    v_mov_b32 v117, 0
    v_mov_b32 v118, 0
    v_mov_b32 v119, 0
    s_waitcnt vmcnt(36)
    s_barrier
    ds_read_b128 a[192:195], v128 offset:0
    ds_read_b128 a[196:199], v129 offset:0
    ds_read_b128 a[200:203], v130 offset:0
    ds_read_b128 a[204:207], v131 offset:0
    ds_read_b128 a[208:211], v128 offset:4096
    ds_read_b128 a[212:215], v129 offset:4096
    ds_read_b128 a[216:219], v130 offset:4096
    ds_read_b128 a[220:223], v131 offset:4096
    v_mov_b32 v176, 0
    v_mov_b32 v177, 0
    v_mov_b32 v178, 0
    v_mov_b32 v179, 0
    s_nop 1
    v_mfma_f32_32x32x16_bf16 a[0:15], v[176:179], v[176:179], 0
    v_mfma_f32_32x32x16_bf16 a[16:31], v[176:179], v[176:179], 0
    v_mfma_f32_32x32x16_bf16 a[32:47], v[176:179], v[176:179], 0
    v_mfma_f32_32x32x16_bf16 a[48:63], v[176:179], v[176:179], 0
    v_mfma_f32_32x32x16_bf16 a[64:79], v[176:179], v[176:179], 0
    v_mfma_f32_32x32x16_bf16 a[80:95], v[176:179], v[176:179], 0
    v_mfma_f32_32x32x16_bf16 a[96:111], v[176:179], v[176:179], 0
    v_mfma_f32_32x32x16_bf16 a[112:127], v[176:179], v[176:179], 0
    s_waitcnt lgkmcnt(0)
    v_mfma_f32_16x16x32_bf16 v[0:3], a[192:195], a[128:131], 0
    v_mfma_f32_16x16x32_bf16 v[0:3], a[196:199], a[132:135], v[0:3]
    v_mfma_f32_16x16x32_bf16 v[0:3], a[200:203], a[136:139], v[0:3]
    v_mfma_f32_16x16x32_bf16 v[0:3], a[204:207], a[140:143], v[0:3]
    v_mfma_f32_16x16x32_bf16 v[4:7], a[208:211], a[128:131], 0
    v_mfma_f32_16x16x32_bf16 v[4:7], a[212:215], a[132:135], v[4:7]
    v_mfma_f32_16x16x32_bf16 v[4:7], a[216:219], a[136:139], v[4:7]
    v_mfma_f32_16x16x32_bf16 v[4:7], a[220:223], a[140:143], v[4:7]
    v_mfma_f32_16x16x32_bf16 v[8:11], a[192:195], a[144:147], 0
    v_mfma_f32_16x16x32_bf16 v[8:11], a[196:199], a[148:151], v[8:11]
    v_mfma_f32_16x16x32_bf16 v[8:11], a[200:203], a[152:155], v[8:11]
    v_mfma_f32_16x16x32_bf16 v[8:11], a[204:207], a[156:159], v[8:11]
    v_mfma_f32_16x16x32_bf16 v[12:15], a[208:211], a[144:147], 0
    v_mfma_f32_16x16x32_bf16 v[12:15], a[212:215], a[148:151], v[12:15]
    v_mfma_f32_16x16x32_bf16 v[12:15], a[216:219], a[152:155], v[12:15]
    v_mfma_f32_16x16x32_bf16 v[12:15], a[220:223], a[156:159], v[12:15]
    v_mfma_f32_16x16x32_bf16 v[16:19], a[192:195], a[160:163], 0
    v_mfma_f32_16x16x32_bf16 v[16:19], a[196:199], a[164:167], v[16:19]
    v_mfma_f32_16x16x32_bf16 v[16:19], a[200:203], a[168:171], v[16:19]
    v_mfma_f32_16x16x32_bf16 v[16:19], a[204:207], a[172:175], v[16:19]
    v_mfma_f32_16x16x32_bf16 v[20:23], a[208:211], a[160:163], 0
    v_mfma_f32_16x16x32_bf16 v[20:23], a[212:215], a[164:167], v[20:23]
    v_mfma_f32_16x16x32_bf16 v[20:23], a[216:219], a[168:171], v[20:23]
    v_mfma_f32_16x16x32_bf16 v[20:23], a[220:223], a[172:175], v[20:23]
    v_mfma_f32_16x16x32_bf16 v[24:27], a[192:195], a[176:179], 0
    ds_read_b128 a[192:195], v128 offset:8192
    v_mfma_f32_16x16x32_bf16 v[24:27], a[196:199], a[180:183], v[24:27]
    ds_read_b128 a[196:199], v129 offset:8192
    v_mfma_f32_16x16x32_bf16 v[24:27], a[200:203], a[184:187], v[24:27]
    ds_read_b128 a[200:203], v130 offset:8192
    v_mfma_f32_16x16x32_bf16 v[24:27], a[204:207], a[188:191], v[24:27]
    ds_read_b128 a[204:207], v131 offset:8192
    v_mfma_f32_16x16x32_bf16 v[28:31], a[208:211], a[176:179], 0
    ds_read_b128 a[208:211], v128 offset:12288
    v_mfma_f32_16x16x32_bf16 v[28:31], a[212:215], a[180:183], v[28:31]
    ds_read_b128 a[212:215], v129 offset:12288
    v_mfma_f32_16x16x32_bf16 v[28:31], a[216:219], a[184:187], v[28:31]
    ds_read_b128 a[216:219], v130 offset:12288
    v_mfma_f32_16x16x32_bf16 v[28:31], a[220:223], a[188:191], v[28:31]
    ds_read_b128 a[220:223], v131 offset:12288
    s_waitcnt vmcnt(32)
    s_barrier
    ds_read_b64_tr_b16 a[224:225], v132 offset:0
    ds_read_b64_tr_b16 a[226:227], v132 offset:4096
    ds_read_b64_tr_b16 a[228:229], v133 offset:0
    ds_read_b64_tr_b16 a[230:231], v133 offset:4096
    v_max3_f32 v176, v0, v1, v2
    v_max3_f32 v176, v176, v3, v4
    v_max3_f32 v176, v176, v5, v6
    v_max_f32 v176, v176, v7
    v_mov_b32 v177, v176
    s_nop 1
    v_permlane16_swap_b32 v176, v177
    v_max_f32 v176, v176, v177
    v_mov_b32 v177, v176
    s_nop 1
    v_permlane32_swap_b32 v176, v177
    v_max_f32 v176, v176, v177
    v_add_f32 v176, 0x42cc0000, v176
    v_sub_f32 v0, v0, v176
    v_sub_f32 v1, v1, v176
    v_sub_f32 v2, v2, v176
    v_sub_f32 v3, v3, v176
    v_sub_f32 v4, v4, v176
    v_sub_f32 v5, v5, v176
    v_sub_f32 v6, v6, v176
    v_sub_f32 v7, v7, v176
    v_sub_f32 v96, 0, v176
    v_sub_f32 v97, 0, v176
    v_sub_f32 v98, 0, v176
    v_sub_f32 v99, 0, v176
    v_max3_f32 v178, v8, v9, v10
    v_max3_f32 v178, v178, v11, v12
    v_max3_f32 v178, v178, v13, v14
    v_max_f32 v178, v178, v15
    v_mov_b32 v179, v178
    s_nop 1
    v_permlane16_swap_b32 v178, v179
    v_max_f32 v178, v178, v179
    v_mov_b32 v179, v178
    s_nop 1
    v_permlane32_swap_b32 v178, v179
    v_max_f32 v178, v178, v179
    v_add_f32 v178, 0x42cc0000, v178
    v_sub_f32 v8, v8, v178
    v_sub_f32 v9, v9, v178
    v_sub_f32 v10, v10, v178
    v_sub_f32 v11, v11, v178
    v_sub_f32 v12, v12, v178
    v_sub_f32 v13, v13, v178
    v_sub_f32 v14, v14, v178
    v_sub_f32 v15, v15, v178
    v_sub_f32 v100, 0, v178
    v_sub_f32 v101, 0, v178
    v_sub_f32 v102, 0, v178
    v_sub_f32 v103, 0, v178
    v_max3_f32 v180, v16, v17, v18
    v_max3_f32 v180, v180, v19, v20
    v_max3_f32 v180, v180, v21, v22
    v_max_f32 v180, v180, v23
    v_mov_b32 v181, v180
    s_nop 1
    v_permlane16_swap_b32 v180, v181
    v_max_f32 v180, v180, v181
    v_mov_b32 v181, v180
    s_nop 1
    v_permlane32_swap_b32 v180, v181
    v_max_f32 v180, v180, v181
    v_add_f32 v180, 0x42cc0000, v180
    v_sub_f32 v16, v16, v180
    v_sub_f32 v17, v17, v180
    v_sub_f32 v18, v18, v180
    v_sub_f32 v19, v19, v180
    v_sub_f32 v20, v20, v180
    v_sub_f32 v21, v21, v180
    v_sub_f32 v22, v22, v180
    v_sub_f32 v23, v23, v180
    v_sub_f32 v104, 0, v180
    v_sub_f32 v105, 0, v180
    v_sub_f32 v106, 0, v180
    v_sub_f32 v107, 0, v180
    v_max3_f32 v182, v24, v25, v26
    v_max3_f32 v182, v182, v27, v28
    v_max3_f32 v182, v182, v29, v30
    v_max_f32 v182, v182, v31
    v_mov_b32 v183, v182
    s_nop 1
    v_permlane16_swap_b32 v182, v183
    v_max_f32 v182, v182, v183
    v_mov_b32 v183, v182
    s_nop 1
    v_permlane32_swap_b32 v182, v183
    v_max_f32 v182, v182, v183
    v_add_f32 v182, 0x42cc0000, v182
    v_sub_f32 v24, v24, v182
    v_sub_f32 v25, v25, v182
    v_sub_f32 v26, v26, v182
    v_sub_f32 v27, v27, v182
    v_sub_f32 v28, v28, v182
    v_sub_f32 v29, v29, v182
    v_sub_f32 v30, v30, v182
    v_sub_f32 v31, v31, v182
    v_sub_f32 v108, 0, v182
    v_sub_f32 v109, 0, v182
    v_sub_f32 v110, 0, v182
    v_sub_f32 v111, 0, v182
    v_exp_f32 v184, v0
    v_exp_f32 v185, v1
    s_nop 0
    v_add_f32 v112, v184, v185
    v_cvt_pk_bf16_f32 v64, v184, v185
    v_exp_f32 v186, v2
    v_exp_f32 v187, v3
    s_nop 0
    v_add_f32 v112, v112, v186
    v_add_f32 v112, v112, v187
    v_cvt_pk_bf16_f32 v65, v186, v187
    v_exp_f32 v184, v4
    v_exp_f32 v185, v5
    s_nop 0
    v_add_f32 v112, v112, v184
    v_add_f32 v112, v112, v185
    v_cvt_pk_bf16_f32 v66, v184, v185
    v_exp_f32 v186, v6
    v_exp_f32 v187, v7
    s_nop 0
    v_add_f32 v112, v112, v186
    v_add_f32 v112, v112, v187
    v_cvt_pk_bf16_f32 v67, v186, v187
    v_exp_f32 v184, v8
    v_exp_f32 v185, v9
    s_nop 0
    v_add_f32 v113, v184, v185
    v_cvt_pk_bf16_f32 v68, v184, v185
    v_exp_f32 v186, v10
    v_exp_f32 v187, v11
    s_nop 0
    v_add_f32 v113, v113, v186
    v_add_f32 v113, v113, v187
    v_cvt_pk_bf16_f32 v69, v186, v187
    v_exp_f32 v184, v12
    v_exp_f32 v185, v13
    s_nop 0
    v_add_f32 v113, v113, v184
    v_add_f32 v113, v113, v185
    v_cvt_pk_bf16_f32 v70, v184, v185
    v_exp_f32 v160, v14
    v_exp_f32 v161, v15
    s_lshl_b32 s42, s2, 2
    s_add_u32 s42, s42, s36
    s_lshl_b32 s42, s42, 13
    v_and_b32 v193, 63, v174
    v_lshlrev_b32 v192, 7, v193
    v_add_u32 v192, s42, v192
    v_cmp_gt_u32 vcc, 16, v193
    v_mov_b32 v193, 0x7f000000
    s_nop 0
    v_cndmask_b32 v192, v193, v192, vcc
    s_mov_b32 s69, 4096
    s_mov_b32 s86, 0x800000
    s_mov_b32 s87, 0x20000
    s_mov_b32 s68, 0x700000
    v_mov_b32 v114, 0
    v_mov_b32 v115, 0
    s_mov_b32 s41, 8
    s_mov_b32 s55, 0x2c800000
    s_waitcnt lgkmcnt(0)
L_attn_loop:
    s_waitcnt lgkmcnt(4)
    v_mfma_f32_16x16x32_bf16 v[32:35], a[192:195], a[128:131], v[96:99]
    v_exp_f32 v154, v16
    v_mfma_f32_16x16x32_bf16 v[32:35], a[196:199], a[132:135], v[32:35]
    ds_read_b64_tr_b16 a[232:233], v134 offset:0
    v_add_f32 v113, v113, v160
    v_mfma_f32_16x16x32_bf16 v[32:35], a[200:203], a[136:139], v[32:35]
    v_exp_f32 v155, v17
    v_mfma_f32_16x16x32_bf16 v[32:35], a[204:207], a[140:143], v[32:35]
    ds_read_b64_tr_b16 a[234:235], v134 offset:4096
    v_add_f32 v113, v113, v161
    v_cvt_pk_bf16_f32 v71, v160, v161
    v_mfma_f32_16x16x32_bf16 v[36:39], a[208:211], a[128:131], v[96:99]
    v_exp_f32 v156, v18
    v_mfma_f32_16x16x32_bf16 v[36:39], a[212:215], a[132:135], v[36:39]
    ds_read_b64_tr_b16 a[236:237], v135 offset:0
    v_add_f32 v118, v118, v114
    v_mfma_f32_16x16x32_bf16 v[36:39], a[216:219], a[136:139], v[36:39]
    v_exp_f32 v157, v19
    v_mfma_f32_16x16x32_bf16 v[36:39], a[220:223], a[140:143], v[36:39]
    ds_read_b64_tr_b16 a[238:239], v135 offset:4096
    v_add_f32 v114, v154, v155
    v_cvt_pk_bf16_f32 v72, v154, v155
    v_mfma_f32_16x16x32_bf16 v[40:43], a[192:195], a[144:147], v[100:103]
    v_exp_f32 v158, v20
    v_mfma_f32_16x16x32_bf16 v[40:43], a[196:199], a[148:151], v[40:43]
    ds_read_b64_tr_b16 a[240:241], v136 offset:0
    v_add_f32 v114, v114, v156
    v_max_f32 v162, v112, v113
    v_mfma_f32_16x16x32_bf16 v[40:43], a[200:203], a[152:155], v[40:43]
    v_exp_f32 v159, v21
    v_mfma_f32_16x16x32_bf16 v[40:43], a[204:207], a[156:159], v[40:43]
    ds_read_b64_tr_b16 a[242:243], v136 offset:4096
    v_add_f32 v114, v114, v157
    v_cvt_pk_bf16_f32 v73, v156, v157
    v_mfma_f32_16x16x32_bf16 v[44:47], a[208:211], a[144:147], v[100:103]
    v_exp_f32 v160, v22
    v_mfma_f32_16x16x32_bf16 v[44:47], a[212:215], a[148:151], v[44:47]
    ds_read_b64_tr_b16 a[244:245], v137 offset:0
    v_add_f32 v114, v114, v158
    v_cmp_lt_f32 vcc, s55, v162
    v_mfma_f32_16x16x32_bf16 v[44:47], a[216:219], a[152:155], v[44:47]
    v_exp_f32 v161, v23
    v_mfma_f32_16x16x32_bf16 v[44:47], a[220:223], a[156:159], v[44:47]
    ds_read_b64_tr_b16 a[246:247], v137 offset:4096
    v_add_f32 v114, v114, v159
    v_cvt_pk_bf16_f32 v74, v158, v159
    v_mfma_f32_16x16x32_bf16 v[48:51], a[192:195], a[160:163], v[104:107]
    v_exp_f32 v154, v24
    v_mfma_f32_16x16x32_bf16 v[48:51], a[196:199], a[164:167], v[48:51]
    ds_read_b64_tr_b16 a[248:249], v138 offset:0
    v_add_f32 v114, v114, v160
    v_mfma_f32_16x16x32_bf16 v[48:51], a[200:203], a[168:171], v[48:51]
    v_exp_f32 v155, v25
    v_mfma_f32_16x16x32_bf16 v[48:51], a[204:207], a[172:175], v[48:51]
    ds_read_b64_tr_b16 a[250:251], v138 offset:4096
    v_add_f32 v114, v114, v161
    v_cvt_pk_bf16_f32 v75, v160, v161
    v_mfma_f32_16x16x32_bf16 v[52:55], a[208:211], a[160:163], v[104:107]
    v_exp_f32 v156, v26
    v_mfma_f32_16x16x32_bf16 v[52:55], a[212:215], a[164:167], v[52:55]
    ds_read_b64_tr_b16 a[252:253], v139 offset:0
    v_add_f32 v119, v119, v115
    s_cbranch_vccnz L_attn_r0_0
L_attn_r0_0_back:
    v_mfma_f32_16x16x32_bf16 v[52:55], a[216:219], a[168:171], v[52:55]
    v_exp_f32 v157, v27
    v_mfma_f32_16x16x32_bf16 v[52:55], a[220:223], a[172:175], v[52:55]
    ds_read_b64_tr_b16 a[254:255], v139 offset:4096
    v_add_f32 v115, v154, v155
    v_cvt_pk_bf16_f32 v76, v154, v155
    s_waitcnt vmcnt(9)
    s_barrier
    v_mfma_f32_16x16x32_bf16 v[56:59], a[192:195], a[176:179], v[108:111]
    v_exp_f32 v158, v28
    v_mfma_f32_16x16x32_bf16 v[56:59], a[196:199], a[180:183], v[56:59]
    ds_read_b128 a[192:195], v128 offset:16384
    v_add_f32 v115, v115, v156
    v_mfma_f32_16x16x32_bf16 v[56:59], a[200:203], a[184:187], v[56:59]
    s_add_u32 s64, s65, s61
    v_exp_f32 v159, v29
    v_mfma_f32_16x16x32_bf16 v[56:59], a[204:207], a[188:191], v[56:59]
    ds_read_b128 a[196:199], v129 offset:16384
    v_add_f32 v115, v115, v157
    v_cvt_pk_bf16_f32 v77, v156, v157
    v_mfma_f32_16x16x32_bf16 v[60:63], a[208:211], a[176:179], v[108:111]
    s_and_b32 s64, s64, 3
    v_exp_f32 v160, v30
    v_mfma_f32_16x16x32_bf16 v[60:63], a[212:215], a[180:183], v[60:63]
    ds_read_b128 a[200:203], v130 offset:16384
    v_add_f32 v115, v115, v158
    v_mfma_f32_16x16x32_bf16 v[60:63], a[216:219], a[184:187], v[60:63]
    s_andn2_b32 s67, s65, 3
    v_exp_f32 v161, v31
    v_mfma_f32_16x16x32_bf16 v[60:63], a[220:223], a[188:191], v[60:63]
    ds_read_b128 a[204:207], v131 offset:16384
    v_add_f32 v115, v115, v159
    v_cvt_pk_bf16_f32 v78, v158, v159
    s_waitcnt lgkmcnt(4)
    v_mfma_f32_16x16x32_bf16 a[0:3], a[224:227], v[64:67], a[0:3]
    s_or_b32 s64, s64, s67
    v_exp_f32 v154, v32
    v_mfma_f32_16x16x32_bf16 a[4:7], a[228:231], v[64:67], a[4:7]
    ds_read_b128 a[208:211], v128 offset:20480
    v_add_f32 v115, v115, v160
    v_mfma_f32_16x16x32_bf16 a[8:11], a[232:235], v[64:67], a[8:11]
    s_add_u32 s65, s65, 1
    v_exp_f32 v155, v33
    v_mfma_f32_16x16x32_bf16 a[12:15], a[236:239], v[64:67], a[12:15]
    ds_read_b128 a[212:215], v129 offset:20480
    v_add_f32 v115, v115, v161
    v_cvt_pk_bf16_f32 v79, v160, v161
    v_mfma_f32_16x16x32_bf16 a[16:19], a[240:243], v[64:67], a[16:19]
    s_lshl_b32 s52, s64, 14
    v_exp_f32 v156, v34
    v_mfma_f32_16x16x32_bf16 a[20:23], a[244:247], v[64:67], a[20:23]
    ds_read_b128 a[216:219], v130 offset:20480
    v_add_f32 v116, v116, v112
    v_max_f32 v163, v114, v115
    v_mfma_f32_16x16x32_bf16 a[24:27], a[248:251], v[64:67], a[24:27]
    s_mov_b32 m0, s47
    v_exp_f32 v157, v35
    v_mfma_f32_16x16x32_bf16 a[28:31], a[252:255], v[64:67], a[28:31]
    ds_read_b128 a[220:223], v131 offset:20480
    v_add_f32 v112, v154, v155
    v_cvt_pk_bf16_f32 v80, v154, v155
    v_mfma_f32_16x16x32_bf16 a[32:35], a[224:227], v[68:71], a[32:35]
    v_exp_f32 v158, v36
    v_mfma_f32_16x16x32_bf16 a[36:39], a[228:231], v[68:71], a[36:39]
    buffer_load_dwordx4 v144, s[12:15], s52 offen offset:0 lds
    v_add_f32 v112, v112, v156
    v_mfma_f32_16x16x32_bf16 a[40:43], a[232:235], v[68:71], a[40:43]
    v_exp_f32 v159, v37
    v_mfma_f32_16x16x32_bf16 a[44:47], a[236:239], v[68:71], a[44:47]
    v_add_f32 v112, v112, v157
    v_cvt_pk_bf16_f32 v81, v156, v157
    v_cmp_lt_f32 vcc, s55, v163
    v_mfma_f32_16x16x32_bf16 a[48:51], a[240:243], v[68:71], a[48:51]
    v_exp_f32 v160, v38
    v_mfma_f32_16x16x32_bf16 a[52:55], a[244:247], v[68:71], a[52:55]
    buffer_load_dwordx4 v145, s[12:15], s52 offen offset:1024 lds
    v_add_f32 v112, v112, v158
    v_mfma_f32_16x16x32_bf16 a[56:59], a[248:251], v[68:71], a[56:59]
    v_exp_f32 v161, v39
    v_mfma_f32_16x16x32_bf16 a[60:63], a[252:255], v[68:71], a[60:63]
    v_add_f32 v112, v112, v159
    v_cvt_pk_bf16_f32 v82, v158, v159
    s_cbranch_vccnz L_attn_r0_1
L_attn_r0_1_back:
    v_mfma_f32_16x16x32_bf16 a[64:67], a[224:227], v[72:75], a[64:67]
    v_exp_f32 v154, v40
    v_mfma_f32_16x16x32_bf16 a[68:71], a[228:231], v[72:75], a[68:71]
    buffer_load_dwordx4 v146, s[12:15], s52 offen offset:2048 lds
    v_add_f32 v112, v112, v160
    v_mfma_f32_16x16x32_bf16 a[72:75], a[232:235], v[72:75], a[72:75]
    v_exp_f32 v155, v41
    v_mfma_f32_16x16x32_bf16 a[76:79], a[236:239], v[72:75], a[76:79]
    v_add_f32 v112, v112, v161
    v_cvt_pk_bf16_f32 v83, v160, v161
    v_mfma_f32_16x16x32_bf16 a[80:83], a[240:243], v[72:75], a[80:83]
    v_exp_f32 v156, v42
    v_mfma_f32_16x16x32_bf16 a[84:87], a[244:247], v[72:75], a[84:87]
    buffer_load_dwordx4 v147, s[12:15], s52 offen offset:3072 lds
    v_add_f32 v117, v117, v113
    v_mfma_f32_16x16x32_bf16 a[88:91], a[248:251], v[72:75], a[88:91]
    v_exp_f32 v157, v43
    v_mfma_f32_16x16x32_bf16 a[92:95], a[252:255], v[72:75], a[92:95]
    v_add_f32 v113, v154, v155
    v_cvt_pk_bf16_f32 v84, v154, v155
    v_mfma_f32_16x16x32_bf16 a[96:99], a[224:227], v[76:79], a[96:99]
    v_exp_f32 v158, v44
    v_mfma_f32_16x16x32_bf16 a[100:103], a[228:231], v[76:79], a[100:103]
    ds_read_b64_tr_b16 a[224:225], v132 offset:8192
    v_add_f32 v113, v113, v156
    v_mfma_f32_16x16x32_bf16 a[104:107], a[232:235], v[76:79], a[104:107]
    v_exp_f32 v159, v45
    v_mfma_f32_16x16x32_bf16 a[108:111], a[236:239], v[76:79], a[108:111]
    ds_read_b64_tr_b16 a[226:227], v132 offset:12288
    v_add_f32 v113, v113, v157
    v_cvt_pk_bf16_f32 v85, v156, v157
    v_mfma_f32_16x16x32_bf16 a[112:115], a[240:243], v[76:79], a[112:115]
    v_exp_f32 v160, v46
    v_mfma_f32_16x16x32_bf16 a[116:119], a[244:247], v[76:79], a[116:119]
    ds_read_b64_tr_b16 a[228:229], v133 offset:8192
    v_add_f32 v113, v113, v158
    v_mfma_f32_16x16x32_bf16 a[120:123], a[248:251], v[76:79], a[120:123]
    v_exp_f32 v161, v47
    v_mfma_f32_16x16x32_bf16 a[124:127], a[252:255], v[76:79], a[124:127]
    ds_read_b64_tr_b16 a[230:231], v133 offset:12288
    v_add_f32 v113, v113, v159
    v_cvt_pk_bf16_f32 v86, v158, v159
    s_waitcnt lgkmcnt(4)
    v_mfma_f32_16x16x32_bf16 v[0:3], a[192:195], a[128:131], v[96:99]
    v_exp_f32 v154, v48
    v_mfma_f32_16x16x32_bf16 v[0:3], a[196:199], a[132:135], v[0:3]
    ds_read_b64_tr_b16 a[232:233], v134 offset:8192
    v_add_f32 v113, v113, v160
    v_mfma_f32_16x16x32_bf16 v[0:3], a[200:203], a[136:139], v[0:3]
    v_exp_f32 v155, v49
    v_mfma_f32_16x16x32_bf16 v[0:3], a[204:207], a[140:143], v[0:3]
    ds_read_b64_tr_b16 a[234:235], v134 offset:12288
    v_add_f32 v113, v113, v161
    v_cvt_pk_bf16_f32 v87, v160, v161
    v_mfma_f32_16x16x32_bf16 v[4:7], a[208:211], a[128:131], v[96:99]
    v_exp_f32 v156, v50
    v_mfma_f32_16x16x32_bf16 v[4:7], a[212:215], a[132:135], v[4:7]
    ds_read_b64_tr_b16 a[236:237], v135 offset:8192
    v_add_f32 v118, v118, v114
    v_mfma_f32_16x16x32_bf16 v[4:7], a[216:219], a[136:139], v[4:7]
    v_exp_f32 v157, v51
    v_mfma_f32_16x16x32_bf16 v[4:7], a[220:223], a[140:143], v[4:7]
    ds_read_b64_tr_b16 a[238:239], v135 offset:12288
    v_add_f32 v114, v154, v155
    v_cvt_pk_bf16_f32 v88, v154, v155
    v_mfma_f32_16x16x32_bf16 v[8:11], a[192:195], a[144:147], v[100:103]
    v_exp_f32 v158, v52
    v_mfma_f32_16x16x32_bf16 v[8:11], a[196:199], a[148:151], v[8:11]
    ds_read_b64_tr_b16 a[240:241], v136 offset:8192
    v_add_f32 v114, v114, v156
    v_max_f32 v162, v112, v113
    v_mfma_f32_16x16x32_bf16 v[8:11], a[200:203], a[152:155], v[8:11]
    v_exp_f32 v159, v53
    v_mfma_f32_16x16x32_bf16 v[8:11], a[204:207], a[156:159], v[8:11]
    ds_read_b64_tr_b16 a[242:243], v136 offset:12288
    v_add_f32 v114, v114, v157
    v_cvt_pk_bf16_f32 v89, v156, v157
    v_mfma_f32_16x16x32_bf16 v[12:15], a[208:211], a[144:147], v[100:103]
    v_exp_f32 v160, v54
    v_mfma_f32_16x16x32_bf16 v[12:15], a[212:215], a[148:151], v[12:15]
    ds_read_b64_tr_b16 a[244:245], v137 offset:8192
    v_add_f32 v114, v114, v158
    v_cmp_lt_f32 vcc, s55, v162
    v_mfma_f32_16x16x32_bf16 v[12:15], a[216:219], a[152:155], v[12:15]
    v_exp_f32 v161, v55
    v_mfma_f32_16x16x32_bf16 v[12:15], a[220:223], a[156:159], v[12:15]
    ds_read_b64_tr_b16 a[246:247], v137 offset:12288
    v_add_f32 v114, v114, v159
    v_cvt_pk_bf16_f32 v90, v158, v159
    v_mfma_f32_16x16x32_bf16 v[16:19], a[192:195], a[160:163], v[104:107]
    v_exp_f32 v154, v56
    v_mfma_f32_16x16x32_bf16 v[16:19], a[196:199], a[164:167], v[16:19]
    ds_read_b64_tr_b16 a[248:249], v138 offset:8192
    v_add_f32 v114, v114, v160
    v_mfma_f32_16x16x32_bf16 v[16:19], a[200:203], a[168:171], v[16:19]
    v_exp_f32 v155, v57
    v_mfma_f32_16x16x32_bf16 v[16:19], a[204:207], a[172:175], v[16:19]
    ds_read_b64_tr_b16 a[250:251], v138 offset:12288
    v_add_f32 v114, v114, v161
    v_cvt_pk_bf16_f32 v91, v160, v161
    v_mfma_f32_16x16x32_bf16 v[20:23], a[208:211], a[160:163], v[104:107]
    v_exp_f32 v156, v58
    v_mfma_f32_16x16x32_bf16 v[20:23], a[212:215], a[164:167], v[20:23]
    ds_read_b64_tr_b16 a[252:253], v139 offset:8192
    v_add_f32 v119, v119, v115
    s_cbranch_vccnz L_attn_r1_0
L_attn_r1_0_back:
    v_mfma_f32_16x16x32_bf16 v[20:23], a[216:219], a[168:171], v[20:23]
    v_exp_f32 v157, v59
    v_mfma_f32_16x16x32_bf16 v[20:23], a[220:223], a[172:175], v[20:23]
    ds_read_b64_tr_b16 a[254:255], v139 offset:12288
    v_add_f32 v115, v154, v155
    v_cvt_pk_bf16_f32 v92, v154, v155
    v_mfma_f32_16x16x32_bf16 v[24:27], a[192:195], a[176:179], v[108:111]
    v_exp_f32 v158, v60
    v_mfma_f32_16x16x32_bf16 v[24:27], a[196:199], a[180:183], v[24:27]
    ds_read_b128 a[192:195], v128 offset:24576
    v_add_f32 v115, v115, v156
    v_mfma_f32_16x16x32_bf16 v[24:27], a[200:203], a[184:187], v[24:27]
    s_add_u32 s64, s66, s61
    v_exp_f32 v159, v61
    v_mfma_f32_16x16x32_bf16 v[24:27], a[204:207], a[188:191], v[24:27]
    ds_read_b128 a[196:199], v129 offset:24576
    v_add_f32 v115, v115, v157
    v_cvt_pk_bf16_f32 v93, v156, v157
    v_mfma_f32_16x16x32_bf16 v[28:31], a[208:211], a[176:179], v[108:111]
    s_and_b32 s64, s64, 3
    v_exp_f32 v160, v62
    v_mfma_f32_16x16x32_bf16 v[28:31], a[212:215], a[180:183], v[28:31]
    ds_read_b128 a[200:203], v130 offset:24576
    v_add_f32 v115, v115, v158
    v_mfma_f32_16x16x32_bf16 v[28:31], a[216:219], a[184:187], v[28:31]
    s_andn2_b32 s67, s66, 3
    v_exp_f32 v161, v63
    v_mfma_f32_16x16x32_bf16 v[28:31], a[220:223], a[188:191], v[28:31]
    ds_read_b128 a[204:207], v131 offset:24576
    v_add_f32 v115, v115, v159
    v_cvt_pk_bf16_f32 v94, v158, v159
    s_waitcnt lgkmcnt(4)
    v_mfma_f32_16x16x32_bf16 a[0:3], a[224:227], v[80:83], a[0:3]
    s_or_b32 s64, s64, s67
    v_exp_f32 v154, v0
    v_mfma_f32_16x16x32_bf16 a[4:7], a[228:231], v[80:83], a[4:7]
    ds_read_b128 a[208:211], v128 offset:28672
    v_add_f32 v115, v115, v160
    v_mfma_f32_16x16x32_bf16 a[8:11], a[232:235], v[80:83], a[8:11]
    s_add_u32 s66, s66, 1
    v_exp_f32 v155, v1
    v_mfma_f32_16x16x32_bf16 a[12:15], a[236:239], v[80:83], a[12:15]
    ds_read_b128 a[212:215], v129 offset:28672
    v_add_f32 v115, v115, v161
    v_cvt_pk_bf16_f32 v95, v160, v161
    v_mfma_f32_16x16x32_bf16 a[16:19], a[240:243], v[80:83], a[16:19]
    s_lshl_b32 s53, s64, 14
    v_exp_f32 v156, v2
    v_mfma_f32_16x16x32_bf16 a[20:23], a[244:247], v[80:83], a[20:23]
    ds_read_b128 a[216:219], v130 offset:28672
    v_add_f32 v116, v116, v112
    v_max_f32 v163, v114, v115
    v_mfma_f32_16x16x32_bf16 a[24:27], a[248:251], v[80:83], a[24:27]
    s_mov_b32 m0, s51
    v_exp_f32 v157, v3
    v_mfma_f32_16x16x32_bf16 a[28:31], a[252:255], v[80:83], a[28:31]
    ds_read_b128 a[220:223], v131 offset:28672
    v_add_f32 v112, v154, v155
    v_cvt_pk_bf16_f32 v64, v154, v155
    v_mfma_f32_16x16x32_bf16 a[32:35], a[224:227], v[84:87], a[32:35]
    v_exp_f32 v158, v4
    v_mfma_f32_16x16x32_bf16 a[36:39], a[228:231], v[84:87], a[36:39]
    buffer_load_dwordx4 v148, s[16:19], s53 offen offset:0 lds
    v_add_f32 v112, v112, v156
    v_mfma_f32_16x16x32_bf16 a[40:43], a[232:235], v[84:87], a[40:43]
    v_exp_f32 v159, v5
    v_mfma_f32_16x16x32_bf16 a[44:47], a[236:239], v[84:87], a[44:47]
    v_add_f32 v112, v112, v157
    v_cvt_pk_bf16_f32 v65, v156, v157
    v_cmp_lt_f32 vcc, s55, v163
    v_mfma_f32_16x16x32_bf16 a[48:51], a[240:243], v[84:87], a[48:51]
    v_exp_f32 v160, v6
    v_mfma_f32_16x16x32_bf16 a[52:55], a[244:247], v[84:87], a[52:55]
    buffer_load_dwordx4 v197, s[16:19], s53 offen offset:1024 lds
    v_add_f32 v112, v112, v158
    v_mfma_f32_16x16x32_bf16 a[56:59], a[248:251], v[84:87], a[56:59]
    v_exp_f32 v161, v7
    v_mfma_f32_16x16x32_bf16 a[60:63], a[252:255], v[84:87], a[60:63]
    buffer_load_dword v193, v192, s[84:87], 0 offen offset:0
    v_add_f32 v112, v112, v159
    v_cvt_pk_bf16_f32 v66, v158, v159
    s_cbranch_vccnz L_attn_r1_1
L_attn_r1_1_back:
    v_mfma_f32_16x16x32_bf16 a[64:67], a[224:227], v[88:91], a[64:67]
    v_exp_f32 v154, v8
    v_mfma_f32_16x16x32_bf16 a[68:71], a[228:231], v[88:91], a[68:71]
    buffer_load_dwordx4 v148, s[16:19], s53 offen offset:2048 lds
    v_add_f32 v112, v112, v160
    v_mfma_f32_16x16x32_bf16 a[72:75], a[232:235], v[88:91], a[72:75]
    v_exp_f32 v155, v9
    v_mfma_f32_16x16x32_bf16 a[76:79], a[236:239], v[88:91], a[76:79]
    v_add_f32 v112, v112, v161
    v_cvt_pk_bf16_f32 v67, v160, v161
    v_mfma_f32_16x16x32_bf16 a[80:83], a[240:243], v[88:91], a[80:83]
    v_exp_f32 v156, v10
    v_mfma_f32_16x16x32_bf16 a[84:87], a[244:247], v[88:91], a[84:87]
    buffer_load_dwordx4 v197, s[16:19], s53 offen offset:3072 lds
    v_add_f32 v117, v117, v113
    v_mfma_f32_16x16x32_bf16 a[88:91], a[248:251], v[88:91], a[88:91]
    v_exp_f32 v157, v11
    v_mfma_f32_16x16x32_bf16 a[92:95], a[252:255], v[88:91], a[92:95]
    v_add_f32 v113, v154, v155
    v_cvt_pk_bf16_f32 v68, v154, v155
    v_mfma_f32_16x16x32_bf16 a[96:99], a[224:227], v[92:95], a[96:99]
    v_exp_f32 v158, v12
    v_mfma_f32_16x16x32_bf16 a[100:103], a[228:231], v[92:95], a[100:103]
    ds_read_b64_tr_b16 a[224:225], v132 offset:16384
    v_add_f32 v113, v113, v156
    v_mfma_f32_16x16x32_bf16 a[104:107], a[232:235], v[92:95], a[104:107]
    v_exp_f32 v159, v13
    v_mfma_f32_16x16x32_bf16 a[108:111], a[236:239], v[92:95], a[108:111]
    ds_read_b64_tr_b16 a[226:227], v132 offset:20480
    v_add_f32 v113, v113, v157
    v_cvt_pk_bf16_f32 v69, v156, v157
    v_mfma_f32_16x16x32_bf16 a[112:115], a[240:243], v[92:95], a[112:115]
    v_exp_f32 v160, v14
    v_mfma_f32_16x16x32_bf16 a[116:119], a[244:247], v[92:95], a[116:119]
    ds_read_b64_tr_b16 a[228:229], v133 offset:16384
    v_add_f32 v113, v113, v158
    v_mfma_f32_16x16x32_bf16 a[120:123], a[248:251], v[92:95], a[120:123]
    v_exp_f32 v161, v15
    v_mfma_f32_16x16x32_bf16 a[124:127], a[252:255], v[92:95], a[124:127]
    ds_read_b64_tr_b16 a[230:231], v133 offset:20480
    v_add_f32 v113, v113, v159
    v_cvt_pk_bf16_f32 v70, v158, v159
    s_waitcnt lgkmcnt(4)
    v_mfma_f32_16x16x32_bf16 v[32:35], a[192:195], a[128:131], v[96:99]
    v_exp_f32 v154, v16
    v_mfma_f32_16x16x32_bf16 v[32:35], a[196:199], a[132:135], v[32:35]
    ds_read_b64_tr_b16 a[232:233], v134 offset:16384
    v_add_f32 v113, v113, v160
    v_mfma_f32_16x16x32_bf16 v[32:35], a[200:203], a[136:139], v[32:35]
    v_exp_f32 v155, v17
    v_mfma_f32_16x16x32_bf16 v[32:35], a[204:207], a[140:143], v[32:35]
    ds_read_b64_tr_b16 a[234:235], v134 offset:20480
    v_add_f32 v113, v113, v161
    v_cvt_pk_bf16_f32 v71, v160, v161
    v_mfma_f32_16x16x32_bf16 v[36:39], a[208:211], a[128:131], v[96:99]
    v_exp_f32 v156, v18
    v_mfma_f32_16x16x32_bf16 v[36:39], a[212:215], a[132:135], v[36:39]
    ds_read_b64_tr_b16 a[236:237], v135 offset:16384
    v_add_f32 v118, v118, v114
    v_mfma_f32_16x16x32_bf16 v[36:39], a[216:219], a[136:139], v[36:39]
    v_exp_f32 v157, v19
    v_mfma_f32_16x16x32_bf16 v[36:39], a[220:223], a[140:143], v[36:39]
    ds_read_b64_tr_b16 a[238:239], v135 offset:20480
    v_add_f32 v114, v154, v155
    v_cvt_pk_bf16_f32 v72, v154, v155
    v_mfma_f32_16x16x32_bf16 v[40:43], a[192:195], a[144:147], v[100:103]
    v_exp_f32 v158, v20
    v_mfma_f32_16x16x32_bf16 v[40:43], a[196:199], a[148:151], v[40:43]
    ds_read_b64_tr_b16 a[240:241], v136 offset:16384
    v_add_f32 v114, v114, v156
    v_max_f32 v162, v112, v113
    v_mfma_f32_16x16x32_bf16 v[40:43], a[200:203], a[152:155], v[40:43]
    v_exp_f32 v159, v21
    v_mfma_f32_16x16x32_bf16 v[40:43], a[204:207], a[156:159], v[40:43]
    ds_read_b64_tr_b16 a[242:243], v136 offset:20480
    v_add_f32 v114, v114, v157
    v_cvt_pk_bf16_f32 v73, v156, v157
    v_mfma_f32_16x16x32_bf16 v[44:47], a[208:211], a[144:147], v[100:103]
    v_exp_f32 v160, v22
    v_mfma_f32_16x16x32_bf16 v[44:47], a[212:215], a[148:151], v[44:47]
    ds_read_b64_tr_b16 a[244:245], v137 offset:16384
    v_add_f32 v114, v114, v158
    v_cmp_lt_f32 vcc, s55, v162
    v_mfma_f32_16x16x32_bf16 v[44:47], a[216:219], a[152:155], v[44:47]
    v_exp_f32 v161, v23
    v_mfma_f32_16x16x32_bf16 v[44:47], a[220:223], a[156:159], v[44:47]
    ds_read_b64_tr_b16 a[246:247], v137 offset:20480
    v_add_f32 v114, v114, v159
    v_cvt_pk_bf16_f32 v74, v158, v159
    v_mfma_f32_16x16x32_bf16 v[48:51], a[192:195], a[160:163], v[104:107]
    v_exp_f32 v154, v24
    v_mfma_f32_16x16x32_bf16 v[48:51], a[196:199], a[164:167], v[48:51]
    ds_read_b64_tr_b16 a[248:249], v138 offset:16384
    v_add_f32 v114, v114, v160
    v_mfma_f32_16x16x32_bf16 v[48:51], a[200:203], a[168:171], v[48:51]
    v_exp_f32 v155, v25
    v_mfma_f32_16x16x32_bf16 v[48:51], a[204:207], a[172:175], v[48:51]
    ds_read_b64_tr_b16 a[250:251], v138 offset:20480
    v_add_f32 v114, v114, v161
    v_cvt_pk_bf16_f32 v75, v160, v161
    v_mfma_f32_16x16x32_bf16 v[52:55], a[208:211], a[160:163], v[104:107]
    v_exp_f32 v156, v26
    v_mfma_f32_16x16x32_bf16 v[52:55], a[212:215], a[164:167], v[52:55]
    ds_read_b64_tr_b16 a[252:253], v139 offset:16384
    v_add_f32 v119, v119, v115
    s_cbranch_vccnz L_attn_r2_0
L_attn_r2_0_back:
    v_mfma_f32_16x16x32_bf16 v[52:55], a[216:219], a[168:171], v[52:55]
    v_exp_f32 v157, v27
    v_mfma_f32_16x16x32_bf16 v[52:55], a[220:223], a[172:175], v[52:55]
    ds_read_b64_tr_b16 a[254:255], v139 offset:20480
    v_add_f32 v115, v154, v155
    v_cvt_pk_bf16_f32 v76, v154, v155
    s_waitcnt vmcnt(9)
    s_barrier
    v_mfma_f32_16x16x32_bf16 v[56:59], a[192:195], a[176:179], v[108:111]
    v_exp_f32 v158, v28
    v_mfma_f32_16x16x32_bf16 v[56:59], a[196:199], a[180:183], v[56:59]
    ds_read_b128 a[192:195], v128 offset:32768
    v_add_f32 v115, v115, v156
    v_mfma_f32_16x16x32_bf16 v[56:59], a[200:203], a[184:187], v[56:59]
    s_add_u32 s64, s65, s61
    v_exp_f32 v159, v29
    v_mfma_f32_16x16x32_bf16 v[56:59], a[204:207], a[188:191], v[56:59]
    ds_read_b128 a[196:199], v129 offset:32768
    v_add_f32 v115, v115, v157
    v_cvt_pk_bf16_f32 v77, v156, v157
    v_mfma_f32_16x16x32_bf16 v[60:63], a[208:211], a[176:179], v[108:111]
    s_and_b32 s64, s64, 3
    v_exp_f32 v160, v30
    v_mfma_f32_16x16x32_bf16 v[60:63], a[212:215], a[180:183], v[60:63]
    ds_read_b128 a[200:203], v130 offset:32768
    v_add_f32 v115, v115, v158
    v_mfma_f32_16x16x32_bf16 v[60:63], a[216:219], a[184:187], v[60:63]
    s_andn2_b32 s67, s65, 3
    v_exp_f32 v161, v31
    v_mfma_f32_16x16x32_bf16 v[60:63], a[220:223], a[188:191], v[60:63]
    ds_read_b128 a[204:207], v131 offset:32768
    v_add_f32 v115, v115, v159
    v_cvt_pk_bf16_f32 v78, v158, v159
    s_waitcnt lgkmcnt(4)
    v_mfma_f32_16x16x32_bf16 a[0:3], a[224:227], v[64:67], a[0:3]
    s_or_b32 s64, s64, s67
    v_exp_f32 v154, v32
    v_mfma_f32_16x16x32_bf16 a[4:7], a[228:231], v[64:67], a[4:7]
    ds_read_b128 a[208:211], v128 offset:36864
    v_add_f32 v115, v115, v160
    v_mfma_f32_16x16x32_bf16 a[8:11], a[232:235], v[64:67], a[8:11]
    s_add_u32 s65, s65, 1
    v_exp_f32 v155, v33
    v_mfma_f32_16x16x32_bf16 a[12:15], a[236:239], v[64:67], a[12:15]
    ds_read_b128 a[212:215], v129 offset:36864
    v_add_f32 v115, v115, v161
    v_cvt_pk_bf16_f32 v79, v160, v161
    v_mfma_f32_16x16x32_bf16 a[16:19], a[240:243], v[64:67], a[16:19]
    s_lshl_b32 s52, s64, 14
    v_exp_f32 v156, v34
    v_mfma_f32_16x16x32_bf16 a[20:23], a[244:247], v[64:67], a[20:23]
    ds_read_b128 a[216:219], v130 offset:36864
    v_add_f32 v116, v116, v112
    v_max_f32 v163, v114, v115
    v_mfma_f32_16x16x32_bf16 a[24:27], a[248:251], v[64:67], a[24:27]
    s_mov_b32 m0, s44
    v_exp_f32 v157, v35
    v_mfma_f32_16x16x32_bf16 a[28:31], a[252:255], v[64:67], a[28:31]
    ds_read_b128 a[220:223], v131 offset:36864
    v_add_f32 v112, v154, v155
    v_cvt_pk_bf16_f32 v80, v154, v155
    v_mfma_f32_16x16x32_bf16 a[32:35], a[224:227], v[68:71], a[32:35]
    v_exp_f32 v158, v36
    v_mfma_f32_16x16x32_bf16 a[36:39], a[228:231], v[68:71], a[36:39]
    buffer_load_dwordx4 v144, s[12:15], s52 offen offset:0 lds
    v_add_f32 v112, v112, v156
    v_mfma_f32_16x16x32_bf16 a[40:43], a[232:235], v[68:71], a[40:43]
    v_exp_f32 v159, v37
    v_mfma_f32_16x16x32_bf16 a[44:47], a[236:239], v[68:71], a[44:47]
    v_add_f32 v112, v112, v157
    v_cvt_pk_bf16_f32 v81, v156, v157
    v_cmp_lt_f32 vcc, s55, v163
    v_mfma_f32_16x16x32_bf16 a[48:51], a[240:243], v[68:71], a[48:51]
    v_exp_f32 v160, v38
    v_mfma_f32_16x16x32_bf16 a[52:55], a[244:247], v[68:71], a[52:55]
    buffer_load_dwordx4 v145, s[12:15], s52 offen offset:1024 lds
    v_add_f32 v112, v112, v158
    v_mfma_f32_16x16x32_bf16 a[56:59], a[248:251], v[68:71], a[56:59]
    v_exp_f32 v161, v39
    v_mfma_f32_16x16x32_bf16 a[60:63], a[252:255], v[68:71], a[60:63]
    v_add_f32 v112, v112, v159
    v_cvt_pk_bf16_f32 v82, v158, v159
    s_cbranch_vccnz L_attn_r2_1
L_attn_r2_1_back:
    v_mfma_f32_16x16x32_bf16 a[64:67], a[224:227], v[72:75], a[64:67]
    v_exp_f32 v154, v40
    v_mfma_f32_16x16x32_bf16 a[68:71], a[228:231], v[72:75], a[68:71]
    buffer_load_dwordx4 v146, s[12:15], s52 offen offset:2048 lds
    v_add_f32 v112, v112, v160
    v_mfma_f32_16x16x32_bf16 a[72:75], a[232:235], v[72:75], a[72:75]
    v_exp_f32 v155, v41
    v_mfma_f32_16x16x32_bf16 a[76:79], a[236:239], v[72:75], a[76:79]
    v_add_f32 v112, v112, v161
    v_cvt_pk_bf16_f32 v83, v160, v161
    v_mfma_f32_16x16x32_bf16 a[80:83], a[240:243], v[72:75], a[80:83]
    v_exp_f32 v156, v42
    v_mfma_f32_16x16x32_bf16 a[84:87], a[244:247], v[72:75], a[84:87]
    buffer_load_dwordx4 v147, s[12:15], s52 offen offset:3072 lds
    v_add_f32 v117, v117, v113
    v_mfma_f32_16x16x32_bf16 a[88:91], a[248:251], v[72:75], a[88:91]
    v_exp_f32 v157, v43
    v_mfma_f32_16x16x32_bf16 a[92:95], a[252:255], v[72:75], a[92:95]
    v_add_f32 v113, v154, v155
    v_cvt_pk_bf16_f32 v84, v154, v155
    v_mfma_f32_16x16x32_bf16 a[96:99], a[224:227], v[76:79], a[96:99]
    v_exp_f32 v158, v44
    v_mfma_f32_16x16x32_bf16 a[100:103], a[228:231], v[76:79], a[100:103]
    ds_read_b64_tr_b16 a[224:225], v132 offset:24576
    v_add_f32 v113, v113, v156
    v_mfma_f32_16x16x32_bf16 a[104:107], a[232:235], v[76:79], a[104:107]
    v_exp_f32 v159, v45
    v_mfma_f32_16x16x32_bf16 a[108:111], a[236:239], v[76:79], a[108:111]
    ds_read_b64_tr_b16 a[226:227], v132 offset:28672
    v_add_f32 v113, v113, v157
    v_cvt_pk_bf16_f32 v85, v156, v157
    v_mfma_f32_16x16x32_bf16 a[112:115], a[240:243], v[76:79], a[112:115]
    v_exp_f32 v160, v46
    v_mfma_f32_16x16x32_bf16 a[116:119], a[244:247], v[76:79], a[116:119]
    ds_read_b64_tr_b16 a[228:229], v133 offset:24576
    v_add_f32 v113, v113, v158
    v_mfma_f32_16x16x32_bf16 a[120:123], a[248:251], v[76:79], a[120:123]
    v_exp_f32 v161, v47
    v_mfma_f32_16x16x32_bf16 a[124:127], a[252:255], v[76:79], a[124:127]
    ds_read_b64_tr_b16 a[230:231], v133 offset:28672
    v_add_f32 v113, v113, v159
    v_cvt_pk_bf16_f32 v86, v158, v159
    s_waitcnt lgkmcnt(4)
    v_mfma_f32_16x16x32_bf16 v[0:3], a[192:195], a[128:131], v[96:99]
    v_exp_f32 v154, v48
    v_mfma_f32_16x16x32_bf16 v[0:3], a[196:199], a[132:135], v[0:3]
    ds_read_b64_tr_b16 a[232:233], v134 offset:24576
    v_add_f32 v113, v113, v160
    v_mfma_f32_16x16x32_bf16 v[0:3], a[200:203], a[136:139], v[0:3]
    v_exp_f32 v155, v49
    v_mfma_f32_16x16x32_bf16 v[0:3], a[204:207], a[140:143], v[0:3]
    ds_read_b64_tr_b16 a[234:235], v134 offset:28672
    v_add_f32 v113, v113, v161
    v_cvt_pk_bf16_f32 v87, v160, v161
    v_mfma_f32_16x16x32_bf16 v[4:7], a[208:211], a[128:131], v[96:99]
    v_exp_f32 v156, v50
    v_mfma_f32_16x16x32_bf16 v[4:7], a[212:215], a[132:135], v[4:7]
    ds_read_b64_tr_b16 a[236:237], v135 offset:24576
    v_add_f32 v118, v118, v114
    v_mfma_f32_16x16x32_bf16 v[4:7], a[216:219], a[136:139], v[4:7]
    v_exp_f32 v157, v51
    v_mfma_f32_16x16x32_bf16 v[4:7], a[220:223], a[140:143], v[4:7]
    ds_read_b64_tr_b16 a[238:239], v135 offset:28672
    v_add_f32 v114, v154, v155
    v_cvt_pk_bf16_f32 v88, v154, v155
    v_mfma_f32_16x16x32_bf16 v[8:11], a[192:195], a[144:147], v[100:103]
    v_exp_f32 v158, v52
    v_mfma_f32_16x16x32_bf16 v[8:11], a[196:199], a[148:151], v[8:11]
    ds_read_b64_tr_b16 a[240:241], v136 offset:24576
    v_add_f32 v114, v114, v156
    v_max_f32 v162, v112, v113
    v_mfma_f32_16x16x32_bf16 v[8:11], a[200:203], a[152:155], v[8:11]
    v_exp_f32 v159, v53
    v_mfma_f32_16x16x32_bf16 v[8:11], a[204:207], a[156:159], v[8:11]
    ds_read_b64_tr_b16 a[242:243], v136 offset:28672
    v_add_f32 v114, v114, v157
    v_cvt_pk_bf16_f32 v89, v156, v157
    v_mfma_f32_16x16x32_bf16 v[12:15], a[208:211], a[144:147], v[100:103]
    v_exp_f32 v160, v54
    v_mfma_f32_16x16x32_bf16 v[12:15], a[212:215], a[148:151], v[12:15]
    ds_read_b64_tr_b16 a[244:245], v137 offset:24576
    v_add_f32 v114, v114, v158
    v_cmp_lt_f32 vcc, s55, v162
    v_mfma_f32_16x16x32_bf16 v[12:15], a[216:219], a[152:155], v[12:15]
    v_exp_f32 v161, v55
    v_mfma_f32_16x16x32_bf16 v[12:15], a[220:223], a[156:159], v[12:15]
    ds_read_b64_tr_b16 a[246:247], v137 offset:28672
    v_add_f32 v114, v114, v159
    v_cvt_pk_bf16_f32 v90, v158, v159
    v_mfma_f32_16x16x32_bf16 v[16:19], a[192:195], a[160:163], v[104:107]
    v_exp_f32 v154, v56
    v_mfma_f32_16x16x32_bf16 v[16:19], a[196:199], a[164:167], v[16:19]
    ds_read_b64_tr_b16 a[248:249], v138 offset:24576
    v_add_f32 v114, v114, v160
    v_mfma_f32_16x16x32_bf16 v[16:19], a[200:203], a[168:171], v[16:19]
    v_exp_f32 v155, v57
    v_mfma_f32_16x16x32_bf16 v[16:19], a[204:207], a[172:175], v[16:19]
    ds_read_b64_tr_b16 a[250:251], v138 offset:28672
    v_add_f32 v114, v114, v161
    v_cvt_pk_bf16_f32 v91, v160, v161
    v_mfma_f32_16x16x32_bf16 v[20:23], a[208:211], a[160:163], v[104:107]
    v_exp_f32 v156, v58
    v_mfma_f32_16x16x32_bf16 v[20:23], a[212:215], a[164:167], v[20:23]
    ds_read_b64_tr_b16 a[252:253], v139 offset:24576
    v_add_f32 v119, v119, v115
    s_cbranch_vccnz L_attn_r3_0
L_attn_r3_0_back:
    v_mfma_f32_16x16x32_bf16 v[20:23], a[216:219], a[168:171], v[20:23]
    v_exp_f32 v157, v59
    v_mfma_f32_16x16x32_bf16 v[20:23], a[220:223], a[172:175], v[20:23]
    ds_read_b64_tr_b16 a[254:255], v139 offset:28672
    v_add_f32 v115, v154, v155
    v_cvt_pk_bf16_f32 v92, v154, v155
    v_mfma_f32_16x16x32_bf16 v[24:27], a[192:195], a[176:179], v[108:111]
    v_exp_f32 v158, v60
    v_mfma_f32_16x16x32_bf16 v[24:27], a[196:199], a[180:183], v[24:27]
    ds_read_b128 a[192:195], v128 offset:40960
    v_add_f32 v115, v115, v156
    v_mfma_f32_16x16x32_bf16 v[24:27], a[200:203], a[184:187], v[24:27]
    s_add_u32 s64, s66, s61
    v_exp_f32 v159, v61
    v_mfma_f32_16x16x32_bf16 v[24:27], a[204:207], a[188:191], v[24:27]
    ds_read_b128 a[196:199], v129 offset:40960
    v_add_f32 v115, v115, v157
    v_cvt_pk_bf16_f32 v93, v156, v157
    v_mfma_f32_16x16x32_bf16 v[28:31], a[208:211], a[176:179], v[108:111]
    s_and_b32 s64, s64, 3
    v_exp_f32 v160, v62
    v_mfma_f32_16x16x32_bf16 v[28:31], a[212:215], a[180:183], v[28:31]
    ds_read_b128 a[200:203], v130 offset:40960
    v_add_f32 v115, v115, v158
    v_mfma_f32_16x16x32_bf16 v[28:31], a[216:219], a[184:187], v[28:31]
    s_andn2_b32 s67, s66, 3
    v_exp_f32 v161, v63
    v_mfma_f32_16x16x32_bf16 v[28:31], a[220:223], a[188:191], v[28:31]
    ds_read_b128 a[204:207], v131 offset:40960
    v_add_f32 v115, v115, v159
    v_cvt_pk_bf16_f32 v94, v158, v159
    s_waitcnt lgkmcnt(4)
    v_mfma_f32_16x16x32_bf16 a[0:3], a[224:227], v[80:83], a[0:3]
    s_or_b32 s64, s64, s67
    v_exp_f32 v154, v0
    v_mfma_f32_16x16x32_bf16 a[4:7], a[228:231], v[80:83], a[4:7]
    ds_read_b128 a[208:211], v128 offset:45056
    v_add_f32 v115, v115, v160
    v_mfma_f32_16x16x32_bf16 a[8:11], a[232:235], v[80:83], a[8:11]
    s_add_u32 s66, s66, 1
    v_exp_f32 v155, v1
    v_mfma_f32_16x16x32_bf16 a[12:15], a[236:239], v[80:83], a[12:15]
    ds_read_b128 a[212:215], v129 offset:45056
    v_add_f32 v115, v115, v161
    v_cvt_pk_bf16_f32 v95, v160, v161
    v_mfma_f32_16x16x32_bf16 a[16:19], a[240:243], v[80:83], a[16:19]
    s_lshl_b32 s53, s64, 14
    v_exp_f32 v156, v2
    v_mfma_f32_16x16x32_bf16 a[20:23], a[244:247], v[80:83], a[20:23]
    ds_read_b128 a[216:219], v130 offset:45056
    v_add_f32 v116, v116, v112
    v_max_f32 v163, v114, v115
    v_mfma_f32_16x16x32_bf16 a[24:27], a[248:251], v[80:83], a[24:27]
    s_mov_b32 m0, s48
    v_exp_f32 v157, v3
    v_mfma_f32_16x16x32_bf16 a[28:31], a[252:255], v[80:83], a[28:31]
    ds_read_b128 a[220:223], v131 offset:45056
    v_add_f32 v112, v154, v155
    v_cvt_pk_bf16_f32 v64, v154, v155
    v_mfma_f32_16x16x32_bf16 a[32:35], a[224:227], v[84:87], a[32:35]
    v_exp_f32 v158, v4
    v_mfma_f32_16x16x32_bf16 a[36:39], a[228:231], v[84:87], a[36:39]
    buffer_load_dwordx4 v148, s[16:19], s53 offen offset:0 lds
    v_add_f32 v112, v112, v156
    v_mfma_f32_16x16x32_bf16 a[40:43], a[232:235], v[84:87], a[40:43]
    v_exp_f32 v159, v5
    v_mfma_f32_16x16x32_bf16 a[44:47], a[236:239], v[84:87], a[44:47]
    v_add_f32 v112, v112, v157
    v_cvt_pk_bf16_f32 v65, v156, v157
    v_cmp_lt_f32 vcc, s55, v163
    v_mfma_f32_16x16x32_bf16 a[48:51], a[240:243], v[84:87], a[48:51]
    v_exp_f32 v160, v6
    v_mfma_f32_16x16x32_bf16 a[52:55], a[244:247], v[84:87], a[52:55]
    buffer_load_dwordx4 v197, s[16:19], s53 offen offset:1024 lds
    v_add_f32 v112, v112, v158
    v_mfma_f32_16x16x32_bf16 a[56:59], a[248:251], v[84:87], a[56:59]
    v_exp_f32 v161, v7
    v_mfma_f32_16x16x32_bf16 a[60:63], a[252:255], v[84:87], a[60:63]
    buffer_load_dword v193, v192, s[84:87], 0 offen offset:2048
    v_add_f32 v112, v112, v159
    v_cvt_pk_bf16_f32 v66, v158, v159
    s_cbranch_vccnz L_attn_r3_1
L_attn_r3_1_back:
    v_mfma_f32_16x16x32_bf16 a[64:67], a[224:227], v[88:91], a[64:67]
    v_exp_f32 v154, v8
    v_mfma_f32_16x16x32_bf16 a[68:71], a[228:231], v[88:91], a[68:71]
    buffer_load_dwordx4 v148, s[16:19], s53 offen offset:2048 lds
    v_add_f32 v112, v112, v160
    v_mfma_f32_16x16x32_bf16 a[72:75], a[232:235], v[88:91], a[72:75]
    v_exp_f32 v155, v9
    v_mfma_f32_16x16x32_bf16 a[76:79], a[236:239], v[88:91], a[76:79]
    v_add_f32 v112, v112, v161
    v_cvt_pk_bf16_f32 v67, v160, v161
    v_mfma_f32_16x16x32_bf16 a[80:83], a[240:243], v[88:91], a[80:83]
    v_exp_f32 v156, v10
    v_mfma_f32_16x16x32_bf16 a[84:87], a[244:247], v[88:91], a[84:87]
    buffer_load_dwordx4 v197, s[16:19], s53 offen offset:3072 lds
    v_add_f32 v117, v117, v113
    v_mfma_f32_16x16x32_bf16 a[88:91], a[248:251], v[88:91], a[88:91]
    v_exp_f32 v157, v11
    v_mfma_f32_16x16x32_bf16 a[92:95], a[252:255], v[88:91], a[92:95]
    v_add_f32 v113, v154, v155
    v_cvt_pk_bf16_f32 v68, v154, v155
    v_mfma_f32_16x16x32_bf16 a[96:99], a[224:227], v[92:95], a[96:99]
    v_exp_f32 v158, v12
    v_mfma_f32_16x16x32_bf16 a[100:103], a[228:231], v[92:95], a[100:103]
    ds_read_b64_tr_b16 a[224:225], v132 offset:32768
    v_add_f32 v113, v113, v156
    v_mfma_f32_16x16x32_bf16 a[104:107], a[232:235], v[92:95], a[104:107]
    v_exp_f32 v159, v13
    v_mfma_f32_16x16x32_bf16 a[108:111], a[236:239], v[92:95], a[108:111]
    ds_read_b64_tr_b16 a[226:227], v132 offset:36864
    v_add_f32 v113, v113, v157
    v_cvt_pk_bf16_f32 v69, v156, v157
    v_mfma_f32_16x16x32_bf16 a[112:115], a[240:243], v[92:95], a[112:115]
    v_exp_f32 v160, v14
    v_mfma_f32_16x16x32_bf16 a[116:119], a[244:247], v[92:95], a[116:119]
    ds_read_b64_tr_b16 a[228:229], v133 offset:32768
    v_add_f32 v113, v113, v158
    v_mfma_f32_16x16x32_bf16 a[120:123], a[248:251], v[92:95], a[120:123]
    v_exp_f32 v161, v15
    v_mfma_f32_16x16x32_bf16 a[124:127], a[252:255], v[92:95], a[124:127]
    ds_read_b64_tr_b16 a[230:231], v133 offset:36864
    v_add_f32 v113, v113, v159
    v_cvt_pk_bf16_f32 v70, v158, v159
    s_waitcnt lgkmcnt(4)
    v_mfma_f32_16x16x32_bf16 v[32:35], a[192:195], a[128:131], v[96:99]
    v_exp_f32 v154, v16
    v_mfma_f32_16x16x32_bf16 v[32:35], a[196:199], a[132:135], v[32:35]
    ds_read_b64_tr_b16 a[232:233], v134 offset:32768
    v_add_f32 v113, v113, v160
    v_mfma_f32_16x16x32_bf16 v[32:35], a[200:203], a[136:139], v[32:35]
    v_exp_f32 v155, v17
    v_mfma_f32_16x16x32_bf16 v[32:35], a[204:207], a[140:143], v[32:35]
    ds_read_b64_tr_b16 a[234:235], v134 offset:36864
    v_add_f32 v113, v113, v161
    v_cvt_pk_bf16_f32 v71, v160, v161
    v_mfma_f32_16x16x32_bf16 v[36:39], a[208:211], a[128:131], v[96:99]
    v_exp_f32 v156, v18
    v_mfma_f32_16x16x32_bf16 v[36:39], a[212:215], a[132:135], v[36:39]
    ds_read_b64_tr_b16 a[236:237], v135 offset:32768
    v_add_f32 v118, v118, v114
    v_mfma_f32_16x16x32_bf16 v[36:39], a[216:219], a[136:139], v[36:39]
    v_exp_f32 v157, v19
    v_mfma_f32_16x16x32_bf16 v[36:39], a[220:223], a[140:143], v[36:39]
    ds_read_b64_tr_b16 a[238:239], v135 offset:36864
    v_add_f32 v114, v154, v155
    v_cvt_pk_bf16_f32 v72, v154, v155
    v_mfma_f32_16x16x32_bf16 v[40:43], a[192:195], a[144:147], v[100:103]
    v_exp_f32 v158, v20
    v_mfma_f32_16x16x32_bf16 v[40:43], a[196:199], a[148:151], v[40:43]
    ds_read_b64_tr_b16 a[240:241], v136 offset:32768
    v_add_f32 v114, v114, v156
    v_max_f32 v162, v112, v113
    v_mfma_f32_16x16x32_bf16 v[40:43], a[200:203], a[152:155], v[40:43]
    v_exp_f32 v159, v21
    v_mfma_f32_16x16x32_bf16 v[40:43], a[204:207], a[156:159], v[40:43]
    ds_read_b64_tr_b16 a[242:243], v136 offset:36864
    v_add_f32 v114, v114, v157
    v_cvt_pk_bf16_f32 v73, v156, v157
    v_mfma_f32_16x16x32_bf16 v[44:47], a[208:211], a[144:147], v[100:103]
    v_exp_f32 v160, v22
    v_mfma_f32_16x16x32_bf16 v[44:47], a[212:215], a[148:151], v[44:47]
    ds_read_b64_tr_b16 a[244:245], v137 offset:32768
    v_add_f32 v114, v114, v158
    v_cmp_lt_f32 vcc, s55, v162
    v_mfma_f32_16x16x32_bf16 v[44:47], a[216:219], a[152:155], v[44:47]
    v_exp_f32 v161, v23
    v_mfma_f32_16x16x32_bf16 v[44:47], a[220:223], a[156:159], v[44:47]
    ds_read_b64_tr_b16 a[246:247], v137 offset:36864
    v_add_f32 v114, v114, v159
    v_cvt_pk_bf16_f32 v74, v158, v159
    v_mfma_f32_16x16x32_bf16 v[48:51], a[192:195], a[160:163], v[104:107]
    v_exp_f32 v154, v24
    v_mfma_f32_16x16x32_bf16 v[48:51], a[196:199], a[164:167], v[48:51]
    ds_read_b64_tr_b16 a[248:249], v138 offset:32768
    v_add_f32 v114, v114, v160
    v_mfma_f32_16x16x32_bf16 v[48:51], a[200:203], a[168:171], v[48:51]
    v_exp_f32 v155, v25
    v_mfma_f32_16x16x32_bf16 v[48:51], a[204:207], a[172:175], v[48:51]
    ds_read_b64_tr_b16 a[250:251], v138 offset:36864
    v_add_f32 v114, v114, v161
    v_cvt_pk_bf16_f32 v75, v160, v161
    v_mfma_f32_16x16x32_bf16 v[52:55], a[208:211], a[160:163], v[104:107]
    v_exp_f32 v156, v26
    v_mfma_f32_16x16x32_bf16 v[52:55], a[212:215], a[164:167], v[52:55]
    ds_read_b64_tr_b16 a[252:253], v139 offset:32768
    v_add_f32 v119, v119, v115
    s_cbranch_vccnz L_attn_r4_0
L_attn_r4_0_back:
    v_mfma_f32_16x16x32_bf16 v[52:55], a[216:219], a[168:171], v[52:55]
    v_exp_f32 v157, v27
    v_mfma_f32_16x16x32_bf16 v[52:55], a[220:223], a[172:175], v[52:55]
    ds_read_b64_tr_b16 a[254:255], v139 offset:36864
    v_add_f32 v115, v154, v155
    v_cvt_pk_bf16_f32 v76, v154, v155
    s_waitcnt vmcnt(9)
    s_barrier
    v_mfma_f32_16x16x32_bf16 v[56:59], a[192:195], a[176:179], v[108:111]
    v_exp_f32 v158, v28
    v_mfma_f32_16x16x32_bf16 v[56:59], a[196:199], a[180:183], v[56:59]
    ds_read_b128 a[192:195], v128 offset:49152
    v_add_f32 v115, v115, v156
    v_mfma_f32_16x16x32_bf16 v[56:59], a[200:203], a[184:187], v[56:59]
    s_add_u32 s64, s65, s61
    v_exp_f32 v159, v29
    v_mfma_f32_16x16x32_bf16 v[56:59], a[204:207], a[188:191], v[56:59]
    ds_read_b128 a[196:199], v129 offset:49152
    v_add_f32 v115, v115, v157
    v_cvt_pk_bf16_f32 v77, v156, v157
    v_mfma_f32_16x16x32_bf16 v[60:63], a[208:211], a[176:179], v[108:111]
    s_and_b32 s64, s64, 3
    v_exp_f32 v160, v30
    v_mfma_f32_16x16x32_bf16 v[60:63], a[212:215], a[180:183], v[60:63]
    ds_read_b128 a[200:203], v130 offset:49152
    v_add_f32 v115, v115, v158
    v_mfma_f32_16x16x32_bf16 v[60:63], a[216:219], a[184:187], v[60:63]
    s_andn2_b32 s67, s65, 3
    v_exp_f32 v161, v31
    v_mfma_f32_16x16x32_bf16 v[60:63], a[220:223], a[188:191], v[60:63]
    ds_read_b128 a[204:207], v131 offset:49152
    v_add_f32 v115, v115, v159
    v_cvt_pk_bf16_f32 v78, v158, v159
    s_waitcnt lgkmcnt(4)
    v_mfma_f32_16x16x32_bf16 a[0:3], a[224:227], v[64:67], a[0:3]
    s_or_b32 s64, s64, s67
    v_exp_f32 v154, v32
    v_mfma_f32_16x16x32_bf16 a[4:7], a[228:231], v[64:67], a[4:7]
    ds_read_b128 a[208:211], v128 offset:53248
    v_add_f32 v115, v115, v160
    v_mfma_f32_16x16x32_bf16 a[8:11], a[232:235], v[64:67], a[8:11]
    s_add_u32 s65, s65, 1
    v_exp_f32 v155, v33
    v_mfma_f32_16x16x32_bf16 a[12:15], a[236:239], v[64:67], a[12:15]
    ds_read_b128 a[212:215], v129 offset:53248
    v_add_f32 v115, v115, v161
    v_cvt_pk_bf16_f32 v79, v160, v161
    v_mfma_f32_16x16x32_bf16 a[16:19], a[240:243], v[64:67], a[16:19]
    s_lshl_b32 s52, s64, 14
    v_exp_f32 v156, v34
    v_mfma_f32_16x16x32_bf16 a[20:23], a[244:247], v[64:67], a[20:23]
    ds_read_b128 a[216:219], v130 offset:53248
    v_add_f32 v116, v116, v112
    v_max_f32 v163, v114, v115
    v_mfma_f32_16x16x32_bf16 a[24:27], a[248:251], v[64:67], a[24:27]
    s_mov_b32 m0, s45
    v_exp_f32 v157, v35
    v_mfma_f32_16x16x32_bf16 a[28:31], a[252:255], v[64:67], a[28:31]
    ds_read_b128 a[220:223], v131 offset:53248
    v_add_f32 v112, v154, v155
    v_cvt_pk_bf16_f32 v80, v154, v155
    v_mfma_f32_16x16x32_bf16 a[32:35], a[224:227], v[68:71], a[32:35]
    v_exp_f32 v158, v36
    v_mfma_f32_16x16x32_bf16 a[36:39], a[228:231], v[68:71], a[36:39]
    buffer_load_dwordx4 v144, s[12:15], s52 offen offset:0 lds
    v_add_f32 v112, v112, v156
    v_mfma_f32_16x16x32_bf16 a[40:43], a[232:235], v[68:71], a[40:43]
    v_exp_f32 v159, v37
    v_mfma_f32_16x16x32_bf16 a[44:47], a[236:239], v[68:71], a[44:47]
    v_add_f32 v112, v112, v157
    v_cvt_pk_bf16_f32 v81, v156, v157
    v_cmp_lt_f32 vcc, s55, v163
    v_mfma_f32_16x16x32_bf16 a[48:51], a[240:243], v[68:71], a[48:51]
    v_exp_f32 v160, v38
    v_mfma_f32_16x16x32_bf16 a[52:55], a[244:247], v[68:71], a[52:55]
    buffer_load_dwordx4 v145, s[12:15], s52 offen offset:1024 lds
    v_add_f32 v112, v112, v158
    v_mfma_f32_16x16x32_bf16 a[56:59], a[248:251], v[68:71], a[56:59]
    v_exp_f32 v161, v39
    v_mfma_f32_16x16x32_bf16 a[60:63], a[252:255], v[68:71], a[60:63]
    v_add_f32 v112, v112, v159
    v_cvt_pk_bf16_f32 v82, v158, v159
    s_cbranch_vccnz L_attn_r4_1
L_attn_r4_1_back:
    v_mfma_f32_16x16x32_bf16 a[64:67], a[224:227], v[72:75], a[64:67]
    v_exp_f32 v154, v40
    v_mfma_f32_16x16x32_bf16 a[68:71], a[228:231], v[72:75], a[68:71]
    buffer_load_dwordx4 v146, s[12:15], s52 offen offset:2048 lds
    v_add_f32 v112, v112, v160
    v_mfma_f32_16x16x32_bf16 a[72:75], a[232:235], v[72:75], a[72:75]
    v_exp_f32 v155, v41
    v_mfma_f32_16x16x32_bf16 a[76:79], a[236:239], v[72:75], a[76:79]
    v_add_f32 v112, v112, v161
    v_cvt_pk_bf16_f32 v83, v160, v161
    v_mfma_f32_16x16x32_bf16 a[80:83], a[240:243], v[72:75], a[80:83]
    v_exp_f32 v156, v42
    v_mfma_f32_16x16x32_bf16 a[84:87], a[244:247], v[72:75], a[84:87]
    buffer_load_dwordx4 v147, s[12:15], s52 offen offset:3072 lds
    v_add_f32 v117, v117, v113
    v_mfma_f32_16x16x32_bf16 a[88:91], a[248:251], v[72:75], a[88:91]
    v_exp_f32 v157, v43
    v_mfma_f32_16x16x32_bf16 a[92:95], a[252:255], v[72:75], a[92:95]
    v_add_f32 v113, v154, v155
    v_cvt_pk_bf16_f32 v84, v154, v155
    v_mfma_f32_16x16x32_bf16 a[96:99], a[224:227], v[76:79], a[96:99]
    v_exp_f32 v158, v44
    v_mfma_f32_16x16x32_bf16 a[100:103], a[228:231], v[76:79], a[100:103]
    ds_read_b64_tr_b16 a[224:225], v132 offset:40960
    v_add_f32 v113, v113, v156
    v_mfma_f32_16x16x32_bf16 a[104:107], a[232:235], v[76:79], a[104:107]
    v_exp_f32 v159, v45
    v_mfma_f32_16x16x32_bf16 a[108:111], a[236:239], v[76:79], a[108:111]
    ds_read_b64_tr_b16 a[226:227], v132 offset:45056
    v_add_f32 v113, v113, v157
    v_cvt_pk_bf16_f32 v85, v156, v157
    v_mfma_f32_16x16x32_bf16 a[112:115], a[240:243], v[76:79], a[112:115]
    v_exp_f32 v160, v46
    v_mfma_f32_16x16x32_bf16 a[116:119], a[244:247], v[76:79], a[116:119]
    ds_read_b64_tr_b16 a[228:229], v133 offset:40960
    v_add_f32 v113, v113, v158
    v_mfma_f32_16x16x32_bf16 a[120:123], a[248:251], v[76:79], a[120:123]
    v_exp_f32 v161, v47
    v_mfma_f32_16x16x32_bf16 a[124:127], a[252:255], v[76:79], a[124:127]
    ds_read_b64_tr_b16 a[230:231], v133 offset:45056
    v_add_f32 v113, v113, v159
    v_cvt_pk_bf16_f32 v86, v158, v159
    s_waitcnt lgkmcnt(4)
    v_mfma_f32_16x16x32_bf16 v[0:3], a[192:195], a[128:131], v[96:99]
    v_exp_f32 v154, v48
    v_mfma_f32_16x16x32_bf16 v[0:3], a[196:199], a[132:135], v[0:3]
    ds_read_b64_tr_b16 a[232:233], v134 offset:40960
    v_add_f32 v113, v113, v160
    v_mfma_f32_16x16x32_bf16 v[0:3], a[200:203], a[136:139], v[0:3]
    v_exp_f32 v155, v49
    v_mfma_f32_16x16x32_bf16 v[0:3], a[204:207], a[140:143], v[0:3]
    ds_read_b64_tr_b16 a[234:235], v134 offset:45056
    v_add_f32 v113, v113, v161
    v_cvt_pk_bf16_f32 v87, v160, v161
    v_mfma_f32_16x16x32_bf16 v[4:7], a[208:211], a[128:131], v[96:99]
    v_exp_f32 v156, v50
    v_mfma_f32_16x16x32_bf16 v[4:7], a[212:215], a[132:135], v[4:7]
    ds_read_b64_tr_b16 a[236:237], v135 offset:40960
    v_add_f32 v118, v118, v114
    v_mfma_f32_16x16x32_bf16 v[4:7], a[216:219], a[136:139], v[4:7]
    v_exp_f32 v157, v51
    v_mfma_f32_16x16x32_bf16 v[4:7], a[220:223], a[140:143], v[4:7]
    ds_read_b64_tr_b16 a[238:239], v135 offset:45056
    v_add_f32 v114, v154, v155
    v_cvt_pk_bf16_f32 v88, v154, v155
    v_mfma_f32_16x16x32_bf16 v[8:11], a[192:195], a[144:147], v[100:103]
    v_exp_f32 v158, v52
    v_mfma_f32_16x16x32_bf16 v[8:11], a[196:199], a[148:151], v[8:11]
    ds_read_b64_tr_b16 a[240:241], v136 offset:40960
    v_add_f32 v114, v114, v156
    v_max_f32 v162, v112, v113
    v_mfma_f32_16x16x32_bf16 v[8:11], a[200:203], a[152:155], v[8:11]
    v_exp_f32 v159, v53
    v_mfma_f32_16x16x32_bf16 v[8:11], a[204:207], a[156:159], v[8:11]
    ds_read_b64_tr_b16 a[242:243], v136 offset:45056
    v_add_f32 v114, v114, v157
    v_cvt_pk_bf16_f32 v89, v156, v157
    v_mfma_f32_16x16x32_bf16 v[12:15], a[208:211], a[144:147], v[100:103]
    v_exp_f32 v160, v54
    v_mfma_f32_16x16x32_bf16 v[12:15], a[212:215], a[148:151], v[12:15]
    ds_read_b64_tr_b16 a[244:245], v137 offset:40960
    v_add_f32 v114, v114, v158
    v_cmp_lt_f32 vcc, s55, v162
    v_mfma_f32_16x16x32_bf16 v[12:15], a[216:219], a[152:155], v[12:15]
    v_exp_f32 v161, v55
    v_mfma_f32_16x16x32_bf16 v[12:15], a[220:223], a[156:159], v[12:15]
    ds_read_b64_tr_b16 a[246:247], v137 offset:45056
    v_add_f32 v114, v114, v159
    v_cvt_pk_bf16_f32 v90, v158, v159
    v_mfma_f32_16x16x32_bf16 v[16:19], a[192:195], a[160:163], v[104:107]
    v_exp_f32 v154, v56
    v_mfma_f32_16x16x32_bf16 v[16:19], a[196:199], a[164:167], v[16:19]
    ds_read_b64_tr_b16 a[248:249], v138 offset:40960
    v_add_f32 v114, v114, v160
    v_mfma_f32_16x16x32_bf16 v[16:19], a[200:203], a[168:171], v[16:19]
    v_exp_f32 v155, v57
    v_mfma_f32_16x16x32_bf16 v[16:19], a[204:207], a[172:175], v[16:19]
    ds_read_b64_tr_b16 a[250:251], v138 offset:45056
    v_add_f32 v114, v114, v161
    v_cvt_pk_bf16_f32 v91, v160, v161
    v_mfma_f32_16x16x32_bf16 v[20:23], a[208:211], a[160:163], v[104:107]
    v_exp_f32 v156, v58
    v_mfma_f32_16x16x32_bf16 v[20:23], a[212:215], a[164:167], v[20:23]
    ds_read_b64_tr_b16 a[252:253], v139 offset:40960
    v_add_f32 v119, v119, v115
    s_cbranch_vccnz L_attn_r5_0
L_attn_r5_0_back:
    v_mfma_f32_16x16x32_bf16 v[20:23], a[216:219], a[168:171], v[20:23]
    v_exp_f32 v157, v59
    v_mfma_f32_16x16x32_bf16 v[20:23], a[220:223], a[172:175], v[20:23]
    ds_read_b64_tr_b16 a[254:255], v139 offset:45056
    v_add_f32 v115, v154, v155
    v_cvt_pk_bf16_f32 v92, v154, v155
    v_mfma_f32_16x16x32_bf16 v[24:27], a[192:195], a[176:179], v[108:111]
    v_exp_f32 v158, v60
    v_mfma_f32_16x16x32_bf16 v[24:27], a[196:199], a[180:183], v[24:27]
    ds_read_b128 a[192:195], v128 offset:57344
    v_add_f32 v115, v115, v156
    v_mfma_f32_16x16x32_bf16 v[24:27], a[200:203], a[184:187], v[24:27]
    s_add_u32 s64, s66, s61
    v_exp_f32 v159, v61
    v_mfma_f32_16x16x32_bf16 v[24:27], a[204:207], a[188:191], v[24:27]
    ds_read_b128 a[196:199], v129 offset:57344
    v_add_f32 v115, v115, v157
    v_cvt_pk_bf16_f32 v93, v156, v157
    v_mfma_f32_16x16x32_bf16 v[28:31], a[208:211], a[176:179], v[108:111]
    s_and_b32 s64, s64, 3
    v_exp_f32 v160, v62
    v_mfma_f32_16x16x32_bf16 v[28:31], a[212:215], a[180:183], v[28:31]
    ds_read_b128 a[200:203], v130 offset:57344
    v_add_f32 v115, v115, v158
    v_mfma_f32_16x16x32_bf16 v[28:31], a[216:219], a[184:187], v[28:31]
    s_andn2_b32 s67, s66, 3
    v_exp_f32 v161, v63
    v_mfma_f32_16x16x32_bf16 v[28:31], a[220:223], a[188:191], v[28:31]
    ds_read_b128 a[204:207], v131 offset:57344
    v_add_f32 v115, v115, v159
    v_cvt_pk_bf16_f32 v94, v158, v159
    s_waitcnt lgkmcnt(4)
    v_mfma_f32_16x16x32_bf16 a[0:3], a[224:227], v[80:83], a[0:3]
    s_or_b32 s64, s64, s67
    v_exp_f32 v154, v0
    v_mfma_f32_16x16x32_bf16 a[4:7], a[228:231], v[80:83], a[4:7]
    ds_read_b128 a[208:211], v128 offset:61440
    v_add_f32 v115, v115, v160
    v_mfma_f32_16x16x32_bf16 a[8:11], a[232:235], v[80:83], a[8:11]
    s_add_u32 s66, s66, 1
    v_exp_f32 v155, v1
    v_mfma_f32_16x16x32_bf16 a[12:15], a[236:239], v[80:83], a[12:15]
    ds_read_b128 a[212:215], v129 offset:61440
    v_add_f32 v115, v115, v161
    v_cvt_pk_bf16_f32 v95, v160, v161
    v_mfma_f32_16x16x32_bf16 a[16:19], a[240:243], v[80:83], a[16:19]
    s_lshl_b32 s53, s64, 14
    v_exp_f32 v156, v2
    v_mfma_f32_16x16x32_bf16 a[20:23], a[244:247], v[80:83], a[20:23]
    ds_read_b128 a[216:219], v130 offset:61440
    v_add_f32 v116, v116, v112
    v_max_f32 v163, v114, v115
    v_mfma_f32_16x16x32_bf16 a[24:27], a[248:251], v[80:83], a[24:27]
    s_mov_b32 m0, s49
    v_exp_f32 v157, v3
    v_mfma_f32_16x16x32_bf16 a[28:31], a[252:255], v[80:83], a[28:31]
    ds_read_b128 a[220:223], v131 offset:61440
    v_add_f32 v112, v154, v155
    v_cvt_pk_bf16_f32 v64, v154, v155
    v_mfma_f32_16x16x32_bf16 a[32:35], a[224:227], v[84:87], a[32:35]
    v_exp_f32 v158, v4
    v_mfma_f32_16x16x32_bf16 a[36:39], a[228:231], v[84:87], a[36:39]
    buffer_load_dwordx4 v148, s[16:19], s53 offen offset:0 lds
    v_add_f32 v112, v112, v156
    v_mfma_f32_16x16x32_bf16 a[40:43], a[232:235], v[84:87], a[40:43]
    v_exp_f32 v159, v5
    v_mfma_f32_16x16x32_bf16 a[44:47], a[236:239], v[84:87], a[44:47]
    v_add_f32 v112, v112, v157
    v_cvt_pk_bf16_f32 v65, v156, v157
    v_cmp_lt_f32 vcc, s55, v163
    v_mfma_f32_16x16x32_bf16 a[48:51], a[240:243], v[84:87], a[48:51]
    v_exp_f32 v160, v6
    v_mfma_f32_16x16x32_bf16 a[52:55], a[244:247], v[84:87], a[52:55]
    buffer_load_dwordx4 v197, s[16:19], s53 offen offset:1024 lds
    v_add_f32 v112, v112, v158
    v_mfma_f32_16x16x32_bf16 a[56:59], a[248:251], v[84:87], a[56:59]
    v_exp_f32 v161, v7
    v_mfma_f32_16x16x32_bf16 a[60:63], a[252:255], v[84:87], a[60:63]
    buffer_load_dword v193, v192, s[84:87], s69 offen offset:0
    v_add_f32 v112, v112, v159
    v_cvt_pk_bf16_f32 v66, v158, v159
    s_cbranch_vccnz L_attn_r5_1
L_attn_r5_1_back:
    v_mfma_f32_16x16x32_bf16 a[64:67], a[224:227], v[88:91], a[64:67]
    v_exp_f32 v154, v8
    v_mfma_f32_16x16x32_bf16 a[68:71], a[228:231], v[88:91], a[68:71]
    buffer_load_dwordx4 v148, s[16:19], s53 offen offset:2048 lds
    v_add_f32 v112, v112, v160
    v_mfma_f32_16x16x32_bf16 a[72:75], a[232:235], v[88:91], a[72:75]
    v_exp_f32 v155, v9
    v_mfma_f32_16x16x32_bf16 a[76:79], a[236:239], v[88:91], a[76:79]
    v_add_f32 v112, v112, v161
    v_cvt_pk_bf16_f32 v67, v160, v161
    v_mfma_f32_16x16x32_bf16 a[80:83], a[240:243], v[88:91], a[80:83]
    v_exp_f32 v156, v10
    v_mfma_f32_16x16x32_bf16 a[84:87], a[244:247], v[88:91], a[84:87]
    buffer_load_dwordx4 v197, s[16:19], s53 offen offset:3072 lds
    v_add_f32 v117, v117, v113
    v_mfma_f32_16x16x32_bf16 a[88:91], a[248:251], v[88:91], a[88:91]
    v_exp_f32 v157, v11
    v_mfma_f32_16x16x32_bf16 a[92:95], a[252:255], v[88:91], a[92:95]
    v_add_f32 v113, v154, v155
    v_cvt_pk_bf16_f32 v68, v154, v155
    v_mfma_f32_16x16x32_bf16 a[96:99], a[224:227], v[92:95], a[96:99]
    v_exp_f32 v158, v12
    v_mfma_f32_16x16x32_bf16 a[100:103], a[228:231], v[92:95], a[100:103]
    ds_read_b64_tr_b16 a[224:225], v132 offset:49152
    v_add_f32 v113, v113, v156
    v_mfma_f32_16x16x32_bf16 a[104:107], a[232:235], v[92:95], a[104:107]
    v_exp_f32 v159, v13
    v_mfma_f32_16x16x32_bf16 a[108:111], a[236:239], v[92:95], a[108:111]
    ds_read_b64_tr_b16 a[226:227], v132 offset:53248
    v_add_f32 v113, v113, v157
    v_cvt_pk_bf16_f32 v69, v156, v157
    v_mfma_f32_16x16x32_bf16 a[112:115], a[240:243], v[92:95], a[112:115]
    v_exp_f32 v160, v14
    v_mfma_f32_16x16x32_bf16 a[116:119], a[244:247], v[92:95], a[116:119]
    ds_read_b64_tr_b16 a[228:229], v133 offset:49152
    v_add_f32 v113, v113, v158
    v_mfma_f32_16x16x32_bf16 a[120:123], a[248:251], v[92:95], a[120:123]
    v_exp_f32 v161, v15
    v_mfma_f32_16x16x32_bf16 a[124:127], a[252:255], v[92:95], a[124:127]
    ds_read_b64_tr_b16 a[230:231], v133 offset:53248
    v_add_f32 v113, v113, v159
    v_cvt_pk_bf16_f32 v70, v158, v159
    s_waitcnt lgkmcnt(4)
    v_mfma_f32_16x16x32_bf16 v[32:35], a[192:195], a[128:131], v[96:99]
    v_exp_f32 v154, v16
    v_mfma_f32_16x16x32_bf16 v[32:35], a[196:199], a[132:135], v[32:35]
    ds_read_b64_tr_b16 a[232:233], v134 offset:49152
    v_add_f32 v113, v113, v160
    v_mfma_f32_16x16x32_bf16 v[32:35], a[200:203], a[136:139], v[32:35]
    v_exp_f32 v155, v17
    v_mfma_f32_16x16x32_bf16 v[32:35], a[204:207], a[140:143], v[32:35]
    ds_read_b64_tr_b16 a[234:235], v134 offset:53248
    v_add_f32 v113, v113, v161
    v_cvt_pk_bf16_f32 v71, v160, v161
    v_mfma_f32_16x16x32_bf16 v[36:39], a[208:211], a[128:131], v[96:99]
    v_exp_f32 v156, v18
    v_mfma_f32_16x16x32_bf16 v[36:39], a[212:215], a[132:135], v[36:39]
    ds_read_b64_tr_b16 a[236:237], v135 offset:49152
    v_add_f32 v118, v118, v114
    v_mfma_f32_16x16x32_bf16 v[36:39], a[216:219], a[136:139], v[36:39]
    v_exp_f32 v157, v19
    v_mfma_f32_16x16x32_bf16 v[36:39], a[220:223], a[140:143], v[36:39]
    ds_read_b64_tr_b16 a[238:239], v135 offset:53248
    v_add_f32 v114, v154, v155
    v_cvt_pk_bf16_f32 v72, v154, v155
    v_mfma_f32_16x16x32_bf16 v[40:43], a[192:195], a[144:147], v[100:103]
    v_exp_f32 v158, v20
    v_mfma_f32_16x16x32_bf16 v[40:43], a[196:199], a[148:151], v[40:43]
    ds_read_b64_tr_b16 a[240:241], v136 offset:49152
    v_add_f32 v114, v114, v156
    v_max_f32 v162, v112, v113
    v_mfma_f32_16x16x32_bf16 v[40:43], a[200:203], a[152:155], v[40:43]
    v_exp_f32 v159, v21
    v_mfma_f32_16x16x32_bf16 v[40:43], a[204:207], a[156:159], v[40:43]
    ds_read_b64_tr_b16 a[242:243], v136 offset:53248
    v_add_f32 v114, v114, v157
    v_cvt_pk_bf16_f32 v73, v156, v157
    v_mfma_f32_16x16x32_bf16 v[44:47], a[208:211], a[144:147], v[100:103]
    v_exp_f32 v160, v22
    v_mfma_f32_16x16x32_bf16 v[44:47], a[212:215], a[148:151], v[44:47]
    ds_read_b64_tr_b16 a[244:245], v137 offset:49152
    v_add_f32 v114, v114, v158
    v_cmp_lt_f32 vcc, s55, v162
    v_mfma_f32_16x16x32_bf16 v[44:47], a[216:219], a[152:155], v[44:47]
    v_exp_f32 v161, v23
    v_mfma_f32_16x16x32_bf16 v[44:47], a[220:223], a[156:159], v[44:47]
    ds_read_b64_tr_b16 a[246:247], v137 offset:53248
    v_add_f32 v114, v114, v159
    v_cvt_pk_bf16_f32 v74, v158, v159
    v_mfma_f32_16x16x32_bf16 v[48:51], a[192:195], a[160:163], v[104:107]
    v_exp_f32 v154, v24
    v_mfma_f32_16x16x32_bf16 v[48:51], a[196:199], a[164:167], v[48:51]
    ds_read_b64_tr_b16 a[248:249], v138 offset:49152
    v_add_f32 v114, v114, v160
    v_mfma_f32_16x16x32_bf16 v[48:51], a[200:203], a[168:171], v[48:51]
    v_exp_f32 v155, v25
    v_mfma_f32_16x16x32_bf16 v[48:51], a[204:207], a[172:175], v[48:51]
    ds_read_b64_tr_b16 a[250:251], v138 offset:53248
    v_add_f32 v114, v114, v161
    v_cvt_pk_bf16_f32 v75, v160, v161
    v_mfma_f32_16x16x32_bf16 v[52:55], a[208:211], a[160:163], v[104:107]
    v_exp_f32 v156, v26
    v_mfma_f32_16x16x32_bf16 v[52:55], a[212:215], a[164:167], v[52:55]
    ds_read_b64_tr_b16 a[252:253], v139 offset:49152
    v_add_f32 v119, v119, v115
    s_cbranch_vccnz L_attn_r6_0
L_attn_r6_0_back:
    v_mfma_f32_16x16x32_bf16 v[52:55], a[216:219], a[168:171], v[52:55]
    v_exp_f32 v157, v27
    v_mfma_f32_16x16x32_bf16 v[52:55], a[220:223], a[172:175], v[52:55]
    ds_read_b64_tr_b16 a[254:255], v139 offset:53248
    v_add_f32 v115, v154, v155
    v_cvt_pk_bf16_f32 v76, v154, v155
    s_waitcnt vmcnt(9)
    s_barrier
    v_mfma_f32_16x16x32_bf16 v[56:59], a[192:195], a[176:179], v[108:111]
    v_exp_f32 v158, v28
    v_mfma_f32_16x16x32_bf16 v[56:59], a[196:199], a[180:183], v[56:59]
    ds_read_b128 a[192:195], v128 offset:0
    v_add_f32 v115, v115, v156
    v_mfma_f32_16x16x32_bf16 v[56:59], a[200:203], a[184:187], v[56:59]
    s_add_u32 s64, s65, s61
    v_exp_f32 v159, v29
    v_mfma_f32_16x16x32_bf16 v[56:59], a[204:207], a[188:191], v[56:59]
    ds_read_b128 a[196:199], v129 offset:0
    v_add_f32 v115, v115, v157
    v_cvt_pk_bf16_f32 v77, v156, v157
    v_mfma_f32_16x16x32_bf16 v[60:63], a[208:211], a[176:179], v[108:111]
    s_and_b32 s64, s64, 3
    v_exp_f32 v160, v30
    v_mfma_f32_16x16x32_bf16 v[60:63], a[212:215], a[180:183], v[60:63]
    ds_read_b128 a[200:203], v130 offset:0
    v_add_f32 v115, v115, v158
    v_mfma_f32_16x16x32_bf16 v[60:63], a[216:219], a[184:187], v[60:63]
    s_andn2_b32 s67, s65, 3
    v_exp_f32 v161, v31
    v_mfma_f32_16x16x32_bf16 v[60:63], a[220:223], a[188:191], v[60:63]
    ds_read_b128 a[204:207], v131 offset:0
    v_add_f32 v115, v115, v159
    v_cvt_pk_bf16_f32 v78, v158, v159
    s_waitcnt lgkmcnt(4)
    v_mfma_f32_16x16x32_bf16 a[0:3], a[224:227], v[64:67], a[0:3]
    s_or_b32 s64, s64, s67
    v_exp_f32 v154, v32
    v_mfma_f32_16x16x32_bf16 a[4:7], a[228:231], v[64:67], a[4:7]
    ds_read_b128 a[208:211], v128 offset:4096
    v_add_f32 v115, v115, v160
    v_mfma_f32_16x16x32_bf16 a[8:11], a[232:235], v[64:67], a[8:11]
    s_add_u32 s65, s65, 1
    v_exp_f32 v155, v33
    v_mfma_f32_16x16x32_bf16 a[12:15], a[236:239], v[64:67], a[12:15]
    ds_read_b128 a[212:215], v129 offset:4096
    v_add_f32 v115, v115, v161
    v_cvt_pk_bf16_f32 v79, v160, v161
    v_mfma_f32_16x16x32_bf16 a[16:19], a[240:243], v[64:67], a[16:19]
    s_lshl_b32 s52, s64, 14
    v_exp_f32 v156, v34
    v_mfma_f32_16x16x32_bf16 a[20:23], a[244:247], v[64:67], a[20:23]
    ds_read_b128 a[216:219], v130 offset:4096
    v_add_f32 v116, v116, v112
    v_max_f32 v163, v114, v115
    v_mfma_f32_16x16x32_bf16 a[24:27], a[248:251], v[64:67], a[24:27]
    s_mov_b32 m0, s46
    v_exp_f32 v157, v35
    v_mfma_f32_16x16x32_bf16 a[28:31], a[252:255], v[64:67], a[28:31]
    ds_read_b128 a[220:223], v131 offset:4096
    v_add_f32 v112, v154, v155
    v_cvt_pk_bf16_f32 v80, v154, v155
    v_mfma_f32_16x16x32_bf16 a[32:35], a[224:227], v[68:71], a[32:35]
    v_exp_f32 v158, v36
    v_mfma_f32_16x16x32_bf16 a[36:39], a[228:231], v[68:71], a[36:39]
    buffer_load_dwordx4 v144, s[12:15], s52 offen offset:0 lds
    v_add_f32 v112, v112, v156
    v_mfma_f32_16x16x32_bf16 a[40:43], a[232:235], v[68:71], a[40:43]
    v_exp_f32 v159, v37
    v_mfma_f32_16x16x32_bf16 a[44:47], a[236:239], v[68:71], a[44:47]
    v_add_f32 v112, v112, v157
    v_cvt_pk_bf16_f32 v81, v156, v157
    v_cmp_lt_f32 vcc, s55, v163
    v_mfma_f32_16x16x32_bf16 a[48:51], a[240:243], v[68:71], a[48:51]
    v_exp_f32 v160, v38
    v_mfma_f32_16x16x32_bf16 a[52:55], a[244:247], v[68:71], a[52:55]
    buffer_load_dwordx4 v145, s[12:15], s52 offen offset:1024 lds
    v_add_f32 v112, v112, v158
    v_mfma_f32_16x16x32_bf16 a[56:59], a[248:251], v[68:71], a[56:59]
    v_exp_f32 v161, v39
    v_mfma_f32_16x16x32_bf16 a[60:63], a[252:255], v[68:71], a[60:63]
    v_add_f32 v112, v112, v159
    v_cvt_pk_bf16_f32 v82, v158, v159
    s_cbranch_vccnz L_attn_r6_1
L_attn_r6_1_back:
    v_mfma_f32_16x16x32_bf16 a[64:67], a[224:227], v[72:75], a[64:67]
    v_exp_f32 v154, v40
    v_mfma_f32_16x16x32_bf16 a[68:71], a[228:231], v[72:75], a[68:71]
    buffer_load_dwordx4 v146, s[12:15], s52 offen offset:2048 lds
    v_add_f32 v112, v112, v160
    v_mfma_f32_16x16x32_bf16 a[72:75], a[232:235], v[72:75], a[72:75]
    v_exp_f32 v155, v41
    v_mfma_f32_16x16x32_bf16 a[76:79], a[236:239], v[72:75], a[76:79]
    v_add_f32 v112, v112, v161
    v_cvt_pk_bf16_f32 v83, v160, v161
    v_mfma_f32_16x16x32_bf16 a[80:83], a[240:243], v[72:75], a[80:83]
    v_exp_f32 v156, v42
    v_mfma_f32_16x16x32_bf16 a[84:87], a[244:247], v[72:75], a[84:87]
    buffer_load_dwordx4 v147, s[12:15], s52 offen offset:3072 lds
    v_add_f32 v117, v117, v113
    v_mfma_f32_16x16x32_bf16 a[88:91], a[248:251], v[72:75], a[88:91]
    v_exp_f32 v157, v43
    v_mfma_f32_16x16x32_bf16 a[92:95], a[252:255], v[72:75], a[92:95]
    v_add_f32 v113, v154, v155
    v_cvt_pk_bf16_f32 v84, v154, v155
    v_mfma_f32_16x16x32_bf16 a[96:99], a[224:227], v[76:79], a[96:99]
    v_exp_f32 v158, v44
    v_mfma_f32_16x16x32_bf16 a[100:103], a[228:231], v[76:79], a[100:103]
    ds_read_b64_tr_b16 a[224:225], v132 offset:57344
    v_add_f32 v113, v113, v156
    v_mfma_f32_16x16x32_bf16 a[104:107], a[232:235], v[76:79], a[104:107]
    v_exp_f32 v159, v45
    v_mfma_f32_16x16x32_bf16 a[108:111], a[236:239], v[76:79], a[108:111]
    ds_read_b64_tr_b16 a[226:227], v132 offset:61440
    v_add_f32 v113, v113, v157
    v_cvt_pk_bf16_f32 v85, v156, v157
    v_mfma_f32_16x16x32_bf16 a[112:115], a[240:243], v[76:79], a[112:115]
    v_exp_f32 v160, v46
    v_mfma_f32_16x16x32_bf16 a[116:119], a[244:247], v[76:79], a[116:119]
    ds_read_b64_tr_b16 a[228:229], v133 offset:57344
    v_add_f32 v113, v113, v158
    v_mfma_f32_16x16x32_bf16 a[120:123], a[248:251], v[76:79], a[120:123]
    v_exp_f32 v161, v47
    v_mfma_f32_16x16x32_bf16 a[124:127], a[252:255], v[76:79], a[124:127]
    ds_read_b64_tr_b16 a[230:231], v133 offset:61440
    v_add_f32 v113, v113, v159
    v_cvt_pk_bf16_f32 v86, v158, v159
    s_waitcnt lgkmcnt(4)
    v_mfma_f32_16x16x32_bf16 v[0:3], a[192:195], a[128:131], v[96:99]
    v_exp_f32 v154, v48
    v_mfma_f32_16x16x32_bf16 v[0:3], a[196:199], a[132:135], v[0:3]
    ds_read_b64_tr_b16 a[232:233], v134 offset:57344
    v_add_f32 v113, v113, v160
    v_mfma_f32_16x16x32_bf16 v[0:3], a[200:203], a[136:139], v[0:3]
    v_exp_f32 v155, v49
    v_mfma_f32_16x16x32_bf16 v[0:3], a[204:207], a[140:143], v[0:3]
    ds_read_b64_tr_b16 a[234:235], v134 offset:61440
    v_add_f32 v113, v113, v161
    v_cvt_pk_bf16_f32 v87, v160, v161
    v_mfma_f32_16x16x32_bf16 v[4:7], a[208:211], a[128:131], v[96:99]
    v_exp_f32 v156, v50
    v_mfma_f32_16x16x32_bf16 v[4:7], a[212:215], a[132:135], v[4:7]
    ds_read_b64_tr_b16 a[236:237], v135 offset:57344
    v_add_f32 v118, v118, v114
    v_mfma_f32_16x16x32_bf16 v[4:7], a[216:219], a[136:139], v[4:7]
    v_exp_f32 v157, v51
    v_mfma_f32_16x16x32_bf16 v[4:7], a[220:223], a[140:143], v[4:7]
    ds_read_b64_tr_b16 a[238:239], v135 offset:61440
    v_add_f32 v114, v154, v155
    v_cvt_pk_bf16_f32 v88, v154, v155
    v_mfma_f32_16x16x32_bf16 v[8:11], a[192:195], a[144:147], v[100:103]
    v_exp_f32 v158, v52
    v_mfma_f32_16x16x32_bf16 v[8:11], a[196:199], a[148:151], v[8:11]
    ds_read_b64_tr_b16 a[240:241], v136 offset:57344
    v_add_f32 v114, v114, v156
    v_max_f32 v162, v112, v113
    v_mfma_f32_16x16x32_bf16 v[8:11], a[200:203], a[152:155], v[8:11]
    v_exp_f32 v159, v53
    v_mfma_f32_16x16x32_bf16 v[8:11], a[204:207], a[156:159], v[8:11]
    ds_read_b64_tr_b16 a[242:243], v136 offset:61440
    v_add_f32 v114, v114, v157
    v_cvt_pk_bf16_f32 v89, v156, v157
    v_mfma_f32_16x16x32_bf16 v[12:15], a[208:211], a[144:147], v[100:103]
    v_exp_f32 v160, v54
    v_mfma_f32_16x16x32_bf16 v[12:15], a[212:215], a[148:151], v[12:15]
    ds_read_b64_tr_b16 a[244:245], v137 offset:57344
    v_add_f32 v114, v114, v158
    v_cmp_lt_f32 vcc, s55, v162
    v_mfma_f32_16x16x32_bf16 v[12:15], a[216:219], a[152:155], v[12:15]
    v_exp_f32 v161, v55
    v_mfma_f32_16x16x32_bf16 v[12:15], a[220:223], a[156:159], v[12:15]
    ds_read_b64_tr_b16 a[246:247], v137 offset:61440
    v_add_f32 v114, v114, v159
    v_cvt_pk_bf16_f32 v90, v158, v159
    v_mfma_f32_16x16x32_bf16 v[16:19], a[192:195], a[160:163], v[104:107]
    v_exp_f32 v154, v56
    v_mfma_f32_16x16x32_bf16 v[16:19], a[196:199], a[164:167], v[16:19]
    ds_read_b64_tr_b16 a[248:249], v138 offset:57344
    v_add_f32 v114, v114, v160
    v_mfma_f32_16x16x32_bf16 v[16:19], a[200:203], a[168:171], v[16:19]
    v_exp_f32 v155, v57
    v_mfma_f32_16x16x32_bf16 v[16:19], a[204:207], a[172:175], v[16:19]
    ds_read_b64_tr_b16 a[250:251], v138 offset:61440
    v_add_f32 v114, v114, v161
    v_cvt_pk_bf16_f32 v91, v160, v161
    v_mfma_f32_16x16x32_bf16 v[20:23], a[208:211], a[160:163], v[104:107]
    v_exp_f32 v156, v58
    v_mfma_f32_16x16x32_bf16 v[20:23], a[212:215], a[164:167], v[20:23]
    ds_read_b64_tr_b16 a[252:253], v139 offset:57344
    v_add_f32 v119, v119, v115
    s_cbranch_vccnz L_attn_r7_0
L_attn_r7_0_back:
    v_mfma_f32_16x16x32_bf16 v[20:23], a[216:219], a[168:171], v[20:23]
    v_exp_f32 v157, v59
    v_mfma_f32_16x16x32_bf16 v[20:23], a[220:223], a[172:175], v[20:23]
    ds_read_b64_tr_b16 a[254:255], v139 offset:61440
    v_add_f32 v115, v154, v155
    v_cvt_pk_bf16_f32 v92, v154, v155
    v_mfma_f32_16x16x32_bf16 v[24:27], a[192:195], a[176:179], v[108:111]
    v_exp_f32 v158, v60
    v_mfma_f32_16x16x32_bf16 v[24:27], a[196:199], a[180:183], v[24:27]
    ds_read_b128 a[192:195], v128 offset:8192
    v_add_f32 v115, v115, v156
    v_mfma_f32_16x16x32_bf16 v[24:27], a[200:203], a[184:187], v[24:27]
    s_add_u32 s64, s66, s61
    v_exp_f32 v159, v61
    v_mfma_f32_16x16x32_bf16 v[24:27], a[204:207], a[188:191], v[24:27]
    ds_read_b128 a[196:199], v129 offset:8192
    v_add_f32 v115, v115, v157
    v_cvt_pk_bf16_f32 v93, v156, v157
    v_mfma_f32_16x16x32_bf16 v[28:31], a[208:211], a[176:179], v[108:111]
    s_and_b32 s64, s64, 3
    v_exp_f32 v160, v62
    v_mfma_f32_16x16x32_bf16 v[28:31], a[212:215], a[180:183], v[28:31]
    ds_read_b128 a[200:203], v130 offset:8192
    v_add_f32 v115, v115, v158
    v_mfma_f32_16x16x32_bf16 v[28:31], a[216:219], a[184:187], v[28:31]
    s_andn2_b32 s67, s66, 3
    v_exp_f32 v161, v63
    v_mfma_f32_16x16x32_bf16 v[28:31], a[220:223], a[188:191], v[28:31]
    ds_read_b128 a[204:207], v131 offset:8192
    v_add_f32 v115, v115, v159
    v_cvt_pk_bf16_f32 v94, v158, v159
    s_waitcnt lgkmcnt(4)
    v_mfma_f32_16x16x32_bf16 a[0:3], a[224:227], v[80:83], a[0:3]
    s_or_b32 s64, s64, s67
    v_exp_f32 v154, v0
    v_mfma_f32_16x16x32_bf16 a[4:7], a[228:231], v[80:83], a[4:7]
    ds_read_b128 a[208:211], v128 offset:12288
    v_add_f32 v115, v115, v160
    v_mfma_f32_16x16x32_bf16 a[8:11], a[232:235], v[80:83], a[8:11]
    s_add_u32 s66, s66, 1
    v_exp_f32 v155, v1
    v_mfma_f32_16x16x32_bf16 a[12:15], a[236:239], v[80:83], a[12:15]
    ds_read_b128 a[212:215], v129 offset:12288
    v_add_f32 v115, v115, v161
    v_cvt_pk_bf16_f32 v95, v160, v161
    v_mfma_f32_16x16x32_bf16 a[16:19], a[240:243], v[80:83], a[16:19]
    s_lshl_b32 s53, s64, 14
    v_exp_f32 v156, v2
    v_mfma_f32_16x16x32_bf16 a[20:23], a[244:247], v[80:83], a[20:23]
    ds_read_b128 a[216:219], v130 offset:12288
    v_add_f32 v116, v116, v112
    v_max_f32 v163, v114, v115
    v_mfma_f32_16x16x32_bf16 a[24:27], a[248:251], v[80:83], a[24:27]
    s_mov_b32 m0, s50
    v_exp_f32 v157, v3
    v_mfma_f32_16x16x32_bf16 a[28:31], a[252:255], v[80:83], a[28:31]
    ds_read_b128 a[220:223], v131 offset:12288
    v_add_f32 v112, v154, v155
    v_cvt_pk_bf16_f32 v64, v154, v155
    v_mfma_f32_16x16x32_bf16 a[32:35], a[224:227], v[84:87], a[32:35]
    v_exp_f32 v158, v4
    v_mfma_f32_16x16x32_bf16 a[36:39], a[228:231], v[84:87], a[36:39]
    buffer_load_dwordx4 v148, s[16:19], s53 offen offset:0 lds
    v_add_f32 v112, v112, v156
    v_mfma_f32_16x16x32_bf16 a[40:43], a[232:235], v[84:87], a[40:43]
    v_exp_f32 v159, v5
    v_mfma_f32_16x16x32_bf16 a[44:47], a[236:239], v[84:87], a[44:47]
    v_add_f32 v112, v112, v157
    v_cvt_pk_bf16_f32 v65, v156, v157
    v_cmp_lt_f32 vcc, s55, v163
    v_mfma_f32_16x16x32_bf16 a[48:51], a[240:243], v[84:87], a[48:51]
    v_exp_f32 v160, v6
    v_mfma_f32_16x16x32_bf16 a[52:55], a[244:247], v[84:87], a[52:55]
    buffer_load_dwordx4 v197, s[16:19], s53 offen offset:1024 lds
    v_add_f32 v112, v112, v158
    v_mfma_f32_16x16x32_bf16 a[56:59], a[248:251], v[84:87], a[56:59]
    v_exp_f32 v161, v7
    v_mfma_f32_16x16x32_bf16 a[60:63], a[252:255], v[84:87], a[60:63]
    buffer_load_dword v193, v192, s[84:87], s69 offen offset:2048
    v_add_f32 v112, v112, v159
    v_cvt_pk_bf16_f32 v66, v158, v159
    s_cbranch_vccnz L_attn_r7_1
L_attn_r7_1_back:
    v_mfma_f32_16x16x32_bf16 a[64:67], a[224:227], v[88:91], a[64:67]
    v_exp_f32 v154, v8
    v_mfma_f32_16x16x32_bf16 a[68:71], a[228:231], v[88:91], a[68:71]
    buffer_load_dwordx4 v148, s[16:19], s53 offen offset:2048 lds
    v_add_f32 v112, v112, v160
    v_mfma_f32_16x16x32_bf16 a[72:75], a[232:235], v[88:91], a[72:75]
    v_exp_f32 v155, v9
    v_mfma_f32_16x16x32_bf16 a[76:79], a[236:239], v[88:91], a[76:79]
    s_mov_b32 s84, s8
    s_mov_b32 s85, s9
    s_mov_b32 s8, s10
    s_mov_b32 s9, s11
    v_add_f32 v112, v112, v161
    v_cvt_pk_bf16_f32 v67, v160, v161
    v_mfma_f32_16x16x32_bf16 a[80:83], a[240:243], v[88:91], a[80:83]
    v_exp_f32 v156, v10
    v_mfma_f32_16x16x32_bf16 a[84:87], a[244:247], v[88:91], a[84:87]
    buffer_load_dwordx4 v197, s[16:19], s53 offen offset:3072 lds
    v_add_f32 v117, v117, v113
    v_mfma_f32_16x16x32_bf16 a[88:91], a[248:251], v[88:91], a[88:91]
    v_exp_f32 v157, v11
    v_mfma_f32_16x16x32_bf16 a[92:95], a[252:255], v[88:91], a[92:95]
    s_mov_b32 s10, s6
    s_mov_b32 s11, s7
    s_cmp_gt_u32 s41, 5
    s_cselect_b32 s86, s68, 0
    v_add_f32 v113, v154, v155
    v_cvt_pk_bf16_f32 v68, v154, v155
    v_mfma_f32_16x16x32_bf16 a[96:99], a[224:227], v[92:95], a[96:99]
    v_exp_f32 v158, v12
    v_mfma_f32_16x16x32_bf16 a[100:103], a[228:231], v[92:95], a[100:103]
    ds_read_b64_tr_b16 a[224:225], v132 offset:0
    v_add_f32 v113, v113, v156
    v_mfma_f32_16x16x32_bf16 a[104:107], a[232:235], v[92:95], a[104:107]
    v_exp_f32 v159, v13
    v_mfma_f32_16x16x32_bf16 a[108:111], a[236:239], v[92:95], a[108:111]
    ds_read_b64_tr_b16 a[226:227], v132 offset:4096
    v_add_f32 v113, v113, v157
    v_cvt_pk_bf16_f32 v69, v156, v157
    v_mfma_f32_16x16x32_bf16 a[112:115], a[240:243], v[92:95], a[112:115]
    v_exp_f32 v160, v14
    v_mfma_f32_16x16x32_bf16 a[116:119], a[244:247], v[92:95], a[116:119]
    ds_read_b64_tr_b16 a[228:229], v133 offset:0
    v_add_f32 v113, v113, v158
    v_mfma_f32_16x16x32_bf16 a[120:123], a[248:251], v[92:95], a[120:123]
    v_exp_f32 v161, v15
    v_mfma_f32_16x16x32_bf16 a[124:127], a[252:255], v[92:95], a[124:127]
    ds_read_b64_tr_b16 a[230:231], v133 offset:4096
    v_add_f32 v113, v113, v159
    v_cvt_pk_bf16_f32 v70, v158, v159
    s_sub_u32 s41, s41, 1
    s_cmp_lg_u32 s41, 0
    s_cbranch_scc1 L_attn_loop
    v_add_f32 v118, v118, v114
    v_add_f32 v119, v119, v115
    v_mov_b32 v176, v116
    v_mov_b32 v177, v117
    v_mov_b32 v178, v118
    v_mov_b32 v179, v119
    v_permlane16_swap_b32 v116, v176
    v_permlane16_swap_b32 v117, v177
    v_permlane16_swap_b32 v118, v178
    v_permlane16_swap_b32 v119, v179
    v_add_f32 v116, v116, v176
    v_add_f32 v117, v117, v177
    v_add_f32 v118, v118, v178
    v_add_f32 v119, v119, v179
    v_mov_b32 v176, v116
    v_mov_b32 v177, v117
    v_mov_b32 v178, v118
    v_mov_b32 v179, v119
    v_permlane32_swap_b32 v116, v176
    v_permlane32_swap_b32 v117, v177
    v_permlane32_swap_b32 v118, v178
    v_permlane32_swap_b32 v119, v179
    v_add_f32 v116, v116, v176
    v_add_f32 v117, v117, v177
    v_add_f32 v118, v118, v178
    v_add_f32 v119, v119, v179
    v_rcp_f32 v120, v116
    v_rcp_f32 v122, v117
    v_rcp_f32 v124, v118
    v_rcp_f32 v126, v119
    s_mov_b32 s56, 0
    s_mov_b32 s57, 0x20000
    s_mov_b32 s68, 0x40000
    s_mov_b32 s69, 0x60000
    v_accvgpr_read_b32 v0, a0
    v_accvgpr_read_b32 v1, a1
    v_accvgpr_read_b32 v2, a2
    v_accvgpr_read_b32 v3, a3
    v_accvgpr_read_b32 v4, a4
    v_accvgpr_read_b32 v5, a5
    v_accvgpr_read_b32 v6, a6
    v_accvgpr_read_b32 v7, a7
    v_pk_mul_f32 v[0:1], v[0:1], v[120:121] op_sel_hi:[1,0]
    v_pk_mul_f32 v[2:3], v[2:3], v[120:121] op_sel_hi:[1,0]
    v_pk_mul_f32 v[4:5], v[4:5], v[120:121] op_sel_hi:[1,0]
    v_pk_mul_f32 v[6:7], v[6:7], v[120:121] op_sel_hi:[1,0]
    v_cvt_pk_bf16_f32 v8, v0, v1
    v_cvt_pk_bf16_f32 v9, v2, v3
    v_cvt_pk_bf16_f32 v10, v4, v5
    v_cvt_pk_bf16_f32 v11, v6, v7
    buffer_store_dwordx4 v[8:11], v175, s[32:35], s56 offen offset:0 sc1
    v_accvgpr_read_b32 v12, a8
    v_accvgpr_read_b32 v13, a9
    v_accvgpr_read_b32 v14, a10
    v_accvgpr_read_b32 v15, a11
    v_accvgpr_read_b32 v16, a12
    v_accvgpr_read_b32 v17, a13
    v_accvgpr_read_b32 v18, a14
    v_accvgpr_read_b32 v19, a15
    v_pk_mul_f32 v[12:13], v[12:13], v[120:121] op_sel_hi:[1,0]
    v_pk_mul_f32 v[14:15], v[14:15], v[120:121] op_sel_hi:[1,0]
    v_pk_mul_f32 v[16:17], v[16:17], v[120:121] op_sel_hi:[1,0]
    v_pk_mul_f32 v[18:19], v[18:19], v[120:121] op_sel_hi:[1,0]
    v_cvt_pk_bf16_f32 v20, v12, v13
    v_cvt_pk_bf16_f32 v21, v14, v15
    v_cvt_pk_bf16_f32 v22, v16, v17
    v_cvt_pk_bf16_f32 v23, v18, v19
    buffer_store_dwordx4 v[20:23], v175, s[32:35], s56 offen offset:1024 sc1
    v_accvgpr_read_b32 v24, a16
    v_accvgpr_read_b32 v25, a17
    v_accvgpr_read_b32 v26, a18
    v_accvgpr_read_b32 v27, a19
    v_accvgpr_read_b32 v28, a20
    v_accvgpr_read_b32 v29, a21
    v_accvgpr_read_b32 v30, a22
    v_accvgpr_read_b32 v31, a23
    v_pk_mul_f32 v[24:25], v[24:25], v[120:121] op_sel_hi:[1,0]
    v_pk_mul_f32 v[26:27], v[26:27], v[120:121] op_sel_hi:[1,0]
    v_pk_mul_f32 v[28:29], v[28:29], v[120:121] op_sel_hi:[1,0]
    v_pk_mul_f32 v[30:31], v[30:31], v[120:121] op_sel_hi:[1,0]
    v_cvt_pk_bf16_f32 v32, v24, v25
    v_cvt_pk_bf16_f32 v33, v26, v27
    v_cvt_pk_bf16_f32 v34, v28, v29
    v_cvt_pk_bf16_f32 v35, v30, v31
    buffer_store_dwordx4 v[32:35], v175, s[32:35], s56 offen offset:2048 sc1
    v_accvgpr_read_b32 v36, a24
    v_accvgpr_read_b32 v37, a25
    v_accvgpr_read_b32 v38, a26
    v_accvgpr_read_b32 v39, a27
    v_accvgpr_read_b32 v40, a28
    v_accvgpr_read_b32 v41, a29
    v_accvgpr_read_b32 v42, a30
    v_accvgpr_read_b32 v43, a31
    v_pk_mul_f32 v[36:37], v[36:37], v[120:121] op_sel_hi:[1,0]
    v_pk_mul_f32 v[38:39], v[38:39], v[120:121] op_sel_hi:[1,0]
    v_pk_mul_f32 v[40:41], v[40:41], v[120:121] op_sel_hi:[1,0]
    v_pk_mul_f32 v[42:43], v[42:43], v[120:121] op_sel_hi:[1,0]
    v_cvt_pk_bf16_f32 v44, v36, v37
    v_cvt_pk_bf16_f32 v45, v38, v39
    v_cvt_pk_bf16_f32 v46, v40, v41
    v_cvt_pk_bf16_f32 v47, v42, v43
    buffer_store_dwordx4 v[44:47], v175, s[32:35], s56 offen offset:3072 sc1
    v_accvgpr_read_b32 v0, a32
    v_accvgpr_read_b32 v1, a33
    v_accvgpr_read_b32 v2, a34
    v_accvgpr_read_b32 v3, a35
    v_accvgpr_read_b32 v4, a36
    v_accvgpr_read_b32 v5, a37
    v_accvgpr_read_b32 v6, a38
    v_accvgpr_read_b32 v7, a39
    v_pk_mul_f32 v[0:1], v[0:1], v[122:123] op_sel_hi:[1,0]
    v_pk_mul_f32 v[2:3], v[2:3], v[122:123] op_sel_hi:[1,0]
    v_pk_mul_f32 v[4:5], v[4:5], v[122:123] op_sel_hi:[1,0]
    v_pk_mul_f32 v[6:7], v[6:7], v[122:123] op_sel_hi:[1,0]
    v_cvt_pk_bf16_f32 v8, v0, v1
    v_cvt_pk_bf16_f32 v9, v2, v3
    v_cvt_pk_bf16_f32 v10, v4, v5
    v_cvt_pk_bf16_f32 v11, v6, v7
    buffer_store_dwordx4 v[8:11], v175, s[32:35], s57 offen offset:0 sc1
    v_accvgpr_read_b32 v12, a40
    v_accvgpr_read_b32 v13, a41
    v_accvgpr_read_b32 v14, a42
    v_accvgpr_read_b32 v15, a43
    v_accvgpr_read_b32 v16, a44
    v_accvgpr_read_b32 v17, a45
    v_accvgpr_read_b32 v18, a46
    v_accvgpr_read_b32 v19, a47
    v_pk_mul_f32 v[12:13], v[12:13], v[122:123] op_sel_hi:[1,0]
    v_pk_mul_f32 v[14:15], v[14:15], v[122:123] op_sel_hi:[1,0]
    v_pk_mul_f32 v[16:17], v[16:17], v[122:123] op_sel_hi:[1,0]
    v_pk_mul_f32 v[18:19], v[18:19], v[122:123] op_sel_hi:[1,0]
    v_cvt_pk_bf16_f32 v20, v12, v13
    v_cvt_pk_bf16_f32 v21, v14, v15
    v_cvt_pk_bf16_f32 v22, v16, v17
    v_cvt_pk_bf16_f32 v23, v18, v19
    buffer_store_dwordx4 v[20:23], v175, s[32:35], s57 offen offset:1024 sc1
    v_accvgpr_read_b32 v24, a48
    v_accvgpr_read_b32 v25, a49
    v_accvgpr_read_b32 v26, a50
    v_accvgpr_read_b32 v27, a51
    v_accvgpr_read_b32 v28, a52
    v_accvgpr_read_b32 v29, a53
    v_accvgpr_read_b32 v30, a54
    v_accvgpr_read_b32 v31, a55
    v_pk_mul_f32 v[24:25], v[24:25], v[122:123] op_sel_hi:[1,0]
    v_pk_mul_f32 v[26:27], v[26:27], v[122:123] op_sel_hi:[1,0]
    v_pk_mul_f32 v[28:29], v[28:29], v[122:123] op_sel_hi:[1,0]
    v_pk_mul_f32 v[30:31], v[30:31], v[122:123] op_sel_hi:[1,0]
    v_cvt_pk_bf16_f32 v32, v24, v25
    v_cvt_pk_bf16_f32 v33, v26, v27
    v_cvt_pk_bf16_f32 v34, v28, v29
    v_cvt_pk_bf16_f32 v35, v30, v31
    buffer_store_dwordx4 v[32:35], v175, s[32:35], s57 offen offset:2048 sc1
    v_accvgpr_read_b32 v36, a56
    v_accvgpr_read_b32 v37, a57
    v_accvgpr_read_b32 v38, a58
    v_accvgpr_read_b32 v39, a59
    v_accvgpr_read_b32 v40, a60
    v_accvgpr_read_b32 v41, a61
    v_accvgpr_read_b32 v42, a62
    v_accvgpr_read_b32 v43, a63
    v_pk_mul_f32 v[36:37], v[36:37], v[122:123] op_sel_hi:[1,0]
    v_pk_mul_f32 v[38:39], v[38:39], v[122:123] op_sel_hi:[1,0]
    v_pk_mul_f32 v[40:41], v[40:41], v[122:123] op_sel_hi:[1,0]
    v_pk_mul_f32 v[42:43], v[42:43], v[122:123] op_sel_hi:[1,0]
    v_cvt_pk_bf16_f32 v44, v36, v37
    v_cvt_pk_bf16_f32 v45, v38, v39
    v_cvt_pk_bf16_f32 v46, v40, v41
    v_cvt_pk_bf16_f32 v47, v42, v43
    buffer_store_dwordx4 v[44:47], v175, s[32:35], s57 offen offset:3072 sc1
    v_accvgpr_read_b32 v0, a64
    v_accvgpr_read_b32 v1, a65
    v_accvgpr_read_b32 v2, a66
    v_accvgpr_read_b32 v3, a67
    v_accvgpr_read_b32 v4, a68
    v_accvgpr_read_b32 v5, a69
    v_accvgpr_read_b32 v6, a70
    v_accvgpr_read_b32 v7, a71
    v_pk_mul_f32 v[0:1], v[0:1], v[124:125] op_sel_hi:[1,0]
    v_pk_mul_f32 v[2:3], v[2:3], v[124:125] op_sel_hi:[1,0]
    v_pk_mul_f32 v[4:5], v[4:5], v[124:125] op_sel_hi:[1,0]
    v_pk_mul_f32 v[6:7], v[6:7], v[124:125] op_sel_hi:[1,0]
    v_cvt_pk_bf16_f32 v8, v0, v1
    v_cvt_pk_bf16_f32 v9, v2, v3
    v_cvt_pk_bf16_f32 v10, v4, v5
    v_cvt_pk_bf16_f32 v11, v6, v7
    buffer_store_dwordx4 v[8:11], v175, s[32:35], s68 offen offset:0 sc1
    v_accvgpr_read_b32 v12, a72
    v_accvgpr_read_b32 v13, a73
    v_accvgpr_read_b32 v14, a74
    v_accvgpr_read_b32 v15, a75
    v_accvgpr_read_b32 v16, a76
    v_accvgpr_read_b32 v17, a77
    v_accvgpr_read_b32 v18, a78
    v_accvgpr_read_b32 v19, a79
    v_pk_mul_f32 v[12:13], v[12:13], v[124:125] op_sel_hi:[1,0]
    v_pk_mul_f32 v[14:15], v[14:15], v[124:125] op_sel_hi:[1,0]
    v_pk_mul_f32 v[16:17], v[16:17], v[124:125] op_sel_hi:[1,0]
    v_pk_mul_f32 v[18:19], v[18:19], v[124:125] op_sel_hi:[1,0]
    v_cvt_pk_bf16_f32 v20, v12, v13
    v_cvt_pk_bf16_f32 v21, v14, v15
    v_cvt_pk_bf16_f32 v22, v16, v17
    v_cvt_pk_bf16_f32 v23, v18, v19
    buffer_store_dwordx4 v[20:23], v175, s[32:35], s68 offen offset:1024 sc1
    v_accvgpr_read_b32 v24, a80
    v_accvgpr_read_b32 v25, a81
    v_accvgpr_read_b32 v26, a82
    v_accvgpr_read_b32 v27, a83
    v_accvgpr_read_b32 v28, a84
    v_accvgpr_read_b32 v29, a85
    v_accvgpr_read_b32 v30, a86
    v_accvgpr_read_b32 v31, a87
    v_pk_mul_f32 v[24:25], v[24:25], v[124:125] op_sel_hi:[1,0]
    v_pk_mul_f32 v[26:27], v[26:27], v[124:125] op_sel_hi:[1,0]
    v_pk_mul_f32 v[28:29], v[28:29], v[124:125] op_sel_hi:[1,0]
    v_pk_mul_f32 v[30:31], v[30:31], v[124:125] op_sel_hi:[1,0]
    v_cvt_pk_bf16_f32 v32, v24, v25
    v_cvt_pk_bf16_f32 v33, v26, v27
    v_cvt_pk_bf16_f32 v34, v28, v29
    v_cvt_pk_bf16_f32 v35, v30, v31
    buffer_store_dwordx4 v[32:35], v175, s[32:35], s68 offen offset:2048 sc1
    v_accvgpr_read_b32 v36, a88
    v_accvgpr_read_b32 v37, a89
    v_accvgpr_read_b32 v38, a90
    v_accvgpr_read_b32 v39, a91
    v_accvgpr_read_b32 v40, a92
    v_accvgpr_read_b32 v41, a93
    v_accvgpr_read_b32 v42, a94
    v_accvgpr_read_b32 v43, a95
    v_pk_mul_f32 v[36:37], v[36:37], v[124:125] op_sel_hi:[1,0]
    v_pk_mul_f32 v[38:39], v[38:39], v[124:125] op_sel_hi:[1,0]
    v_pk_mul_f32 v[40:41], v[40:41], v[124:125] op_sel_hi:[1,0]
    v_pk_mul_f32 v[42:43], v[42:43], v[124:125] op_sel_hi:[1,0]
    v_cvt_pk_bf16_f32 v44, v36, v37
    v_cvt_pk_bf16_f32 v45, v38, v39
    v_cvt_pk_bf16_f32 v46, v40, v41
    v_cvt_pk_bf16_f32 v47, v42, v43
    buffer_store_dwordx4 v[44:47], v175, s[32:35], s68 offen offset:3072 sc1
    v_accvgpr_read_b32 v0, a96
    v_accvgpr_read_b32 v1, a97
    v_accvgpr_read_b32 v2, a98
    v_accvgpr_read_b32 v3, a99
    v_accvgpr_read_b32 v4, a100
    v_accvgpr_read_b32 v5, a101
    v_accvgpr_read_b32 v6, a102
    v_accvgpr_read_b32 v7, a103
    v_pk_mul_f32 v[0:1], v[0:1], v[126:127] op_sel_hi:[1,0]
    v_pk_mul_f32 v[2:3], v[2:3], v[126:127] op_sel_hi:[1,0]
    v_pk_mul_f32 v[4:5], v[4:5], v[126:127] op_sel_hi:[1,0]
    v_pk_mul_f32 v[6:7], v[6:7], v[126:127] op_sel_hi:[1,0]
    v_cvt_pk_bf16_f32 v8, v0, v1
    v_cvt_pk_bf16_f32 v9, v2, v3
    v_cvt_pk_bf16_f32 v10, v4, v5
    v_cvt_pk_bf16_f32 v11, v6, v7
    buffer_store_dwordx4 v[8:11], v175, s[32:35], s69 offen offset:0 sc1
    v_accvgpr_read_b32 v12, a104
    v_accvgpr_read_b32 v13, a105
    v_accvgpr_read_b32 v14, a106
    v_accvgpr_read_b32 v15, a107
    v_accvgpr_read_b32 v16, a108
    v_accvgpr_read_b32 v17, a109
    v_accvgpr_read_b32 v18, a110
    v_accvgpr_read_b32 v19, a111
    v_pk_mul_f32 v[12:13], v[12:13], v[126:127] op_sel_hi:[1,0]
    v_pk_mul_f32 v[14:15], v[14:15], v[126:127] op_sel_hi:[1,0]
    v_pk_mul_f32 v[16:17], v[16:17], v[126:127] op_sel_hi:[1,0]
    v_pk_mul_f32 v[18:19], v[18:19], v[126:127] op_sel_hi:[1,0]
    v_cvt_pk_bf16_f32 v20, v12, v13
    v_cvt_pk_bf16_f32 v21, v14, v15
    v_cvt_pk_bf16_f32 v22, v16, v17
    v_cvt_pk_bf16_f32 v23, v18, v19
    buffer_store_dwordx4 v[20:23], v175, s[32:35], s69 offen offset:1024 sc1
    v_accvgpr_read_b32 v24, a112
    v_accvgpr_read_b32 v25, a113
    v_accvgpr_read_b32 v26, a114
    v_accvgpr_read_b32 v27, a115
    v_accvgpr_read_b32 v28, a116
    v_accvgpr_read_b32 v29, a117
    v_accvgpr_read_b32 v30, a118
    v_accvgpr_read_b32 v31, a119
    v_pk_mul_f32 v[24:25], v[24:25], v[126:127] op_sel_hi:[1,0]
    v_pk_mul_f32 v[26:27], v[26:27], v[126:127] op_sel_hi:[1,0]
    v_pk_mul_f32 v[28:29], v[28:29], v[126:127] op_sel_hi:[1,0]
    v_pk_mul_f32 v[30:31], v[30:31], v[126:127] op_sel_hi:[1,0]
    v_cvt_pk_bf16_f32 v32, v24, v25
    v_cvt_pk_bf16_f32 v33, v26, v27
    v_cvt_pk_bf16_f32 v34, v28, v29
    v_cvt_pk_bf16_f32 v35, v30, v31
    buffer_store_dwordx4 v[32:35], v175, s[32:35], s69 offen offset:2048 sc1
    v_accvgpr_read_b32 v36, a120
    v_accvgpr_read_b32 v37, a121
    v_accvgpr_read_b32 v38, a122
    v_accvgpr_read_b32 v39, a123
    v_accvgpr_read_b32 v40, a124
    v_accvgpr_read_b32 v41, a125
    v_accvgpr_read_b32 v42, a126
    v_accvgpr_read_b32 v43, a127
    v_pk_mul_f32 v[36:37], v[36:37], v[126:127] op_sel_hi:[1,0]
    v_pk_mul_f32 v[38:39], v[38:39], v[126:127] op_sel_hi:[1,0]
    v_pk_mul_f32 v[40:41], v[40:41], v[126:127] op_sel_hi:[1,0]
    v_pk_mul_f32 v[42:43], v[42:43], v[126:127] op_sel_hi:[1,0]
    v_cvt_pk_bf16_f32 v44, v36, v37
    v_cvt_pk_bf16_f32 v45, v38, v39
    v_cvt_pk_bf16_f32 v46, v40, v41
    v_cvt_pk_bf16_f32 v47, v42, v43
    buffer_store_dwordx4 v[44:47], v175, s[32:35], s69 offen offset:3072 sc1
    v_lshlrev_b32 v236, 16, v236
    v_lshlrev_b32 v237, 16, v237
    v_lshlrev_b32 v238, 16, v238
    v_lshlrev_b32 v239, 16, v239
    v_lshlrev_b32 v240, 16, v240
    v_lshlrev_b32 v241, 16, v241
    v_lshlrev_b32 v242, 16, v242
    v_lshlrev_b32 v243, 16, v243
    v_mul_f32 v244, 0xbfb8aa3b, v236
    v_mul_f32 v245, 0xbfb8aa3b, v237
    v_mul_f32 v246, 0xbfb8aa3b, v238
    v_mul_f32 v247, 0xbfb8aa3b, v239
    v_mul_f32 v248, 0xbfb8aa3b, v240
    v_mul_f32 v249, 0xbfb8aa3b, v241
    v_mul_f32 v250, 0xbfb8aa3b, v242
    v_mul_f32 v251, 0xbfb8aa3b, v243
    v_exp_f32 v244, v244
    v_exp_f32 v245, v245
    v_exp_f32 v246, v246
    v_exp_f32 v247, v247
    v_exp_f32 v248, v248
    v_exp_f32 v249, v249
    v_exp_f32 v250, v250
    v_exp_f32 v251, v251
    v_add_f32 v244, 1.0, v244
    v_add_f32 v245, 1.0, v245
    v_add_f32 v246, 1.0, v246
    v_add_f32 v247, 1.0, v247
    v_add_f32 v248, 1.0, v248
    v_add_f32 v249, 1.0, v249
    v_add_f32 v250, 1.0, v250
    v_add_f32 v251, 1.0, v251
    v_rcp_f32 v244, v244
    v_rcp_f32 v245, v245
    v_rcp_f32 v246, v246
    v_rcp_f32 v247, v247
    v_rcp_f32 v248, v248
    v_rcp_f32 v249, v249
    v_rcp_f32 v250, v250
    v_rcp_f32 v251, v251
    v_mul_f32 v236, v236, v244
    v_mul_f32 v237, v237, v245
    v_mul_f32 v238, v238, v246
    v_mul_f32 v239, v239, v247
    v_mul_f32 v240, v240, v248
    v_mul_f32 v241, v241, v249
    v_mul_f32 v242, v242, v250
    v_mul_f32 v243, v243, v251
    v_cvt_pk_bf16_f32 v236, v236, v236
    v_cvt_pk_bf16_f32 v237, v237, v237
    v_cvt_pk_bf16_f32 v238, v238, v238
    v_cvt_pk_bf16_f32 v239, v239, v239
    v_cvt_pk_bf16_f32 v240, v240, v240
    v_cvt_pk_bf16_f32 v241, v241, v241
    v_cvt_pk_bf16_f32 v242, v242, v242
    v_cvt_pk_bf16_f32 v243, v243, v243
    v_lshlrev_b32 v236, 16, v236
    v_lshlrev_b32 v237, 16, v237
    v_lshlrev_b32 v238, 16, v238
    v_lshlrev_b32 v239, 16, v239
    v_lshlrev_b32 v240, 16, v240
    v_lshlrev_b32 v241, 16, v241
    v_lshlrev_b32 v242, 16, v242
    v_lshlrev_b32 v243, 16, v243
    v_lshlrev_b32 v40, 16, v204
    v_and_b32 v41, 0xffff0000, v204
    v_mul_f32 v32, v236, v40
    v_mul_f32 v33, v236, v41
    v_lshlrev_b32 v40, 16, v205
    v_and_b32 v41, 0xffff0000, v205
    v_mul_f32 v34, v236, v40
    v_mul_f32 v35, v236, v41
    v_lshlrev_b32 v40, 16, v206
    v_and_b32 v41, 0xffff0000, v206
    v_mul_f32 v36, v236, v40
    v_mul_f32 v37, v236, v41
    v_lshlrev_b32 v40, 16, v207
    v_and_b32 v41, 0xffff0000, v207
    v_mul_f32 v38, v236, v40
    v_mul_f32 v39, v236, v41
    v_lshlrev_b32 v40, 16, v208
    v_and_b32 v41, 0xffff0000, v208
    v_fmac_f32 v32, v237, v40
    v_fmac_f32 v33, v237, v41
    v_lshlrev_b32 v40, 16, v209
    v_and_b32 v41, 0xffff0000, v209
    v_fmac_f32 v34, v237, v40
    v_fmac_f32 v35, v237, v41
    v_lshlrev_b32 v40, 16, v210
    v_and_b32 v41, 0xffff0000, v210
    v_fmac_f32 v36, v237, v40
    v_fmac_f32 v37, v237, v41
    v_lshlrev_b32 v40, 16, v211
    v_and_b32 v41, 0xffff0000, v211
    v_fmac_f32 v38, v237, v40
    v_fmac_f32 v39, v237, v41
    v_lshlrev_b32 v40, 16, v212
    v_and_b32 v41, 0xffff0000, v212
    v_fmac_f32 v32, v238, v40
    v_fmac_f32 v33, v238, v41
    v_lshlrev_b32 v40, 16, v213
    v_and_b32 v41, 0xffff0000, v213
    v_fmac_f32 v34, v238, v40
    v_fmac_f32 v35, v238, v41
    v_lshlrev_b32 v40, 16, v214
    v_and_b32 v41, 0xffff0000, v214
    v_fmac_f32 v36, v238, v40
    v_fmac_f32 v37, v238, v41
    v_lshlrev_b32 v40, 16, v215
    v_and_b32 v41, 0xffff0000, v215
    v_fmac_f32 v38, v238, v40
    v_fmac_f32 v39, v238, v41
    v_lshlrev_b32 v40, 16, v216
    v_and_b32 v41, 0xffff0000, v216
    v_fmac_f32 v32, v239, v40
    v_fmac_f32 v33, v239, v41
    v_lshlrev_b32 v40, 16, v217
    v_and_b32 v41, 0xffff0000, v217
    v_fmac_f32 v34, v239, v40
    v_fmac_f32 v35, v239, v41
    v_lshlrev_b32 v40, 16, v218
    v_and_b32 v41, 0xffff0000, v218
    v_fmac_f32 v36, v239, v40
    v_fmac_f32 v37, v239, v41
    v_lshlrev_b32 v40, 16, v219
    v_and_b32 v41, 0xffff0000, v219
    v_fmac_f32 v38, v239, v40
    v_fmac_f32 v39, v239, v41
    v_lshlrev_b32 v40, 16, v220
    v_and_b32 v41, 0xffff0000, v220
    v_fmac_f32 v32, v240, v40
    v_fmac_f32 v33, v240, v41
    v_lshlrev_b32 v40, 16, v221
    v_and_b32 v41, 0xffff0000, v221
    v_fmac_f32 v34, v240, v40
    v_fmac_f32 v35, v240, v41
    v_lshlrev_b32 v40, 16, v222
    v_and_b32 v41, 0xffff0000, v222
    v_fmac_f32 v36, v240, v40
    v_fmac_f32 v37, v240, v41
    v_lshlrev_b32 v40, 16, v223
    v_and_b32 v41, 0xffff0000, v223
    v_fmac_f32 v38, v240, v40
    v_fmac_f32 v39, v240, v41
    v_lshlrev_b32 v40, 16, v224
    v_and_b32 v41, 0xffff0000, v224
    v_fmac_f32 v32, v241, v40
    v_fmac_f32 v33, v241, v41
    v_lshlrev_b32 v40, 16, v225
    v_and_b32 v41, 0xffff0000, v225
    v_fmac_f32 v34, v241, v40
    v_fmac_f32 v35, v241, v41
    v_lshlrev_b32 v40, 16, v226
    v_and_b32 v41, 0xffff0000, v226
    v_fmac_f32 v36, v241, v40
    v_fmac_f32 v37, v241, v41
    v_lshlrev_b32 v40, 16, v227
    v_and_b32 v41, 0xffff0000, v227
    v_fmac_f32 v38, v241, v40
    v_fmac_f32 v39, v241, v41
    v_lshlrev_b32 v40, 16, v228
    v_and_b32 v41, 0xffff0000, v228
    v_fmac_f32 v32, v242, v40
    v_fmac_f32 v33, v242, v41
    v_lshlrev_b32 v40, 16, v229
    v_and_b32 v41, 0xffff0000, v229
    v_fmac_f32 v34, v242, v40
    v_fmac_f32 v35, v242, v41
    v_lshlrev_b32 v40, 16, v230
    v_and_b32 v41, 0xffff0000, v230
    v_fmac_f32 v36, v242, v40
    v_fmac_f32 v37, v242, v41
    v_lshlrev_b32 v40, 16, v231
    v_and_b32 v41, 0xffff0000, v231
    v_fmac_f32 v38, v242, v40
    v_fmac_f32 v39, v242, v41
    v_lshlrev_b32 v40, 16, v232
    v_and_b32 v41, 0xffff0000, v232
    v_fmac_f32 v32, v243, v40
    v_fmac_f32 v33, v243, v41
    v_lshlrev_b32 v40, 16, v233
    v_and_b32 v41, 0xffff0000, v233
    v_fmac_f32 v34, v243, v40
    v_fmac_f32 v35, v243, v41
    v_lshlrev_b32 v40, 16, v234
    v_and_b32 v41, 0xffff0000, v234
    v_fmac_f32 v36, v243, v40
    v_fmac_f32 v37, v243, v41
    v_lshlrev_b32 v40, 16, v235
    v_and_b32 v41, 0xffff0000, v235
    v_fmac_f32 v38, v243, v40
    v_fmac_f32 v39, v243, v41
    v_add_f32_dpp v32, v32, v32 row_ror:4 row_mask:0xf bank_mask:0xf
    v_add_f32_dpp v33, v33, v33 row_ror:4 row_mask:0xf bank_mask:0xf
    v_add_f32_dpp v34, v34, v34 row_ror:4 row_mask:0xf bank_mask:0xf
    v_add_f32_dpp v35, v35, v35 row_ror:4 row_mask:0xf bank_mask:0xf
    v_add_f32_dpp v36, v36, v36 row_ror:4 row_mask:0xf bank_mask:0xf
    v_add_f32_dpp v37, v37, v37 row_ror:4 row_mask:0xf bank_mask:0xf
    v_add_f32_dpp v38, v38, v38 row_ror:4 row_mask:0xf bank_mask:0xf
    v_add_f32_dpp v39, v39, v39 row_ror:4 row_mask:0xf bank_mask:0xf
    v_add_f32_dpp v32, v32, v32 row_ror:8 row_mask:0xf bank_mask:0xf
    v_add_f32_dpp v33, v33, v33 row_ror:8 row_mask:0xf bank_mask:0xf
    v_add_f32_dpp v34, v34, v34 row_ror:8 row_mask:0xf bank_mask:0xf
    v_add_f32_dpp v35, v35, v35 row_ror:8 row_mask:0xf bank_mask:0xf
    v_add_f32_dpp v36, v36, v36 row_ror:8 row_mask:0xf bank_mask:0xf
    v_add_f32_dpp v37, v37, v37 row_ror:8 row_mask:0xf bank_mask:0xf
    v_add_f32_dpp v38, v38, v38 row_ror:8 row_mask:0xf bank_mask:0xf
    v_add_f32_dpp v39, v39, v39 row_ror:8 row_mask:0xf bank_mask:0xf
    v_mov_b32 v8, v32
    v_mov_b32 v9, v33
    v_mov_b32 v10, v34
    v_mov_b32 v11, v35
    v_mov_b32 v12, v36
    v_mov_b32 v13, v37
    v_mov_b32 v14, v38
    v_mov_b32 v15, v39
    v_permlane16_swap_b32 v32, v8
    v_permlane16_swap_b32 v33, v9
    v_permlane16_swap_b32 v34, v10
    v_permlane16_swap_b32 v35, v11
    v_permlane16_swap_b32 v36, v12
    v_permlane16_swap_b32 v37, v13
    v_permlane16_swap_b32 v38, v14
    v_permlane16_swap_b32 v39, v15
    v_add_f32 v32, v32, v8
    v_add_f32 v33, v33, v9
    v_add_f32 v34, v34, v10
    v_add_f32 v35, v35, v11
    v_add_f32 v36, v36, v12
    v_add_f32 v37, v37, v13
    v_add_f32 v38, v38, v14
    v_add_f32 v39, v39, v15
    v_mov_b32 v8, v32
    v_mov_b32 v9, v33
    v_mov_b32 v10, v34
    v_mov_b32 v11, v35
    v_mov_b32 v12, v36
    v_mov_b32 v13, v37
    v_mov_b32 v14, v38
    v_mov_b32 v15, v39
    v_permlane32_swap_b32 v32, v8
    v_permlane32_swap_b32 v33, v9
    v_permlane32_swap_b32 v34, v10
    v_permlane32_swap_b32 v35, v11
    v_permlane32_swap_b32 v36, v12
    v_permlane32_swap_b32 v37, v13
    v_permlane32_swap_b32 v38, v14
    v_permlane32_swap_b32 v39, v15
    v_add_f32 v32, v32, v8
    v_add_f32 v33, v33, v9
    v_add_f32 v34, v34, v10
    v_add_f32 v35, v35, v11
    v_add_f32 v36, v36, v12
    v_add_f32 v37, v37, v13
    v_add_f32 v38, v38, v14
    v_add_f32 v39, v39, v15
    v_and_b32 v8, 63, v174
    s_lshl_b32 s42, s36, 7
    v_lshl_add_u32 v9, v8, 5, s42
    v_cmp_gt_u32 vcc, 4, v8
    s_nop 0
    s_and_saveexec_b64 s[92:93], vcc
    ds_write_b128 v9, v[32:35]
    ds_write_b128 v9, v[36:39] offset:16
    s_mov_b64 exec, s[92:93]
    s_waitcnt lgkmcnt(0)
    s_lshr_b32 s42, s37, 4
    s_lshl_b32 s43, s38, 1
    s_add_u32 s42, s42, s43
    s_add_u32 s42, s42, 24
    s_waitcnt vmcnt(0)
    s_barrier
    s_cmp_lg_u32 s94, 0
    s_cbranch_scc1 L_attn_nosig
    s_add_u32 s88, s4, 0x60000
    s_addc_u32 s89, s5, 0
    s_mov_b32 s90, 0x6800
    s_mov_b32 s91, 0x20000
    s_lshl_b32 s92, s42, 7
    v_mov_b32 v252, s92
    v_mov_b32 v253, 1
    s_mov_b64 s[92:93], exec
    s_mov_b64 exec, 1
    buffer_atomic_add v253, v252, s[88:91], 0 offen
    s_mov_b64 exec, s[92:93]
L_attn_nosig:
    s_cmp_lg_u32 s36, 0
    s_cbranch_scc1 L_attn_g2done
    v_lshlrev_b32 v9, 2, v8
    ds_read_b32 v10, v9 offset:0
    ds_read_b32 v11, v9 offset:128
    ds_read_b32 v12, v9 offset:256
    ds_read_b32 v13, v9 offset:384
    s_waitcnt lgkmcnt(0)
    v_add_f32 v10, v10, v11
    v_add_f32 v12, v12, v13
    v_add_f32 v10, v10, v12
    s_add_u32 s88, s4, 0x20000
    s_addc_u32 s89, s5, 0
    s_mov_b32 s90, 0xc000
    s_mov_b32 s91, 0x20000
    s_lshr_b32 s42, s2, 7
    s_mul_i32 s42, s42, 24576
    s_and_b32 s43, s2, 127
    s_lshl_b32 s43, s43, 7
    s_add_u32 s42, s42, s43
    s_add_u32 s42, s42, 8192
    v_cmp_gt_u32 vcc, 32, v8
    s_nop 0
    s_and_saveexec_b64 s[92:93], vcc
    buffer_store_dword v10, v9, s[88:91], s42 offen sc1
    s_mov_b64 exec, s[92:93]
L_attn_g2done:
    s_mov_b64 exec, -1
    v_mbcnt_lo_u32_b32 v0, -1, 0
    v_mbcnt_hi_u32_b32 v0, -1, v0
    v_add_u32 v0, s94, v0
    s_load_dwordx2 s[4:5], s[0:1], 104
    s_load_dwordx2 s[6:7], s[0:1], 32
    s_load_dwordx2 s[8:9], s[0:1], 0
    v_mov_b32 v210, v0
    v_lshrrev_b32 v211, 6, v0
    s_nop 0
    v_readfirstlane_b32 s36, v211
    s_and_b32 s42, s2, 3
    s_lshl_b32 s42, s42, 2
    s_bfe_u32 s60, s2, 0x20003
    s_add_u32 s37, s42, s60
    s_lshr_b32 s38, s2, 5
    s_bfe_u32 s49, s2, 0x10002
    s_lshl_b32 s42, s60, 0
    s_add_u32 s62, s38, s42
    v_and_b32 v212, 63, v210
    v_lshlrev_b32 v192, 4, v212
    v_lshrrev_b32 v213, 4, v212
    v_and_b32 v214, 15, v212
    s_lshl_b32 s42, s36, 4
    v_add_u32 v215, s42, v213
    v_lshlrev_b32 v215, 11, v215
    v_add_u32 v216, 0, v213
    v_lshlrev_b32 v216, 1, v216
    v_xor_b32 v216, v216, v214
    v_lshl_add_u32 v216, v216, 4, v215
    v_add_u32 v193, 0, v216
    v_add_u32 v195, 14336, v216
    v_add_u32 v216, 4, v213
    v_lshlrev_b32 v216, 1, v216
    v_xor_b32 v216, v216, v214
    v_lshl_add_u32 v216, v216, 4, v215
    v_add_u32 v194, 7168, v216
    v_add_u32 v196, 21504, v216
    s_lshl_b32 s44, s36, 12
    s_add_u32 s45, s44, 16384
    s_add_u32 s46, s44, 32768
    s_add_u32 s47, s44, 49152
    s_waitcnt lgkmcnt(0)
    s_lshl_b32 s42, s37, 3
    s_lshl_b32 s43, s36, 1
    s_add_u32 s42, s42, s43
    s_lshl_b32 s42, s42, 17
    s_lshl_b32 s43, s49, 16
    s_add_u32 s42, s42, s43
    s_add_u32 s42, s42, 0x2000000
    s_add_u32 s12, s4, s42
    s_addc_u32 s13, s5, 0
    s_mov_b32 s14, 0x10000
    s_mov_b32 s15, 0x20000
    s_add_u32 s42, s42, 131072
    s_add_u32 s16, s4, s42
    s_addc_u32 s17, s5, 0
    s_mov_b32 s18, 0x10000
    s_mov_b32 s19, 0x20000
    s_lshl_b32 s42, s49, 22
    s_lshl_b32 s43, s38, 8
    s_add_u32 s42, s42, s43
    s_add_u32 s20, s6, s42
    s_addc_u32 s21, s7, 0
    s_mov_b32 s22, 0x0
    s_mov_b32 s23, 0x20000
    s_sub_u32 s22, 4194304, s43
    s_mov_b32 s63, 0
    s_mov_b32 s65, s63
    s_add_u32 s64, s63, s62
    s_and_b32 s64, s64, 3
    s_andn2_b32 s67, s63, 3
    s_or_b32 s64, s64, s67
    s_add_u32 s63, s63, 1
    s_lshl_b32 s39, s64, 11
    s_lshl_b32 s40, s64, 17
    s_mov_b32 m0, s44
    s_nop 0
    buffer_load_dwordx4 v193, s[20:23], s40 offen offset:0 lds
    buffer_load_dwordx4 v194, s[20:23], s40 offen offset:1024 lds
    buffer_load_dwordx4 v195, s[20:23], s40 offen offset:2048 lds
    buffer_load_dwordx4 v196, s[20:23], s40 offen offset:3072 lds
    s_add_u32 s64, s63, s62
    s_and_b32 s64, s64, 3
    s_andn2_b32 s67, s63, 3
    s_or_b32 s64, s64, s67
    s_add_u32 s63, s63, 1
    s_lshl_b32 s39, s64, 11
    s_lshl_b32 s40, s64, 17
    s_mov_b32 m0, s45
    s_nop 0
    buffer_load_dwordx4 v193, s[20:23], s40 offen offset:0 lds
    buffer_load_dwordx4 v194, s[20:23], s40 offen offset:1024 lds
    buffer_load_dwordx4 v195, s[20:23], s40 offen offset:2048 lds
    buffer_load_dwordx4 v196, s[20:23], s40 offen offset:3072 lds
    s_cmp_lg_u32 s94, 0
    s_cbranch_scc1 L_oproj_nomod
    s_waitcnt vmcnt(0)
    s_add_u32 s88, s4, 0x60000
    s_addc_u32 s89, s5, 0
    s_mov_b32 s90, 0x6800
    s_mov_b32 s91, 0x20000
    s_and_b32 s92, s2, 7
    s_add_u32 s92, s92, 56
    s_lshl_b32 s92, s92, 7
    v_mov_b32 v252, s92
    v_mov_b32 v253, 1
    s_mov_b64 s[92:93], exec
    s_mov_b64 exec, 1
    buffer_atomic_add v253, v252, s[88:91], 0 offen
    s_mov_b64 exec, s[92:93]
L_oproj_nomod:
    s_and_b32 s50, s37, 14
    s_add_u32 s50, s50, s49
    s_add_u32 s50, s50, 24
    s_cmp_lg_u32 s94, 0
    s_cbranch_scc1 L_oproj_wgo
    s_add_u32 s88, s4, 0x60000
    s_addc_u32 s89, s5, 0
    s_mov_b32 s90, 0x6800
    s_mov_b32 s91, 0x20000
    s_lshl_b32 s92, s50, 7
    v_mov_b32 v252, s92
    s_mov_b64 s[92:93], exec
    s_mov_b64 exec, 1
    s_mov_b32 s3, 0x40000
L_oproj_wpoll:
    buffer_load_dword v253, v252, s[88:91], 0 offen sc1
    s_waitcnt vmcnt(0)
    v_cmp_ne_u32 vcc, 16, v253
    s_cbranch_vccz L_oproj_wdone
    s_sleep 1
    s_sub_u32 s3, s3, 1
    s_cmp_lg_u32 s3, 0
    s_cbranch_scc1 L_oproj_wpoll
L_oproj_wdone:
    s_mov_b64 exec, s[92:93]
L_oproj_wgo:
    s_barrier
    v_mov_b32 v252, 0x7f000000
    s_mov_b32 s63, s65
    s_add_u32 s64, s63, s62
    s_and_b32 s64, s64, 3
    s_andn2_b32 s67, s63, 3
    s_or_b32 s64, s64, s67
    s_add_u32 s63, s63, 1
    s_lshl_b32 s39, s64, 11
    s_lshl_b32 s40, s64, 17
    buffer_load_dwordx4 v[128:131], v192, s[12:15], s39 offen offset:0 sc1
    buffer_load_dwordx4 v[132:135], v192, s[16:19], s39 offen offset:0 sc1
    buffer_load_dwordx4 v[136:139], v192, s[12:15], s39 offen offset:1024 sc1
    buffer_load_dwordx4 v[140:143], v192, s[16:19], s39 offen offset:1024 sc1
    s_add_u32 s64, s63, s62
    s_and_b32 s64, s64, 3
    s_andn2_b32 s67, s63, 3
    s_or_b32 s64, s64, s67
    s_add_u32 s63, s63, 1
    s_lshl_b32 s39, s64, 11
    s_lshl_b32 s40, s64, 17
    buffer_load_dwordx4 v[144:147], v192, s[12:15], s39 offen offset:0 sc1
    buffer_load_dwordx4 v[148:151], v192, s[16:19], s39 offen offset:0 sc1
    buffer_load_dwordx4 v[152:155], v192, s[12:15], s39 offen offset:1024 sc1
    buffer_load_dwordx4 v[156:159], v192, s[16:19], s39 offen offset:1024 sc1
    buffer_load_dword v253, v252, s[20:23], 0 offen
    buffer_load_dword v253, v252, s[20:23], 0 offen
    buffer_load_dword v253, v252, s[20:23], 0 offen
    buffer_load_dword v253, v252, s[20:23], 0 offen
    buffer_load_dword v253, v252, s[20:23], 0 offen
    buffer_load_dword v253, v252, s[20:23], 0 offen
    s_add_u32 s64, s63, s62
    s_and_b32 s64, s64, 3
    s_andn2_b32 s67, s63, 3
    s_or_b32 s64, s64, s67
    s_add_u32 s63, s63, 1
    s_lshl_b32 s39, s64, 11
    s_lshl_b32 s40, s64, 17
    v_lshrrev_b32 v213, 2, v212
    v_lshlrev_b32 v214, 8, v213
    v_and_b32 v215, 3, v212
    v_lshl_add_u32 v214, v215, 3, v214
    v_and_b32 v215, 7, v213
    v_lshl_add_u32 v200, v215, 5, v214
    v_xor_b32 v201, 32, v200
    v_xor_b32 v202, 64, v200
    v_xor_b32 v203, 96, v200
    v_xor_b32 v204, 128, v200
    v_xor_b32 v205, 160, v200
    v_xor_b32 v206, 192, v200
    v_xor_b32 v207, 224, v200
    s_lshl_b32 s42, s49, 22
    s_add_u32 s42, s42, 0x3000000
    s_add_u32 s28, s4, s42
    s_addc_u32 s29, s5, 0
    s_mov_b32 s30, 0x400000
    s_mov_b32 s31, 0x20000
    s_lshl_b32 s42, s37, 7
    s_lshl_b32 s43, s36, 5
    s_add_u32 s42, s42, s43
    v_and_b32 v213, 15, v212
    v_add_u32 v213, s42, v213
    v_lshlrev_b32 v213, 11, v213
    v_lshrrev_b32 v214, 4, v212
    v_lshl_add_u32 v213, v214, 4, v213
    s_lshl_b32 s42, s38, 8
    v_add_u32 v208, s42, v213
    s_mov_b32 s48, 0x8000
    v_mov_b32 v0, 0
    v_mov_b32 v1, 0
    v_mov_b32 v2, 0
    v_mov_b32 v3, 0
    v_mov_b32 v4, 0
    v_mov_b32 v5, 0
    v_mov_b32 v6, 0
    v_mov_b32 v7, 0
    v_mov_b32 v8, 0
    v_mov_b32 v9, 0
    v_mov_b32 v10, 0
    v_mov_b32 v11, 0
    v_mov_b32 v12, 0
    v_mov_b32 v13, 0
    v_mov_b32 v14, 0
    v_mov_b32 v15, 0
    v_mov_b32 v16, 0
    v_mov_b32 v17, 0
    v_mov_b32 v18, 0
    v_mov_b32 v19, 0
    v_mov_b32 v20, 0
    v_mov_b32 v21, 0
    v_mov_b32 v22, 0
    v_mov_b32 v23, 0
    v_mov_b32 v24, 0
    v_mov_b32 v25, 0
    v_mov_b32 v26, 0
    v_mov_b32 v27, 0
    v_mov_b32 v28, 0
    v_mov_b32 v29, 0
    v_mov_b32 v30, 0
    v_mov_b32 v31, 0
    v_mov_b32 v32, 0
    v_mov_b32 v33, 0
    v_mov_b32 v34, 0
    v_mov_b32 v35, 0
    v_mov_b32 v36, 0
    v_mov_b32 v37, 0
    v_mov_b32 v38, 0
    v_mov_b32 v39, 0
    v_mov_b32 v40, 0
    v_mov_b32 v41, 0
    v_mov_b32 v42, 0
    v_mov_b32 v43, 0
    v_mov_b32 v44, 0
    v_mov_b32 v45, 0
    v_mov_b32 v46, 0
    v_mov_b32 v47, 0
    v_mov_b32 v48, 0
    v_mov_b32 v49, 0
    v_mov_b32 v50, 0
    v_mov_b32 v51, 0
    v_mov_b32 v52, 0
    v_mov_b32 v53, 0
    v_mov_b32 v54, 0
    v_mov_b32 v55, 0
    v_mov_b32 v56, 0
    v_mov_b32 v57, 0
    v_mov_b32 v58, 0
    v_mov_b32 v59, 0
    v_mov_b32 v60, 0
    v_mov_b32 v61, 0
    v_mov_b32 v62, 0
    v_mov_b32 v63, 0
    s_waitcnt vmcnt(18)
    s_barrier
    ds_read_b64_tr_b16 v[64:65], v200 offset:0
    ds_read_b64_tr_b16 v[66:67], v200 offset:4096
    ds_read_b64_tr_b16 v[68:69], v201 offset:0
    ds_read_b64_tr_b16 v[70:71], v201 offset:4096
    ds_read_b64_tr_b16 v[72:73], v202 offset:0
    ds_read_b64_tr_b16 v[74:75], v202 offset:4096
    ds_read_b64_tr_b16 v[76:77], v203 offset:0
    ds_read_b64_tr_b16 v[78:79], v203 offset:4096
    ds_read_b64_tr_b16 v[80:81], v204 offset:0
    ds_read_b64_tr_b16 v[82:83], v204 offset:4096
    ds_read_b64_tr_b16 v[84:85], v205 offset:0
    ds_read_b64_tr_b16 v[86:87], v205 offset:4096
    ds_read_b64_tr_b16 v[88:89], v206 offset:0
    ds_read_b64_tr_b16 v[90:91], v206 offset:4096
    ds_read_b64_tr_b16 v[92:93], v207 offset:0
    ds_read_b64_tr_b16 v[94:95], v207 offset:4096
    s_mov_b32 s41, 8
L_oproj_loop:
    s_waitcnt vmcnt(12)
    s_waitcnt lgkmcnt(12)
    v_mfma_f32_16x16x32_bf16 v[0:3], v[64:67], v[128:131], v[0:3]
    ds_read_b64_tr_b16 v[96:97], v200 offset:8192
    ds_read_b64_tr_b16 v[98:99], v200 offset:12288
    v_mfma_f32_16x16x32_bf16 v[32:35], v[64:67], v[132:135], v[32:35]
    s_mov_b32 m0, s46
    s_nop 0
    buffer_load_dwordx4 v193, s[20:23], s40 offen offset:0 lds
    v_mfma_f32_16x16x32_bf16 v[4:7], v[68:71], v[128:131], v[4:7]
    ds_read_b64_tr_b16 v[100:101], v201 offset:8192
    ds_read_b64_tr_b16 v[102:103], v201 offset:12288
    v_mfma_f32_16x16x32_bf16 v[36:39], v[68:71], v[132:135], v[36:39]
    s_waitcnt lgkmcnt(12)
    v_mfma_f32_16x16x32_bf16 v[8:11], v[72:75], v[128:131], v[8:11]
    ds_read_b64_tr_b16 v[104:105], v202 offset:8192
    ds_read_b64_tr_b16 v[106:107], v202 offset:12288
    v_mfma_f32_16x16x32_bf16 v[40:43], v[72:75], v[132:135], v[40:43]
    buffer_load_dwordx4 v[160:163], v192, s[12:15], s39 offen offset:0 sc1
    v_mfma_f32_16x16x32_bf16 v[12:15], v[76:79], v[128:131], v[12:15]
    ds_read_b64_tr_b16 v[108:109], v203 offset:8192
    ds_read_b64_tr_b16 v[110:111], v203 offset:12288
    v_mfma_f32_16x16x32_bf16 v[44:47], v[76:79], v[132:135], v[44:47]
    s_waitcnt lgkmcnt(12)
    v_mfma_f32_16x16x32_bf16 v[16:19], v[80:83], v[128:131], v[16:19]
    ds_read_b64_tr_b16 v[112:113], v204 offset:8192
    ds_read_b64_tr_b16 v[114:115], v204 offset:12288
    v_mfma_f32_16x16x32_bf16 v[48:51], v[80:83], v[132:135], v[48:51]
    buffer_load_dwordx4 v194, s[20:23], s40 offen offset:1024 lds
    v_mfma_f32_16x16x32_bf16 v[20:23], v[84:87], v[128:131], v[20:23]
    ds_read_b64_tr_b16 v[116:117], v205 offset:8192
    ds_read_b64_tr_b16 v[118:119], v205 offset:12288
    v_mfma_f32_16x16x32_bf16 v[52:55], v[84:87], v[132:135], v[52:55]
    s_waitcnt lgkmcnt(12)
    v_mfma_f32_16x16x32_bf16 v[24:27], v[88:91], v[128:131], v[24:27]
    ds_read_b64_tr_b16 v[120:121], v206 offset:8192
    ds_read_b64_tr_b16 v[122:123], v206 offset:12288
    v_mfma_f32_16x16x32_bf16 v[56:59], v[88:91], v[132:135], v[56:59]
    buffer_load_dwordx4 v[164:167], v192, s[16:19], s39 offen offset:0 sc1
    v_mfma_f32_16x16x32_bf16 v[28:31], v[92:95], v[128:131], v[28:31]
    ds_read_b64_tr_b16 v[124:125], v207 offset:8192
    ds_read_b64_tr_b16 v[126:127], v207 offset:12288
    v_mfma_f32_16x16x32_bf16 v[60:63], v[92:95], v[132:135], v[60:63]
    s_waitcnt vmcnt(12)
    s_waitcnt vmcnt(5)
    s_barrier
    s_waitcnt lgkmcnt(12)
    v_mfma_f32_16x16x32_bf16 v[0:3], v[96:99], v[136:139], v[0:3]
    ds_read_b64_tr_b16 v[64:65], v200 offset:16384
    ds_read_b64_tr_b16 v[66:67], v200 offset:20480
    v_mfma_f32_16x16x32_bf16 v[32:35], v[96:99], v[140:143], v[32:35]
    buffer_load_dwordx4 v195, s[20:23], s40 offen offset:2048 lds
    v_mfma_f32_16x16x32_bf16 v[4:7], v[100:103], v[136:139], v[4:7]
    ds_read_b64_tr_b16 v[68:69], v201 offset:16384
    ds_read_b64_tr_b16 v[70:71], v201 offset:20480
    v_mfma_f32_16x16x32_bf16 v[36:39], v[100:103], v[140:143], v[36:39]
    s_waitcnt lgkmcnt(12)
    s_add_u32 s64, s63, s62
    v_mfma_f32_16x16x32_bf16 v[8:11], v[104:107], v[136:139], v[8:11]
    ds_read_b64_tr_b16 v[72:73], v202 offset:16384
    ds_read_b64_tr_b16 v[74:75], v202 offset:20480
    v_mfma_f32_16x16x32_bf16 v[40:43], v[104:107], v[140:143], v[40:43]
    buffer_load_dwordx4 v[168:171], v192, s[12:15], s39 offen offset:1024 sc1
    v_mfma_f32_16x16x32_bf16 v[12:15], v[108:111], v[136:139], v[12:15]
    ds_read_b64_tr_b16 v[76:77], v203 offset:16384
    ds_read_b64_tr_b16 v[78:79], v203 offset:20480
    v_mfma_f32_16x16x32_bf16 v[44:47], v[108:111], v[140:143], v[44:47]
    s_waitcnt lgkmcnt(12)
    s_and_b32 s64, s64, 3
    v_mfma_f32_16x16x32_bf16 v[16:19], v[112:115], v[136:139], v[16:19]
    ds_read_b64_tr_b16 v[80:81], v204 offset:16384
    ds_read_b64_tr_b16 v[82:83], v204 offset:20480
    v_mfma_f32_16x16x32_bf16 v[48:51], v[112:115], v[140:143], v[48:51]
    buffer_load_dwordx4 v196, s[20:23], s40 offen offset:3072 lds
    v_mfma_f32_16x16x32_bf16 v[20:23], v[116:119], v[136:139], v[20:23]
    ds_read_b64_tr_b16 v[84:85], v205 offset:16384
    ds_read_b64_tr_b16 v[86:87], v205 offset:20480
    v_mfma_f32_16x16x32_bf16 v[52:55], v[116:119], v[140:143], v[52:55]
    s_waitcnt lgkmcnt(12)
    s_andn2_b32 s67, s63, 3
    v_mfma_f32_16x16x32_bf16 v[24:27], v[120:123], v[136:139], v[24:27]
    ds_read_b64_tr_b16 v[88:89], v206 offset:16384
    ds_read_b64_tr_b16 v[90:91], v206 offset:20480
    v_mfma_f32_16x16x32_bf16 v[56:59], v[120:123], v[140:143], v[56:59]
    buffer_load_dwordx4 v[172:175], v192, s[16:19], s39 offen offset:1024 sc1
    v_mfma_f32_16x16x32_bf16 v[28:31], v[124:127], v[136:139], v[28:31]
    ds_read_b64_tr_b16 v[92:93], v207 offset:16384
    ds_read_b64_tr_b16 v[94:95], v207 offset:20480
    v_mfma_f32_16x16x32_bf16 v[60:63], v[124:127], v[140:143], v[60:63]
    s_or_b32 s64, s64, s67
    s_add_u32 s63, s63, 1
    s_lshl_b32 s39, s64, 11
    s_lshl_b32 s40, s64, 17
    s_waitcnt vmcnt(16)
    s_waitcnt lgkmcnt(12)
    v_mfma_f32_16x16x32_bf16 v[0:3], v[64:67], v[144:147], v[0:3]
    ds_read_b64_tr_b16 v[96:97], v200 offset:24576
    ds_read_b64_tr_b16 v[98:99], v200 offset:28672
    v_mfma_f32_16x16x32_bf16 v[32:35], v[64:67], v[148:151], v[32:35]
    s_mov_b32 m0, s47
    s_nop 0
    buffer_load_dwordx4 v193, s[20:23], s40 offen offset:0 lds
    v_mfma_f32_16x16x32_bf16 v[4:7], v[68:71], v[144:147], v[4:7]
    ds_read_b64_tr_b16 v[100:101], v201 offset:24576
    ds_read_b64_tr_b16 v[102:103], v201 offset:28672
    v_mfma_f32_16x16x32_bf16 v[36:39], v[68:71], v[148:151], v[36:39]
    s_waitcnt lgkmcnt(12)
    v_mfma_f32_16x16x32_bf16 v[8:11], v[72:75], v[144:147], v[8:11]
    ds_read_b64_tr_b16 v[104:105], v202 offset:24576
    ds_read_b64_tr_b16 v[106:107], v202 offset:28672
    v_mfma_f32_16x16x32_bf16 v[40:43], v[72:75], v[148:151], v[40:43]
    buffer_load_dwordx4 v[176:179], v192, s[12:15], s39 offen offset:0 sc1
    v_mfma_f32_16x16x32_bf16 v[12:15], v[76:79], v[144:147], v[12:15]
    ds_read_b64_tr_b16 v[108:109], v203 offset:24576
    ds_read_b64_tr_b16 v[110:111], v203 offset:28672
    v_mfma_f32_16x16x32_bf16 v[44:47], v[76:79], v[148:151], v[44:47]
    s_waitcnt lgkmcnt(12)
    v_mfma_f32_16x16x32_bf16 v[16:19], v[80:83], v[144:147], v[16:19]
    ds_read_b64_tr_b16 v[112:113], v204 offset:24576
    ds_read_b64_tr_b16 v[114:115], v204 offset:28672
    v_mfma_f32_16x16x32_bf16 v[48:51], v[80:83], v[148:151], v[48:51]
    buffer_load_dwordx4 v194, s[20:23], s40 offen offset:1024 lds
    v_mfma_f32_16x16x32_bf16 v[20:23], v[84:87], v[144:147], v[20:23]
    ds_read_b64_tr_b16 v[116:117], v205 offset:24576
    ds_read_b64_tr_b16 v[118:119], v205 offset:28672
    v_mfma_f32_16x16x32_bf16 v[52:55], v[84:87], v[148:151], v[52:55]
    s_waitcnt lgkmcnt(12)
    v_mfma_f32_16x16x32_bf16 v[24:27], v[88:91], v[144:147], v[24:27]
    ds_read_b64_tr_b16 v[120:121], v206 offset:24576
    ds_read_b64_tr_b16 v[122:123], v206 offset:28672
    v_mfma_f32_16x16x32_bf16 v[56:59], v[88:91], v[148:151], v[56:59]
    buffer_load_dwordx4 v[180:183], v192, s[16:19], s39 offen offset:0 sc1
    v_mfma_f32_16x16x32_bf16 v[28:31], v[92:95], v[144:147], v[28:31]
    ds_read_b64_tr_b16 v[124:125], v207 offset:24576
    ds_read_b64_tr_b16 v[126:127], v207 offset:28672
    v_mfma_f32_16x16x32_bf16 v[60:63], v[92:95], v[148:151], v[60:63]
    s_waitcnt vmcnt(12)
    s_waitcnt vmcnt(5)
    s_barrier
    s_waitcnt lgkmcnt(12)
    v_mfma_f32_16x16x32_bf16 v[0:3], v[96:99], v[152:155], v[0:3]
    ds_read_b64_tr_b16 v[64:65], v200 offset:32768
    ds_read_b64_tr_b16 v[66:67], v200 offset:36864
    v_mfma_f32_16x16x32_bf16 v[32:35], v[96:99], v[156:159], v[32:35]
    buffer_load_dwordx4 v195, s[20:23], s40 offen offset:2048 lds
    v_mfma_f32_16x16x32_bf16 v[4:7], v[100:103], v[152:155], v[4:7]
    ds_read_b64_tr_b16 v[68:69], v201 offset:32768
    ds_read_b64_tr_b16 v[70:71], v201 offset:36864
    v_mfma_f32_16x16x32_bf16 v[36:39], v[100:103], v[156:159], v[36:39]
    s_waitcnt lgkmcnt(12)
    s_add_u32 s64, s63, s62
    v_mfma_f32_16x16x32_bf16 v[8:11], v[104:107], v[152:155], v[8:11]
    ds_read_b64_tr_b16 v[72:73], v202 offset:32768
    ds_read_b64_tr_b16 v[74:75], v202 offset:36864
    v_mfma_f32_16x16x32_bf16 v[40:43], v[104:107], v[156:159], v[40:43]
    buffer_load_dwordx4 v[184:187], v192, s[12:15], s39 offen offset:1024 sc1
    v_mfma_f32_16x16x32_bf16 v[12:15], v[108:111], v[152:155], v[12:15]
    ds_read_b64_tr_b16 v[76:77], v203 offset:32768
    ds_read_b64_tr_b16 v[78:79], v203 offset:36864
    v_mfma_f32_16x16x32_bf16 v[44:47], v[108:111], v[156:159], v[44:47]
    s_waitcnt lgkmcnt(12)
    s_and_b32 s64, s64, 3
    v_mfma_f32_16x16x32_bf16 v[16:19], v[112:115], v[152:155], v[16:19]
    ds_read_b64_tr_b16 v[80:81], v204 offset:32768
    ds_read_b64_tr_b16 v[82:83], v204 offset:36864
    v_mfma_f32_16x16x32_bf16 v[48:51], v[112:115], v[156:159], v[48:51]
    buffer_load_dwordx4 v196, s[20:23], s40 offen offset:3072 lds
    v_mfma_f32_16x16x32_bf16 v[20:23], v[116:119], v[152:155], v[20:23]
    ds_read_b64_tr_b16 v[84:85], v205 offset:32768
    ds_read_b64_tr_b16 v[86:87], v205 offset:36864
    v_mfma_f32_16x16x32_bf16 v[52:55], v[116:119], v[156:159], v[52:55]
    s_waitcnt lgkmcnt(12)
    s_andn2_b32 s67, s63, 3
    v_mfma_f32_16x16x32_bf16 v[24:27], v[120:123], v[152:155], v[24:27]
    ds_read_b64_tr_b16 v[88:89], v206 offset:32768
    ds_read_b64_tr_b16 v[90:91], v206 offset:36864
    v_mfma_f32_16x16x32_bf16 v[56:59], v[120:123], v[156:159], v[56:59]
    buffer_load_dwordx4 v[188:191], v192, s[16:19], s39 offen offset:1024 sc1
    v_mfma_f32_16x16x32_bf16 v[28:31], v[124:127], v[152:155], v[28:31]
    ds_read_b64_tr_b16 v[92:93], v207 offset:32768
    ds_read_b64_tr_b16 v[94:95], v207 offset:36864
    v_mfma_f32_16x16x32_bf16 v[60:63], v[124:127], v[156:159], v[60:63]
    s_or_b32 s64, s64, s67
    s_add_u32 s63, s63, 1
    s_lshl_b32 s39, s64, 11
    s_lshl_b32 s40, s64, 17
    s_waitcnt lgkmcnt(12)
    v_mfma_f32_16x16x32_bf16 v[0:3], v[64:67], v[160:163], v[0:3]
    ds_read_b64_tr_b16 v[96:97], v200 offset:40960
    ds_read_b64_tr_b16 v[98:99], v200 offset:45056
    v_mfma_f32_16x16x32_bf16 v[32:35], v[64:67], v[164:167], v[32:35]
    s_mov_b32 m0, s44
    s_nop 0
    buffer_load_dwordx4 v193, s[20:23], s40 offen offset:0 lds
    v_mfma_f32_16x16x32_bf16 v[4:7], v[68:71], v[160:163], v[4:7]
    ds_read_b64_tr_b16 v[100:101], v201 offset:40960
    ds_read_b64_tr_b16 v[102:103], v201 offset:45056
    v_mfma_f32_16x16x32_bf16 v[36:39], v[68:71], v[164:167], v[36:39]
    s_waitcnt lgkmcnt(12)
    v_mfma_f32_16x16x32_bf16 v[8:11], v[72:75], v[160:163], v[8:11]
    ds_read_b64_tr_b16 v[104:105], v202 offset:40960
    ds_read_b64_tr_b16 v[106:107], v202 offset:45056
    v_mfma_f32_16x16x32_bf16 v[40:43], v[72:75], v[164:167], v[40:43]
    buffer_load_dwordx4 v[128:131], v192, s[12:15], s39 offen offset:0 sc1
    v_mfma_f32_16x16x32_bf16 v[12:15], v[76:79], v[160:163], v[12:15]
    ds_read_b64_tr_b16 v[108:109], v203 offset:40960
    ds_read_b64_tr_b16 v[110:111], v203 offset:45056
    v_mfma_f32_16x16x32_bf16 v[44:47], v[76:79], v[164:167], v[44:47]
    s_waitcnt lgkmcnt(12)
    v_mfma_f32_16x16x32_bf16 v[16:19], v[80:83], v[160:163], v[16:19]
    ds_read_b64_tr_b16 v[112:113], v204 offset:40960
    ds_read_b64_tr_b16 v[114:115], v204 offset:45056
    v_mfma_f32_16x16x32_bf16 v[48:51], v[80:83], v[164:167], v[48:51]
    buffer_load_dwordx4 v194, s[20:23], s40 offen offset:1024 lds
    v_mfma_f32_16x16x32_bf16 v[20:23], v[84:87], v[160:163], v[20:23]
    ds_read_b64_tr_b16 v[116:117], v205 offset:40960
    ds_read_b64_tr_b16 v[118:119], v205 offset:45056
    v_mfma_f32_16x16x32_bf16 v[52:55], v[84:87], v[164:167], v[52:55]
    s_waitcnt lgkmcnt(12)
    v_mfma_f32_16x16x32_bf16 v[24:27], v[88:91], v[160:163], v[24:27]
    ds_read_b64_tr_b16 v[120:121], v206 offset:40960
    ds_read_b64_tr_b16 v[122:123], v206 offset:45056
    v_mfma_f32_16x16x32_bf16 v[56:59], v[88:91], v[164:167], v[56:59]
    buffer_load_dwordx4 v[132:135], v192, s[16:19], s39 offen offset:0 sc1
    v_mfma_f32_16x16x32_bf16 v[28:31], v[92:95], v[160:163], v[28:31]
    ds_read_b64_tr_b16 v[124:125], v207 offset:40960
    ds_read_b64_tr_b16 v[126:127], v207 offset:45056
    v_mfma_f32_16x16x32_bf16 v[60:63], v[92:95], v[164:167], v[60:63]
    s_waitcnt vmcnt(12)
    s_waitcnt vmcnt(5)
    s_barrier
    s_waitcnt lgkmcnt(12)
    v_mfma_f32_16x16x32_bf16 v[0:3], v[96:99], v[168:171], v[0:3]
    ds_read_b64_tr_b16 v[64:65], v200 offset:49152
    ds_read_b64_tr_b16 v[66:67], v200 offset:53248
    v_mfma_f32_16x16x32_bf16 v[32:35], v[96:99], v[172:175], v[32:35]
    buffer_load_dwordx4 v195, s[20:23], s40 offen offset:2048 lds
    v_mfma_f32_16x16x32_bf16 v[4:7], v[100:103], v[168:171], v[4:7]
    ds_read_b64_tr_b16 v[68:69], v201 offset:49152
    ds_read_b64_tr_b16 v[70:71], v201 offset:53248
    v_mfma_f32_16x16x32_bf16 v[36:39], v[100:103], v[172:175], v[36:39]
    s_waitcnt lgkmcnt(12)
    s_add_u32 s64, s63, s62
    v_mfma_f32_16x16x32_bf16 v[8:11], v[104:107], v[168:171], v[8:11]
    ds_read_b64_tr_b16 v[72:73], v202 offset:49152
    ds_read_b64_tr_b16 v[74:75], v202 offset:53248
    v_mfma_f32_16x16x32_bf16 v[40:43], v[104:107], v[172:175], v[40:43]
    buffer_load_dwordx4 v[136:139], v192, s[12:15], s39 offen offset:1024 sc1
    v_mfma_f32_16x16x32_bf16 v[12:15], v[108:111], v[168:171], v[12:15]
    ds_read_b64_tr_b16 v[76:77], v203 offset:49152
    ds_read_b64_tr_b16 v[78:79], v203 offset:53248
    v_mfma_f32_16x16x32_bf16 v[44:47], v[108:111], v[172:175], v[44:47]
    s_waitcnt lgkmcnt(12)
    s_and_b32 s64, s64, 3
    v_mfma_f32_16x16x32_bf16 v[16:19], v[112:115], v[168:171], v[16:19]
    ds_read_b64_tr_b16 v[80:81], v204 offset:49152
    ds_read_b64_tr_b16 v[82:83], v204 offset:53248
    v_mfma_f32_16x16x32_bf16 v[48:51], v[112:115], v[172:175], v[48:51]
    buffer_load_dwordx4 v196, s[20:23], s40 offen offset:3072 lds
    v_mfma_f32_16x16x32_bf16 v[20:23], v[116:119], v[168:171], v[20:23]
    ds_read_b64_tr_b16 v[84:85], v205 offset:49152
    ds_read_b64_tr_b16 v[86:87], v205 offset:53248
    v_mfma_f32_16x16x32_bf16 v[52:55], v[116:119], v[172:175], v[52:55]
    s_waitcnt lgkmcnt(12)
    s_andn2_b32 s67, s63, 3
    v_mfma_f32_16x16x32_bf16 v[24:27], v[120:123], v[168:171], v[24:27]
    ds_read_b64_tr_b16 v[88:89], v206 offset:49152
    ds_read_b64_tr_b16 v[90:91], v206 offset:53248
    v_mfma_f32_16x16x32_bf16 v[56:59], v[120:123], v[172:175], v[56:59]
    buffer_load_dwordx4 v[140:143], v192, s[16:19], s39 offen offset:1024 sc1
    v_mfma_f32_16x16x32_bf16 v[28:31], v[124:127], v[168:171], v[28:31]
    ds_read_b64_tr_b16 v[92:93], v207 offset:49152
    ds_read_b64_tr_b16 v[94:95], v207 offset:53248
    v_mfma_f32_16x16x32_bf16 v[60:63], v[124:127], v[172:175], v[60:63]
    s_or_b32 s64, s64, s67
    s_add_u32 s63, s63, 1
    s_lshl_b32 s39, s64, 11
    s_lshl_b32 s40, s64, 17
    s_waitcnt lgkmcnt(12)
    v_mfma_f32_16x16x32_bf16 v[0:3], v[64:67], v[176:179], v[0:3]
    ds_read_b64_tr_b16 v[96:97], v200 offset:57344
    ds_read_b64_tr_b16 v[98:99], v200 offset:61440
    v_mfma_f32_16x16x32_bf16 v[32:35], v[64:67], v[180:183], v[32:35]
    s_mov_b32 m0, s45
    s_nop 0
    buffer_load_dwordx4 v193, s[20:23], s40 offen offset:0 lds
    v_mfma_f32_16x16x32_bf16 v[4:7], v[68:71], v[176:179], v[4:7]
    ds_read_b64_tr_b16 v[100:101], v201 offset:57344
    ds_read_b64_tr_b16 v[102:103], v201 offset:61440
    v_mfma_f32_16x16x32_bf16 v[36:39], v[68:71], v[180:183], v[36:39]
    s_waitcnt lgkmcnt(12)
    v_mfma_f32_16x16x32_bf16 v[8:11], v[72:75], v[176:179], v[8:11]
    ds_read_b64_tr_b16 v[104:105], v202 offset:57344
    ds_read_b64_tr_b16 v[106:107], v202 offset:61440
    v_mfma_f32_16x16x32_bf16 v[40:43], v[72:75], v[180:183], v[40:43]
    buffer_load_dwordx4 v[144:147], v192, s[12:15], s39 offen offset:0 sc1
    v_mfma_f32_16x16x32_bf16 v[12:15], v[76:79], v[176:179], v[12:15]
    ds_read_b64_tr_b16 v[108:109], v203 offset:57344
    ds_read_b64_tr_b16 v[110:111], v203 offset:61440
    v_mfma_f32_16x16x32_bf16 v[44:47], v[76:79], v[180:183], v[44:47]
    s_waitcnt lgkmcnt(12)
    v_mfma_f32_16x16x32_bf16 v[16:19], v[80:83], v[176:179], v[16:19]
    ds_read_b64_tr_b16 v[112:113], v204 offset:57344
    ds_read_b64_tr_b16 v[114:115], v204 offset:61440
    v_mfma_f32_16x16x32_bf16 v[48:51], v[80:83], v[180:183], v[48:51]
    buffer_load_dwordx4 v194, s[20:23], s40 offen offset:1024 lds
    v_mfma_f32_16x16x32_bf16 v[20:23], v[84:87], v[176:179], v[20:23]
    ds_read_b64_tr_b16 v[116:117], v205 offset:57344
    ds_read_b64_tr_b16 v[118:119], v205 offset:61440
    v_mfma_f32_16x16x32_bf16 v[52:55], v[84:87], v[180:183], v[52:55]
    s_waitcnt lgkmcnt(12)
    v_mfma_f32_16x16x32_bf16 v[24:27], v[88:91], v[176:179], v[24:27]
    ds_read_b64_tr_b16 v[120:121], v206 offset:57344
    ds_read_b64_tr_b16 v[122:123], v206 offset:61440
    v_mfma_f32_16x16x32_bf16 v[56:59], v[88:91], v[180:183], v[56:59]
    buffer_load_dwordx4 v[148:151], v192, s[16:19], s39 offen offset:0 sc1
    v_mfma_f32_16x16x32_bf16 v[28:31], v[92:95], v[176:179], v[28:31]
    ds_read_b64_tr_b16 v[124:125], v207 offset:57344
    ds_read_b64_tr_b16 v[126:127], v207 offset:61440
    v_mfma_f32_16x16x32_bf16 v[60:63], v[92:95], v[180:183], v[60:63]
    s_waitcnt vmcnt(12)
    s_waitcnt vmcnt(5)
    s_barrier
    s_waitcnt lgkmcnt(12)
    v_mfma_f32_16x16x32_bf16 v[0:3], v[96:99], v[184:187], v[0:3]
    ds_read_b64_tr_b16 v[64:65], v200 offset:0
    ds_read_b64_tr_b16 v[66:67], v200 offset:4096
    v_mfma_f32_16x16x32_bf16 v[32:35], v[96:99], v[188:191], v[32:35]
    buffer_load_dwordx4 v195, s[20:23], s40 offen offset:2048 lds
    v_mfma_f32_16x16x32_bf16 v[4:7], v[100:103], v[184:187], v[4:7]
    ds_read_b64_tr_b16 v[68:69], v201 offset:0
    ds_read_b64_tr_b16 v[70:71], v201 offset:4096
    v_mfma_f32_16x16x32_bf16 v[36:39], v[100:103], v[188:191], v[36:39]
    s_waitcnt lgkmcnt(12)
    s_add_u32 s64, s63, s62
    v_mfma_f32_16x16x32_bf16 v[8:11], v[104:107], v[184:187], v[8:11]
    ds_read_b64_tr_b16 v[72:73], v202 offset:0
    ds_read_b64_tr_b16 v[74:75], v202 offset:4096
    v_mfma_f32_16x16x32_bf16 v[40:43], v[104:107], v[188:191], v[40:43]
    buffer_load_dwordx4 v[152:155], v192, s[12:15], s39 offen offset:1024 sc1
    v_mfma_f32_16x16x32_bf16 v[12:15], v[108:111], v[184:187], v[12:15]
    ds_read_b64_tr_b16 v[76:77], v203 offset:0
    ds_read_b64_tr_b16 v[78:79], v203 offset:4096
    v_mfma_f32_16x16x32_bf16 v[44:47], v[108:111], v[188:191], v[44:47]
    s_waitcnt lgkmcnt(12)
    s_and_b32 s64, s64, 3
    v_mfma_f32_16x16x32_bf16 v[16:19], v[112:115], v[184:187], v[16:19]
    ds_read_b64_tr_b16 v[80:81], v204 offset:0
    ds_read_b64_tr_b16 v[82:83], v204 offset:4096
    v_mfma_f32_16x16x32_bf16 v[48:51], v[112:115], v[188:191], v[48:51]
    buffer_load_dwordx4 v196, s[20:23], s40 offen offset:3072 lds
    v_mfma_f32_16x16x32_bf16 v[20:23], v[116:119], v[184:187], v[20:23]
    ds_read_b64_tr_b16 v[84:85], v205 offset:0
    ds_read_b64_tr_b16 v[86:87], v205 offset:4096
    v_mfma_f32_16x16x32_bf16 v[52:55], v[116:119], v[188:191], v[52:55]
    s_waitcnt lgkmcnt(12)
    s_andn2_b32 s67, s63, 3
    v_mfma_f32_16x16x32_bf16 v[24:27], v[120:123], v[184:187], v[24:27]
    ds_read_b64_tr_b16 v[88:89], v206 offset:0
    ds_read_b64_tr_b16 v[90:91], v206 offset:4096
    v_mfma_f32_16x16x32_bf16 v[56:59], v[120:123], v[188:191], v[56:59]
    buffer_load_dwordx4 v[156:159], v192, s[16:19], s39 offen offset:1024 sc1
    v_mfma_f32_16x16x32_bf16 v[28:31], v[124:127], v[184:187], v[28:31]
    ds_read_b64_tr_b16 v[92:93], v207 offset:0
    ds_read_b64_tr_b16 v[94:95], v207 offset:4096
    v_mfma_f32_16x16x32_bf16 v[60:63], v[124:127], v[188:191], v[60:63]
    s_or_b32 s64, s64, s67
    s_add_u32 s63, s63, 1
    s_lshl_b32 s39, s64, 11
    s_lshl_b32 s40, s64, 17
    s_sub_u32 s41, s41, 1
    s_cmp_lg_u32 s41, 0
    s_cbranch_scc1 L_oproj_loop
    s_waitcnt lgkmcnt(0)
    s_nop 7
    v_lshrrev_b32 v214, 4, v212
    v_and_b32 v215, 1, v214
    v_lshlrev_b32 v215, 5, v215
    v_lshrrev_b32 v216, 1, v214
    v_lshl_add_u32 v215, v216, 4, v215
    v_lshlrev_b32 v214, 4, v214
    v_sub_u32 v215, v215, v214
    v_add_u32 v208, v208, v215
    v_cvt_pk_bf16_f32 v64, v0, v1
    v_cvt_pk_bf16_f32 v65, v2, v3
    v_cvt_pk_bf16_f32 v66, v4, v5
    v_cvt_pk_bf16_f32 v67, v6, v7
    s_nop 0
    v_permlane16_swap_b32 v64, v66
    v_permlane16_swap_b32 v65, v67
    buffer_store_dwordx4 v[64:67], v208, s[28:31], 0 offen offset:0 sc1
    v_cvt_pk_bf16_f32 v68, v8, v9
    v_cvt_pk_bf16_f32 v69, v10, v11
    v_cvt_pk_bf16_f32 v70, v12, v13
    v_cvt_pk_bf16_f32 v71, v14, v15
    s_nop 0
    v_permlane16_swap_b32 v68, v70
    v_permlane16_swap_b32 v69, v71
    buffer_store_dwordx4 v[68:71], v208, s[28:31], 0 offen offset:64 sc1
    v_cvt_pk_bf16_f32 v72, v16, v17
    v_cvt_pk_bf16_f32 v73, v18, v19
    v_cvt_pk_bf16_f32 v74, v20, v21
    v_cvt_pk_bf16_f32 v75, v22, v23
    s_nop 0
    v_permlane16_swap_b32 v72, v74
    v_permlane16_swap_b32 v73, v75
    buffer_store_dwordx4 v[72:75], v208, s[28:31], 0 offen offset:128 sc1
    v_cvt_pk_bf16_f32 v76, v24, v25
    v_cvt_pk_bf16_f32 v77, v26, v27
    v_cvt_pk_bf16_f32 v78, v28, v29
    v_cvt_pk_bf16_f32 v79, v30, v31
    s_nop 0
    v_permlane16_swap_b32 v76, v78
    v_permlane16_swap_b32 v77, v79
    buffer_store_dwordx4 v[76:79], v208, s[28:31], 0 offen offset:192 sc1
    v_cvt_pk_bf16_f32 v64, v32, v33
    v_cvt_pk_bf16_f32 v65, v34, v35
    v_cvt_pk_bf16_f32 v66, v36, v37
    v_cvt_pk_bf16_f32 v67, v38, v39
    s_nop 0
    v_permlane16_swap_b32 v64, v66
    v_permlane16_swap_b32 v65, v67
    buffer_store_dwordx4 v[64:67], v208, s[28:31], s48 offen offset:0 sc1
    v_cvt_pk_bf16_f32 v68, v40, v41
    v_cvt_pk_bf16_f32 v69, v42, v43
    v_cvt_pk_bf16_f32 v70, v44, v45
    v_cvt_pk_bf16_f32 v71, v46, v47
    s_nop 0
    v_permlane16_swap_b32 v68, v70
    v_permlane16_swap_b32 v69, v71
    buffer_store_dwordx4 v[68:71], v208, s[28:31], s48 offen offset:64 sc1
    v_cvt_pk_bf16_f32 v72, v48, v49
    v_cvt_pk_bf16_f32 v73, v50, v51
    v_cvt_pk_bf16_f32 v74, v52, v53
    v_cvt_pk_bf16_f32 v75, v54, v55
    s_nop 0
    v_permlane16_swap_b32 v72, v74
    v_permlane16_swap_b32 v73, v75
    buffer_store_dwordx4 v[72:75], v208, s[28:31], s48 offen offset:128 sc1
    v_cvt_pk_bf16_f32 v76, v56, v57
    v_cvt_pk_bf16_f32 v77, v58, v59
    v_cvt_pk_bf16_f32 v78, v60, v61
    v_cvt_pk_bf16_f32 v79, v62, v63
    s_nop 0
    v_permlane16_swap_b32 v76, v78
    v_permlane16_swap_b32 v77, v79
    buffer_store_dwordx4 v[76:79], v208, s[28:31], s48 offen offset:192 sc1
    s_lshl_b32 s42, s38, 1
    s_add_u32 s42, s42, s49
    s_lshl_b32 s42, s42, 3
    s_lshl_b32 s43, s37, 7
    s_add_u32 s50, s42, s43
    v_and_b32 v1, 7, v212
    v_lshrrev_b32 v2, 3, v212
    v_add_u32 v3, s50, v1
    s_lshl_b32 s42, s36, 5
    v_add_u32 v2, s42, v2
    v_lshlrev_b32 v4, 11, v3
    v_lshl_add_u32 v5, v2, 4, v4
    s_mov_b32 s12, s8
    s_mov_b32 s13, s9
    s_mov_b32 s14, 0x400000
    s_mov_b32 s15, 0x20000
    s_add_u32 s16, s4, 0x3000000
    s_addc_u32 s17, s5, 0
    s_mov_b32 s18, 0x800000
    s_mov_b32 s19, 0x20000
    s_add_u32 s20, s4, 0x20000
    s_addc_u32 s21, s5, 0
    s_mov_b32 s22, 0xc000
    s_mov_b32 s23, 0x20000
    s_add_u32 s24, s4, 0x60000
    s_addc_u32 s25, s5, 0
    s_mov_b32 s26, 0x6800
    s_mov_b32 s27, 0x20000
    buffer_load_dwordx4 v[16:19], v5, s[12:15], 0 offen offset:0
    buffer_load_dwordx4 v[20:23], v5, s[12:15], 0 offen offset:128
    buffer_load_dwordx4 v[24:27], v5, s[12:15], 0 offen offset:256
    buffer_load_dwordx4 v[28:31], v5, s[12:15], 0 offen offset:384
    v_lshlrev_b32 v6, 4, v210
    v_add_u32 v46, 114688, v6
    s_cmp_lg_u32 s36, 0
    s_cbranch_scc1 L_oproj_mok
    v_lshlrev_b32 v7, 7, v212
    v_add_u32 v7, 7168, v7
    s_mov_b64 s[52:53], exec
    s_mov_b64 exec, 0xff
    s_mov_b32 s42, 0x40000
L_oproj_mpoll:
    buffer_load_dword v8, v7, s[24:27], 0 offen sc1
    s_waitcnt vmcnt(0)
    v_cmp_ne_u32 vcc, 32, v8
    s_cbranch_vccz L_oproj_mdone
    s_sleep 1
    s_sub_u32 s42, s42, 1
    s_cmp_lg_u32 s42, 0
    s_cbranch_scc1 L_oproj_mpoll
L_oproj_mdone:
    s_mov_b64 exec, s[52:53]
L_oproj_mok:
    s_waitcnt vmcnt(4)
    s_barrier
    s_cmp_lg_u32 s36, 0
    s_cbranch_scc1 L_oproj_sig
    s_lshl_b32 s42, s37, 7
    v_mov_b32 v7, s42
    v_mov_b32 v8, 1
    s_mov_b64 s[52:53], exec
    s_mov_b64 exec, 1
    buffer_atomic_add v8, v7, s[24:27], 0 offen
    s_mov_b64 exec, s[52:53]
L_oproj_sig:
    s_mov_b32 s42, 8192
    s_mov_b32 s43, 12288
    s_mov_b32 s51, 16384
    buffer_load_dwordx4 v[32:35], v6, s[20:23], s42 offen sc1
    buffer_load_dwordx4 v[36:39], v6, s[20:23], s43 offen sc1
    buffer_load_dwordx4 v[40:43], v6, s[20:23], s51 offen sc1
    s_add_u32 s42, s42, 24576
    s_add_u32 s43, s43, 24576
    s_add_u32 s51, s51, 24576
    buffer_load_dwordx4 v[80:83], v6, s[20:23], s42 offen sc1
    buffer_load_dwordx4 v[84:87], v6, s[20:23], s43 offen sc1
    buffer_load_dwordx4 v[88:91], v6, s[20:23], s51 offen sc1
    s_waitcnt vmcnt(0)
    v_add_f32 v32, v32, v80
    v_add_f32 v33, v33, v81
    v_add_f32 v34, v34, v82
    v_add_f32 v35, v35, v83
    v_add_f32 v36, v36, v84
    v_add_f32 v37, v37, v85
    v_add_f32 v38, v38, v86
    v_add_f32 v39, v39, v87
    v_add_f32 v40, v40, v88
    v_add_f32 v41, v41, v89
    v_add_f32 v42, v42, v90
    v_add_f32 v43, v43, v91
    v_cvt_pk_bf16_f32 v44, v32, v33
    v_lshlrev_b32 v32, 16, v44
    v_and_b32 v33, 0xffff0000, v44
    v_cvt_pk_bf16_f32 v45, v34, v35
    v_lshlrev_b32 v34, 16, v45
    v_and_b32 v35, 0xffff0000, v45
    v_cvt_pk_bf16_f32 v44, v36, v37
    v_lshlrev_b32 v36, 16, v44
    v_and_b32 v37, 0xffff0000, v44
    v_cvt_pk_bf16_f32 v45, v38, v39
    v_lshlrev_b32 v38, 16, v45
    v_and_b32 v39, 0xffff0000, v45
    v_cvt_pk_bf16_f32 v44, v40, v41
    v_lshlrev_b32 v40, 16, v44
    v_and_b32 v41, 0xffff0000, v44
    v_cvt_pk_bf16_f32 v45, v42, v43
    v_lshlrev_b32 v42, 16, v45
    v_and_b32 v43, 0xffff0000, v45
    v_add_f32 v40, 1.0, v40
    v_add_f32 v41, 1.0, v41
    v_add_f32 v42, 1.0, v42
    v_add_f32 v43, 1.0, v43
    v_cvt_pk_bf16_f32 v44, v40, v41
    v_lshlrev_b32 v40, 16, v44
    v_and_b32 v41, 0xffff0000, v44
    v_cvt_pk_bf16_f32 v44, v42, v43
    v_lshlrev_b32 v42, 16, v44
    v_and_b32 v43, 0xffff0000, v44
    ds_write_b128 v46, v[32:35] offset:1024
    ds_write_b128 v46, v[36:39] offset:5120
    ds_write_b128 v46, v[40:43] offset:9216
    s_cmp_lg_u32 s36, 0
    s_cbranch_scc1 L_oproj_go
    s_mov_b64 s[52:53], exec
    s_mov_b64 exec, 1
    s_mov_b32 s42, 0x40000
L_oproj_poll:
    buffer_load_dword v8, v7, s[24:27], 0 offen sc1
    s_waitcnt vmcnt(0)
    v_cmp_ne_u32 vcc, 16, v8
    s_cbranch_vccz L_oproj_polled
    s_sleep 1
    s_sub_u32 s42, s42, 1
    s_cmp_lg_u32 s42, 0
    s_cbranch_scc1 L_oproj_poll
L_oproj_polled:
    s_mov_b64 exec, s[52:53]
L_oproj_go:
    s_waitcnt lgkmcnt(0)
    s_barrier
    s_mov_b32 s42, 0x400000
    buffer_load_dwordx4 v[48:51], v5, s[16:19], 0 offen offset:0 sc1
    buffer_load_dwordx4 v[64:67], v5, s[16:19], s42 offen offset:0 sc1
    buffer_load_dwordx4 v[52:55], v5, s[16:19], 0 offen offset:128 sc1
    buffer_load_dwordx4 v[68:71], v5, s[16:19], s42 offen offset:128 sc1
    buffer_load_dwordx4 v[56:59], v5, s[16:19], 0 offen offset:256 sc1
    buffer_load_dwordx4 v[72:75], v5, s[16:19], s42 offen offset:256 sc1
    buffer_load_dwordx4 v[60:63], v5, s[16:19], 0 offen offset:384 sc1
    buffer_load_dwordx4 v[76:79], v5, s[16:19], s42 offen offset:384 sc1
    s_add_u32 s28, s4, 0x500000
    s_addc_u32 s29, s5, 0
    s_mov_b32 s30, 0x400000
    s_mov_b32 s31, 0x20000
    s_add_u32 s32, s4, 0x900000
    s_addc_u32 s33, s5, 0
    s_mov_b32 s34, 0x400000
    s_mov_b32 s35, 0x20000
    v_lshlrev_b32 v9, 5, v2
    v_add_u32 v9, 114688, v9
    v_lshrrev_b32 v10, 2, v2
    v_and_b32 v11, 1, v2
    v_lshlrev_b32 v11, 1, v11
    v_bfe_u32 v12, v2, 1, 1
    v_sub_u32 v11, v11, v12
    v_add_u32 v11, 1, v11
    v_lshl_add_u32 v12, v10, 6, v4
    v_lshl_add_u32 v12, v11, 4, v12
    ds_read_b128 v[128:131], v9 offset:1024
    ds_read_b128 v[132:135], v9 offset:1040
    s_waitcnt vmcnt(6)
    v_lshlrev_b32 v136, 16, v48
    v_and_b32 v137, 0xffff0000, v48
    v_lshlrev_b32 v138, 16, v49
    v_and_b32 v139, 0xffff0000, v49
    v_lshlrev_b32 v140, 16, v50
    v_and_b32 v141, 0xffff0000, v50
    v_lshlrev_b32 v142, 16, v51
    v_and_b32 v143, 0xffff0000, v51
    v_lshlrev_b32 v144, 16, v64
    v_and_b32 v145, 0xffff0000, v64
    v_lshlrev_b32 v146, 16, v65
    v_and_b32 v147, 0xffff0000, v65
    v_lshlrev_b32 v148, 16, v66
    v_and_b32 v149, 0xffff0000, v66
    v_lshlrev_b32 v150, 16, v67
    v_and_b32 v151, 0xffff0000, v67
    v_lshlrev_b32 v96, 16, v16
    v_and_b32 v97, 0xffff0000, v16
    v_lshlrev_b32 v98, 16, v17
    v_and_b32 v99, 0xffff0000, v17
    v_lshlrev_b32 v100, 16, v18
    v_and_b32 v101, 0xffff0000, v18
    v_lshlrev_b32 v102, 16, v19
    v_and_b32 v103, 0xffff0000, v19
    v_pk_add_f32 v[136:137], v[136:137], v[144:145]
    v_pk_add_f32 v[138:139], v[138:139], v[146:147]
    v_pk_add_f32 v[140:141], v[140:141], v[148:149]
    v_pk_add_f32 v[142:143], v[142:143], v[150:151]
    s_waitcnt lgkmcnt(0)
    v_pk_fma_f32 v[96:97], v[136:137], v[128:129], v[96:97]
    v_pk_fma_f32 v[98:99], v[138:139], v[130:131], v[98:99]
    v_pk_fma_f32 v[100:101], v[140:141], v[132:133], v[100:101]
    v_pk_fma_f32 v[102:103], v[142:143], v[134:135], v[102:103]
    v_cvt_pk_bf16_f32 v152, v100, v101
    v_lshlrev_b32 v100, 16, v152
    v_and_b32 v101, 0xffff0000, v152
    v_cvt_pk_bf16_f32 v153, v102, v103
    v_lshlrev_b32 v102, 16, v153
    v_and_b32 v103, 0xffff0000, v153
    v_cvt_pk_bf16_f32 v154, v96, v97
    v_lshlrev_b32 v96, 16, v154
    v_and_b32 v97, 0xffff0000, v154
    v_cvt_pk_bf16_f32 v155, v98, v99
    v_lshlrev_b32 v98, 16, v155
    v_and_b32 v99, 0xffff0000, v155
    v_permlane16_swap_b32 v152, v154
    v_permlane16_swap_b32 v153, v155
    buffer_store_dwordx4 v[152:155], v12, s[28:31], 0 offen offset:0 sc1
    ds_read_b128 v[128:131], v9 offset:1280
    ds_read_b128 v[132:135], v9 offset:1296
    s_waitcnt vmcnt(5)
    v_lshlrev_b32 v136, 16, v52
    v_and_b32 v137, 0xffff0000, v52
    v_lshlrev_b32 v138, 16, v53
    v_and_b32 v139, 0xffff0000, v53
    v_lshlrev_b32 v140, 16, v54
    v_and_b32 v141, 0xffff0000, v54
    v_lshlrev_b32 v142, 16, v55
    v_and_b32 v143, 0xffff0000, v55
    v_lshlrev_b32 v144, 16, v68
    v_and_b32 v145, 0xffff0000, v68
    v_lshlrev_b32 v146, 16, v69
    v_and_b32 v147, 0xffff0000, v69
    v_lshlrev_b32 v148, 16, v70
    v_and_b32 v149, 0xffff0000, v70
    v_lshlrev_b32 v150, 16, v71
    v_and_b32 v151, 0xffff0000, v71
    v_lshlrev_b32 v104, 16, v20
    v_and_b32 v105, 0xffff0000, v20
    v_lshlrev_b32 v106, 16, v21
    v_and_b32 v107, 0xffff0000, v21
    v_lshlrev_b32 v108, 16, v22
    v_and_b32 v109, 0xffff0000, v22
    v_lshlrev_b32 v110, 16, v23
    v_and_b32 v111, 0xffff0000, v23
    v_pk_add_f32 v[136:137], v[136:137], v[144:145]
    v_pk_add_f32 v[138:139], v[138:139], v[146:147]
    v_pk_add_f32 v[140:141], v[140:141], v[148:149]
    v_pk_add_f32 v[142:143], v[142:143], v[150:151]
    s_waitcnt lgkmcnt(0)
    v_pk_fma_f32 v[104:105], v[136:137], v[128:129], v[104:105]
    v_pk_fma_f32 v[106:107], v[138:139], v[130:131], v[106:107]
    v_pk_fma_f32 v[108:109], v[140:141], v[132:133], v[108:109]
    v_pk_fma_f32 v[110:111], v[142:143], v[134:135], v[110:111]
    v_cvt_pk_bf16_f32 v156, v108, v109
    v_lshlrev_b32 v108, 16, v156
    v_and_b32 v109, 0xffff0000, v156
    v_cvt_pk_bf16_f32 v157, v110, v111
    v_lshlrev_b32 v110, 16, v157
    v_and_b32 v111, 0xffff0000, v157
    v_cvt_pk_bf16_f32 v158, v104, v105
    v_lshlrev_b32 v104, 16, v158
    v_and_b32 v105, 0xffff0000, v158
    v_cvt_pk_bf16_f32 v159, v106, v107
    v_lshlrev_b32 v106, 16, v159
    v_and_b32 v107, 0xffff0000, v159
    v_permlane16_swap_b32 v156, v158
    v_permlane16_swap_b32 v157, v159
    buffer_store_dwordx4 v[156:159], v12, s[28:31], 0 offen offset:128 sc1
    ds_read_b128 v[128:131], v9 offset:1536
    ds_read_b128 v[132:135], v9 offset:1552
    s_waitcnt vmcnt(4)
    v_lshlrev_b32 v136, 16, v56
    v_and_b32 v137, 0xffff0000, v56
    v_lshlrev_b32 v138, 16, v57
    v_and_b32 v139, 0xffff0000, v57
    v_lshlrev_b32 v140, 16, v58
    v_and_b32 v141, 0xffff0000, v58
    v_lshlrev_b32 v142, 16, v59
    v_and_b32 v143, 0xffff0000, v59
    v_lshlrev_b32 v144, 16, v72
    v_and_b32 v145, 0xffff0000, v72
    v_lshlrev_b32 v146, 16, v73
    v_and_b32 v147, 0xffff0000, v73
    v_lshlrev_b32 v148, 16, v74
    v_and_b32 v149, 0xffff0000, v74
    v_lshlrev_b32 v150, 16, v75
    v_and_b32 v151, 0xffff0000, v75
    v_lshlrev_b32 v112, 16, v24
    v_and_b32 v113, 0xffff0000, v24
    v_lshlrev_b32 v114, 16, v25
    v_and_b32 v115, 0xffff0000, v25
    v_lshlrev_b32 v116, 16, v26
    v_and_b32 v117, 0xffff0000, v26
    v_lshlrev_b32 v118, 16, v27
    v_and_b32 v119, 0xffff0000, v27
    v_pk_add_f32 v[136:137], v[136:137], v[144:145]
    v_pk_add_f32 v[138:139], v[138:139], v[146:147]
    v_pk_add_f32 v[140:141], v[140:141], v[148:149]
    v_pk_add_f32 v[142:143], v[142:143], v[150:151]
    s_waitcnt lgkmcnt(0)
    v_pk_fma_f32 v[112:113], v[136:137], v[128:129], v[112:113]
    v_pk_fma_f32 v[114:115], v[138:139], v[130:131], v[114:115]
    v_pk_fma_f32 v[116:117], v[140:141], v[132:133], v[116:117]
    v_pk_fma_f32 v[118:119], v[142:143], v[134:135], v[118:119]
    v_cvt_pk_bf16_f32 v152, v116, v117
    v_lshlrev_b32 v116, 16, v152
    v_and_b32 v117, 0xffff0000, v152
    v_cvt_pk_bf16_f32 v153, v118, v119
    v_lshlrev_b32 v118, 16, v153
    v_and_b32 v119, 0xffff0000, v153
    v_cvt_pk_bf16_f32 v154, v112, v113
    v_lshlrev_b32 v112, 16, v154
    v_and_b32 v113, 0xffff0000, v154
    v_cvt_pk_bf16_f32 v155, v114, v115
    v_lshlrev_b32 v114, 16, v155
    v_and_b32 v115, 0xffff0000, v155
    v_permlane16_swap_b32 v152, v154
    v_permlane16_swap_b32 v153, v155
    buffer_store_dwordx4 v[152:155], v12, s[28:31], 0 offen offset:256 sc1
    ds_read_b128 v[128:131], v9 offset:1792
    ds_read_b128 v[132:135], v9 offset:1808
    s_waitcnt vmcnt(3)
    v_lshlrev_b32 v136, 16, v60
    v_and_b32 v137, 0xffff0000, v60
    v_lshlrev_b32 v138, 16, v61
    v_and_b32 v139, 0xffff0000, v61
    v_lshlrev_b32 v140, 16, v62
    v_and_b32 v141, 0xffff0000, v62
    v_lshlrev_b32 v142, 16, v63
    v_and_b32 v143, 0xffff0000, v63
    v_lshlrev_b32 v144, 16, v76
    v_and_b32 v145, 0xffff0000, v76
    v_lshlrev_b32 v146, 16, v77
    v_and_b32 v147, 0xffff0000, v77
    v_lshlrev_b32 v148, 16, v78
    v_and_b32 v149, 0xffff0000, v78
    v_lshlrev_b32 v150, 16, v79
    v_and_b32 v151, 0xffff0000, v79
    v_lshlrev_b32 v120, 16, v28
    v_and_b32 v121, 0xffff0000, v28
    v_lshlrev_b32 v122, 16, v29
    v_and_b32 v123, 0xffff0000, v29
    v_lshlrev_b32 v124, 16, v30
    v_and_b32 v125, 0xffff0000, v30
    v_lshlrev_b32 v126, 16, v31
    v_and_b32 v127, 0xffff0000, v31
    v_pk_add_f32 v[136:137], v[136:137], v[144:145]
    v_pk_add_f32 v[138:139], v[138:139], v[146:147]
    v_pk_add_f32 v[140:141], v[140:141], v[148:149]
    v_pk_add_f32 v[142:143], v[142:143], v[150:151]
    s_waitcnt lgkmcnt(0)
    v_pk_fma_f32 v[120:121], v[136:137], v[128:129], v[120:121]
    v_pk_fma_f32 v[122:123], v[138:139], v[130:131], v[122:123]
    v_pk_fma_f32 v[124:125], v[140:141], v[132:133], v[124:125]
    v_pk_fma_f32 v[126:127], v[142:143], v[134:135], v[126:127]
    v_cvt_pk_bf16_f32 v156, v124, v125
    v_lshlrev_b32 v124, 16, v156
    v_and_b32 v125, 0xffff0000, v156
    v_cvt_pk_bf16_f32 v157, v126, v127
    v_lshlrev_b32 v126, 16, v157
    v_and_b32 v127, 0xffff0000, v157
    v_cvt_pk_bf16_f32 v158, v120, v121
    v_lshlrev_b32 v120, 16, v158
    v_and_b32 v121, 0xffff0000, v158
    v_cvt_pk_bf16_f32 v159, v122, v123
    v_lshlrev_b32 v122, 16, v159
    v_and_b32 v123, 0xffff0000, v159
    v_permlane16_swap_b32 v156, v158
    v_permlane16_swap_b32 v157, v159
    buffer_store_dwordx4 v[156:159], v12, s[28:31], 0 offen offset:384 sc1
    v_pk_add_f32 v[14:15], v[96:97], v[98:99]
    v_pk_add_f32 v[14:15], v[14:15], v[100:101]
    v_pk_add_f32 v[14:15], v[14:15], v[102:103]
    v_pk_add_f32 v[14:15], v[14:15], v[104:105]
    v_pk_add_f32 v[14:15], v[14:15], v[106:107]
    v_pk_add_f32 v[14:15], v[14:15], v[108:109]
    v_pk_add_f32 v[14:15], v[14:15], v[110:111]
    v_pk_add_f32 v[14:15], v[14:15], v[112:113]
    v_pk_add_f32 v[14:15], v[14:15], v[114:115]
    v_pk_add_f32 v[14:15], v[14:15], v[116:117]
    v_pk_add_f32 v[14:15], v[14:15], v[118:119]
    v_pk_add_f32 v[14:15], v[14:15], v[120:121]
    v_pk_add_f32 v[14:15], v[14:15], v[122:123]
    v_pk_add_f32 v[14:15], v[14:15], v[124:125]
    v_pk_add_f32 v[14:15], v[14:15], v[126:127]
    v_add_f32 v14, v14, v15
    s_nop 1
    v_add_f32_dpp v14, v14, v14 row_ror:8 row_mask:0xf bank_mask:0xf
    v_mov_b32 v13, v14
    s_nop 1
    v_permlane16_swap_b32 v14, v13
    v_add_f32 v14, v14, v13
    v_mov_b32 v13, v14
    s_nop 1
    v_permlane32_swap_b32 v14, v13
    v_add_f32 v14, v14, v13
    v_cmp_gt_u32 vcc, 8, v212
    v_lshlrev_b32 v13, 4, v1
    s_lshl_b32 s42, s36, 2
    s_add_u32 s42, s42, 114688
    v_add_u32 v13, s42, v13
    s_and_saveexec_b64 s[52:53], vcc
    ds_write_b32 v13, v14 offset:0
    s_mov_b64 exec, s[52:53]
    s_waitcnt lgkmcnt(0)
    s_barrier
    v_lshlrev_b32 v13, 4, v1
    v_add_u32 v13, 114688, v13
    ds_read_b128 v[128:131], v13 offset:0
    s_waitcnt lgkmcnt(0)
    v_add_f32 v128, v128, v129
    v_add_f32 v130, v130, v131
    v_add_f32 v14, v128, v130
    v_mul_f32 v14, 0x3a800000, v14
    v_pk_add_f32 v[96:97], v[96:97], v[14:15] op_sel_hi:[1,0] neg_lo:[0,1] neg_hi:[0,1]
    v_pk_add_f32 v[98:99], v[98:99], v[14:15] op_sel_hi:[1,0] neg_lo:[0,1] neg_hi:[0,1]
    v_pk_add_f32 v[100:101], v[100:101], v[14:15] op_sel_hi:[1,0] neg_lo:[0,1] neg_hi:[0,1]
    v_pk_add_f32 v[102:103], v[102:103], v[14:15] op_sel_hi:[1,0] neg_lo:[0,1] neg_hi:[0,1]
    v_pk_add_f32 v[104:105], v[104:105], v[14:15] op_sel_hi:[1,0] neg_lo:[0,1] neg_hi:[0,1]
    v_pk_add_f32 v[106:107], v[106:107], v[14:15] op_sel_hi:[1,0] neg_lo:[0,1] neg_hi:[0,1]
    v_pk_add_f32 v[108:109], v[108:109], v[14:15] op_sel_hi:[1,0] neg_lo:[0,1] neg_hi:[0,1]
    v_pk_add_f32 v[110:111], v[110:111], v[14:15] op_sel_hi:[1,0] neg_lo:[0,1] neg_hi:[0,1]
    v_pk_add_f32 v[112:113], v[112:113], v[14:15] op_sel_hi:[1,0] neg_lo:[0,1] neg_hi:[0,1]
    v_pk_add_f32 v[114:115], v[114:115], v[14:15] op_sel_hi:[1,0] neg_lo:[0,1] neg_hi:[0,1]
    v_pk_add_f32 v[116:117], v[116:117], v[14:15] op_sel_hi:[1,0] neg_lo:[0,1] neg_hi:[0,1]
    v_pk_add_f32 v[118:119], v[118:119], v[14:15] op_sel_hi:[1,0] neg_lo:[0,1] neg_hi:[0,1]
    v_pk_add_f32 v[120:121], v[120:121], v[14:15] op_sel_hi:[1,0] neg_lo:[0,1] neg_hi:[0,1]
    v_pk_add_f32 v[122:123], v[122:123], v[14:15] op_sel_hi:[1,0] neg_lo:[0,1] neg_hi:[0,1]
    v_pk_add_f32 v[124:125], v[124:125], v[14:15] op_sel_hi:[1,0] neg_lo:[0,1] neg_hi:[0,1]
    v_pk_add_f32 v[126:127], v[126:127], v[14:15] op_sel_hi:[1,0] neg_lo:[0,1] neg_hi:[0,1]
    v_pk_mul_f32 v[14:15], v[96:97], v[96:97]
    v_pk_fma_f32 v[14:15], v[98:99], v[98:99], v[14:15]
    v_pk_fma_f32 v[14:15], v[100:101], v[100:101], v[14:15]
    v_pk_fma_f32 v[14:15], v[102:103], v[102:103], v[14:15]
    v_pk_fma_f32 v[14:15], v[104:105], v[104:105], v[14:15]
    v_pk_fma_f32 v[14:15], v[106:107], v[106:107], v[14:15]
    v_pk_fma_f32 v[14:15], v[108:109], v[108:109], v[14:15]
    v_pk_fma_f32 v[14:15], v[110:111], v[110:111], v[14:15]
    v_pk_fma_f32 v[14:15], v[112:113], v[112:113], v[14:15]
    v_pk_fma_f32 v[14:15], v[114:115], v[114:115], v[14:15]
    v_pk_fma_f32 v[14:15], v[116:117], v[116:117], v[14:15]
    v_pk_fma_f32 v[14:15], v[118:119], v[118:119], v[14:15]
    v_pk_fma_f32 v[14:15], v[120:121], v[120:121], v[14:15]
    v_pk_fma_f32 v[14:15], v[122:123], v[122:123], v[14:15]
    v_pk_fma_f32 v[14:15], v[124:125], v[124:125], v[14:15]
    v_pk_fma_f32 v[14:15], v[126:127], v[126:127], v[14:15]
    v_add_f32 v14, v14, v15
    s_nop 1
    v_add_f32_dpp v14, v14, v14 row_ror:8 row_mask:0xf bank_mask:0xf
    v_mov_b32 v13, v14
    s_nop 1
    v_permlane16_swap_b32 v14, v13
    v_add_f32 v14, v14, v13
    v_mov_b32 v13, v14
    s_nop 1
    v_permlane32_swap_b32 v14, v13
    v_add_f32 v14, v14, v13
    v_cmp_gt_u32 vcc, 8, v212
    v_lshlrev_b32 v13, 4, v1
    s_lshl_b32 s42, s36, 2
    s_add_u32 s42, s42, 114688
    v_add_u32 v13, s42, v13
    s_and_saveexec_b64 s[52:53], vcc
    ds_write_b32 v13, v14 offset:256
    s_mov_b64 exec, s[52:53]
    s_waitcnt lgkmcnt(0)
    s_barrier
    v_lshlrev_b32 v13, 4, v1
    v_add_u32 v13, 114688, v13
    ds_read_b128 v[128:131], v13 offset:256
    s_waitcnt lgkmcnt(0)
    v_add_f32 v128, v128, v129
    v_add_f32 v130, v130, v131
    v_add_f32 v14, v128, v130
    v_mov_b32 v15, 0x3727c5ac
    v_fmac_f32 v15, 0x3a800000, v14
    v_rsq_f32 v160, v15
    v_lshrrev_b32 v13, 4, v3
    v_lshlrev_b32 v13, 15, v13
    v_lshl_add_u32 v13, v10, 10, v13
    v_and_b32 v14, 15, v3
    v_lshl_add_u32 v13, v14, 4, v13
    v_lshl_add_u32 v13, v11, 8, v13
    s_mov_b32 s42, 4096
    ds_read_b128 v[128:131], v9 offset:5120
    ds_read_b128 v[132:135], v9 offset:5136
    ds_read_b128 v[136:139], v9 offset:9216
    ds_read_b128 v[140:143], v9 offset:9232
    v_pk_mul_f32 v[96:97], v[96:97], v[160:161] op_sel_hi:[1,0]
    v_pk_mul_f32 v[98:99], v[98:99], v[160:161] op_sel_hi:[1,0]
    v_pk_mul_f32 v[100:101], v[100:101], v[160:161] op_sel_hi:[1,0]
    v_pk_mul_f32 v[102:103], v[102:103], v[160:161] op_sel_hi:[1,0]
    s_waitcnt lgkmcnt(0)
    v_pk_fma_f32 v[96:97], v[96:97], v[136:137], v[128:129]
    v_pk_fma_f32 v[98:99], v[98:99], v[138:139], v[130:131]
    v_pk_fma_f32 v[100:101], v[100:101], v[140:141], v[132:133]
    v_pk_fma_f32 v[102:103], v[102:103], v[142:143], v[134:135]
    v_cvt_pk_bf16_f32 v152, v100, v101
    v_cvt_pk_bf16_f32 v153, v102, v103
    v_cvt_pk_bf16_f32 v154, v96, v97
    v_cvt_pk_bf16_f32 v155, v98, v99
    s_nop 0
    v_permlane16_swap_b32 v152, v154
    v_permlane16_swap_b32 v153, v155
    buffer_store_dwordx4 v[152:155], v13, s[32:35], 0 offen offset:0 sc1
    ds_read_b128 v[128:131], v9 offset:5376
    ds_read_b128 v[132:135], v9 offset:5392
    ds_read_b128 v[136:139], v9 offset:9472
    ds_read_b128 v[140:143], v9 offset:9488
    v_pk_mul_f32 v[104:105], v[104:105], v[160:161] op_sel_hi:[1,0]
    v_pk_mul_f32 v[106:107], v[106:107], v[160:161] op_sel_hi:[1,0]
    v_pk_mul_f32 v[108:109], v[108:109], v[160:161] op_sel_hi:[1,0]
    v_pk_mul_f32 v[110:111], v[110:111], v[160:161] op_sel_hi:[1,0]
    s_waitcnt lgkmcnt(0)
    v_pk_fma_f32 v[104:105], v[104:105], v[136:137], v[128:129]
    v_pk_fma_f32 v[106:107], v[106:107], v[138:139], v[130:131]
    v_pk_fma_f32 v[108:109], v[108:109], v[140:141], v[132:133]
    v_pk_fma_f32 v[110:111], v[110:111], v[142:143], v[134:135]
    v_cvt_pk_bf16_f32 v156, v108, v109
    v_cvt_pk_bf16_f32 v157, v110, v111
    v_cvt_pk_bf16_f32 v158, v104, v105
    v_cvt_pk_bf16_f32 v159, v106, v107
    s_nop 0
    v_permlane16_swap_b32 v156, v158
    v_permlane16_swap_b32 v157, v159
    buffer_store_dwordx4 v[156:159], v13, s[32:35], 0 offen offset:2048 sc1
    ds_read_b128 v[128:131], v9 offset:5632
    ds_read_b128 v[132:135], v9 offset:5648
    ds_read_b128 v[136:139], v9 offset:9728
    ds_read_b128 v[140:143], v9 offset:9744
    v_pk_mul_f32 v[112:113], v[112:113], v[160:161] op_sel_hi:[1,0]
    v_pk_mul_f32 v[114:115], v[114:115], v[160:161] op_sel_hi:[1,0]
    v_pk_mul_f32 v[116:117], v[116:117], v[160:161] op_sel_hi:[1,0]
    v_pk_mul_f32 v[118:119], v[118:119], v[160:161] op_sel_hi:[1,0]
    s_waitcnt lgkmcnt(0)
    v_pk_fma_f32 v[112:113], v[112:113], v[136:137], v[128:129]
    v_pk_fma_f32 v[114:115], v[114:115], v[138:139], v[130:131]
    v_pk_fma_f32 v[116:117], v[116:117], v[140:141], v[132:133]
    v_pk_fma_f32 v[118:119], v[118:119], v[142:143], v[134:135]
    v_cvt_pk_bf16_f32 v152, v116, v117
    v_cvt_pk_bf16_f32 v153, v118, v119
    v_cvt_pk_bf16_f32 v154, v112, v113
    v_cvt_pk_bf16_f32 v155, v114, v115
    s_nop 0
    v_permlane16_swap_b32 v152, v154
    v_permlane16_swap_b32 v153, v155
    buffer_store_dwordx4 v[152:155], v13, s[32:35], s42 offen offset:0 sc1
    ds_read_b128 v[128:131], v9 offset:5888
    ds_read_b128 v[132:135], v9 offset:5904
    ds_read_b128 v[136:139], v9 offset:9984
    ds_read_b128 v[140:143], v9 offset:10000
    v_pk_mul_f32 v[120:121], v[120:121], v[160:161] op_sel_hi:[1,0]
    v_pk_mul_f32 v[122:123], v[122:123], v[160:161] op_sel_hi:[1,0]
    v_pk_mul_f32 v[124:125], v[124:125], v[160:161] op_sel_hi:[1,0]
    v_pk_mul_f32 v[126:127], v[126:127], v[160:161] op_sel_hi:[1,0]
    s_waitcnt lgkmcnt(0)
    v_pk_fma_f32 v[120:121], v[120:121], v[136:137], v[128:129]
    v_pk_fma_f32 v[122:123], v[122:123], v[138:139], v[130:131]
    v_pk_fma_f32 v[124:125], v[124:125], v[140:141], v[132:133]
    v_pk_fma_f32 v[126:127], v[126:127], v[142:143], v[134:135]
    v_cvt_pk_bf16_f32 v156, v124, v125
    v_cvt_pk_bf16_f32 v157, v126, v127
    v_cvt_pk_bf16_f32 v158, v120, v121
    v_cvt_pk_bf16_f32 v159, v122, v123
    s_nop 0
    v_permlane16_swap_b32 v156, v158
    v_permlane16_swap_b32 v157, v159
    buffer_store_dwordx4 v[156:159], v13, s[32:35], s42 offen offset:2048 sc1
    s_lshr_b32 s50, s37, 1
    s_add_u32 s50, s50, 40
    s_waitcnt vmcnt(0)
    s_barrier
    s_cmp_lg_u32 s94, 0
    s_cbranch_scc1 L_oproj_nosig
    s_add_u32 s88, s4, 0x60000
    s_addc_u32 s89, s5, 0
    s_mov_b32 s90, 0x6800
    s_mov_b32 s91, 0x20000
    s_lshl_b32 s92, s50, 7
    v_mov_b32 v252, s92
    v_mov_b32 v253, 1
    s_mov_b64 s[92:93], exec
    s_mov_b64 exec, 1
    buffer_atomic_add v253, v252, s[88:91], 0 offen
    s_mov_b64 exec, s[92:93]
L_oproj_nosig:
    s_mov_b64 exec, -1
    v_mbcnt_lo_u32_b32 v0, -1, 0
    v_mbcnt_hi_u32_b32 v0, -1, v0
    v_add_u32 v0, s94, v0
    s_load_dwordx2 s[4:5], s[0:1], 104
    s_load_dwordx2 s[6:7], s[0:1], 48
    s_load_dwordx2 s[8:9], s[0:1], 56
    v_mov_b32 v240, v0
    v_lshrrev_b32 v1, 6, v0
    s_nop 0
    v_readfirstlane_b32 s36, v1
    s_and_b32 s42, s2, 1
    s_lshl_b32 s42, s42, 2
    s_bfe_u32 s68, s2, 0x20003
    s_add_u32 s37, s42, s68
    s_bfe_u32 s42, s2, 0x20001
    s_lshl_b32 s42, s42, 3
    s_lshr_b32 s61, s2, 5
    s_add_u32 s38, s42, s61
    s_lshl_b32 s42, s68, 1
    s_add_u32 s62, s61, s42
    s_mov_b32 s63, 0
    v_and_b32 v10, 63, v240
    v_lshlrev_b32 v224, 4, v10
    s_and_b32 s42, s36, 1
    s_mul_i32 s42, s42, 229376
    v_add_u32 v11, 0, v10
    v_mul_u32_u24 v12, 4682, v11
    v_lshrrev_b32 v12, 16, v12
    v_mul_u32_u24 v13, 14, v12
    v_sub_u32 v13, v11, v13
    v_mul_u32_u24 v12, 7168, v12
    v_lshl_add_u32 v12, v13, 4, v12
    v_add_u32 v12, s42, v12
    v_subrev_u32 v225, 0, v12
    v_add_u32 v11, 64, v10
    v_mul_u32_u24 v12, 4682, v11
    v_lshrrev_b32 v12, 16, v12
    v_mul_u32_u24 v13, 14, v12
    v_sub_u32 v13, v11, v13
    v_mul_u32_u24 v12, 7168, v12
    v_lshl_add_u32 v12, v13, 4, v12
    v_add_u32 v12, s42, v12
    v_subrev_u32 v226, 1024, v12
    v_add_u32 v11, 128, v10
    v_mul_u32_u24 v12, 4682, v11
    v_lshrrev_b32 v12, 16, v12
    v_mul_u32_u24 v13, 14, v12
    v_sub_u32 v13, v11, v13
    v_mul_u32_u24 v12, 7168, v12
    v_lshl_add_u32 v12, v13, 4, v12
    v_add_u32 v12, s42, v12
    v_subrev_u32 v227, 2048, v12
    v_add_u32 v11, 192, v10
    v_mul_u32_u24 v12, 4682, v11
    v_lshrrev_b32 v12, 16, v12
    v_mul_u32_u24 v13, 14, v12
    v_sub_u32 v13, v11, v13
    v_mul_u32_u24 v12, 7168, v12
    v_lshl_add_u32 v12, v13, 4, v12
    v_add_u32 v12, s42, v12
    v_subrev_u32 v228, 3072, v12
    v_add_u32 v11, 256, v10
    v_mul_u32_u24 v12, 4682, v11
    v_lshrrev_b32 v12, 16, v12
    v_mul_u32_u24 v13, 14, v12
    v_sub_u32 v13, v11, v13
    v_mul_u32_u24 v12, 7168, v12
    v_lshl_add_u32 v12, v13, 4, v12
    v_add_u32 v12, s42, v12
    v_subrev_u32 v229, 0, v12
    v_add_u32 v11, 320, v10
    v_mul_u32_u24 v12, 4682, v11
    v_lshrrev_b32 v12, 16, v12
    v_mul_u32_u24 v13, 14, v12
    v_sub_u32 v13, v11, v13
    v_mul_u32_u24 v12, 7168, v12
    v_lshl_add_u32 v12, v13, 4, v12
    v_add_u32 v12, s42, v12
    v_subrev_u32 v230, 1024, v12
    v_add_u32 v11, 384, v10
    v_mul_u32_u24 v12, 4682, v11
    v_lshrrev_b32 v12, 16, v12
    v_mul_u32_u24 v13, 14, v12
    v_sub_u32 v13, v11, v13
    v_mul_u32_u24 v12, 7168, v12
    v_lshl_add_u32 v12, v13, 4, v12
    v_add_u32 v12, s42, v12
    v_subrev_u32 v231, 2048, v12
    v_lshrrev_b32 v11, 2, v10
    v_mul_u32_u24 v11, 224, v11
    v_and_b32 v12, 3, v10
    v_lshl_add_u32 v232, v12, 3, v11
    v_add_u32 v233, 57344, v232
    s_waitcnt lgkmcnt(0)
    s_lshl_b32 s42, s37, 4
    s_lshl_b32 s43, s36, 2
    s_add_u32 s42, s42, s43
    s_lshl_b32 s49, s42, 15
    s_mul_i32 s50, s42, 114688
    s_add_u32 s42, s49, 0x900000
    s_add_u32 s12, s4, s42
    s_addc_u32 s13, s5, 0
    s_mov_b32 s14, 0x8000
    s_mov_b32 s15, 0x20000
    s_add_u32 s42, s42, 32768
    s_add_u32 s16, s4, s42
    s_addc_u32 s17, s5, 0
    s_mov_b32 s18, 0x8000
    s_mov_b32 s19, 0x20000
    s_add_u32 s42, s42, 32768
    s_add_u32 s20, s4, s42
    s_addc_u32 s21, s5, 0
    s_mov_b32 s22, 0x8000
    s_mov_b32 s23, 0x20000
    s_add_u32 s42, s42, 32768
    s_add_u32 s24, s4, s42
    s_addc_u32 s25, s5, 0
    s_mov_b32 s26, 0x8000
    s_mov_b32 s27, 0x20000
    s_cmp_ge_u32 s36, 2
    s_cselect_b32 s6, s8, s6
    s_cselect_b32 s7, s9, s7
    s_mul_i32 s42, s38, 224
    s_add_u32 s28, s6, s42
    s_addc_u32 s29, s7, 0
    s_mov_b32 s30, 0x0
    s_mov_b32 s31, 0x20000
    s_sub_u32 s30, 7340032, s42
    s_add_u32 s42, s50, 0x1000000
    s_add_u32 s32, s4, s42
    s_addc_u32 s33, s5, 0
    s_mov_b32 s34, 0x70000
    s_mov_b32 s35, 0x20000
    s_mul_i32 s44, s36, 7168
    s_add_u32 s44, s44, 0
    s_mul_i32 s45, s36, 7168
    s_add_u32 s45, s45, 28672
    s_mul_i32 s46, s36, 7168
    s_add_u32 s46, s46, 57344
    s_mul_i32 s47, s36, 7168
    s_add_u32 s47, s47, 86016
    s_mov_b32 s65, s63
    s_add_u32 s64, s63, s62
    s_and_b32 s64, s64, 0
    s_andn2_b32 s67, s63, 0
    s_or_b32 s64, s64, s67
    s_add_u32 s63, s63, 1
    s_lshl_b32 s39, s64, 11
    s_mul_i32 s40, s64, 458752
    s_mov_b32 m0, s44
    s_nop 0
    buffer_load_dwordx4 v225, s[28:31], s40 offen offset:0 lds
    buffer_load_dwordx4 v226, s[28:31], s40 offen offset:1024 lds
    buffer_load_dwordx4 v227, s[28:31], s40 offen offset:2048 lds
    buffer_load_dwordx4 v228, s[28:31], s40 offen offset:3072 lds
    s_add_u32 m0, s44, 4096
    s_nop 0
    buffer_load_dwordx4 v229, s[28:31], s40 offen offset:0 lds
    buffer_load_dwordx4 v230, s[28:31], s40 offen offset:1024 lds
    buffer_load_dwordx4 v231, s[28:31], s40 offen offset:2048 lds
    s_add_u32 s51, s37, 40
    s_cmp_lg_u32 s94, 0
    s_cbranch_scc1 L_gu_wgo
    s_add_u32 s88, s4, 0x60000
    s_addc_u32 s89, s5, 0
    s_mov_b32 s90, 0x6800
    s_mov_b32 s91, 0x20000
    s_lshl_b32 s92, s51, 7
    v_mov_b32 v252, s92
    s_mov_b64 s[92:93], exec
    s_mov_b64 exec, 1
    s_mov_b32 s3, 0x40000
L_gu_wpoll:
    buffer_load_dword v253, v252, s[88:91], 0 offen sc1
    s_waitcnt vmcnt(0)
    v_cmp_ne_u32 vcc, 32, v253
    s_cbranch_vccz L_gu_wdone
    s_sleep 1
    s_sub_u32 s3, s3, 1
    s_cmp_lg_u32 s3, 0
    s_cbranch_scc1 L_gu_wpoll
L_gu_wdone:
    s_mov_b64 exec, s[92:93]
L_gu_wgo:
    s_barrier
    v_mov_b32 v252, 0x7f000000
    s_mov_b32 s63, s65
    s_add_u32 s64, s63, s62
    s_and_b32 s64, s64, 0
    s_andn2_b32 s67, s63, 0
    s_or_b32 s64, s64, s67
    s_add_u32 s63, s63, 1
    s_lshl_b32 s39, s64, 11
    s_mul_i32 s40, s64, 458752
    buffer_load_dwordx4 a[0:3], v224, s[12:15], s39 offen offset:0 sc1
    buffer_load_dwordx4 a[4:7], v224, s[16:19], s39 offen offset:0 sc1
    buffer_load_dwordx4 a[8:11], v224, s[20:23], s39 offen offset:0 sc1
    buffer_load_dwordx4 a[12:15], v224, s[24:27], s39 offen offset:0 sc1
    buffer_load_dwordx4 a[16:19], v224, s[12:15], s39 offen offset:1024 sc1
    buffer_load_dwordx4 a[20:23], v224, s[16:19], s39 offen offset:1024 sc1
    buffer_load_dwordx4 a[24:27], v224, s[20:23], s39 offen offset:1024 sc1
    buffer_load_dwordx4 a[28:31], v224, s[24:27], s39 offen offset:1024 sc1
    s_add_u32 s64, s63, s62
    s_and_b32 s64, s64, 0
    s_andn2_b32 s67, s63, 0
    s_or_b32 s64, s64, s67
    s_add_u32 s63, s63, 1
    s_lshl_b32 s39, s64, 11
    s_mul_i32 s40, s64, 458752
    v_mov_b32 v0, 0
    v_mov_b32 v1, 0
    v_mov_b32 v2, 0
    v_mov_b32 v3, 0
    v_mov_b32 v4, 0
    v_mov_b32 v5, 0
    v_mov_b32 v6, 0
    v_mov_b32 v7, 0
    v_mov_b32 v8, 0
    v_mov_b32 v9, 0
    v_mov_b32 v10, 0
    v_mov_b32 v11, 0
    v_mov_b32 v12, 0
    v_mov_b32 v13, 0
    v_mov_b32 v14, 0
    v_mov_b32 v15, 0
    v_mov_b32 v16, 0
    v_mov_b32 v17, 0
    v_mov_b32 v18, 0
    v_mov_b32 v19, 0
    v_mov_b32 v20, 0
    v_mov_b32 v21, 0
    v_mov_b32 v22, 0
    v_mov_b32 v23, 0
    v_mov_b32 v24, 0
    v_mov_b32 v25, 0
    v_mov_b32 v26, 0
    v_mov_b32 v27, 0
    v_mov_b32 v28, 0
    v_mov_b32 v29, 0
    v_mov_b32 v30, 0
    v_mov_b32 v31, 0
    v_mov_b32 v32, 0
    v_mov_b32 v33, 0
    v_mov_b32 v34, 0
    v_mov_b32 v35, 0
    v_mov_b32 v36, 0
    v_mov_b32 v37, 0
    v_mov_b32 v38, 0
    v_mov_b32 v39, 0
    v_mov_b32 v40, 0
    v_mov_b32 v41, 0
    v_mov_b32 v42, 0
    v_mov_b32 v43, 0
    v_mov_b32 v44, 0
    v_mov_b32 v45, 0
    v_mov_b32 v46, 0
    v_mov_b32 v47, 0
    v_mov_b32 v48, 0
    v_mov_b32 v49, 0
    v_mov_b32 v50, 0
    v_mov_b32 v51, 0
    v_mov_b32 v52, 0
    v_mov_b32 v53, 0
    v_mov_b32 v54, 0
    v_mov_b32 v55, 0
    v_mov_b32 v56, 0
    v_mov_b32 v57, 0
    v_mov_b32 v58, 0
    v_mov_b32 v59, 0
    v_mov_b32 v60, 0
    v_mov_b32 v61, 0
    v_mov_b32 v62, 0
    v_mov_b32 v63, 0
    v_mov_b32 v64, 0
    v_mov_b32 v65, 0
    v_mov_b32 v66, 0
    v_mov_b32 v67, 0
    v_mov_b32 v68, 0
    v_mov_b32 v69, 0
    v_mov_b32 v70, 0
    v_mov_b32 v71, 0
    v_mov_b32 v72, 0
    v_mov_b32 v73, 0
    v_mov_b32 v74, 0
    v_mov_b32 v75, 0
    v_mov_b32 v76, 0
    v_mov_b32 v77, 0
    v_mov_b32 v78, 0
    v_mov_b32 v79, 0
    v_mov_b32 v80, 0
    v_mov_b32 v81, 0
    v_mov_b32 v82, 0
    v_mov_b32 v83, 0
    v_mov_b32 v84, 0
    v_mov_b32 v85, 0
    v_mov_b32 v86, 0
    v_mov_b32 v87, 0
    v_mov_b32 v88, 0
    v_mov_b32 v89, 0
    v_mov_b32 v90, 0
    v_mov_b32 v91, 0
    v_mov_b32 v92, 0
    v_mov_b32 v93, 0
    v_mov_b32 v94, 0
    v_mov_b32 v95, 0
    v_mov_b32 v96, 0
    v_mov_b32 v97, 0
    v_mov_b32 v98, 0
    v_mov_b32 v99, 0
    v_mov_b32 v100, 0
    v_mov_b32 v101, 0
    v_mov_b32 v102, 0
    v_mov_b32 v103, 0
    v_mov_b32 v104, 0
    v_mov_b32 v105, 0
    v_mov_b32 v106, 0
    v_mov_b32 v107, 0
    v_mov_b32 v108, 0
    v_mov_b32 v109, 0
    v_mov_b32 v110, 0
    v_mov_b32 v111, 0
    v_mov_b32 v112, 0
    v_mov_b32 v113, 0
    v_mov_b32 v114, 0
    v_mov_b32 v115, 0
    v_mov_b32 v116, 0
    v_mov_b32 v117, 0
    v_mov_b32 v118, 0
    v_mov_b32 v119, 0
    v_mov_b32 v120, 0
    v_mov_b32 v121, 0
    v_mov_b32 v122, 0
    v_mov_b32 v123, 0
    v_mov_b32 v124, 0
    v_mov_b32 v125, 0
    v_mov_b32 v126, 0
    v_mov_b32 v127, 0
    v_mov_b32 v128, 0
    v_mov_b32 v129, 0
    v_mov_b32 v130, 0
    v_mov_b32 v131, 0
    v_mov_b32 v132, 0
    v_mov_b32 v133, 0
    v_mov_b32 v134, 0
    v_mov_b32 v135, 0
    v_mov_b32 v136, 0
    v_mov_b32 v137, 0
    v_mov_b32 v138, 0
    v_mov_b32 v139, 0
    v_mov_b32 v140, 0
    v_mov_b32 v141, 0
    v_mov_b32 v142, 0
    v_mov_b32 v143, 0
    v_mov_b32 v144, 0
    v_mov_b32 v145, 0
    v_mov_b32 v146, 0
    v_mov_b32 v147, 0
    v_mov_b32 v148, 0
    v_mov_b32 v149, 0
    v_mov_b32 v150, 0
    v_mov_b32 v151, 0
    v_mov_b32 v152, 0
    v_mov_b32 v153, 0
    v_mov_b32 v154, 0
    v_mov_b32 v155, 0
    v_mov_b32 v156, 0
    v_mov_b32 v157, 0
    v_mov_b32 v158, 0
    v_mov_b32 v159, 0
    v_mov_b32 v160, 0
    v_mov_b32 v161, 0
    v_mov_b32 v162, 0
    v_mov_b32 v163, 0
    v_mov_b32 v164, 0
    v_mov_b32 v165, 0
    v_mov_b32 v166, 0
    v_mov_b32 v167, 0
    v_mov_b32 v168, 0
    v_mov_b32 v169, 0
    v_mov_b32 v170, 0
    v_mov_b32 v171, 0
    v_mov_b32 v172, 0
    v_mov_b32 v173, 0
    v_mov_b32 v174, 0
    v_mov_b32 v175, 0
    v_mov_b32 v176, 0
    v_mov_b32 v177, 0
    v_mov_b32 v178, 0
    v_mov_b32 v179, 0
    v_mov_b32 v180, 0
    v_mov_b32 v181, 0
    v_mov_b32 v182, 0
    v_mov_b32 v183, 0
    v_mov_b32 v184, 0
    v_mov_b32 v185, 0
    v_mov_b32 v186, 0
    v_mov_b32 v187, 0
    v_mov_b32 v188, 0
    v_mov_b32 v189, 0
    v_mov_b32 v190, 0
    v_mov_b32 v191, 0
    v_mov_b32 v192, 0
    v_mov_b32 v193, 0
    v_mov_b32 v194, 0
    v_mov_b32 v195, 0
    v_mov_b32 v196, 0
    v_mov_b32 v197, 0
    v_mov_b32 v198, 0
    v_mov_b32 v199, 0
    v_mov_b32 v200, 0
    v_mov_b32 v201, 0
    v_mov_b32 v202, 0
    v_mov_b32 v203, 0
    v_mov_b32 v204, 0
    v_mov_b32 v205, 0
    v_mov_b32 v206, 0
    v_mov_b32 v207, 0
    v_mov_b32 v208, 0
    v_mov_b32 v209, 0
    v_mov_b32 v210, 0
    v_mov_b32 v211, 0
    v_mov_b32 v212, 0
    v_mov_b32 v213, 0
    v_mov_b32 v214, 0
    v_mov_b32 v215, 0
    v_mov_b32 v216, 0
    v_mov_b32 v217, 0
    v_mov_b32 v218, 0
    v_mov_b32 v219, 0
    v_mov_b32 v220, 0
    v_mov_b32 v221, 0
    v_mov_b32 v222, 0
    v_mov_b32 v223, 0
    s_waitcnt vmcnt(8)
    s_barrier
    ds_read_b64_tr_b16 a[128:129], v232 offset:0
    ds_read_b64_tr_b16 a[130:131], v232 offset:3584
    ds_read_b64_tr_b16 a[132:133], v232 offset:14336
    ds_read_b64_tr_b16 a[134:135], v232 offset:17920
    ds_read_b64_tr_b16 a[136:137], v232 offset:32
    ds_read_b64_tr_b16 a[138:139], v232 offset:3616
    ds_read_b64_tr_b16 a[140:141], v232 offset:14368
    ds_read_b64_tr_b16 a[142:143], v232 offset:17952
    s_mov_b32 s41, 4
L_gu_loop:
    s_waitcnt lgkmcnt(4)
    s_waitcnt vmcnt(4)
    v_mfma_f32_16x16x32_bf16 v[0:3], a[128:131], a[0:3], v[0:3]
    ds_read_b64_tr_b16 a[144:145], v232 offset:64
    v_mfma_f32_16x16x32_bf16 v[56:59], a[128:131], a[4:7], v[56:59]
    ds_read_b64_tr_b16 a[146:147], v232 offset:3648
    v_mfma_f32_16x16x32_bf16 v[112:115], a[128:131], a[8:11], v[112:115]
    s_mov_b32 m0, s45
    s_nop 0
    buffer_load_dwordx4 v225, s[28:31], s40 offen offset:0 lds
    v_mfma_f32_16x16x32_bf16 v[168:171], a[128:131], a[12:15], v[168:171]
    v_mfma_f32_16x16x32_bf16 v[28:31], a[132:135], a[0:3], v[28:31]
    ds_read_b64_tr_b16 a[148:149], v232 offset:14400
    v_mfma_f32_16x16x32_bf16 v[84:87], a[132:135], a[4:7], v[84:87]
    ds_read_b64_tr_b16 a[150:151], v232 offset:17984
    v_mfma_f32_16x16x32_bf16 v[140:143], a[132:135], a[8:11], v[140:143]
    buffer_load_dwordx4 v226, s[28:31], s40 offen offset:1024 lds
    v_mfma_f32_16x16x32_bf16 v[196:199], a[132:135], a[12:15], v[196:199]
    s_waitcnt lgkmcnt(4)
    v_mfma_f32_16x16x32_bf16 v[4:7], a[136:139], a[0:3], v[4:7]
    ds_read_b64_tr_b16 a[152:153], v232 offset:96
    v_mfma_f32_16x16x32_bf16 v[60:63], a[136:139], a[4:7], v[60:63]
    ds_read_b64_tr_b16 a[154:155], v232 offset:3680
    v_mfma_f32_16x16x32_bf16 v[116:119], a[136:139], a[8:11], v[116:119]
    buffer_load_dwordx4 v227, s[28:31], s40 offen offset:2048 lds
    v_mfma_f32_16x16x32_bf16 v[172:175], a[136:139], a[12:15], v[172:175]
    v_mfma_f32_16x16x32_bf16 v[32:35], a[140:143], a[0:3], v[32:35]
    ds_read_b64_tr_b16 a[156:157], v232 offset:14432
    v_mfma_f32_16x16x32_bf16 v[88:91], a[140:143], a[4:7], v[88:91]
    ds_read_b64_tr_b16 a[158:159], v232 offset:18016
    v_mfma_f32_16x16x32_bf16 v[144:147], a[140:143], a[8:11], v[144:147]
    buffer_load_dwordx4 v228, s[28:31], s40 offen offset:3072 lds
    v_mfma_f32_16x16x32_bf16 v[200:203], a[140:143], a[12:15], v[200:203]
    s_waitcnt lgkmcnt(4)
    v_mfma_f32_16x16x32_bf16 v[8:11], a[144:147], a[0:3], v[8:11]
    ds_read_b64_tr_b16 a[128:129], v232 offset:128
    v_mfma_f32_16x16x32_bf16 v[64:67], a[144:147], a[4:7], v[64:67]
    ds_read_b64_tr_b16 a[130:131], v232 offset:3712
    v_mfma_f32_16x16x32_bf16 v[120:123], a[144:147], a[8:11], v[120:123]
    s_add_u32 m0, s45, 4096
    s_nop 0
    buffer_load_dwordx4 v229, s[28:31], s40 offen offset:0 lds
    v_mfma_f32_16x16x32_bf16 v[176:179], a[144:147], a[12:15], v[176:179]
    v_mfma_f32_16x16x32_bf16 v[36:39], a[148:151], a[0:3], v[36:39]
    ds_read_b64_tr_b16 a[132:133], v232 offset:14464
    v_mfma_f32_16x16x32_bf16 v[92:95], a[148:151], a[4:7], v[92:95]
    ds_read_b64_tr_b16 a[134:135], v232 offset:18048
    v_mfma_f32_16x16x32_bf16 v[148:151], a[148:151], a[8:11], v[148:151]
    buffer_load_dwordx4 v230, s[28:31], s40 offen offset:1024 lds
    v_mfma_f32_16x16x32_bf16 v[204:207], a[148:151], a[12:15], v[204:207]
    s_waitcnt lgkmcnt(4)
    v_mfma_f32_16x16x32_bf16 v[12:15], a[152:155], a[0:3], v[12:15]
    ds_read_b64_tr_b16 a[136:137], v232 offset:160
    v_mfma_f32_16x16x32_bf16 v[68:71], a[152:155], a[4:7], v[68:71]
    ds_read_b64_tr_b16 a[138:139], v232 offset:3744
    v_mfma_f32_16x16x32_bf16 v[124:127], a[152:155], a[8:11], v[124:127]
    buffer_load_dwordx4 v231, s[28:31], s40 offen offset:2048 lds
    v_mfma_f32_16x16x32_bf16 v[180:183], a[152:155], a[12:15], v[180:183]
    v_mfma_f32_16x16x32_bf16 v[40:43], a[156:159], a[0:3], v[40:43]
    ds_read_b64_tr_b16 a[140:141], v232 offset:14496
    v_mfma_f32_16x16x32_bf16 v[96:99], a[156:159], a[4:7], v[96:99]
    ds_read_b64_tr_b16 a[142:143], v232 offset:18080
    v_mfma_f32_16x16x32_bf16 v[152:155], a[156:159], a[8:11], v[152:155]
    v_mfma_f32_16x16x32_bf16 v[208:211], a[156:159], a[12:15], v[208:211]
    s_waitcnt lgkmcnt(4)
    v_mfma_f32_16x16x32_bf16 v[16:19], a[128:131], a[0:3], v[16:19]
    ds_read_b64_tr_b16 a[144:145], v232 offset:192
    v_mfma_f32_16x16x32_bf16 v[72:75], a[128:131], a[4:7], v[72:75]
    ds_read_b64_tr_b16 a[146:147], v232 offset:3776
    v_mfma_f32_16x16x32_bf16 v[128:131], a[128:131], a[8:11], v[128:131]
    buffer_load_dwordx4 a[32:35], v224, s[12:15], s39 offen offset:0 sc1
    v_mfma_f32_16x16x32_bf16 v[184:187], a[128:131], a[12:15], v[184:187]
    v_mfma_f32_16x16x32_bf16 v[44:47], a[132:135], a[0:3], v[44:47]
    ds_read_b64_tr_b16 a[148:149], v232 offset:14528
    v_mfma_f32_16x16x32_bf16 v[100:103], a[132:135], a[4:7], v[100:103]
    ds_read_b64_tr_b16 a[150:151], v232 offset:18112
    v_mfma_f32_16x16x32_bf16 v[156:159], a[132:135], a[8:11], v[156:159]
    v_mfma_f32_16x16x32_bf16 v[212:215], a[132:135], a[12:15], v[212:215]
    s_waitcnt lgkmcnt(4)
    v_mfma_f32_16x16x32_bf16 v[20:23], a[136:139], a[0:3], v[20:23]
    ds_read_b64_tr_b16 a[152:153], v232 offset:7168
    v_mfma_f32_16x16x32_bf16 v[76:79], a[136:139], a[4:7], v[76:79]
    ds_read_b64_tr_b16 a[154:155], v232 offset:10752
    v_mfma_f32_16x16x32_bf16 v[132:135], a[136:139], a[8:11], v[132:135]
    buffer_load_dwordx4 a[36:39], v224, s[16:19], s39 offen offset:0 sc1
    v_mfma_f32_16x16x32_bf16 v[188:191], a[136:139], a[12:15], v[188:191]
    v_mfma_f32_16x16x32_bf16 v[48:51], a[140:143], a[0:3], v[48:51]
    ds_read_b64_tr_b16 a[156:157], v232 offset:21504
    v_mfma_f32_16x16x32_bf16 v[104:107], a[140:143], a[4:7], v[104:107]
    ds_read_b64_tr_b16 a[158:159], v232 offset:25088
    v_mfma_f32_16x16x32_bf16 v[160:163], a[140:143], a[8:11], v[160:163]
    v_mfma_f32_16x16x32_bf16 v[216:219], a[140:143], a[12:15], v[216:219]
    s_waitcnt lgkmcnt(4)
    v_mfma_f32_16x16x32_bf16 v[24:27], a[144:147], a[0:3], v[24:27]
    ds_read_b64_tr_b16 a[128:129], v232 offset:7200
    v_mfma_f32_16x16x32_bf16 v[80:83], a[144:147], a[4:7], v[80:83]
    ds_read_b64_tr_b16 a[130:131], v232 offset:10784
    v_mfma_f32_16x16x32_bf16 v[136:139], a[144:147], a[8:11], v[136:139]
    buffer_load_dwordx4 a[40:43], v224, s[20:23], s39 offen offset:0 sc1
    v_mfma_f32_16x16x32_bf16 v[192:195], a[144:147], a[12:15], v[192:195]
    v_mfma_f32_16x16x32_bf16 v[52:55], a[148:151], a[0:3], v[52:55]
    ds_read_b64_tr_b16 a[132:133], v232 offset:21536
    v_mfma_f32_16x16x32_bf16 v[108:111], a[148:151], a[4:7], v[108:111]
    ds_read_b64_tr_b16 a[134:135], v232 offset:25120
    v_mfma_f32_16x16x32_bf16 v[164:167], a[148:151], a[8:11], v[164:167]
    v_mfma_f32_16x16x32_bf16 v[220:223], a[148:151], a[12:15], v[220:223]
    s_waitcnt lgkmcnt(4)
    s_waitcnt vmcnt(10)
    v_mfma_f32_16x16x32_bf16 v[0:3], a[152:155], a[16:19], v[0:3]
    ds_read_b64_tr_b16 a[136:137], v232 offset:7232
    v_mfma_f32_16x16x32_bf16 v[56:59], a[152:155], a[20:23], v[56:59]
    ds_read_b64_tr_b16 a[138:139], v232 offset:10816
    v_mfma_f32_16x16x32_bf16 v[112:115], a[152:155], a[24:27], v[112:115]
    buffer_load_dwordx4 a[44:47], v224, s[24:27], s39 offen offset:0 sc1
    v_mfma_f32_16x16x32_bf16 v[168:171], a[152:155], a[28:31], v[168:171]
    v_mfma_f32_16x16x32_bf16 v[28:31], a[156:159], a[16:19], v[28:31]
    ds_read_b64_tr_b16 a[140:141], v232 offset:21568
    v_mfma_f32_16x16x32_bf16 v[84:87], a[156:159], a[20:23], v[84:87]
    ds_read_b64_tr_b16 a[142:143], v232 offset:25152
    v_mfma_f32_16x16x32_bf16 v[140:143], a[156:159], a[24:27], v[140:143]
    v_mfma_f32_16x16x32_bf16 v[196:199], a[156:159], a[28:31], v[196:199]
    s_waitcnt lgkmcnt(4)
    v_mfma_f32_16x16x32_bf16 v[4:7], a[128:131], a[16:19], v[4:7]
    ds_read_b64_tr_b16 a[144:145], v232 offset:7264
    v_mfma_f32_16x16x32_bf16 v[60:63], a[128:131], a[20:23], v[60:63]
    ds_read_b64_tr_b16 a[146:147], v232 offset:10848
    v_mfma_f32_16x16x32_bf16 v[116:119], a[128:131], a[24:27], v[116:119]
    buffer_load_dwordx4 a[48:51], v224, s[12:15], s39 offen offset:1024 sc1
    v_mfma_f32_16x16x32_bf16 v[172:175], a[128:131], a[28:31], v[172:175]
    v_mfma_f32_16x16x32_bf16 v[32:35], a[132:135], a[16:19], v[32:35]
    ds_read_b64_tr_b16 a[148:149], v232 offset:21600
    v_mfma_f32_16x16x32_bf16 v[88:91], a[132:135], a[20:23], v[88:91]
    ds_read_b64_tr_b16 a[150:151], v232 offset:25184
    v_mfma_f32_16x16x32_bf16 v[144:147], a[132:135], a[24:27], v[144:147]
    v_mfma_f32_16x16x32_bf16 v[200:203], a[132:135], a[28:31], v[200:203]
    s_waitcnt lgkmcnt(4)
    v_mfma_f32_16x16x32_bf16 v[8:11], a[136:139], a[16:19], v[8:11]
    ds_read_b64_tr_b16 a[152:153], v232 offset:7296
    v_mfma_f32_16x16x32_bf16 v[64:67], a[136:139], a[20:23], v[64:67]
    ds_read_b64_tr_b16 a[154:155], v232 offset:10880
    v_mfma_f32_16x16x32_bf16 v[120:123], a[136:139], a[24:27], v[120:123]
    buffer_load_dwordx4 a[52:55], v224, s[16:19], s39 offen offset:1024 sc1
    v_mfma_f32_16x16x32_bf16 v[176:179], a[136:139], a[28:31], v[176:179]
    v_mfma_f32_16x16x32_bf16 v[36:39], a[140:143], a[16:19], v[36:39]
    ds_read_b64_tr_b16 a[156:157], v232 offset:21632
    v_mfma_f32_16x16x32_bf16 v[92:95], a[140:143], a[20:23], v[92:95]
    ds_read_b64_tr_b16 a[158:159], v232 offset:25216
    v_mfma_f32_16x16x32_bf16 v[148:151], a[140:143], a[24:27], v[148:151]
    v_mfma_f32_16x16x32_bf16 v[204:207], a[140:143], a[28:31], v[204:207]
    s_waitcnt lgkmcnt(4)
    v_mfma_f32_16x16x32_bf16 v[12:15], a[144:147], a[16:19], v[12:15]
    ds_read_b64_tr_b16 a[128:129], v232 offset:7328
    v_mfma_f32_16x16x32_bf16 v[68:71], a[144:147], a[20:23], v[68:71]
    ds_read_b64_tr_b16 a[130:131], v232 offset:10912
    v_mfma_f32_16x16x32_bf16 v[124:127], a[144:147], a[24:27], v[124:127]
    buffer_load_dwordx4 a[56:59], v224, s[20:23], s39 offen offset:1024 sc1
    v_mfma_f32_16x16x32_bf16 v[180:183], a[144:147], a[28:31], v[180:183]
    v_mfma_f32_16x16x32_bf16 v[40:43], a[148:151], a[16:19], v[40:43]
    ds_read_b64_tr_b16 a[132:133], v232 offset:21664
    v_mfma_f32_16x16x32_bf16 v[96:99], a[148:151], a[20:23], v[96:99]
    ds_read_b64_tr_b16 a[134:135], v232 offset:25248
    v_mfma_f32_16x16x32_bf16 v[152:155], a[148:151], a[24:27], v[152:155]
    buffer_load_dwordx4 a[60:63], v224, s[24:27], s39 offen offset:1024 sc1
    v_mfma_f32_16x16x32_bf16 v[208:211], a[148:151], a[28:31], v[208:211]
    s_add_u32 s64, s63, s62
    s_waitcnt lgkmcnt(4)
    v_mfma_f32_16x16x32_bf16 v[16:19], a[152:155], a[16:19], v[16:19]
    ds_read_b64_tr_b16 a[136:137], v232 offset:7360
    v_mfma_f32_16x16x32_bf16 v[72:75], a[152:155], a[20:23], v[72:75]
    ds_read_b64_tr_b16 a[138:139], v232 offset:10944
    v_mfma_f32_16x16x32_bf16 v[128:131], a[152:155], a[24:27], v[128:131]
    v_mfma_f32_16x16x32_bf16 v[184:187], a[152:155], a[28:31], v[184:187]
    s_and_b32 s64, s64, 0
    v_mfma_f32_16x16x32_bf16 v[44:47], a[156:159], a[16:19], v[44:47]
    ds_read_b64_tr_b16 a[140:141], v232 offset:21696
    v_mfma_f32_16x16x32_bf16 v[100:103], a[156:159], a[20:23], v[100:103]
    ds_read_b64_tr_b16 a[142:143], v232 offset:25280
    v_mfma_f32_16x16x32_bf16 v[156:159], a[156:159], a[24:27], v[156:159]
    v_mfma_f32_16x16x32_bf16 v[212:215], a[156:159], a[28:31], v[212:215]
    s_andn2_b32 s67, s63, 0
    s_waitcnt vmcnt(8)
    s_barrier
    s_waitcnt lgkmcnt(4)
    v_mfma_f32_16x16x32_bf16 v[20:23], a[128:131], a[16:19], v[20:23]
    ds_read_b64_tr_b16 a[144:145], v232 offset:28672
    v_mfma_f32_16x16x32_bf16 v[76:79], a[128:131], a[20:23], v[76:79]
    ds_read_b64_tr_b16 a[146:147], v232 offset:32256
    v_mfma_f32_16x16x32_bf16 v[132:135], a[128:131], a[24:27], v[132:135]
    v_mfma_f32_16x16x32_bf16 v[188:191], a[128:131], a[28:31], v[188:191]
    s_or_b32 s64, s64, s67
    v_mfma_f32_16x16x32_bf16 v[48:51], a[132:135], a[16:19], v[48:51]
    ds_read_b64_tr_b16 a[148:149], v232 offset:43008
    v_mfma_f32_16x16x32_bf16 v[104:107], a[132:135], a[20:23], v[104:107]
    ds_read_b64_tr_b16 a[150:151], v232 offset:46592
    v_mfma_f32_16x16x32_bf16 v[160:163], a[132:135], a[24:27], v[160:163]
    v_mfma_f32_16x16x32_bf16 v[216:219], a[132:135], a[28:31], v[216:219]
    s_add_u32 s63, s63, 1
    s_waitcnt lgkmcnt(4)
    v_mfma_f32_16x16x32_bf16 v[24:27], a[136:139], a[16:19], v[24:27]
    ds_read_b64_tr_b16 a[152:153], v232 offset:28704
    v_mfma_f32_16x16x32_bf16 v[80:83], a[136:139], a[20:23], v[80:83]
    ds_read_b64_tr_b16 a[154:155], v232 offset:32288
    v_mfma_f32_16x16x32_bf16 v[136:139], a[136:139], a[24:27], v[136:139]
    v_mfma_f32_16x16x32_bf16 v[192:195], a[136:139], a[28:31], v[192:195]
    s_lshl_b32 s39, s64, 11
    v_mfma_f32_16x16x32_bf16 v[52:55], a[140:143], a[16:19], v[52:55]
    ds_read_b64_tr_b16 a[156:157], v232 offset:43040
    v_mfma_f32_16x16x32_bf16 v[108:111], a[140:143], a[20:23], v[108:111]
    ds_read_b64_tr_b16 a[158:159], v232 offset:46624
    v_mfma_f32_16x16x32_bf16 v[164:167], a[140:143], a[24:27], v[164:167]
    v_mfma_f32_16x16x32_bf16 v[220:223], a[140:143], a[28:31], v[220:223]
    s_mul_i32 s40, s64, 458752
    s_waitcnt lgkmcnt(4)
    s_waitcnt vmcnt(4)
    v_mfma_f32_16x16x32_bf16 v[0:3], a[144:147], a[32:35], v[0:3]
    ds_read_b64_tr_b16 a[128:129], v232 offset:28736
    v_mfma_f32_16x16x32_bf16 v[56:59], a[144:147], a[36:39], v[56:59]
    ds_read_b64_tr_b16 a[130:131], v232 offset:32320
    v_mfma_f32_16x16x32_bf16 v[112:115], a[144:147], a[40:43], v[112:115]
    s_mov_b32 m0, s46
    s_nop 0
    buffer_load_dwordx4 v225, s[28:31], s40 offen offset:0 lds
    v_mfma_f32_16x16x32_bf16 v[168:171], a[144:147], a[44:47], v[168:171]
    v_mfma_f32_16x16x32_bf16 v[28:31], a[148:151], a[32:35], v[28:31]
    ds_read_b64_tr_b16 a[132:133], v232 offset:43072
    v_mfma_f32_16x16x32_bf16 v[84:87], a[148:151], a[36:39], v[84:87]
    ds_read_b64_tr_b16 a[134:135], v232 offset:46656
    v_mfma_f32_16x16x32_bf16 v[140:143], a[148:151], a[40:43], v[140:143]
    buffer_load_dwordx4 v226, s[28:31], s40 offen offset:1024 lds
    v_mfma_f32_16x16x32_bf16 v[196:199], a[148:151], a[44:47], v[196:199]
    s_waitcnt lgkmcnt(4)
    v_mfma_f32_16x16x32_bf16 v[4:7], a[152:155], a[32:35], v[4:7]
    ds_read_b64_tr_b16 a[136:137], v232 offset:28768
    v_mfma_f32_16x16x32_bf16 v[60:63], a[152:155], a[36:39], v[60:63]
    ds_read_b64_tr_b16 a[138:139], v232 offset:32352
    v_mfma_f32_16x16x32_bf16 v[116:119], a[152:155], a[40:43], v[116:119]
    buffer_load_dwordx4 v227, s[28:31], s40 offen offset:2048 lds
    v_mfma_f32_16x16x32_bf16 v[172:175], a[152:155], a[44:47], v[172:175]
    v_mfma_f32_16x16x32_bf16 v[32:35], a[156:159], a[32:35], v[32:35]
    ds_read_b64_tr_b16 a[140:141], v232 offset:43104
    v_mfma_f32_16x16x32_bf16 v[88:91], a[156:159], a[36:39], v[88:91]
    ds_read_b64_tr_b16 a[142:143], v232 offset:46688
    v_mfma_f32_16x16x32_bf16 v[144:147], a[156:159], a[40:43], v[144:147]
    buffer_load_dwordx4 v228, s[28:31], s40 offen offset:3072 lds
    v_mfma_f32_16x16x32_bf16 v[200:203], a[156:159], a[44:47], v[200:203]
    s_waitcnt lgkmcnt(4)
    v_mfma_f32_16x16x32_bf16 v[8:11], a[128:131], a[32:35], v[8:11]
    ds_read_b64_tr_b16 a[144:145], v232 offset:28800
    v_mfma_f32_16x16x32_bf16 v[64:67], a[128:131], a[36:39], v[64:67]
    ds_read_b64_tr_b16 a[146:147], v232 offset:32384
    v_mfma_f32_16x16x32_bf16 v[120:123], a[128:131], a[40:43], v[120:123]
    s_add_u32 m0, s46, 4096
    s_nop 0
    buffer_load_dwordx4 v229, s[28:31], s40 offen offset:0 lds
    v_mfma_f32_16x16x32_bf16 v[176:179], a[128:131], a[44:47], v[176:179]
    v_mfma_f32_16x16x32_bf16 v[36:39], a[132:135], a[32:35], v[36:39]
    ds_read_b64_tr_b16 a[148:149], v232 offset:43136
    v_mfma_f32_16x16x32_bf16 v[92:95], a[132:135], a[36:39], v[92:95]
    ds_read_b64_tr_b16 a[150:151], v232 offset:46720
    v_mfma_f32_16x16x32_bf16 v[148:151], a[132:135], a[40:43], v[148:151]
    buffer_load_dwordx4 v230, s[28:31], s40 offen offset:1024 lds
    v_mfma_f32_16x16x32_bf16 v[204:207], a[132:135], a[44:47], v[204:207]
    s_waitcnt lgkmcnt(4)
    v_mfma_f32_16x16x32_bf16 v[12:15], a[136:139], a[32:35], v[12:15]
    ds_read_b64_tr_b16 a[152:153], v232 offset:28832
    v_mfma_f32_16x16x32_bf16 v[68:71], a[136:139], a[36:39], v[68:71]
    ds_read_b64_tr_b16 a[154:155], v232 offset:32416
    v_mfma_f32_16x16x32_bf16 v[124:127], a[136:139], a[40:43], v[124:127]
    buffer_load_dwordx4 v231, s[28:31], s40 offen offset:2048 lds
    v_mfma_f32_16x16x32_bf16 v[180:183], a[136:139], a[44:47], v[180:183]
    v_mfma_f32_16x16x32_bf16 v[40:43], a[140:143], a[32:35], v[40:43]
    ds_read_b64_tr_b16 a[156:157], v232 offset:43168
    v_mfma_f32_16x16x32_bf16 v[96:99], a[140:143], a[36:39], v[96:99]
    ds_read_b64_tr_b16 a[158:159], v232 offset:46752
    v_mfma_f32_16x16x32_bf16 v[152:155], a[140:143], a[40:43], v[152:155]
    v_mfma_f32_16x16x32_bf16 v[208:211], a[140:143], a[44:47], v[208:211]
    s_waitcnt lgkmcnt(4)
    v_mfma_f32_16x16x32_bf16 v[16:19], a[144:147], a[32:35], v[16:19]
    ds_read_b64_tr_b16 a[128:129], v232 offset:28864
    v_mfma_f32_16x16x32_bf16 v[72:75], a[144:147], a[36:39], v[72:75]
    ds_read_b64_tr_b16 a[130:131], v232 offset:32448
    v_mfma_f32_16x16x32_bf16 v[128:131], a[144:147], a[40:43], v[128:131]
    buffer_load_dwordx4 a[64:67], v224, s[12:15], s39 offen offset:0 sc1
    v_mfma_f32_16x16x32_bf16 v[184:187], a[144:147], a[44:47], v[184:187]
    v_mfma_f32_16x16x32_bf16 v[44:47], a[148:151], a[32:35], v[44:47]
    ds_read_b64_tr_b16 a[132:133], v232 offset:43200
    v_mfma_f32_16x16x32_bf16 v[100:103], a[148:151], a[36:39], v[100:103]
    ds_read_b64_tr_b16 a[134:135], v232 offset:46784
    v_mfma_f32_16x16x32_bf16 v[156:159], a[148:151], a[40:43], v[156:159]
    v_mfma_f32_16x16x32_bf16 v[212:215], a[148:151], a[44:47], v[212:215]
    s_waitcnt lgkmcnt(4)
    v_mfma_f32_16x16x32_bf16 v[20:23], a[152:155], a[32:35], v[20:23]
    ds_read_b64_tr_b16 a[136:137], v232 offset:35840
    v_mfma_f32_16x16x32_bf16 v[76:79], a[152:155], a[36:39], v[76:79]
    ds_read_b64_tr_b16 a[138:139], v232 offset:39424
    v_mfma_f32_16x16x32_bf16 v[132:135], a[152:155], a[40:43], v[132:135]
    buffer_load_dwordx4 a[68:71], v224, s[16:19], s39 offen offset:0 sc1
    v_mfma_f32_16x16x32_bf16 v[188:191], a[152:155], a[44:47], v[188:191]
    v_mfma_f32_16x16x32_bf16 v[48:51], a[156:159], a[32:35], v[48:51]
    ds_read_b64_tr_b16 a[140:141], v232 offset:50176
    v_mfma_f32_16x16x32_bf16 v[104:107], a[156:159], a[36:39], v[104:107]
    ds_read_b64_tr_b16 a[142:143], v232 offset:53760
    v_mfma_f32_16x16x32_bf16 v[160:163], a[156:159], a[40:43], v[160:163]
    v_mfma_f32_16x16x32_bf16 v[216:219], a[156:159], a[44:47], v[216:219]
    s_waitcnt lgkmcnt(4)
    v_mfma_f32_16x16x32_bf16 v[24:27], a[128:131], a[32:35], v[24:27]
    ds_read_b64_tr_b16 a[144:145], v232 offset:35872
    v_mfma_f32_16x16x32_bf16 v[80:83], a[128:131], a[36:39], v[80:83]
    ds_read_b64_tr_b16 a[146:147], v232 offset:39456
    v_mfma_f32_16x16x32_bf16 v[136:139], a[128:131], a[40:43], v[136:139]
    buffer_load_dwordx4 a[72:75], v224, s[20:23], s39 offen offset:0 sc1
    v_mfma_f32_16x16x32_bf16 v[192:195], a[128:131], a[44:47], v[192:195]
    v_mfma_f32_16x16x32_bf16 v[52:55], a[132:135], a[32:35], v[52:55]
    ds_read_b64_tr_b16 a[148:149], v232 offset:50208
    v_mfma_f32_16x16x32_bf16 v[108:111], a[132:135], a[36:39], v[108:111]
    ds_read_b64_tr_b16 a[150:151], v232 offset:53792
    v_mfma_f32_16x16x32_bf16 v[164:167], a[132:135], a[40:43], v[164:167]
    v_mfma_f32_16x16x32_bf16 v[220:223], a[132:135], a[44:47], v[220:223]
    s_waitcnt lgkmcnt(4)
    s_waitcnt vmcnt(10)
    v_mfma_f32_16x16x32_bf16 v[0:3], a[136:139], a[48:51], v[0:3]
    ds_read_b64_tr_b16 a[152:153], v232 offset:35904
    v_mfma_f32_16x16x32_bf16 v[56:59], a[136:139], a[52:55], v[56:59]
    ds_read_b64_tr_b16 a[154:155], v232 offset:39488
    v_mfma_f32_16x16x32_bf16 v[112:115], a[136:139], a[56:59], v[112:115]
    buffer_load_dwordx4 a[76:79], v224, s[24:27], s39 offen offset:0 sc1
    v_mfma_f32_16x16x32_bf16 v[168:171], a[136:139], a[60:63], v[168:171]
    v_mfma_f32_16x16x32_bf16 v[28:31], a[140:143], a[48:51], v[28:31]
    ds_read_b64_tr_b16 a[156:157], v232 offset:50240
    v_mfma_f32_16x16x32_bf16 v[84:87], a[140:143], a[52:55], v[84:87]
    ds_read_b64_tr_b16 a[158:159], v232 offset:53824
    v_mfma_f32_16x16x32_bf16 v[140:143], a[140:143], a[56:59], v[140:143]
    v_mfma_f32_16x16x32_bf16 v[196:199], a[140:143], a[60:63], v[196:199]
    s_waitcnt lgkmcnt(4)
    v_mfma_f32_16x16x32_bf16 v[4:7], a[144:147], a[48:51], v[4:7]
    ds_read_b64_tr_b16 a[128:129], v232 offset:35936
    v_mfma_f32_16x16x32_bf16 v[60:63], a[144:147], a[52:55], v[60:63]
    ds_read_b64_tr_b16 a[130:131], v232 offset:39520
    v_mfma_f32_16x16x32_bf16 v[116:119], a[144:147], a[56:59], v[116:119]
    buffer_load_dwordx4 a[80:83], v224, s[12:15], s39 offen offset:1024 sc1
    v_mfma_f32_16x16x32_bf16 v[172:175], a[144:147], a[60:63], v[172:175]
    v_mfma_f32_16x16x32_bf16 v[32:35], a[148:151], a[48:51], v[32:35]
    ds_read_b64_tr_b16 a[132:133], v232 offset:50272
    v_mfma_f32_16x16x32_bf16 v[88:91], a[148:151], a[52:55], v[88:91]
    ds_read_b64_tr_b16 a[134:135], v232 offset:53856
    v_mfma_f32_16x16x32_bf16 v[144:147], a[148:151], a[56:59], v[144:147]
    v_mfma_f32_16x16x32_bf16 v[200:203], a[148:151], a[60:63], v[200:203]
    s_waitcnt lgkmcnt(4)
    v_mfma_f32_16x16x32_bf16 v[8:11], a[152:155], a[48:51], v[8:11]
    ds_read_b64_tr_b16 a[136:137], v232 offset:35968
    v_mfma_f32_16x16x32_bf16 v[64:67], a[152:155], a[52:55], v[64:67]
    ds_read_b64_tr_b16 a[138:139], v232 offset:39552
    v_mfma_f32_16x16x32_bf16 v[120:123], a[152:155], a[56:59], v[120:123]
    buffer_load_dwordx4 a[84:87], v224, s[16:19], s39 offen offset:1024 sc1
    v_mfma_f32_16x16x32_bf16 v[176:179], a[152:155], a[60:63], v[176:179]
    v_mfma_f32_16x16x32_bf16 v[36:39], a[156:159], a[48:51], v[36:39]
    ds_read_b64_tr_b16 a[140:141], v232 offset:50304
    v_mfma_f32_16x16x32_bf16 v[92:95], a[156:159], a[52:55], v[92:95]
    ds_read_b64_tr_b16 a[142:143], v232 offset:53888
    v_mfma_f32_16x16x32_bf16 v[148:151], a[156:159], a[56:59], v[148:151]
    v_mfma_f32_16x16x32_bf16 v[204:207], a[156:159], a[60:63], v[204:207]
    s_waitcnt lgkmcnt(4)
    v_mfma_f32_16x16x32_bf16 v[12:15], a[128:131], a[48:51], v[12:15]
    ds_read_b64_tr_b16 a[144:145], v232 offset:36000
    v_mfma_f32_16x16x32_bf16 v[68:71], a[128:131], a[52:55], v[68:71]
    ds_read_b64_tr_b16 a[146:147], v232 offset:39584
    v_mfma_f32_16x16x32_bf16 v[124:127], a[128:131], a[56:59], v[124:127]
    buffer_load_dwordx4 a[88:91], v224, s[20:23], s39 offen offset:1024 sc1
    v_mfma_f32_16x16x32_bf16 v[180:183], a[128:131], a[60:63], v[180:183]
    v_mfma_f32_16x16x32_bf16 v[40:43], a[132:135], a[48:51], v[40:43]
    ds_read_b64_tr_b16 a[148:149], v232 offset:50336
    v_mfma_f32_16x16x32_bf16 v[96:99], a[132:135], a[52:55], v[96:99]
    ds_read_b64_tr_b16 a[150:151], v232 offset:53920
    v_mfma_f32_16x16x32_bf16 v[152:155], a[132:135], a[56:59], v[152:155]
    buffer_load_dwordx4 a[92:95], v224, s[24:27], s39 offen offset:1024 sc1
    v_mfma_f32_16x16x32_bf16 v[208:211], a[132:135], a[60:63], v[208:211]
    s_add_u32 s64, s63, s62
    s_waitcnt lgkmcnt(4)
    v_mfma_f32_16x16x32_bf16 v[16:19], a[136:139], a[48:51], v[16:19]
    ds_read_b64_tr_b16 a[152:153], v232 offset:36032
    v_mfma_f32_16x16x32_bf16 v[72:75], a[136:139], a[52:55], v[72:75]
    ds_read_b64_tr_b16 a[154:155], v232 offset:39616
    v_mfma_f32_16x16x32_bf16 v[128:131], a[136:139], a[56:59], v[128:131]
    v_mfma_f32_16x16x32_bf16 v[184:187], a[136:139], a[60:63], v[184:187]
    s_and_b32 s64, s64, 0
    v_mfma_f32_16x16x32_bf16 v[44:47], a[140:143], a[48:51], v[44:47]
    ds_read_b64_tr_b16 a[156:157], v232 offset:50368
    v_mfma_f32_16x16x32_bf16 v[100:103], a[140:143], a[52:55], v[100:103]
    ds_read_b64_tr_b16 a[158:159], v232 offset:53952
    v_mfma_f32_16x16x32_bf16 v[156:159], a[140:143], a[56:59], v[156:159]
    v_mfma_f32_16x16x32_bf16 v[212:215], a[140:143], a[60:63], v[212:215]
    s_andn2_b32 s67, s63, 0
    s_waitcnt vmcnt(8)
    s_barrier
    s_waitcnt lgkmcnt(4)
    v_mfma_f32_16x16x32_bf16 v[20:23], a[144:147], a[48:51], v[20:23]
    ds_read_b64_tr_b16 a[128:129], v233 offset:0
    v_mfma_f32_16x16x32_bf16 v[76:79], a[144:147], a[52:55], v[76:79]
    ds_read_b64_tr_b16 a[130:131], v233 offset:3584
    v_mfma_f32_16x16x32_bf16 v[132:135], a[144:147], a[56:59], v[132:135]
    v_mfma_f32_16x16x32_bf16 v[188:191], a[144:147], a[60:63], v[188:191]
    s_or_b32 s64, s64, s67
    v_mfma_f32_16x16x32_bf16 v[48:51], a[148:151], a[48:51], v[48:51]
    ds_read_b64_tr_b16 a[132:133], v233 offset:14336
    v_mfma_f32_16x16x32_bf16 v[104:107], a[148:151], a[52:55], v[104:107]
    ds_read_b64_tr_b16 a[134:135], v233 offset:17920
    v_mfma_f32_16x16x32_bf16 v[160:163], a[148:151], a[56:59], v[160:163]
    v_mfma_f32_16x16x32_bf16 v[216:219], a[148:151], a[60:63], v[216:219]
    s_add_u32 s63, s63, 1
    s_waitcnt lgkmcnt(4)
    v_mfma_f32_16x16x32_bf16 v[24:27], a[152:155], a[48:51], v[24:27]
    ds_read_b64_tr_b16 a[136:137], v233 offset:32
    v_mfma_f32_16x16x32_bf16 v[80:83], a[152:155], a[52:55], v[80:83]
    ds_read_b64_tr_b16 a[138:139], v233 offset:3616
    v_mfma_f32_16x16x32_bf16 v[136:139], a[152:155], a[56:59], v[136:139]
    v_mfma_f32_16x16x32_bf16 v[192:195], a[152:155], a[60:63], v[192:195]
    s_lshl_b32 s39, s64, 11
    v_mfma_f32_16x16x32_bf16 v[52:55], a[156:159], a[48:51], v[52:55]
    ds_read_b64_tr_b16 a[140:141], v233 offset:14368
    v_mfma_f32_16x16x32_bf16 v[108:111], a[156:159], a[52:55], v[108:111]
    ds_read_b64_tr_b16 a[142:143], v233 offset:17952
    v_mfma_f32_16x16x32_bf16 v[164:167], a[156:159], a[56:59], v[164:167]
    v_mfma_f32_16x16x32_bf16 v[220:223], a[156:159], a[60:63], v[220:223]
    s_mul_i32 s40, s64, 458752
    s_waitcnt lgkmcnt(4)
    s_waitcnt vmcnt(4)
    v_mfma_f32_16x16x32_bf16 v[0:3], a[128:131], a[64:67], v[0:3]
    ds_read_b64_tr_b16 a[144:145], v233 offset:64
    v_mfma_f32_16x16x32_bf16 v[56:59], a[128:131], a[68:71], v[56:59]
    ds_read_b64_tr_b16 a[146:147], v233 offset:3648
    v_mfma_f32_16x16x32_bf16 v[112:115], a[128:131], a[72:75], v[112:115]
    s_mov_b32 m0, s47
    s_nop 0
    buffer_load_dwordx4 v225, s[28:31], s40 offen offset:0 lds
    v_mfma_f32_16x16x32_bf16 v[168:171], a[128:131], a[76:79], v[168:171]
    v_mfma_f32_16x16x32_bf16 v[28:31], a[132:135], a[64:67], v[28:31]
    ds_read_b64_tr_b16 a[148:149], v233 offset:14400
    v_mfma_f32_16x16x32_bf16 v[84:87], a[132:135], a[68:71], v[84:87]
    ds_read_b64_tr_b16 a[150:151], v233 offset:17984
    v_mfma_f32_16x16x32_bf16 v[140:143], a[132:135], a[72:75], v[140:143]
    buffer_load_dwordx4 v226, s[28:31], s40 offen offset:1024 lds
    v_mfma_f32_16x16x32_bf16 v[196:199], a[132:135], a[76:79], v[196:199]
    s_waitcnt lgkmcnt(4)
    v_mfma_f32_16x16x32_bf16 v[4:7], a[136:139], a[64:67], v[4:7]
    ds_read_b64_tr_b16 a[152:153], v233 offset:96
    v_mfma_f32_16x16x32_bf16 v[60:63], a[136:139], a[68:71], v[60:63]
    ds_read_b64_tr_b16 a[154:155], v233 offset:3680
    v_mfma_f32_16x16x32_bf16 v[116:119], a[136:139], a[72:75], v[116:119]
    buffer_load_dwordx4 v227, s[28:31], s40 offen offset:2048 lds
    v_mfma_f32_16x16x32_bf16 v[172:175], a[136:139], a[76:79], v[172:175]
    v_mfma_f32_16x16x32_bf16 v[32:35], a[140:143], a[64:67], v[32:35]
    ds_read_b64_tr_b16 a[156:157], v233 offset:14432
    v_mfma_f32_16x16x32_bf16 v[88:91], a[140:143], a[68:71], v[88:91]
    ds_read_b64_tr_b16 a[158:159], v233 offset:18016
    v_mfma_f32_16x16x32_bf16 v[144:147], a[140:143], a[72:75], v[144:147]
    buffer_load_dwordx4 v228, s[28:31], s40 offen offset:3072 lds
    v_mfma_f32_16x16x32_bf16 v[200:203], a[140:143], a[76:79], v[200:203]
    s_waitcnt lgkmcnt(4)
    v_mfma_f32_16x16x32_bf16 v[8:11], a[144:147], a[64:67], v[8:11]
    ds_read_b64_tr_b16 a[128:129], v233 offset:128
    v_mfma_f32_16x16x32_bf16 v[64:67], a[144:147], a[68:71], v[64:67]
    ds_read_b64_tr_b16 a[130:131], v233 offset:3712
    v_mfma_f32_16x16x32_bf16 v[120:123], a[144:147], a[72:75], v[120:123]
    s_add_u32 m0, s47, 4096
    s_nop 0
    buffer_load_dwordx4 v229, s[28:31], s40 offen offset:0 lds
    v_mfma_f32_16x16x32_bf16 v[176:179], a[144:147], a[76:79], v[176:179]
    v_mfma_f32_16x16x32_bf16 v[36:39], a[148:151], a[64:67], v[36:39]
    ds_read_b64_tr_b16 a[132:133], v233 offset:14464
    v_mfma_f32_16x16x32_bf16 v[92:95], a[148:151], a[68:71], v[92:95]
    ds_read_b64_tr_b16 a[134:135], v233 offset:18048
    v_mfma_f32_16x16x32_bf16 v[148:151], a[148:151], a[72:75], v[148:151]
    buffer_load_dwordx4 v230, s[28:31], s40 offen offset:1024 lds
    v_mfma_f32_16x16x32_bf16 v[204:207], a[148:151], a[76:79], v[204:207]
    s_waitcnt lgkmcnt(4)
    v_mfma_f32_16x16x32_bf16 v[12:15], a[152:155], a[64:67], v[12:15]
    ds_read_b64_tr_b16 a[136:137], v233 offset:160
    v_mfma_f32_16x16x32_bf16 v[68:71], a[152:155], a[68:71], v[68:71]
    ds_read_b64_tr_b16 a[138:139], v233 offset:3744
    v_mfma_f32_16x16x32_bf16 v[124:127], a[152:155], a[72:75], v[124:127]
    buffer_load_dwordx4 v231, s[28:31], s40 offen offset:2048 lds
    v_mfma_f32_16x16x32_bf16 v[180:183], a[152:155], a[76:79], v[180:183]
    v_mfma_f32_16x16x32_bf16 v[40:43], a[156:159], a[64:67], v[40:43]
    ds_read_b64_tr_b16 a[140:141], v233 offset:14496
    v_mfma_f32_16x16x32_bf16 v[96:99], a[156:159], a[68:71], v[96:99]
    ds_read_b64_tr_b16 a[142:143], v233 offset:18080
    v_mfma_f32_16x16x32_bf16 v[152:155], a[156:159], a[72:75], v[152:155]
    v_mfma_f32_16x16x32_bf16 v[208:211], a[156:159], a[76:79], v[208:211]
    s_waitcnt lgkmcnt(4)
    v_mfma_f32_16x16x32_bf16 v[16:19], a[128:131], a[64:67], v[16:19]
    ds_read_b64_tr_b16 a[144:145], v233 offset:192
    v_mfma_f32_16x16x32_bf16 v[72:75], a[128:131], a[68:71], v[72:75]
    ds_read_b64_tr_b16 a[146:147], v233 offset:3776
    v_mfma_f32_16x16x32_bf16 v[128:131], a[128:131], a[72:75], v[128:131]
    buffer_load_dwordx4 a[96:99], v224, s[12:15], s39 offen offset:0 sc1
    v_mfma_f32_16x16x32_bf16 v[184:187], a[128:131], a[76:79], v[184:187]
    v_mfma_f32_16x16x32_bf16 v[44:47], a[132:135], a[64:67], v[44:47]
    ds_read_b64_tr_b16 a[148:149], v233 offset:14528
    v_mfma_f32_16x16x32_bf16 v[100:103], a[132:135], a[68:71], v[100:103]
    ds_read_b64_tr_b16 a[150:151], v233 offset:18112
    v_mfma_f32_16x16x32_bf16 v[156:159], a[132:135], a[72:75], v[156:159]
    v_mfma_f32_16x16x32_bf16 v[212:215], a[132:135], a[76:79], v[212:215]
    s_waitcnt lgkmcnt(4)
    v_mfma_f32_16x16x32_bf16 v[20:23], a[136:139], a[64:67], v[20:23]
    ds_read_b64_tr_b16 a[152:153], v233 offset:7168
    v_mfma_f32_16x16x32_bf16 v[76:79], a[136:139], a[68:71], v[76:79]
    ds_read_b64_tr_b16 a[154:155], v233 offset:10752
    v_mfma_f32_16x16x32_bf16 v[132:135], a[136:139], a[72:75], v[132:135]
    buffer_load_dwordx4 a[100:103], v224, s[16:19], s39 offen offset:0 sc1
    v_mfma_f32_16x16x32_bf16 v[188:191], a[136:139], a[76:79], v[188:191]
    v_mfma_f32_16x16x32_bf16 v[48:51], a[140:143], a[64:67], v[48:51]
    ds_read_b64_tr_b16 a[156:157], v233 offset:21504
    v_mfma_f32_16x16x32_bf16 v[104:107], a[140:143], a[68:71], v[104:107]
    ds_read_b64_tr_b16 a[158:159], v233 offset:25088
    v_mfma_f32_16x16x32_bf16 v[160:163], a[140:143], a[72:75], v[160:163]
    v_mfma_f32_16x16x32_bf16 v[216:219], a[140:143], a[76:79], v[216:219]
    s_waitcnt lgkmcnt(4)
    v_mfma_f32_16x16x32_bf16 v[24:27], a[144:147], a[64:67], v[24:27]
    ds_read_b64_tr_b16 a[128:129], v233 offset:7200
    v_mfma_f32_16x16x32_bf16 v[80:83], a[144:147], a[68:71], v[80:83]
    ds_read_b64_tr_b16 a[130:131], v233 offset:10784
    v_mfma_f32_16x16x32_bf16 v[136:139], a[144:147], a[72:75], v[136:139]
    buffer_load_dwordx4 a[104:107], v224, s[20:23], s39 offen offset:0 sc1
    v_mfma_f32_16x16x32_bf16 v[192:195], a[144:147], a[76:79], v[192:195]
    v_mfma_f32_16x16x32_bf16 v[52:55], a[148:151], a[64:67], v[52:55]
    ds_read_b64_tr_b16 a[132:133], v233 offset:21536
    v_mfma_f32_16x16x32_bf16 v[108:111], a[148:151], a[68:71], v[108:111]
    ds_read_b64_tr_b16 a[134:135], v233 offset:25120
    v_mfma_f32_16x16x32_bf16 v[164:167], a[148:151], a[72:75], v[164:167]
    v_mfma_f32_16x16x32_bf16 v[220:223], a[148:151], a[76:79], v[220:223]
    s_waitcnt lgkmcnt(4)
    s_waitcnt vmcnt(10)
    v_mfma_f32_16x16x32_bf16 v[0:3], a[152:155], a[80:83], v[0:3]
    ds_read_b64_tr_b16 a[136:137], v233 offset:7232
    v_mfma_f32_16x16x32_bf16 v[56:59], a[152:155], a[84:87], v[56:59]
    ds_read_b64_tr_b16 a[138:139], v233 offset:10816
    v_mfma_f32_16x16x32_bf16 v[112:115], a[152:155], a[88:91], v[112:115]
    buffer_load_dwordx4 a[108:111], v224, s[24:27], s39 offen offset:0 sc1
    v_mfma_f32_16x16x32_bf16 v[168:171], a[152:155], a[92:95], v[168:171]
    v_mfma_f32_16x16x32_bf16 v[28:31], a[156:159], a[80:83], v[28:31]
    ds_read_b64_tr_b16 a[140:141], v233 offset:21568
    v_mfma_f32_16x16x32_bf16 v[84:87], a[156:159], a[84:87], v[84:87]
    ds_read_b64_tr_b16 a[142:143], v233 offset:25152
    v_mfma_f32_16x16x32_bf16 v[140:143], a[156:159], a[88:91], v[140:143]
    v_mfma_f32_16x16x32_bf16 v[196:199], a[156:159], a[92:95], v[196:199]
    s_waitcnt lgkmcnt(4)
    v_mfma_f32_16x16x32_bf16 v[4:7], a[128:131], a[80:83], v[4:7]
    ds_read_b64_tr_b16 a[144:145], v233 offset:7264
    v_mfma_f32_16x16x32_bf16 v[60:63], a[128:131], a[84:87], v[60:63]
    ds_read_b64_tr_b16 a[146:147], v233 offset:10848
    v_mfma_f32_16x16x32_bf16 v[116:119], a[128:131], a[88:91], v[116:119]
    buffer_load_dwordx4 a[112:115], v224, s[12:15], s39 offen offset:1024 sc1
    v_mfma_f32_16x16x32_bf16 v[172:175], a[128:131], a[92:95], v[172:175]
    v_mfma_f32_16x16x32_bf16 v[32:35], a[132:135], a[80:83], v[32:35]
    ds_read_b64_tr_b16 a[148:149], v233 offset:21600
    v_mfma_f32_16x16x32_bf16 v[88:91], a[132:135], a[84:87], v[88:91]
    ds_read_b64_tr_b16 a[150:151], v233 offset:25184
    v_mfma_f32_16x16x32_bf16 v[144:147], a[132:135], a[88:91], v[144:147]
    v_mfma_f32_16x16x32_bf16 v[200:203], a[132:135], a[92:95], v[200:203]
    s_waitcnt lgkmcnt(4)
    v_mfma_f32_16x16x32_bf16 v[8:11], a[136:139], a[80:83], v[8:11]
    ds_read_b64_tr_b16 a[152:153], v233 offset:7296
    v_mfma_f32_16x16x32_bf16 v[64:67], a[136:139], a[84:87], v[64:67]
    ds_read_b64_tr_b16 a[154:155], v233 offset:10880
    v_mfma_f32_16x16x32_bf16 v[120:123], a[136:139], a[88:91], v[120:123]
    buffer_load_dwordx4 a[116:119], v224, s[16:19], s39 offen offset:1024 sc1
    v_mfma_f32_16x16x32_bf16 v[176:179], a[136:139], a[92:95], v[176:179]
    v_mfma_f32_16x16x32_bf16 v[36:39], a[140:143], a[80:83], v[36:39]
    ds_read_b64_tr_b16 a[156:157], v233 offset:21632
    v_mfma_f32_16x16x32_bf16 v[92:95], a[140:143], a[84:87], v[92:95]
    ds_read_b64_tr_b16 a[158:159], v233 offset:25216
    v_mfma_f32_16x16x32_bf16 v[148:151], a[140:143], a[88:91], v[148:151]
    v_mfma_f32_16x16x32_bf16 v[204:207], a[140:143], a[92:95], v[204:207]
    s_waitcnt lgkmcnt(4)
    v_mfma_f32_16x16x32_bf16 v[12:15], a[144:147], a[80:83], v[12:15]
    ds_read_b64_tr_b16 a[128:129], v233 offset:7328
    v_mfma_f32_16x16x32_bf16 v[68:71], a[144:147], a[84:87], v[68:71]
    ds_read_b64_tr_b16 a[130:131], v233 offset:10912
    v_mfma_f32_16x16x32_bf16 v[124:127], a[144:147], a[88:91], v[124:127]
    buffer_load_dwordx4 a[120:123], v224, s[20:23], s39 offen offset:1024 sc1
    v_mfma_f32_16x16x32_bf16 v[180:183], a[144:147], a[92:95], v[180:183]
    v_mfma_f32_16x16x32_bf16 v[40:43], a[148:151], a[80:83], v[40:43]
    ds_read_b64_tr_b16 a[132:133], v233 offset:21664
    v_mfma_f32_16x16x32_bf16 v[96:99], a[148:151], a[84:87], v[96:99]
    ds_read_b64_tr_b16 a[134:135], v233 offset:25248
    v_mfma_f32_16x16x32_bf16 v[152:155], a[148:151], a[88:91], v[152:155]
    buffer_load_dwordx4 a[124:127], v224, s[24:27], s39 offen offset:1024 sc1
    v_mfma_f32_16x16x32_bf16 v[208:211], a[148:151], a[92:95], v[208:211]
    s_add_u32 s64, s63, s62
    s_waitcnt lgkmcnt(4)
    v_mfma_f32_16x16x32_bf16 v[16:19], a[152:155], a[80:83], v[16:19]
    ds_read_b64_tr_b16 a[136:137], v233 offset:7360
    v_mfma_f32_16x16x32_bf16 v[72:75], a[152:155], a[84:87], v[72:75]
    ds_read_b64_tr_b16 a[138:139], v233 offset:10944
    v_mfma_f32_16x16x32_bf16 v[128:131], a[152:155], a[88:91], v[128:131]
    v_mfma_f32_16x16x32_bf16 v[184:187], a[152:155], a[92:95], v[184:187]
    s_and_b32 s64, s64, 0
    v_mfma_f32_16x16x32_bf16 v[44:47], a[156:159], a[80:83], v[44:47]
    ds_read_b64_tr_b16 a[140:141], v233 offset:21696
    v_mfma_f32_16x16x32_bf16 v[100:103], a[156:159], a[84:87], v[100:103]
    ds_read_b64_tr_b16 a[142:143], v233 offset:25280
    v_mfma_f32_16x16x32_bf16 v[156:159], a[156:159], a[88:91], v[156:159]
    v_mfma_f32_16x16x32_bf16 v[212:215], a[156:159], a[92:95], v[212:215]
    s_andn2_b32 s67, s63, 0
    s_waitcnt vmcnt(8)
    s_barrier
    s_waitcnt lgkmcnt(4)
    v_mfma_f32_16x16x32_bf16 v[20:23], a[128:131], a[80:83], v[20:23]
    ds_read_b64_tr_b16 a[144:145], v233 offset:28672
    v_mfma_f32_16x16x32_bf16 v[76:79], a[128:131], a[84:87], v[76:79]
    ds_read_b64_tr_b16 a[146:147], v233 offset:32256
    v_mfma_f32_16x16x32_bf16 v[132:135], a[128:131], a[88:91], v[132:135]
    v_mfma_f32_16x16x32_bf16 v[188:191], a[128:131], a[92:95], v[188:191]
    s_or_b32 s64, s64, s67
    v_mfma_f32_16x16x32_bf16 v[48:51], a[132:135], a[80:83], v[48:51]
    ds_read_b64_tr_b16 a[148:149], v233 offset:43008
    v_mfma_f32_16x16x32_bf16 v[104:107], a[132:135], a[84:87], v[104:107]
    ds_read_b64_tr_b16 a[150:151], v233 offset:46592
    v_mfma_f32_16x16x32_bf16 v[160:163], a[132:135], a[88:91], v[160:163]
    v_mfma_f32_16x16x32_bf16 v[216:219], a[132:135], a[92:95], v[216:219]
    s_add_u32 s63, s63, 1
    s_waitcnt lgkmcnt(4)
    v_mfma_f32_16x16x32_bf16 v[24:27], a[136:139], a[80:83], v[24:27]
    ds_read_b64_tr_b16 a[152:153], v233 offset:28704
    v_mfma_f32_16x16x32_bf16 v[80:83], a[136:139], a[84:87], v[80:83]
    ds_read_b64_tr_b16 a[154:155], v233 offset:32288
    v_mfma_f32_16x16x32_bf16 v[136:139], a[136:139], a[88:91], v[136:139]
    v_mfma_f32_16x16x32_bf16 v[192:195], a[136:139], a[92:95], v[192:195]
    s_lshl_b32 s39, s64, 11
    v_mfma_f32_16x16x32_bf16 v[52:55], a[140:143], a[80:83], v[52:55]
    ds_read_b64_tr_b16 a[156:157], v233 offset:43040
    v_mfma_f32_16x16x32_bf16 v[108:111], a[140:143], a[84:87], v[108:111]
    ds_read_b64_tr_b16 a[158:159], v233 offset:46624
    v_mfma_f32_16x16x32_bf16 v[164:167], a[140:143], a[88:91], v[164:167]
    v_mfma_f32_16x16x32_bf16 v[220:223], a[140:143], a[92:95], v[220:223]
    s_mul_i32 s40, s64, 458752
    s_cmp_eq_u32 s41, 1
    s_cbranch_scc1 L_gu_last
    s_waitcnt lgkmcnt(4)
    s_waitcnt vmcnt(4)
    v_mfma_f32_16x16x32_bf16 v[0:3], a[144:147], a[96:99], v[0:3]
    ds_read_b64_tr_b16 a[128:129], v233 offset:28736
    v_mfma_f32_16x16x32_bf16 v[56:59], a[144:147], a[100:103], v[56:59]
    ds_read_b64_tr_b16 a[130:131], v233 offset:32320
    v_mfma_f32_16x16x32_bf16 v[112:115], a[144:147], a[104:107], v[112:115]
    s_mov_b32 m0, s44
    s_nop 0
    buffer_load_dwordx4 v225, s[28:31], s40 offen offset:0 lds
    v_mfma_f32_16x16x32_bf16 v[168:171], a[144:147], a[108:111], v[168:171]
    v_mfma_f32_16x16x32_bf16 v[28:31], a[148:151], a[96:99], v[28:31]
    ds_read_b64_tr_b16 a[132:133], v233 offset:43072
    v_mfma_f32_16x16x32_bf16 v[84:87], a[148:151], a[100:103], v[84:87]
    ds_read_b64_tr_b16 a[134:135], v233 offset:46656
    v_mfma_f32_16x16x32_bf16 v[140:143], a[148:151], a[104:107], v[140:143]
    buffer_load_dwordx4 v226, s[28:31], s40 offen offset:1024 lds
    v_mfma_f32_16x16x32_bf16 v[196:199], a[148:151], a[108:111], v[196:199]
    s_waitcnt lgkmcnt(4)
    v_mfma_f32_16x16x32_bf16 v[4:7], a[152:155], a[96:99], v[4:7]
    ds_read_b64_tr_b16 a[136:137], v233 offset:28768
    v_mfma_f32_16x16x32_bf16 v[60:63], a[152:155], a[100:103], v[60:63]
    ds_read_b64_tr_b16 a[138:139], v233 offset:32352
    v_mfma_f32_16x16x32_bf16 v[116:119], a[152:155], a[104:107], v[116:119]
    buffer_load_dwordx4 v227, s[28:31], s40 offen offset:2048 lds
    v_mfma_f32_16x16x32_bf16 v[172:175], a[152:155], a[108:111], v[172:175]
    v_mfma_f32_16x16x32_bf16 v[32:35], a[156:159], a[96:99], v[32:35]
    ds_read_b64_tr_b16 a[140:141], v233 offset:43104
    v_mfma_f32_16x16x32_bf16 v[88:91], a[156:159], a[100:103], v[88:91]
    ds_read_b64_tr_b16 a[142:143], v233 offset:46688
    v_mfma_f32_16x16x32_bf16 v[144:147], a[156:159], a[104:107], v[144:147]
    buffer_load_dwordx4 v228, s[28:31], s40 offen offset:3072 lds
    v_mfma_f32_16x16x32_bf16 v[200:203], a[156:159], a[108:111], v[200:203]
    s_waitcnt lgkmcnt(4)
    v_mfma_f32_16x16x32_bf16 v[8:11], a[128:131], a[96:99], v[8:11]
    ds_read_b64_tr_b16 a[144:145], v233 offset:28800
    v_mfma_f32_16x16x32_bf16 v[64:67], a[128:131], a[100:103], v[64:67]
    ds_read_b64_tr_b16 a[146:147], v233 offset:32384
    v_mfma_f32_16x16x32_bf16 v[120:123], a[128:131], a[104:107], v[120:123]
    s_add_u32 m0, s44, 4096
    s_nop 0
    buffer_load_dwordx4 v229, s[28:31], s40 offen offset:0 lds
    v_mfma_f32_16x16x32_bf16 v[176:179], a[128:131], a[108:111], v[176:179]
    v_mfma_f32_16x16x32_bf16 v[36:39], a[132:135], a[96:99], v[36:39]
    ds_read_b64_tr_b16 a[148:149], v233 offset:43136
    v_mfma_f32_16x16x32_bf16 v[92:95], a[132:135], a[100:103], v[92:95]
    ds_read_b64_tr_b16 a[150:151], v233 offset:46720
    v_mfma_f32_16x16x32_bf16 v[148:151], a[132:135], a[104:107], v[148:151]
    buffer_load_dwordx4 v230, s[28:31], s40 offen offset:1024 lds
    v_mfma_f32_16x16x32_bf16 v[204:207], a[132:135], a[108:111], v[204:207]
    s_waitcnt lgkmcnt(4)
    v_mfma_f32_16x16x32_bf16 v[12:15], a[136:139], a[96:99], v[12:15]
    ds_read_b64_tr_b16 a[152:153], v233 offset:28832
    v_mfma_f32_16x16x32_bf16 v[68:71], a[136:139], a[100:103], v[68:71]
    ds_read_b64_tr_b16 a[154:155], v233 offset:32416
    v_mfma_f32_16x16x32_bf16 v[124:127], a[136:139], a[104:107], v[124:127]
    buffer_load_dwordx4 v231, s[28:31], s40 offen offset:2048 lds
    v_mfma_f32_16x16x32_bf16 v[180:183], a[136:139], a[108:111], v[180:183]
    v_mfma_f32_16x16x32_bf16 v[40:43], a[140:143], a[96:99], v[40:43]
    ds_read_b64_tr_b16 a[156:157], v233 offset:43168
    v_mfma_f32_16x16x32_bf16 v[96:99], a[140:143], a[100:103], v[96:99]
    ds_read_b64_tr_b16 a[158:159], v233 offset:46752
    v_mfma_f32_16x16x32_bf16 v[152:155], a[140:143], a[104:107], v[152:155]
    v_mfma_f32_16x16x32_bf16 v[208:211], a[140:143], a[108:111], v[208:211]
    s_waitcnt lgkmcnt(4)
    v_mfma_f32_16x16x32_bf16 v[16:19], a[144:147], a[96:99], v[16:19]
    ds_read_b64_tr_b16 a[128:129], v233 offset:28864
    v_mfma_f32_16x16x32_bf16 v[72:75], a[144:147], a[100:103], v[72:75]
    ds_read_b64_tr_b16 a[130:131], v233 offset:32448
    v_mfma_f32_16x16x32_bf16 v[128:131], a[144:147], a[104:107], v[128:131]
    buffer_load_dwordx4 a[0:3], v224, s[12:15], s39 offen offset:0 sc1
    v_mfma_f32_16x16x32_bf16 v[184:187], a[144:147], a[108:111], v[184:187]
    v_mfma_f32_16x16x32_bf16 v[44:47], a[148:151], a[96:99], v[44:47]
    ds_read_b64_tr_b16 a[132:133], v233 offset:43200
    v_mfma_f32_16x16x32_bf16 v[100:103], a[148:151], a[100:103], v[100:103]
    ds_read_b64_tr_b16 a[134:135], v233 offset:46784
    v_mfma_f32_16x16x32_bf16 v[156:159], a[148:151], a[104:107], v[156:159]
    v_mfma_f32_16x16x32_bf16 v[212:215], a[148:151], a[108:111], v[212:215]
    s_waitcnt lgkmcnt(4)
    v_mfma_f32_16x16x32_bf16 v[20:23], a[152:155], a[96:99], v[20:23]
    ds_read_b64_tr_b16 a[136:137], v233 offset:35840
    v_mfma_f32_16x16x32_bf16 v[76:79], a[152:155], a[100:103], v[76:79]
    ds_read_b64_tr_b16 a[138:139], v233 offset:39424
    v_mfma_f32_16x16x32_bf16 v[132:135], a[152:155], a[104:107], v[132:135]
    buffer_load_dwordx4 a[4:7], v224, s[16:19], s39 offen offset:0 sc1
    v_mfma_f32_16x16x32_bf16 v[188:191], a[152:155], a[108:111], v[188:191]
    v_mfma_f32_16x16x32_bf16 v[48:51], a[156:159], a[96:99], v[48:51]
    ds_read_b64_tr_b16 a[140:141], v233 offset:50176
    v_mfma_f32_16x16x32_bf16 v[104:107], a[156:159], a[100:103], v[104:107]
    ds_read_b64_tr_b16 a[142:143], v233 offset:53760
    v_mfma_f32_16x16x32_bf16 v[160:163], a[156:159], a[104:107], v[160:163]
    v_mfma_f32_16x16x32_bf16 v[216:219], a[156:159], a[108:111], v[216:219]
    s_waitcnt lgkmcnt(4)
    v_mfma_f32_16x16x32_bf16 v[24:27], a[128:131], a[96:99], v[24:27]
    ds_read_b64_tr_b16 a[144:145], v233 offset:35872
    v_mfma_f32_16x16x32_bf16 v[80:83], a[128:131], a[100:103], v[80:83]
    ds_read_b64_tr_b16 a[146:147], v233 offset:39456
    v_mfma_f32_16x16x32_bf16 v[136:139], a[128:131], a[104:107], v[136:139]
    buffer_load_dwordx4 a[8:11], v224, s[20:23], s39 offen offset:0 sc1
    v_mfma_f32_16x16x32_bf16 v[192:195], a[128:131], a[108:111], v[192:195]
    v_mfma_f32_16x16x32_bf16 v[52:55], a[132:135], a[96:99], v[52:55]
    ds_read_b64_tr_b16 a[148:149], v233 offset:50208
    v_mfma_f32_16x16x32_bf16 v[108:111], a[132:135], a[100:103], v[108:111]
    ds_read_b64_tr_b16 a[150:151], v233 offset:53792
    v_mfma_f32_16x16x32_bf16 v[164:167], a[132:135], a[104:107], v[164:167]
    v_mfma_f32_16x16x32_bf16 v[220:223], a[132:135], a[108:111], v[220:223]
    s_waitcnt lgkmcnt(4)
    s_waitcnt vmcnt(10)
    v_mfma_f32_16x16x32_bf16 v[0:3], a[136:139], a[112:115], v[0:3]
    ds_read_b64_tr_b16 a[152:153], v233 offset:35904
    v_mfma_f32_16x16x32_bf16 v[56:59], a[136:139], a[116:119], v[56:59]
    ds_read_b64_tr_b16 a[154:155], v233 offset:39488
    v_mfma_f32_16x16x32_bf16 v[112:115], a[136:139], a[120:123], v[112:115]
    buffer_load_dwordx4 a[12:15], v224, s[24:27], s39 offen offset:0 sc1
    v_mfma_f32_16x16x32_bf16 v[168:171], a[136:139], a[124:127], v[168:171]
    v_mfma_f32_16x16x32_bf16 v[28:31], a[140:143], a[112:115], v[28:31]
    ds_read_b64_tr_b16 a[156:157], v233 offset:50240
    v_mfma_f32_16x16x32_bf16 v[84:87], a[140:143], a[116:119], v[84:87]
    ds_read_b64_tr_b16 a[158:159], v233 offset:53824
    v_mfma_f32_16x16x32_bf16 v[140:143], a[140:143], a[120:123], v[140:143]
    v_mfma_f32_16x16x32_bf16 v[196:199], a[140:143], a[124:127], v[196:199]
    s_waitcnt lgkmcnt(4)
    v_mfma_f32_16x16x32_bf16 v[4:7], a[144:147], a[112:115], v[4:7]
    ds_read_b64_tr_b16 a[128:129], v233 offset:35936
    v_mfma_f32_16x16x32_bf16 v[60:63], a[144:147], a[116:119], v[60:63]
    ds_read_b64_tr_b16 a[130:131], v233 offset:39520
    v_mfma_f32_16x16x32_bf16 v[116:119], a[144:147], a[120:123], v[116:119]
    buffer_load_dwordx4 a[16:19], v224, s[12:15], s39 offen offset:1024 sc1
    v_mfma_f32_16x16x32_bf16 v[172:175], a[144:147], a[124:127], v[172:175]
    v_mfma_f32_16x16x32_bf16 v[32:35], a[148:151], a[112:115], v[32:35]
    ds_read_b64_tr_b16 a[132:133], v233 offset:50272
    v_mfma_f32_16x16x32_bf16 v[88:91], a[148:151], a[116:119], v[88:91]
    ds_read_b64_tr_b16 a[134:135], v233 offset:53856
    v_mfma_f32_16x16x32_bf16 v[144:147], a[148:151], a[120:123], v[144:147]
    v_mfma_f32_16x16x32_bf16 v[200:203], a[148:151], a[124:127], v[200:203]
    s_waitcnt lgkmcnt(4)
    v_mfma_f32_16x16x32_bf16 v[8:11], a[152:155], a[112:115], v[8:11]
    ds_read_b64_tr_b16 a[136:137], v233 offset:35968
    v_mfma_f32_16x16x32_bf16 v[64:67], a[152:155], a[116:119], v[64:67]
    ds_read_b64_tr_b16 a[138:139], v233 offset:39552
    v_mfma_f32_16x16x32_bf16 v[120:123], a[152:155], a[120:123], v[120:123]
    buffer_load_dwordx4 a[20:23], v224, s[16:19], s39 offen offset:1024 sc1
    v_mfma_f32_16x16x32_bf16 v[176:179], a[152:155], a[124:127], v[176:179]
    v_mfma_f32_16x16x32_bf16 v[36:39], a[156:159], a[112:115], v[36:39]
    ds_read_b64_tr_b16 a[140:141], v233 offset:50304
    v_mfma_f32_16x16x32_bf16 v[92:95], a[156:159], a[116:119], v[92:95]
    ds_read_b64_tr_b16 a[142:143], v233 offset:53888
    v_mfma_f32_16x16x32_bf16 v[148:151], a[156:159], a[120:123], v[148:151]
    v_mfma_f32_16x16x32_bf16 v[204:207], a[156:159], a[124:127], v[204:207]
    s_waitcnt lgkmcnt(4)
    v_mfma_f32_16x16x32_bf16 v[12:15], a[128:131], a[112:115], v[12:15]
    ds_read_b64_tr_b16 a[144:145], v233 offset:36000
    v_mfma_f32_16x16x32_bf16 v[68:71], a[128:131], a[116:119], v[68:71]
    ds_read_b64_tr_b16 a[146:147], v233 offset:39584
    v_mfma_f32_16x16x32_bf16 v[124:127], a[128:131], a[120:123], v[124:127]
    buffer_load_dwordx4 a[24:27], v224, s[20:23], s39 offen offset:1024 sc1
    v_mfma_f32_16x16x32_bf16 v[180:183], a[128:131], a[124:127], v[180:183]
    v_mfma_f32_16x16x32_bf16 v[40:43], a[132:135], a[112:115], v[40:43]
    ds_read_b64_tr_b16 a[148:149], v233 offset:50336
    v_mfma_f32_16x16x32_bf16 v[96:99], a[132:135], a[116:119], v[96:99]
    ds_read_b64_tr_b16 a[150:151], v233 offset:53920
    v_mfma_f32_16x16x32_bf16 v[152:155], a[132:135], a[120:123], v[152:155]
    buffer_load_dwordx4 a[28:31], v224, s[24:27], s39 offen offset:1024 sc1
    v_mfma_f32_16x16x32_bf16 v[208:211], a[132:135], a[124:127], v[208:211]
    s_add_u32 s64, s63, s62
    s_waitcnt lgkmcnt(4)
    v_mfma_f32_16x16x32_bf16 v[16:19], a[136:139], a[112:115], v[16:19]
    ds_read_b64_tr_b16 a[152:153], v233 offset:36032
    v_mfma_f32_16x16x32_bf16 v[72:75], a[136:139], a[116:119], v[72:75]
    ds_read_b64_tr_b16 a[154:155], v233 offset:39616
    v_mfma_f32_16x16x32_bf16 v[128:131], a[136:139], a[120:123], v[128:131]
    v_mfma_f32_16x16x32_bf16 v[184:187], a[136:139], a[124:127], v[184:187]
    s_and_b32 s64, s64, 0
    v_mfma_f32_16x16x32_bf16 v[44:47], a[140:143], a[112:115], v[44:47]
    ds_read_b64_tr_b16 a[156:157], v233 offset:50368
    v_mfma_f32_16x16x32_bf16 v[100:103], a[140:143], a[116:119], v[100:103]
    ds_read_b64_tr_b16 a[158:159], v233 offset:53952
    v_mfma_f32_16x16x32_bf16 v[156:159], a[140:143], a[120:123], v[156:159]
    v_mfma_f32_16x16x32_bf16 v[212:215], a[140:143], a[124:127], v[212:215]
    s_andn2_b32 s67, s63, 0
    s_waitcnt vmcnt(8)
    s_barrier
    s_waitcnt lgkmcnt(4)
    v_mfma_f32_16x16x32_bf16 v[20:23], a[144:147], a[112:115], v[20:23]
    ds_read_b64_tr_b16 a[128:129], v232 offset:0
    v_mfma_f32_16x16x32_bf16 v[76:79], a[144:147], a[116:119], v[76:79]
    ds_read_b64_tr_b16 a[130:131], v232 offset:3584
    v_mfma_f32_16x16x32_bf16 v[132:135], a[144:147], a[120:123], v[132:135]
    v_mfma_f32_16x16x32_bf16 v[188:191], a[144:147], a[124:127], v[188:191]
    s_or_b32 s64, s64, s67
    v_mfma_f32_16x16x32_bf16 v[48:51], a[148:151], a[112:115], v[48:51]
    ds_read_b64_tr_b16 a[132:133], v232 offset:14336
    v_mfma_f32_16x16x32_bf16 v[104:107], a[148:151], a[116:119], v[104:107]
    ds_read_b64_tr_b16 a[134:135], v232 offset:17920
    v_mfma_f32_16x16x32_bf16 v[160:163], a[148:151], a[120:123], v[160:163]
    v_mfma_f32_16x16x32_bf16 v[216:219], a[148:151], a[124:127], v[216:219]
    s_add_u32 s63, s63, 1
    s_waitcnt lgkmcnt(4)
    v_mfma_f32_16x16x32_bf16 v[24:27], a[152:155], a[112:115], v[24:27]
    ds_read_b64_tr_b16 a[136:137], v232 offset:32
    v_mfma_f32_16x16x32_bf16 v[80:83], a[152:155], a[116:119], v[80:83]
    ds_read_b64_tr_b16 a[138:139], v232 offset:3616
    v_mfma_f32_16x16x32_bf16 v[136:139], a[152:155], a[120:123], v[136:139]
    v_mfma_f32_16x16x32_bf16 v[192:195], a[152:155], a[124:127], v[192:195]
    s_lshl_b32 s39, s64, 11
    v_mfma_f32_16x16x32_bf16 v[52:55], a[156:159], a[112:115], v[52:55]
    ds_read_b64_tr_b16 a[140:141], v232 offset:14368
    v_mfma_f32_16x16x32_bf16 v[108:111], a[156:159], a[116:119], v[108:111]
    ds_read_b64_tr_b16 a[142:143], v232 offset:17952
    v_mfma_f32_16x16x32_bf16 v[164:167], a[156:159], a[120:123], v[164:167]
    v_mfma_f32_16x16x32_bf16 v[220:223], a[156:159], a[124:127], v[220:223]
    s_mul_i32 s40, s64, 458752
    s_sub_u32 s41, s41, 1
    s_cmp_lg_u32 s41, 0
    s_cbranch_scc1 L_gu_loop
    s_endpgm
L_gu_last:
    s_mul_i32 s42, s38, 7
    s_lshr_b32 s52, s42, 1
    s_lshl_b32 s52, s52, 10
    s_add_u32 s53, s52, 1024
    s_add_u32 s54, s52, 2048
    s_add_u32 s55, s52, 3072
    v_add_u32 v225, 0, v224
    v_add_u32 v226, 114688, v224
    v_add_u32 v227, 229376, v224
    v_add_u32 v228, 344064, v224
    s_mov_b32 s60, 0xbfb8aa3b
    s_mov_b32 s61, 0xbfb8aa3b
    s_and_b32 s42, s38, 1
    s_cmp_eq_u32 s42, 1
    s_cbranch_scc1 L_gu_odd
    s_waitcnt lgkmcnt(6)
    s_waitcnt vmcnt(4)
    v_mfma_f32_16x16x32_bf16 v[0:3], a[144:147], a[96:99], v[0:3]
    ds_read_b64_tr_b16 a[128:129], v233 offset:35840
    v_mfma_f32_16x16x32_bf16 v[56:59], a[144:147], a[100:103], v[56:59]
    ds_read_b64_tr_b16 a[130:131], v233 offset:39424
    v_mfma_f32_16x16x32_bf16 v[112:115], a[144:147], a[104:107], v[112:115]
    v_mfma_f32_16x16x32_bf16 v[168:171], a[144:147], a[108:111], v[168:171]
    s_waitcnt lgkmcnt(6)
    v_mfma_f32_16x16x32_bf16 v[28:31], a[148:151], a[96:99], v[28:31]
    ds_read_b64_tr_b16 a[132:133], v233 offset:50176
    v_mfma_f32_16x16x32_bf16 v[84:87], a[148:151], a[100:103], v[84:87]
    ds_read_b64_tr_b16 a[134:135], v233 offset:53760
    v_mfma_f32_16x16x32_bf16 v[140:143], a[148:151], a[104:107], v[140:143]
    v_mfma_f32_16x16x32_bf16 v[196:199], a[148:151], a[108:111], v[196:199]
    s_waitcnt lgkmcnt(6)
    v_mfma_f32_16x16x32_bf16 v[4:7], a[152:155], a[96:99], v[4:7]
    ds_read_b64_tr_b16 a[136:137], v233 offset:35872
    v_mfma_f32_16x16x32_bf16 v[60:63], a[152:155], a[100:103], v[60:63]
    ds_read_b64_tr_b16 a[138:139], v233 offset:39456
    v_mfma_f32_16x16x32_bf16 v[116:119], a[152:155], a[104:107], v[116:119]
    v_mfma_f32_16x16x32_bf16 v[172:175], a[152:155], a[108:111], v[172:175]
    s_waitcnt lgkmcnt(6)
    v_mfma_f32_16x16x32_bf16 v[32:35], a[156:159], a[96:99], v[32:35]
    ds_read_b64_tr_b16 a[140:141], v233 offset:50208
    v_mfma_f32_16x16x32_bf16 v[88:91], a[156:159], a[100:103], v[88:91]
    ds_read_b64_tr_b16 a[142:143], v233 offset:53792
    v_mfma_f32_16x16x32_bf16 v[144:147], a[156:159], a[104:107], v[144:147]
    v_mfma_f32_16x16x32_bf16 v[200:203], a[156:159], a[108:111], v[200:203]
    s_waitcnt lgkmcnt(6)
    s_waitcnt vmcnt(0)
    v_mfma_f32_16x16x32_bf16 v[0:3], a[128:131], a[112:115], v[0:3]
    ds_read_b64_tr_b16 a[144:145], v233 offset:28736
    v_mfma_f32_16x16x32_bf16 v[56:59], a[128:131], a[116:119], v[56:59]
    ds_read_b64_tr_b16 a[146:147], v233 offset:32320
    v_mfma_f32_16x16x32_bf16 v[112:115], a[128:131], a[120:123], v[112:115]
    v_mfma_f32_16x16x32_bf16 v[168:171], a[128:131], a[124:127], v[168:171]
    s_waitcnt lgkmcnt(6)
    v_mfma_f32_16x16x32_bf16 v[28:31], a[132:135], a[112:115], v[28:31]
    ds_read_b64_tr_b16 a[148:149], v233 offset:43072
    v_mfma_f32_16x16x32_bf16 v[84:87], a[132:135], a[116:119], v[84:87]
    ds_read_b64_tr_b16 a[150:151], v233 offset:46656
    v_mfma_f32_16x16x32_bf16 v[140:143], a[132:135], a[120:123], v[140:143]
    v_mfma_f32_16x16x32_bf16 v[196:199], a[132:135], a[124:127], v[196:199]
    s_waitcnt lgkmcnt(6)
    v_mfma_f32_16x16x32_bf16 v[4:7], a[136:139], a[112:115], v[4:7]
    ds_read_b64_tr_b16 a[152:153], v233 offset:35904
    v_pk_mul_f32 v[234:235], v[0:1], s[60:61]
    v_pk_mul_f32 v[236:237], v[2:3], s[60:61]
    v_pk_mul_f32 v[28:29], v[0:1], v[28:29]
    v_pk_mul_f32 v[30:31], v[2:3], v[30:31]
    v_exp_f32 v234, v234
    v_mfma_f32_16x16x32_bf16 v[60:63], a[136:139], a[116:119], v[60:63]
    ds_read_b64_tr_b16 a[154:155], v233 offset:39488
    v_exp_f32 v235, v235
    v_exp_f32 v236, v236
    v_exp_f32 v237, v237
    v_pk_add_f32 v[234:235], v[234:235], 1.0 op_sel_hi:[1,0]
    v_pk_add_f32 v[236:237], v[236:237], 1.0 op_sel_hi:[1,0]
    v_mfma_f32_16x16x32_bf16 v[116:119], a[136:139], a[120:123], v[116:119]
    v_rcp_f32 v234, v234
    v_rcp_f32 v235, v235
    v_rcp_f32 v236, v236
    v_rcp_f32 v237, v237
    v_pk_mul_f32 v[234:235], v[234:235], v[28:29]
    v_mfma_f32_16x16x32_bf16 v[172:175], a[136:139], a[124:127], v[172:175]
    v_pk_mul_f32 v[236:237], v[236:237], v[30:31]
    v_cvt_pk_bf16_f32 v0, v234, v235
    v_cvt_pk_bf16_f32 v1, v236, v237
    v_pk_mul_f32 v[238:239], v[56:57], s[60:61]
    v_pk_mul_f32 v[240:241], v[58:59], s[60:61]
    s_waitcnt lgkmcnt(6)
    v_mfma_f32_16x16x32_bf16 v[32:35], a[140:143], a[112:115], v[32:35]
    ds_read_b64_tr_b16 a[156:157], v233 offset:50240
    v_pk_mul_f32 v[84:85], v[56:57], v[84:85]
    v_pk_mul_f32 v[86:87], v[58:59], v[86:87]
    v_exp_f32 v238, v238
    v_exp_f32 v239, v239
    v_exp_f32 v240, v240
    v_mfma_f32_16x16x32_bf16 v[88:91], a[140:143], a[116:119], v[88:91]
    ds_read_b64_tr_b16 a[158:159], v233 offset:53824
    v_exp_f32 v241, v241
    v_pk_add_f32 v[238:239], v[238:239], 1.0 op_sel_hi:[1,0]
    v_pk_add_f32 v[240:241], v[240:241], 1.0 op_sel_hi:[1,0]
    v_rcp_f32 v238, v238
    v_rcp_f32 v239, v239
    v_mfma_f32_16x16x32_bf16 v[144:147], a[140:143], a[120:123], v[144:147]
    v_rcp_f32 v240, v240
    v_rcp_f32 v241, v241
    v_pk_mul_f32 v[238:239], v[238:239], v[84:85]
    v_pk_mul_f32 v[240:241], v[240:241], v[86:87]
    v_cvt_pk_bf16_f32 v56, v238, v239
    v_mfma_f32_16x16x32_bf16 v[200:203], a[140:143], a[124:127], v[200:203]
    v_cvt_pk_bf16_f32 v57, v240, v241
    v_pk_mul_f32 v[242:243], v[112:113], s[60:61]
    v_pk_mul_f32 v[244:245], v[114:115], s[60:61]
    v_pk_mul_f32 v[140:141], v[112:113], v[140:141]
    v_pk_mul_f32 v[142:143], v[114:115], v[142:143]
    s_waitcnt lgkmcnt(6)
    v_mfma_f32_16x16x32_bf16 v[8:11], a[144:147], a[96:99], v[8:11]
    ds_read_b64_tr_b16 a[128:129], v233 offset:28768
    v_exp_f32 v242, v242
    v_exp_f32 v243, v243
    v_exp_f32 v244, v244
    v_exp_f32 v245, v245
    v_pk_add_f32 v[242:243], v[242:243], 1.0 op_sel_hi:[1,0]
    v_mfma_f32_16x16x32_bf16 v[64:67], a[144:147], a[100:103], v[64:67]
    ds_read_b64_tr_b16 a[130:131], v233 offset:32352
    v_pk_add_f32 v[244:245], v[244:245], 1.0 op_sel_hi:[1,0]
    v_rcp_f32 v242, v242
    v_rcp_f32 v243, v243
    v_rcp_f32 v244, v244
    v_rcp_f32 v245, v245
    v_mfma_f32_16x16x32_bf16 v[120:123], a[144:147], a[104:107], v[120:123]
    v_pk_mul_f32 v[242:243], v[242:243], v[140:141]
    v_pk_mul_f32 v[244:245], v[244:245], v[142:143]
    v_cvt_pk_bf16_f32 v112, v242, v243
    v_cvt_pk_bf16_f32 v113, v244, v245
    v_pk_mul_f32 v[246:247], v[168:169], s[60:61]
    v_mfma_f32_16x16x32_bf16 v[176:179], a[144:147], a[108:111], v[176:179]
    v_pk_mul_f32 v[248:249], v[170:171], s[60:61]
    v_pk_mul_f32 v[196:197], v[168:169], v[196:197]
    v_pk_mul_f32 v[198:199], v[170:171], v[198:199]
    v_exp_f32 v246, v246
    v_exp_f32 v247, v247
    s_waitcnt lgkmcnt(6)
    v_mfma_f32_16x16x32_bf16 v[36:39], a[148:151], a[96:99], v[36:39]
    ds_read_b64_tr_b16 a[132:133], v233 offset:43104
    v_exp_f32 v248, v248
    v_exp_f32 v249, v249
    v_pk_add_f32 v[246:247], v[246:247], 1.0 op_sel_hi:[1,0]
    v_pk_add_f32 v[248:249], v[248:249], 1.0 op_sel_hi:[1,0]
    v_rcp_f32 v246, v246
    v_mfma_f32_16x16x32_bf16 v[92:95], a[148:151], a[100:103], v[92:95]
    ds_read_b64_tr_b16 a[134:135], v233 offset:46688
    v_rcp_f32 v247, v247
    v_rcp_f32 v248, v248
    v_rcp_f32 v249, v249
    v_pk_mul_f32 v[246:247], v[246:247], v[196:197]
    v_pk_mul_f32 v[248:249], v[248:249], v[198:199]
    v_mfma_f32_16x16x32_bf16 v[148:151], a[148:151], a[104:107], v[148:151]
    v_cvt_pk_bf16_f32 v168, v246, v247
    v_cvt_pk_bf16_f32 v169, v248, v249
    v_pk_mul_f32 v[234:235], v[4:5], s[60:61]
    v_pk_mul_f32 v[236:237], v[6:7], s[60:61]
    v_pk_mul_f32 v[32:33], v[4:5], v[32:33]
    v_mfma_f32_16x16x32_bf16 v[204:207], a[148:151], a[108:111], v[204:207]
    v_pk_mul_f32 v[34:35], v[6:7], v[34:35]
    v_exp_f32 v234, v234
    v_exp_f32 v235, v235
    v_exp_f32 v236, v236
    v_exp_f32 v237, v237
    s_waitcnt lgkmcnt(6)
    v_mfma_f32_16x16x32_bf16 v[8:11], a[152:155], a[112:115], v[8:11]
    ds_read_b64_tr_b16 a[136:137], v233 offset:35936
    v_pk_add_f32 v[234:235], v[234:235], 1.0 op_sel_hi:[1,0]
    v_pk_add_f32 v[236:237], v[236:237], 1.0 op_sel_hi:[1,0]
    v_rcp_f32 v234, v234
    v_rcp_f32 v235, v235
    v_rcp_f32 v236, v236
    v_mfma_f32_16x16x32_bf16 v[64:67], a[152:155], a[116:119], v[64:67]
    ds_read_b64_tr_b16 a[138:139], v233 offset:39520
    v_rcp_f32 v237, v237
    v_pk_mul_f32 v[234:235], v[234:235], v[32:33]
    v_pk_mul_f32 v[236:237], v[236:237], v[34:35]
    v_cvt_pk_bf16_f32 v2, v234, v235
    v_cvt_pk_bf16_f32 v3, v236, v237
    v_mfma_f32_16x16x32_bf16 v[120:123], a[152:155], a[120:123], v[120:123]
    buffer_store_dwordx4 v[0:3], v225, s[32:35], s52 offen sc1
    v_pk_mul_f32 v[238:239], v[60:61], s[60:61]
    v_pk_mul_f32 v[240:241], v[62:63], s[60:61]
    v_pk_mul_f32 v[88:89], v[60:61], v[88:89]
    v_pk_mul_f32 v[90:91], v[62:63], v[90:91]
    v_mfma_f32_16x16x32_bf16 v[176:179], a[152:155], a[124:127], v[176:179]
    v_exp_f32 v238, v238
    v_exp_f32 v239, v239
    v_exp_f32 v240, v240
    v_exp_f32 v241, v241
    v_pk_add_f32 v[238:239], v[238:239], 1.0 op_sel_hi:[1,0]
    s_waitcnt lgkmcnt(6)
    v_mfma_f32_16x16x32_bf16 v[36:39], a[156:159], a[112:115], v[36:39]
    ds_read_b64_tr_b16 a[140:141], v233 offset:50272
    v_pk_add_f32 v[240:241], v[240:241], 1.0 op_sel_hi:[1,0]
    v_rcp_f32 v238, v238
    v_rcp_f32 v239, v239
    v_rcp_f32 v240, v240
    v_rcp_f32 v241, v241
    v_mfma_f32_16x16x32_bf16 v[92:95], a[156:159], a[116:119], v[92:95]
    ds_read_b64_tr_b16 a[142:143], v233 offset:53856
    v_pk_mul_f32 v[238:239], v[238:239], v[88:89]
    v_pk_mul_f32 v[240:241], v[240:241], v[90:91]
    v_cvt_pk_bf16_f32 v58, v238, v239
    v_cvt_pk_bf16_f32 v59, v240, v241
    buffer_store_dwordx4 v[56:59], v226, s[32:35], s52 offen sc1
    v_mfma_f32_16x16x32_bf16 v[148:151], a[156:159], a[120:123], v[148:151]
    v_pk_mul_f32 v[242:243], v[116:117], s[60:61]
    v_pk_mul_f32 v[244:245], v[118:119], s[60:61]
    v_pk_mul_f32 v[144:145], v[116:117], v[144:145]
    v_pk_mul_f32 v[146:147], v[118:119], v[146:147]
    v_exp_f32 v242, v242
    v_mfma_f32_16x16x32_bf16 v[204:207], a[156:159], a[124:127], v[204:207]
    v_exp_f32 v243, v243
    v_exp_f32 v244, v244
    v_exp_f32 v245, v245
    v_pk_add_f32 v[242:243], v[242:243], 1.0 op_sel_hi:[1,0]
    v_pk_add_f32 v[244:245], v[244:245], 1.0 op_sel_hi:[1,0]
    s_waitcnt lgkmcnt(6)
    v_mfma_f32_16x16x32_bf16 v[12:15], a[128:131], a[96:99], v[12:15]
    ds_read_b64_tr_b16 a[144:145], v233 offset:28800
    v_rcp_f32 v242, v242
    v_rcp_f32 v243, v243
    v_rcp_f32 v244, v244
    v_rcp_f32 v245, v245
    v_pk_mul_f32 v[242:243], v[242:243], v[144:145]
    v_mfma_f32_16x16x32_bf16 v[68:71], a[128:131], a[100:103], v[68:71]
    ds_read_b64_tr_b16 a[146:147], v233 offset:32384
    v_pk_mul_f32 v[244:245], v[244:245], v[146:147]
    v_cvt_pk_bf16_f32 v114, v242, v243
    v_cvt_pk_bf16_f32 v115, v244, v245
    buffer_store_dwordx4 v[112:115], v227, s[32:35], s52 offen sc1
    v_pk_mul_f32 v[246:247], v[172:173], s[60:61]
    v_mfma_f32_16x16x32_bf16 v[124:127], a[128:131], a[104:107], v[124:127]
    v_pk_mul_f32 v[248:249], v[174:175], s[60:61]
    v_pk_mul_f32 v[200:201], v[172:173], v[200:201]
    v_pk_mul_f32 v[202:203], v[174:175], v[202:203]
    v_exp_f32 v246, v246
    v_exp_f32 v247, v247
    v_mfma_f32_16x16x32_bf16 v[180:183], a[128:131], a[108:111], v[180:183]
    v_exp_f32 v248, v248
    v_exp_f32 v249, v249
    v_pk_add_f32 v[246:247], v[246:247], 1.0 op_sel_hi:[1,0]
    v_pk_add_f32 v[248:249], v[248:249], 1.0 op_sel_hi:[1,0]
    v_rcp_f32 v246, v246
    s_waitcnt lgkmcnt(6)
    v_mfma_f32_16x16x32_bf16 v[40:43], a[132:135], a[96:99], v[40:43]
    ds_read_b64_tr_b16 a[148:149], v233 offset:43136
    v_rcp_f32 v247, v247
    v_rcp_f32 v248, v248
    v_rcp_f32 v249, v249
    v_pk_mul_f32 v[246:247], v[246:247], v[200:201]
    v_pk_mul_f32 v[248:249], v[248:249], v[202:203]
    v_mfma_f32_16x16x32_bf16 v[96:99], a[132:135], a[100:103], v[96:99]
    ds_read_b64_tr_b16 a[150:151], v233 offset:46720
    v_cvt_pk_bf16_f32 v170, v246, v247
    v_cvt_pk_bf16_f32 v171, v248, v249
    buffer_store_dwordx4 v[168:171], v228, s[32:35], s52 offen sc1
    v_pk_mul_f32 v[234:235], v[8:9], s[60:61]
    v_pk_mul_f32 v[236:237], v[10:11], s[60:61]
    v_mfma_f32_16x16x32_bf16 v[152:155], a[132:135], a[104:107], v[152:155]
    v_pk_mul_f32 v[36:37], v[8:9], v[36:37]
    v_pk_mul_f32 v[38:39], v[10:11], v[38:39]
    v_exp_f32 v234, v234
    v_exp_f32 v235, v235
    v_exp_f32 v236, v236
    v_mfma_f32_16x16x32_bf16 v[208:211], a[132:135], a[108:111], v[208:211]
    v_exp_f32 v237, v237
    v_pk_add_f32 v[234:235], v[234:235], 1.0 op_sel_hi:[1,0]
    v_pk_add_f32 v[236:237], v[236:237], 1.0 op_sel_hi:[1,0]
    v_rcp_f32 v234, v234
    v_rcp_f32 v235, v235
    s_waitcnt lgkmcnt(6)
    v_mfma_f32_16x16x32_bf16 v[12:15], a[136:139], a[112:115], v[12:15]
    ds_read_b64_tr_b16 a[152:153], v233 offset:35968
    v_rcp_f32 v236, v236
    v_rcp_f32 v237, v237
    v_pk_mul_f32 v[234:235], v[234:235], v[36:37]
    v_pk_mul_f32 v[236:237], v[236:237], v[38:39]
    v_cvt_pk_bf16_f32 v8, v234, v235
    v_mfma_f32_16x16x32_bf16 v[68:71], a[136:139], a[116:119], v[68:71]
    ds_read_b64_tr_b16 a[154:155], v233 offset:39552
    v_cvt_pk_bf16_f32 v9, v236, v237
    v_pk_mul_f32 v[238:239], v[64:65], s[60:61]
    v_pk_mul_f32 v[240:241], v[66:67], s[60:61]
    v_pk_mul_f32 v[92:93], v[64:65], v[92:93]
    v_pk_mul_f32 v[94:95], v[66:67], v[94:95]
    v_mfma_f32_16x16x32_bf16 v[124:127], a[136:139], a[120:123], v[124:127]
    v_exp_f32 v238, v238
    v_exp_f32 v239, v239
    v_exp_f32 v240, v240
    v_exp_f32 v241, v241
    v_pk_add_f32 v[238:239], v[238:239], 1.0 op_sel_hi:[1,0]
    v_mfma_f32_16x16x32_bf16 v[180:183], a[136:139], a[124:127], v[180:183]
    v_pk_add_f32 v[240:241], v[240:241], 1.0 op_sel_hi:[1,0]
    v_rcp_f32 v238, v238
    v_rcp_f32 v239, v239
    v_rcp_f32 v240, v240
    v_rcp_f32 v241, v241
    s_waitcnt lgkmcnt(6)
    v_mfma_f32_16x16x32_bf16 v[40:43], a[140:143], a[112:115], v[40:43]
    ds_read_b64_tr_b16 a[156:157], v233 offset:50304
    v_pk_mul_f32 v[238:239], v[238:239], v[92:93]
    v_pk_mul_f32 v[240:241], v[240:241], v[94:95]
    v_cvt_pk_bf16_f32 v64, v238, v239
    v_cvt_pk_bf16_f32 v65, v240, v241
    v_pk_mul_f32 v[242:243], v[120:121], s[60:61]
    v_mfma_f32_16x16x32_bf16 v[96:99], a[140:143], a[116:119], v[96:99]
    ds_read_b64_tr_b16 a[158:159], v233 offset:53888
    v_pk_mul_f32 v[244:245], v[122:123], s[60:61]
    v_pk_mul_f32 v[148:149], v[120:121], v[148:149]
    v_pk_mul_f32 v[150:151], v[122:123], v[150:151]
    v_exp_f32 v242, v242
    v_exp_f32 v243, v243
    v_mfma_f32_16x16x32_bf16 v[152:155], a[140:143], a[120:123], v[152:155]
    v_exp_f32 v244, v244
    v_exp_f32 v245, v245
    v_pk_add_f32 v[242:243], v[242:243], 1.0 op_sel_hi:[1,0]
    v_pk_add_f32 v[244:245], v[244:245], 1.0 op_sel_hi:[1,0]
    v_rcp_f32 v242, v242
    v_mfma_f32_16x16x32_bf16 v[208:211], a[140:143], a[124:127], v[208:211]
    v_rcp_f32 v243, v243
    v_rcp_f32 v244, v244
    v_rcp_f32 v245, v245
    v_pk_mul_f32 v[242:243], v[242:243], v[148:149]
    v_pk_mul_f32 v[244:245], v[244:245], v[150:151]
    s_waitcnt lgkmcnt(6)
    v_mfma_f32_16x16x32_bf16 v[16:19], a[144:147], a[96:99], v[16:19]
    ds_read_b64_tr_b16 a[128:129], v233 offset:28832
    v_cvt_pk_bf16_f32 v120, v242, v243
    v_cvt_pk_bf16_f32 v121, v244, v245
    v_pk_mul_f32 v[246:247], v[176:177], s[60:61]
    v_pk_mul_f32 v[248:249], v[178:179], s[60:61]
    v_pk_mul_f32 v[204:205], v[176:177], v[204:205]
    v_mfma_f32_16x16x32_bf16 v[72:75], a[144:147], a[100:103], v[72:75]
    ds_read_b64_tr_b16 a[130:131], v233 offset:32416
    v_pk_mul_f32 v[206:207], v[178:179], v[206:207]
    v_exp_f32 v246, v246
    v_exp_f32 v247, v247
    v_exp_f32 v248, v248
    v_exp_f32 v249, v249
    v_mfma_f32_16x16x32_bf16 v[128:131], a[144:147], a[104:107], v[128:131]
    v_pk_add_f32 v[246:247], v[246:247], 1.0 op_sel_hi:[1,0]
    v_pk_add_f32 v[248:249], v[248:249], 1.0 op_sel_hi:[1,0]
    v_rcp_f32 v246, v246
    v_rcp_f32 v247, v247
    v_rcp_f32 v248, v248
    v_mfma_f32_16x16x32_bf16 v[184:187], a[144:147], a[108:111], v[184:187]
    v_rcp_f32 v249, v249
    v_pk_mul_f32 v[246:247], v[246:247], v[204:205]
    v_pk_mul_f32 v[248:249], v[248:249], v[206:207]
    v_cvt_pk_bf16_f32 v176, v246, v247
    v_cvt_pk_bf16_f32 v177, v248, v249
    s_waitcnt lgkmcnt(6)
    v_mfma_f32_16x16x32_bf16 v[44:47], a[148:151], a[96:99], v[44:47]
    ds_read_b64_tr_b16 a[132:133], v233 offset:43168
    v_pk_mul_f32 v[234:235], v[12:13], s[60:61]
    v_pk_mul_f32 v[236:237], v[14:15], s[60:61]
    v_pk_mul_f32 v[40:41], v[12:13], v[40:41]
    v_pk_mul_f32 v[42:43], v[14:15], v[42:43]
    v_exp_f32 v234, v234
    v_mfma_f32_16x16x32_bf16 v[100:103], a[148:151], a[100:103], v[100:103]
    ds_read_b64_tr_b16 a[134:135], v233 offset:46752
    v_exp_f32 v235, v235
    v_exp_f32 v236, v236
    v_exp_f32 v237, v237
    v_pk_add_f32 v[234:235], v[234:235], 1.0 op_sel_hi:[1,0]
    v_pk_add_f32 v[236:237], v[236:237], 1.0 op_sel_hi:[1,0]
    v_mfma_f32_16x16x32_bf16 v[156:159], a[148:151], a[104:107], v[156:159]
    v_rcp_f32 v234, v234
    v_rcp_f32 v235, v235
    v_rcp_f32 v236, v236
    v_rcp_f32 v237, v237
    v_pk_mul_f32 v[234:235], v[234:235], v[40:41]
    v_mfma_f32_16x16x32_bf16 v[212:215], a[148:151], a[108:111], v[212:215]
    v_pk_mul_f32 v[236:237], v[236:237], v[42:43]
    v_cvt_pk_bf16_f32 v10, v234, v235
    v_cvt_pk_bf16_f32 v11, v236, v237
    buffer_store_dwordx4 v[8:11], v225, s[32:35], s53 offen sc1
    v_pk_mul_f32 v[238:239], v[68:69], s[60:61]
    s_waitcnt lgkmcnt(6)
    v_mfma_f32_16x16x32_bf16 v[16:19], a[152:155], a[112:115], v[16:19]
    ds_read_b64_tr_b16 a[136:137], v233 offset:36000
    v_pk_mul_f32 v[240:241], v[70:71], s[60:61]
    v_pk_mul_f32 v[96:97], v[68:69], v[96:97]
    v_pk_mul_f32 v[98:99], v[70:71], v[98:99]
    v_exp_f32 v238, v238
    v_exp_f32 v239, v239
    v_mfma_f32_16x16x32_bf16 v[72:75], a[152:155], a[116:119], v[72:75]
    ds_read_b64_tr_b16 a[138:139], v233 offset:39584
    v_exp_f32 v240, v240
    v_exp_f32 v241, v241
    v_pk_add_f32 v[238:239], v[238:239], 1.0 op_sel_hi:[1,0]
    v_pk_add_f32 v[240:241], v[240:241], 1.0 op_sel_hi:[1,0]
    v_rcp_f32 v238, v238
    v_mfma_f32_16x16x32_bf16 v[128:131], a[152:155], a[120:123], v[128:131]
    v_rcp_f32 v239, v239
    v_rcp_f32 v240, v240
    v_rcp_f32 v241, v241
    v_pk_mul_f32 v[238:239], v[238:239], v[96:97]
    v_pk_mul_f32 v[240:241], v[240:241], v[98:99]
    v_mfma_f32_16x16x32_bf16 v[184:187], a[152:155], a[124:127], v[184:187]
    v_cvt_pk_bf16_f32 v66, v238, v239
    v_cvt_pk_bf16_f32 v67, v240, v241
    buffer_store_dwordx4 v[64:67], v226, s[32:35], s53 offen sc1
    v_pk_mul_f32 v[242:243], v[124:125], s[60:61]
    v_pk_mul_f32 v[244:245], v[126:127], s[60:61]
    s_waitcnt lgkmcnt(6)
    v_mfma_f32_16x16x32_bf16 v[44:47], a[156:159], a[112:115], v[44:47]
    ds_read_b64_tr_b16 a[140:141], v233 offset:50336
    v_pk_mul_f32 v[152:153], v[124:125], v[152:153]
    v_pk_mul_f32 v[154:155], v[126:127], v[154:155]
    v_exp_f32 v242, v242
    v_exp_f32 v243, v243
    v_exp_f32 v244, v244
    v_mfma_f32_16x16x32_bf16 v[100:103], a[156:159], a[116:119], v[100:103]
    ds_read_b64_tr_b16 a[142:143], v233 offset:53920
    v_exp_f32 v245, v245
    v_pk_add_f32 v[242:243], v[242:243], 1.0 op_sel_hi:[1,0]
    v_pk_add_f32 v[244:245], v[244:245], 1.0 op_sel_hi:[1,0]
    v_rcp_f32 v242, v242
    v_rcp_f32 v243, v243
    v_mfma_f32_16x16x32_bf16 v[156:159], a[156:159], a[120:123], v[156:159]
    v_rcp_f32 v244, v244
    v_rcp_f32 v245, v245
    v_pk_mul_f32 v[242:243], v[242:243], v[152:153]
    v_pk_mul_f32 v[244:245], v[244:245], v[154:155]
    v_cvt_pk_bf16_f32 v122, v242, v243
    v_mfma_f32_16x16x32_bf16 v[212:215], a[156:159], a[124:127], v[212:215]
    v_cvt_pk_bf16_f32 v123, v244, v245
    buffer_store_dwordx4 v[120:123], v227, s[32:35], s53 offen sc1
    v_pk_mul_f32 v[246:247], v[180:181], s[60:61]
    v_pk_mul_f32 v[248:249], v[182:183], s[60:61]
    v_pk_mul_f32 v[208:209], v[180:181], v[208:209]
    s_waitcnt lgkmcnt(6)
    v_mfma_f32_16x16x32_bf16 v[20:23], a[128:131], a[96:99], v[20:23]
    ds_read_b64_tr_b16 a[144:145], v233 offset:28864
    v_pk_mul_f32 v[210:211], v[182:183], v[210:211]
    v_exp_f32 v246, v246
    v_exp_f32 v247, v247
    v_exp_f32 v248, v248
    v_exp_f32 v249, v249
    v_mfma_f32_16x16x32_bf16 v[76:79], a[128:131], a[100:103], v[76:79]
    ds_read_b64_tr_b16 a[146:147], v233 offset:32448
    v_pk_add_f32 v[246:247], v[246:247], 1.0 op_sel_hi:[1,0]
    v_pk_add_f32 v[248:249], v[248:249], 1.0 op_sel_hi:[1,0]
    v_rcp_f32 v246, v246
    v_rcp_f32 v247, v247
    v_rcp_f32 v248, v248
    v_mfma_f32_16x16x32_bf16 v[132:135], a[128:131], a[104:107], v[132:135]
    v_rcp_f32 v249, v249
    v_pk_mul_f32 v[246:247], v[246:247], v[208:209]
    v_pk_mul_f32 v[248:249], v[248:249], v[210:211]
    v_cvt_pk_bf16_f32 v178, v246, v247
    v_cvt_pk_bf16_f32 v179, v248, v249
    v_mfma_f32_16x16x32_bf16 v[188:191], a[128:131], a[108:111], v[188:191]
    buffer_store_dwordx4 v[176:179], v228, s[32:35], s53 offen sc1
    v_pk_mul_f32 v[234:235], v[16:17], s[60:61]
    v_pk_mul_f32 v[236:237], v[18:19], s[60:61]
    v_pk_mul_f32 v[44:45], v[16:17], v[44:45]
    v_pk_mul_f32 v[46:47], v[18:19], v[46:47]
    s_waitcnt lgkmcnt(6)
    v_mfma_f32_16x16x32_bf16 v[48:51], a[132:135], a[96:99], v[48:51]
    ds_read_b64_tr_b16 a[148:149], v233 offset:43200
    v_exp_f32 v234, v234
    v_exp_f32 v235, v235
    v_exp_f32 v236, v236
    v_exp_f32 v237, v237
    v_pk_add_f32 v[234:235], v[234:235], 1.0 op_sel_hi:[1,0]
    v_mfma_f32_16x16x32_bf16 v[104:107], a[132:135], a[100:103], v[104:107]
    ds_read_b64_tr_b16 a[150:151], v233 offset:46784
    v_pk_add_f32 v[236:237], v[236:237], 1.0 op_sel_hi:[1,0]
    v_rcp_f32 v234, v234
    v_rcp_f32 v235, v235
    v_rcp_f32 v236, v236
    v_rcp_f32 v237, v237
    v_mfma_f32_16x16x32_bf16 v[160:163], a[132:135], a[104:107], v[160:163]
    v_pk_mul_f32 v[234:235], v[234:235], v[44:45]
    v_pk_mul_f32 v[236:237], v[236:237], v[46:47]
    v_cvt_pk_bf16_f32 v16, v234, v235
    v_cvt_pk_bf16_f32 v17, v236, v237
    v_pk_mul_f32 v[238:239], v[72:73], s[60:61]
    v_mfma_f32_16x16x32_bf16 v[216:219], a[132:135], a[108:111], v[216:219]
    v_pk_mul_f32 v[240:241], v[74:75], s[60:61]
    v_pk_mul_f32 v[100:101], v[72:73], v[100:101]
    v_pk_mul_f32 v[102:103], v[74:75], v[102:103]
    v_exp_f32 v238, v238
    v_exp_f32 v239, v239
    s_waitcnt lgkmcnt(6)
    v_mfma_f32_16x16x32_bf16 v[20:23], a[136:139], a[112:115], v[20:23]
    ds_read_b64_tr_b16 a[152:153], v233 offset:36032
    v_exp_f32 v240, v240
    v_exp_f32 v241, v241
    v_pk_add_f32 v[238:239], v[238:239], 1.0 op_sel_hi:[1,0]
    v_pk_add_f32 v[240:241], v[240:241], 1.0 op_sel_hi:[1,0]
    v_rcp_f32 v238, v238
    v_mfma_f32_16x16x32_bf16 v[76:79], a[136:139], a[116:119], v[76:79]
    ds_read_b64_tr_b16 a[154:155], v233 offset:39616
    v_rcp_f32 v239, v239
    v_rcp_f32 v240, v240
    v_rcp_f32 v241, v241
    v_pk_mul_f32 v[238:239], v[238:239], v[100:101]
    v_pk_mul_f32 v[240:241], v[240:241], v[102:103]
    v_mfma_f32_16x16x32_bf16 v[132:135], a[136:139], a[120:123], v[132:135]
    v_cvt_pk_bf16_f32 v72, v238, v239
    v_cvt_pk_bf16_f32 v73, v240, v241
    v_pk_mul_f32 v[242:243], v[128:129], s[60:61]
    v_pk_mul_f32 v[244:245], v[130:131], s[60:61]
    v_pk_mul_f32 v[156:157], v[128:129], v[156:157]
    v_mfma_f32_16x16x32_bf16 v[188:191], a[136:139], a[124:127], v[188:191]
    v_pk_mul_f32 v[158:159], v[130:131], v[158:159]
    v_exp_f32 v242, v242
    v_exp_f32 v243, v243
    v_exp_f32 v244, v244
    v_exp_f32 v245, v245
    s_waitcnt lgkmcnt(6)
    v_mfma_f32_16x16x32_bf16 v[48:51], a[140:143], a[112:115], v[48:51]
    ds_read_b64_tr_b16 a[156:157], v233 offset:50368
    v_pk_add_f32 v[242:243], v[242:243], 1.0 op_sel_hi:[1,0]
    v_pk_add_f32 v[244:245], v[244:245], 1.0 op_sel_hi:[1,0]
    v_rcp_f32 v242, v242
    v_rcp_f32 v243, v243
    v_rcp_f32 v244, v244
    v_mfma_f32_16x16x32_bf16 v[104:107], a[140:143], a[116:119], v[104:107]
    ds_read_b64_tr_b16 a[158:159], v233 offset:53952
    v_rcp_f32 v245, v245
    v_pk_mul_f32 v[242:243], v[242:243], v[156:157]
    v_pk_mul_f32 v[244:245], v[244:245], v[158:159]
    v_cvt_pk_bf16_f32 v128, v242, v243
    v_cvt_pk_bf16_f32 v129, v244, v245
    v_mfma_f32_16x16x32_bf16 v[160:163], a[140:143], a[120:123], v[160:163]
    v_pk_mul_f32 v[246:247], v[184:185], s[60:61]
    v_pk_mul_f32 v[248:249], v[186:187], s[60:61]
    v_pk_mul_f32 v[212:213], v[184:185], v[212:213]
    v_pk_mul_f32 v[214:215], v[186:187], v[214:215]
    v_exp_f32 v246, v246
    v_mfma_f32_16x16x32_bf16 v[216:219], a[140:143], a[124:127], v[216:219]
    v_exp_f32 v247, v247
    v_exp_f32 v248, v248
    v_exp_f32 v249, v249
    v_pk_add_f32 v[246:247], v[246:247], 1.0 op_sel_hi:[1,0]
    v_pk_add_f32 v[248:249], v[248:249], 1.0 op_sel_hi:[1,0]
    s_waitcnt lgkmcnt(6)
    v_mfma_f32_16x16x32_bf16 v[24:27], a[144:147], a[96:99], v[24:27]
    v_rcp_f32 v246, v246
    v_rcp_f32 v247, v247
    v_rcp_f32 v248, v248
    v_rcp_f32 v249, v249
    v_pk_mul_f32 v[246:247], v[246:247], v[212:213]
    v_mfma_f32_16x16x32_bf16 v[80:83], a[144:147], a[100:103], v[80:83]
    v_pk_mul_f32 v[248:249], v[248:249], v[214:215]
    v_cvt_pk_bf16_f32 v184, v246, v247
    v_cvt_pk_bf16_f32 v185, v248, v249
    v_pk_mul_f32 v[234:235], v[20:21], s[60:61]
    v_pk_mul_f32 v[236:237], v[22:23], s[60:61]
    v_mfma_f32_16x16x32_bf16 v[136:139], a[144:147], a[104:107], v[136:139]
    v_pk_mul_f32 v[48:49], v[20:21], v[48:49]
    v_pk_mul_f32 v[50:51], v[22:23], v[50:51]
    v_exp_f32 v234, v234
    v_exp_f32 v235, v235
    v_exp_f32 v236, v236
    v_mfma_f32_16x16x32_bf16 v[192:195], a[144:147], a[108:111], v[192:195]
    v_exp_f32 v237, v237
    v_pk_add_f32 v[234:235], v[234:235], 1.0 op_sel_hi:[1,0]
    v_pk_add_f32 v[236:237], v[236:237], 1.0 op_sel_hi:[1,0]
    v_rcp_f32 v234, v234
    v_rcp_f32 v235, v235
    s_waitcnt lgkmcnt(4)
    v_mfma_f32_16x16x32_bf16 v[52:55], a[148:151], a[96:99], v[52:55]
    v_rcp_f32 v236, v236
    v_rcp_f32 v237, v237
    v_pk_mul_f32 v[234:235], v[234:235], v[48:49]
    v_pk_mul_f32 v[236:237], v[236:237], v[50:51]
    v_cvt_pk_bf16_f32 v18, v234, v235
    v_mfma_f32_16x16x32_bf16 v[108:111], a[148:151], a[100:103], v[108:111]
    v_cvt_pk_bf16_f32 v19, v236, v237
    buffer_store_dwordx4 v[16:19], v225, s[32:35], s54 offen sc1
    v_pk_mul_f32 v[238:239], v[76:77], s[60:61]
    v_pk_mul_f32 v[240:241], v[78:79], s[60:61]
    v_pk_mul_f32 v[104:105], v[76:77], v[104:105]
    v_mfma_f32_16x16x32_bf16 v[164:167], a[148:151], a[104:107], v[164:167]
    v_pk_mul_f32 v[106:107], v[78:79], v[106:107]
    v_exp_f32 v238, v238
    v_exp_f32 v239, v239
    v_exp_f32 v240, v240
    v_exp_f32 v241, v241
    v_mfma_f32_16x16x32_bf16 v[220:223], a[148:151], a[108:111], v[220:223]
    v_pk_add_f32 v[238:239], v[238:239], 1.0 op_sel_hi:[1,0]
    v_pk_add_f32 v[240:241], v[240:241], 1.0 op_sel_hi:[1,0]
    v_rcp_f32 v238, v238
    v_rcp_f32 v239, v239
    v_rcp_f32 v240, v240
    s_waitcnt lgkmcnt(2)
    v_mfma_f32_16x16x32_bf16 v[24:27], a[152:155], a[112:115], v[24:27]
    v_rcp_f32 v241, v241
    v_pk_mul_f32 v[238:239], v[238:239], v[104:105]
    v_pk_mul_f32 v[240:241], v[240:241], v[106:107]
    v_cvt_pk_bf16_f32 v74, v238, v239
    v_cvt_pk_bf16_f32 v75, v240, v241
    v_mfma_f32_16x16x32_bf16 v[80:83], a[152:155], a[116:119], v[80:83]
    buffer_store_dwordx4 v[72:75], v226, s[32:35], s54 offen sc1
    v_pk_mul_f32 v[242:243], v[132:133], s[60:61]
    v_pk_mul_f32 v[244:245], v[134:135], s[60:61]
    v_pk_mul_f32 v[160:161], v[132:133], v[160:161]
    v_pk_mul_f32 v[162:163], v[134:135], v[162:163]
    v_mfma_f32_16x16x32_bf16 v[136:139], a[152:155], a[120:123], v[136:139]
    v_exp_f32 v242, v242
    v_exp_f32 v243, v243
    v_exp_f32 v244, v244
    v_exp_f32 v245, v245
    v_pk_add_f32 v[242:243], v[242:243], 1.0 op_sel_hi:[1,0]
    v_mfma_f32_16x16x32_bf16 v[192:195], a[152:155], a[124:127], v[192:195]
    v_pk_add_f32 v[244:245], v[244:245], 1.0 op_sel_hi:[1,0]
    v_rcp_f32 v242, v242
    v_rcp_f32 v243, v243
    v_rcp_f32 v244, v244
    v_rcp_f32 v245, v245
    s_waitcnt lgkmcnt(0)
    v_mfma_f32_16x16x32_bf16 v[52:55], a[156:159], a[112:115], v[52:55]
    v_pk_mul_f32 v[242:243], v[242:243], v[160:161]
    v_pk_mul_f32 v[244:245], v[244:245], v[162:163]
    v_cvt_pk_bf16_f32 v130, v242, v243
    v_cvt_pk_bf16_f32 v131, v244, v245
    buffer_store_dwordx4 v[128:131], v227, s[32:35], s54 offen sc1
    v_mfma_f32_16x16x32_bf16 v[108:111], a[156:159], a[116:119], v[108:111]
    v_pk_mul_f32 v[246:247], v[188:189], s[60:61]
    v_pk_mul_f32 v[248:249], v[190:191], s[60:61]
    v_pk_mul_f32 v[216:217], v[188:189], v[216:217]
    v_pk_mul_f32 v[218:219], v[190:191], v[218:219]
    v_exp_f32 v246, v246
    v_mfma_f32_16x16x32_bf16 v[164:167], a[156:159], a[120:123], v[164:167]
    v_exp_f32 v247, v247
    v_exp_f32 v248, v248
    v_exp_f32 v249, v249
    v_pk_add_f32 v[246:247], v[246:247], 1.0 op_sel_hi:[1,0]
    v_pk_add_f32 v[248:249], v[248:249], 1.0 op_sel_hi:[1,0]
    v_mfma_f32_16x16x32_bf16 v[220:223], a[156:159], a[124:127], v[220:223]
    v_rcp_f32 v246, v246
    v_rcp_f32 v247, v247
    v_rcp_f32 v248, v248
    v_rcp_f32 v249, v249
    v_pk_mul_f32 v[246:247], v[246:247], v[216:217]
    s_nop 7
    v_pk_mul_f32 v[248:249], v[248:249], v[218:219]
    v_cvt_pk_bf16_f32 v186, v246, v247
    v_cvt_pk_bf16_f32 v187, v248, v249
    buffer_store_dwordx4 v[184:187], v228, s[32:35], s54 offen sc1
    v_pk_mul_f32 v[234:235], v[24:25], s[60:61]
    v_pk_mul_f32 v[236:237], v[26:27], s[60:61]
    v_pk_mul_f32 v[52:53], v[24:25], v[52:53]
    v_pk_mul_f32 v[54:55], v[26:27], v[54:55]
    v_exp_f32 v234, v234
    v_exp_f32 v235, v235
    v_exp_f32 v236, v236
    v_exp_f32 v237, v237
    v_pk_add_f32 v[234:235], v[234:235], 1.0 op_sel_hi:[1,0]
    v_pk_add_f32 v[236:237], v[236:237], 1.0 op_sel_hi:[1,0]
    v_rcp_f32 v234, v234
    v_rcp_f32 v235, v235
    v_rcp_f32 v236, v236
    v_rcp_f32 v237, v237
    v_pk_mul_f32 v[234:235], v[234:235], v[52:53]
    v_pk_mul_f32 v[236:237], v[236:237], v[54:55]
    v_cvt_pk_bf16_f32 v24, v234, v235
    v_cvt_pk_bf16_f32 v25, v236, v237
    buffer_store_dwordx2 v[24:25], v225, s[32:35], s55 offen offset:0 sc1
    v_pk_mul_f32 v[238:239], v[80:81], s[60:61]
    v_pk_mul_f32 v[240:241], v[82:83], s[60:61]
    v_pk_mul_f32 v[108:109], v[80:81], v[108:109]
    v_pk_mul_f32 v[110:111], v[82:83], v[110:111]
    v_exp_f32 v238, v238
    v_exp_f32 v239, v239
    v_exp_f32 v240, v240
    v_exp_f32 v241, v241
    v_pk_add_f32 v[238:239], v[238:239], 1.0 op_sel_hi:[1,0]
    v_pk_add_f32 v[240:241], v[240:241], 1.0 op_sel_hi:[1,0]
    v_rcp_f32 v238, v238
    v_rcp_f32 v239, v239
    v_rcp_f32 v240, v240
    v_rcp_f32 v241, v241
    v_pk_mul_f32 v[238:239], v[238:239], v[108:109]
    v_pk_mul_f32 v[240:241], v[240:241], v[110:111]
    v_cvt_pk_bf16_f32 v80, v238, v239
    v_cvt_pk_bf16_f32 v81, v240, v241
    buffer_store_dwordx2 v[80:81], v226, s[32:35], s55 offen offset:0 sc1
    v_pk_mul_f32 v[242:243], v[136:137], s[60:61]
    v_pk_mul_f32 v[244:245], v[138:139], s[60:61]
    v_pk_mul_f32 v[164:165], v[136:137], v[164:165]
    v_pk_mul_f32 v[166:167], v[138:139], v[166:167]
    v_exp_f32 v242, v242
    v_exp_f32 v243, v243
    v_exp_f32 v244, v244
    v_exp_f32 v245, v245
    v_pk_add_f32 v[242:243], v[242:243], 1.0 op_sel_hi:[1,0]
    v_pk_add_f32 v[244:245], v[244:245], 1.0 op_sel_hi:[1,0]
    v_rcp_f32 v242, v242
    v_rcp_f32 v243, v243
    v_rcp_f32 v244, v244
    v_rcp_f32 v245, v245
    v_pk_mul_f32 v[242:243], v[242:243], v[164:165]
    v_pk_mul_f32 v[244:245], v[244:245], v[166:167]
    v_cvt_pk_bf16_f32 v136, v242, v243
    v_cvt_pk_bf16_f32 v137, v244, v245
    buffer_store_dwordx2 v[136:137], v227, s[32:35], s55 offen offset:0 sc1
    v_pk_mul_f32 v[246:247], v[192:193], s[60:61]
    v_pk_mul_f32 v[248:249], v[194:195], s[60:61]
    v_pk_mul_f32 v[220:221], v[192:193], v[220:221]
    v_pk_mul_f32 v[222:223], v[194:195], v[222:223]
    v_exp_f32 v246, v246
    v_exp_f32 v247, v247
    v_exp_f32 v248, v248
    v_exp_f32 v249, v249
    v_pk_add_f32 v[246:247], v[246:247], 1.0 op_sel_hi:[1,0]
    v_pk_add_f32 v[248:249], v[248:249], 1.0 op_sel_hi:[1,0]
    v_rcp_f32 v246, v246
    v_rcp_f32 v247, v247
    v_rcp_f32 v248, v248
    v_rcp_f32 v249, v249
    v_pk_mul_f32 v[246:247], v[246:247], v[220:221]
    v_pk_mul_f32 v[248:249], v[248:249], v[222:223]
    v_cvt_pk_bf16_f32 v192, v246, v247
    v_cvt_pk_bf16_f32 v193, v248, v249
    buffer_store_dwordx2 v[192:193], v228, s[32:35], s55 offen offset:0 sc1
    s_branch L_gu_stored
L_gu_odd:
    s_waitcnt lgkmcnt(6)
    s_waitcnt vmcnt(4)
    v_mfma_f32_16x16x32_bf16 v[0:3], a[144:147], a[96:99], v[0:3]
    ds_read_b64_tr_b16 a[128:129], v233 offset:35840
    v_mfma_f32_16x16x32_bf16 v[56:59], a[144:147], a[100:103], v[56:59]
    ds_read_b64_tr_b16 a[130:131], v233 offset:39424
    v_mfma_f32_16x16x32_bf16 v[112:115], a[144:147], a[104:107], v[112:115]
    v_mfma_f32_16x16x32_bf16 v[168:171], a[144:147], a[108:111], v[168:171]
    s_waitcnt lgkmcnt(6)
    v_mfma_f32_16x16x32_bf16 v[28:31], a[148:151], a[96:99], v[28:31]
    ds_read_b64_tr_b16 a[132:133], v233 offset:50176
    v_mfma_f32_16x16x32_bf16 v[84:87], a[148:151], a[100:103], v[84:87]
    ds_read_b64_tr_b16 a[134:135], v233 offset:53760
    v_mfma_f32_16x16x32_bf16 v[140:143], a[148:151], a[104:107], v[140:143]
    v_mfma_f32_16x16x32_bf16 v[196:199], a[148:151], a[108:111], v[196:199]
    s_waitcnt lgkmcnt(6)
    v_mfma_f32_16x16x32_bf16 v[4:7], a[152:155], a[96:99], v[4:7]
    ds_read_b64_tr_b16 a[136:137], v233 offset:35872
    v_mfma_f32_16x16x32_bf16 v[60:63], a[152:155], a[100:103], v[60:63]
    ds_read_b64_tr_b16 a[138:139], v233 offset:39456
    v_mfma_f32_16x16x32_bf16 v[116:119], a[152:155], a[104:107], v[116:119]
    v_mfma_f32_16x16x32_bf16 v[172:175], a[152:155], a[108:111], v[172:175]
    s_waitcnt lgkmcnt(6)
    v_mfma_f32_16x16x32_bf16 v[32:35], a[156:159], a[96:99], v[32:35]
    ds_read_b64_tr_b16 a[140:141], v233 offset:50208
    v_mfma_f32_16x16x32_bf16 v[88:91], a[156:159], a[100:103], v[88:91]
    ds_read_b64_tr_b16 a[142:143], v233 offset:53792
    v_mfma_f32_16x16x32_bf16 v[144:147], a[156:159], a[104:107], v[144:147]
    v_mfma_f32_16x16x32_bf16 v[200:203], a[156:159], a[108:111], v[200:203]
    s_waitcnt lgkmcnt(6)
    s_waitcnt vmcnt(0)
    v_mfma_f32_16x16x32_bf16 v[0:3], a[128:131], a[112:115], v[0:3]
    ds_read_b64_tr_b16 a[144:145], v233 offset:28736
    v_mfma_f32_16x16x32_bf16 v[56:59], a[128:131], a[116:119], v[56:59]
    ds_read_b64_tr_b16 a[146:147], v233 offset:32320
    v_mfma_f32_16x16x32_bf16 v[112:115], a[128:131], a[120:123], v[112:115]
    v_mfma_f32_16x16x32_bf16 v[168:171], a[128:131], a[124:127], v[168:171]
    s_waitcnt lgkmcnt(6)
    v_mfma_f32_16x16x32_bf16 v[28:31], a[132:135], a[112:115], v[28:31]
    ds_read_b64_tr_b16 a[148:149], v233 offset:43072
    v_mfma_f32_16x16x32_bf16 v[84:87], a[132:135], a[116:119], v[84:87]
    ds_read_b64_tr_b16 a[150:151], v233 offset:46656
    v_mfma_f32_16x16x32_bf16 v[140:143], a[132:135], a[120:123], v[140:143]
    v_mfma_f32_16x16x32_bf16 v[196:199], a[132:135], a[124:127], v[196:199]
    s_waitcnt lgkmcnt(6)
    v_mfma_f32_16x16x32_bf16 v[4:7], a[136:139], a[112:115], v[4:7]
    ds_read_b64_tr_b16 a[152:153], v233 offset:35904
    v_pk_mul_f32 v[234:235], v[0:1], s[60:61]
    v_pk_mul_f32 v[236:237], v[2:3], s[60:61]
    v_pk_mul_f32 v[28:29], v[0:1], v[28:29]
    v_pk_mul_f32 v[30:31], v[2:3], v[30:31]
    v_exp_f32 v234, v234
    v_mfma_f32_16x16x32_bf16 v[60:63], a[136:139], a[116:119], v[60:63]
    ds_read_b64_tr_b16 a[154:155], v233 offset:39488
    v_exp_f32 v235, v235
    v_exp_f32 v236, v236
    v_exp_f32 v237, v237
    v_pk_add_f32 v[234:235], v[234:235], 1.0 op_sel_hi:[1,0]
    v_pk_add_f32 v[236:237], v[236:237], 1.0 op_sel_hi:[1,0]
    v_mfma_f32_16x16x32_bf16 v[116:119], a[136:139], a[120:123], v[116:119]
    v_rcp_f32 v234, v234
    v_rcp_f32 v235, v235
    v_rcp_f32 v236, v236
    v_rcp_f32 v237, v237
    v_pk_mul_f32 v[234:235], v[234:235], v[28:29]
    v_mfma_f32_16x16x32_bf16 v[172:175], a[136:139], a[124:127], v[172:175]
    v_pk_mul_f32 v[236:237], v[236:237], v[30:31]
    v_cvt_pk_bf16_f32 v0, v234, v235
    v_cvt_pk_bf16_f32 v1, v236, v237
    buffer_store_dwordx2 v[0:1], v225, s[32:35], s52 offen offset:8 sc1
    v_pk_mul_f32 v[238:239], v[56:57], s[60:61]
    s_waitcnt lgkmcnt(6)
    v_mfma_f32_16x16x32_bf16 v[32:35], a[140:143], a[112:115], v[32:35]
    ds_read_b64_tr_b16 a[156:157], v233 offset:50240
    v_pk_mul_f32 v[240:241], v[58:59], s[60:61]
    v_pk_mul_f32 v[84:85], v[56:57], v[84:85]
    v_pk_mul_f32 v[86:87], v[58:59], v[86:87]
    v_exp_f32 v238, v238
    v_exp_f32 v239, v239
    v_mfma_f32_16x16x32_bf16 v[88:91], a[140:143], a[116:119], v[88:91]
    ds_read_b64_tr_b16 a[158:159], v233 offset:53824
    v_exp_f32 v240, v240
    v_exp_f32 v241, v241
    v_pk_add_f32 v[238:239], v[238:239], 1.0 op_sel_hi:[1,0]
    v_pk_add_f32 v[240:241], v[240:241], 1.0 op_sel_hi:[1,0]
    v_rcp_f32 v238, v238
    v_mfma_f32_16x16x32_bf16 v[144:147], a[140:143], a[120:123], v[144:147]
    v_rcp_f32 v239, v239
    v_rcp_f32 v240, v240
    v_rcp_f32 v241, v241
    v_pk_mul_f32 v[238:239], v[238:239], v[84:85]
    v_pk_mul_f32 v[240:241], v[240:241], v[86:87]
    v_mfma_f32_16x16x32_bf16 v[200:203], a[140:143], a[124:127], v[200:203]
    v_cvt_pk_bf16_f32 v56, v238, v239
    v_cvt_pk_bf16_f32 v57, v240, v241
    buffer_store_dwordx2 v[56:57], v226, s[32:35], s52 offen offset:8 sc1
    v_pk_mul_f32 v[242:243], v[112:113], s[60:61]
    v_pk_mul_f32 v[244:245], v[114:115], s[60:61]
    s_waitcnt lgkmcnt(6)
    v_mfma_f32_16x16x32_bf16 v[8:11], a[144:147], a[96:99], v[8:11]
    ds_read_b64_tr_b16 a[128:129], v233 offset:28768
    v_pk_mul_f32 v[140:141], v[112:113], v[140:141]
    v_pk_mul_f32 v[142:143], v[114:115], v[142:143]
    v_exp_f32 v242, v242
    v_exp_f32 v243, v243
    v_exp_f32 v244, v244
    v_mfma_f32_16x16x32_bf16 v[64:67], a[144:147], a[100:103], v[64:67]
    ds_read_b64_tr_b16 a[130:131], v233 offset:32352
    v_exp_f32 v245, v245
    v_pk_add_f32 v[242:243], v[242:243], 1.0 op_sel_hi:[1,0]
    v_pk_add_f32 v[244:245], v[244:245], 1.0 op_sel_hi:[1,0]
    v_rcp_f32 v242, v242
    v_rcp_f32 v243, v243
    v_mfma_f32_16x16x32_bf16 v[120:123], a[144:147], a[104:107], v[120:123]
    v_rcp_f32 v244, v244
    v_rcp_f32 v245, v245
    v_pk_mul_f32 v[242:243], v[242:243], v[140:141]
    v_pk_mul_f32 v[244:245], v[244:245], v[142:143]
    v_cvt_pk_bf16_f32 v112, v242, v243
    v_mfma_f32_16x16x32_bf16 v[176:179], a[144:147], a[108:111], v[176:179]
    v_cvt_pk_bf16_f32 v113, v244, v245
    buffer_store_dwordx2 v[112:113], v227, s[32:35], s52 offen offset:8 sc1
    v_pk_mul_f32 v[246:247], v[168:169], s[60:61]
    v_pk_mul_f32 v[248:249], v[170:171], s[60:61]
    v_pk_mul_f32 v[196:197], v[168:169], v[196:197]
    s_waitcnt lgkmcnt(6)
    v_mfma_f32_16x16x32_bf16 v[36:39], a[148:151], a[96:99], v[36:39]
    ds_read_b64_tr_b16 a[132:133], v233 offset:43104
    v_pk_mul_f32 v[198:199], v[170:171], v[198:199]
    v_exp_f32 v246, v246
    v_exp_f32 v247, v247
    v_exp_f32 v248, v248
    v_exp_f32 v249, v249
    v_mfma_f32_16x16x32_bf16 v[92:95], a[148:151], a[100:103], v[92:95]
    ds_read_b64_tr_b16 a[134:135], v233 offset:46688
    v_pk_add_f32 v[246:247], v[246:247], 1.0 op_sel_hi:[1,0]
    v_pk_add_f32 v[248:249], v[248:249], 1.0 op_sel_hi:[1,0]
    v_rcp_f32 v246, v246
    v_rcp_f32 v247, v247
    v_rcp_f32 v248, v248
    v_mfma_f32_16x16x32_bf16 v[148:151], a[148:151], a[104:107], v[148:151]
    v_rcp_f32 v249, v249
    v_pk_mul_f32 v[246:247], v[246:247], v[196:197]
    v_pk_mul_f32 v[248:249], v[248:249], v[198:199]
    v_cvt_pk_bf16_f32 v168, v246, v247
    v_cvt_pk_bf16_f32 v169, v248, v249
    v_mfma_f32_16x16x32_bf16 v[204:207], a[148:151], a[108:111], v[204:207]
    buffer_store_dwordx2 v[168:169], v228, s[32:35], s52 offen offset:8 sc1
    v_pk_mul_f32 v[234:235], v[4:5], s[60:61]
    v_pk_mul_f32 v[236:237], v[6:7], s[60:61]
    v_pk_mul_f32 v[32:33], v[4:5], v[32:33]
    v_pk_mul_f32 v[34:35], v[6:7], v[34:35]
    s_waitcnt lgkmcnt(6)
    v_mfma_f32_16x16x32_bf16 v[8:11], a[152:155], a[112:115], v[8:11]
    ds_read_b64_tr_b16 a[136:137], v233 offset:35936
    v_exp_f32 v234, v234
    v_exp_f32 v235, v235
    v_exp_f32 v236, v236
    v_exp_f32 v237, v237
    v_pk_add_f32 v[234:235], v[234:235], 1.0 op_sel_hi:[1,0]
    v_mfma_f32_16x16x32_bf16 v[64:67], a[152:155], a[116:119], v[64:67]
    ds_read_b64_tr_b16 a[138:139], v233 offset:39520
    v_pk_add_f32 v[236:237], v[236:237], 1.0 op_sel_hi:[1,0]
    v_rcp_f32 v234, v234
    v_rcp_f32 v235, v235
    v_rcp_f32 v236, v236
    v_rcp_f32 v237, v237
    v_mfma_f32_16x16x32_bf16 v[120:123], a[152:155], a[120:123], v[120:123]
    v_pk_mul_f32 v[234:235], v[234:235], v[32:33]
    v_pk_mul_f32 v[236:237], v[236:237], v[34:35]
    v_cvt_pk_bf16_f32 v4, v234, v235
    v_cvt_pk_bf16_f32 v5, v236, v237
    v_pk_mul_f32 v[238:239], v[60:61], s[60:61]
    v_mfma_f32_16x16x32_bf16 v[176:179], a[152:155], a[124:127], v[176:179]
    v_pk_mul_f32 v[240:241], v[62:63], s[60:61]
    v_pk_mul_f32 v[88:89], v[60:61], v[88:89]
    v_pk_mul_f32 v[90:91], v[62:63], v[90:91]
    v_exp_f32 v238, v238
    v_exp_f32 v239, v239
    s_waitcnt lgkmcnt(6)
    v_mfma_f32_16x16x32_bf16 v[36:39], a[156:159], a[112:115], v[36:39]
    ds_read_b64_tr_b16 a[140:141], v233 offset:50272
    v_exp_f32 v240, v240
    v_exp_f32 v241, v241
    v_pk_add_f32 v[238:239], v[238:239], 1.0 op_sel_hi:[1,0]
    v_pk_add_f32 v[240:241], v[240:241], 1.0 op_sel_hi:[1,0]
    v_rcp_f32 v238, v238
    v_mfma_f32_16x16x32_bf16 v[92:95], a[156:159], a[116:119], v[92:95]
    ds_read_b64_tr_b16 a[142:143], v233 offset:53856
    v_rcp_f32 v239, v239
    v_rcp_f32 v240, v240
    v_rcp_f32 v241, v241
    v_pk_mul_f32 v[238:239], v[238:239], v[88:89]
    v_pk_mul_f32 v[240:241], v[240:241], v[90:91]
    v_mfma_f32_16x16x32_bf16 v[148:151], a[156:159], a[120:123], v[148:151]
    v_cvt_pk_bf16_f32 v60, v238, v239
    v_cvt_pk_bf16_f32 v61, v240, v241
    v_pk_mul_f32 v[242:243], v[116:117], s[60:61]
    v_pk_mul_f32 v[244:245], v[118:119], s[60:61]
    v_pk_mul_f32 v[144:145], v[116:117], v[144:145]
    v_mfma_f32_16x16x32_bf16 v[204:207], a[156:159], a[124:127], v[204:207]
    v_pk_mul_f32 v[146:147], v[118:119], v[146:147]
    v_exp_f32 v242, v242
    v_exp_f32 v243, v243
    v_exp_f32 v244, v244
    v_exp_f32 v245, v245
    s_waitcnt lgkmcnt(6)
    v_mfma_f32_16x16x32_bf16 v[12:15], a[128:131], a[96:99], v[12:15]
    ds_read_b64_tr_b16 a[144:145], v233 offset:28800
    v_pk_add_f32 v[242:243], v[242:243], 1.0 op_sel_hi:[1,0]
    v_pk_add_f32 v[244:245], v[244:245], 1.0 op_sel_hi:[1,0]
    v_rcp_f32 v242, v242
    v_rcp_f32 v243, v243
    v_rcp_f32 v244, v244
    v_mfma_f32_16x16x32_bf16 v[68:71], a[128:131], a[100:103], v[68:71]
    ds_read_b64_tr_b16 a[146:147], v233 offset:32384
    v_rcp_f32 v245, v245
    v_pk_mul_f32 v[242:243], v[242:243], v[144:145]
    v_pk_mul_f32 v[244:245], v[244:245], v[146:147]
    v_cvt_pk_bf16_f32 v116, v242, v243
    v_cvt_pk_bf16_f32 v117, v244, v245
    v_mfma_f32_16x16x32_bf16 v[124:127], a[128:131], a[104:107], v[124:127]
    v_pk_mul_f32 v[246:247], v[172:173], s[60:61]
    v_pk_mul_f32 v[248:249], v[174:175], s[60:61]
    v_pk_mul_f32 v[200:201], v[172:173], v[200:201]
    v_pk_mul_f32 v[202:203], v[174:175], v[202:203]
    v_exp_f32 v246, v246
    v_mfma_f32_16x16x32_bf16 v[180:183], a[128:131], a[108:111], v[180:183]
    v_exp_f32 v247, v247
    v_exp_f32 v248, v248
    v_exp_f32 v249, v249
    v_pk_add_f32 v[246:247], v[246:247], 1.0 op_sel_hi:[1,0]
    v_pk_add_f32 v[248:249], v[248:249], 1.0 op_sel_hi:[1,0]
    s_waitcnt lgkmcnt(6)
    v_mfma_f32_16x16x32_bf16 v[40:43], a[132:135], a[96:99], v[40:43]
    ds_read_b64_tr_b16 a[148:149], v233 offset:43136
    v_rcp_f32 v246, v246
    v_rcp_f32 v247, v247
    v_rcp_f32 v248, v248
    v_rcp_f32 v249, v249
    v_pk_mul_f32 v[246:247], v[246:247], v[200:201]
    v_mfma_f32_16x16x32_bf16 v[96:99], a[132:135], a[100:103], v[96:99]
    ds_read_b64_tr_b16 a[150:151], v233 offset:46720
    v_pk_mul_f32 v[248:249], v[248:249], v[202:203]
    v_cvt_pk_bf16_f32 v172, v246, v247
    v_cvt_pk_bf16_f32 v173, v248, v249
    v_pk_mul_f32 v[234:235], v[8:9], s[60:61]
    v_pk_mul_f32 v[236:237], v[10:11], s[60:61]
    v_mfma_f32_16x16x32_bf16 v[152:155], a[132:135], a[104:107], v[152:155]
    v_pk_mul_f32 v[36:37], v[8:9], v[36:37]
    v_pk_mul_f32 v[38:39], v[10:11], v[38:39]
    v_exp_f32 v234, v234
    v_exp_f32 v235, v235
    v_exp_f32 v236, v236
    v_mfma_f32_16x16x32_bf16 v[208:211], a[132:135], a[108:111], v[208:211]
    v_exp_f32 v237, v237
    v_pk_add_f32 v[234:235], v[234:235], 1.0 op_sel_hi:[1,0]
    v_pk_add_f32 v[236:237], v[236:237], 1.0 op_sel_hi:[1,0]
    v_rcp_f32 v234, v234
    v_rcp_f32 v235, v235
    s_waitcnt lgkmcnt(6)
    v_mfma_f32_16x16x32_bf16 v[12:15], a[136:139], a[112:115], v[12:15]
    ds_read_b64_tr_b16 a[152:153], v233 offset:35968
    v_rcp_f32 v236, v236
    v_rcp_f32 v237, v237
    v_pk_mul_f32 v[234:235], v[234:235], v[36:37]
    v_pk_mul_f32 v[236:237], v[236:237], v[38:39]
    v_cvt_pk_bf16_f32 v6, v234, v235
    v_mfma_f32_16x16x32_bf16 v[68:71], a[136:139], a[116:119], v[68:71]
    ds_read_b64_tr_b16 a[154:155], v233 offset:39552
    v_cvt_pk_bf16_f32 v7, v236, v237
    buffer_store_dwordx4 v[4:7], v225, s[32:35], s53 offen sc1
    v_pk_mul_f32 v[238:239], v[64:65], s[60:61]
    v_pk_mul_f32 v[240:241], v[66:67], s[60:61]
    v_pk_mul_f32 v[92:93], v[64:65], v[92:93]
    v_mfma_f32_16x16x32_bf16 v[124:127], a[136:139], a[120:123], v[124:127]
    v_pk_mul_f32 v[94:95], v[66:67], v[94:95]
    v_exp_f32 v238, v238
    v_exp_f32 v239, v239
    v_exp_f32 v240, v240
    v_exp_f32 v241, v241
    v_mfma_f32_16x16x32_bf16 v[180:183], a[136:139], a[124:127], v[180:183]
    v_pk_add_f32 v[238:239], v[238:239], 1.0 op_sel_hi:[1,0]
    v_pk_add_f32 v[240:241], v[240:241], 1.0 op_sel_hi:[1,0]
    v_rcp_f32 v238, v238
    v_rcp_f32 v239, v239
    v_rcp_f32 v240, v240
    s_waitcnt lgkmcnt(6)
    v_mfma_f32_16x16x32_bf16 v[40:43], a[140:143], a[112:115], v[40:43]
    ds_read_b64_tr_b16 a[156:157], v233 offset:50304
    v_rcp_f32 v241, v241
    v_pk_mul_f32 v[238:239], v[238:239], v[92:93]
    v_pk_mul_f32 v[240:241], v[240:241], v[94:95]
    v_cvt_pk_bf16_f32 v62, v238, v239
    v_cvt_pk_bf16_f32 v63, v240, v241
    v_mfma_f32_16x16x32_bf16 v[96:99], a[140:143], a[116:119], v[96:99]
    ds_read_b64_tr_b16 a[158:159], v233 offset:53888
    buffer_store_dwordx4 v[60:63], v226, s[32:35], s53 offen sc1
    v_pk_mul_f32 v[242:243], v[120:121], s[60:61]
    v_pk_mul_f32 v[244:245], v[122:123], s[60:61]
    v_pk_mul_f32 v[148:149], v[120:121], v[148:149]
    v_pk_mul_f32 v[150:151], v[122:123], v[150:151]
    v_mfma_f32_16x16x32_bf16 v[152:155], a[140:143], a[120:123], v[152:155]
    v_exp_f32 v242, v242
    v_exp_f32 v243, v243
    v_exp_f32 v244, v244
    v_exp_f32 v245, v245
    v_pk_add_f32 v[242:243], v[242:243], 1.0 op_sel_hi:[1,0]
    v_mfma_f32_16x16x32_bf16 v[208:211], a[140:143], a[124:127], v[208:211]
    v_pk_add_f32 v[244:245], v[244:245], 1.0 op_sel_hi:[1,0]
    v_rcp_f32 v242, v242
    v_rcp_f32 v243, v243
    v_rcp_f32 v244, v244
    v_rcp_f32 v245, v245
    s_waitcnt lgkmcnt(6)
    v_mfma_f32_16x16x32_bf16 v[16:19], a[144:147], a[96:99], v[16:19]
    ds_read_b64_tr_b16 a[128:129], v233 offset:28832
    v_pk_mul_f32 v[242:243], v[242:243], v[148:149]
    v_pk_mul_f32 v[244:245], v[244:245], v[150:151]
    v_cvt_pk_bf16_f32 v118, v242, v243
    v_cvt_pk_bf16_f32 v119, v244, v245
    buffer_store_dwordx4 v[116:119], v227, s[32:35], s53 offen sc1
    v_mfma_f32_16x16x32_bf16 v[72:75], a[144:147], a[100:103], v[72:75]
    ds_read_b64_tr_b16 a[130:131], v233 offset:32416
    v_pk_mul_f32 v[246:247], v[176:177], s[60:61]
    v_pk_mul_f32 v[248:249], v[178:179], s[60:61]
    v_pk_mul_f32 v[204:205], v[176:177], v[204:205]
    v_pk_mul_f32 v[206:207], v[178:179], v[206:207]
    v_exp_f32 v246, v246
    v_mfma_f32_16x16x32_bf16 v[128:131], a[144:147], a[104:107], v[128:131]
    v_exp_f32 v247, v247
    v_exp_f32 v248, v248
    v_exp_f32 v249, v249
    v_pk_add_f32 v[246:247], v[246:247], 1.0 op_sel_hi:[1,0]
    v_pk_add_f32 v[248:249], v[248:249], 1.0 op_sel_hi:[1,0]
    v_mfma_f32_16x16x32_bf16 v[184:187], a[144:147], a[108:111], v[184:187]
    v_rcp_f32 v246, v246
    v_rcp_f32 v247, v247
    v_rcp_f32 v248, v248
    v_rcp_f32 v249, v249
    v_pk_mul_f32 v[246:247], v[246:247], v[204:205]
    s_waitcnt lgkmcnt(6)
    v_mfma_f32_16x16x32_bf16 v[44:47], a[148:151], a[96:99], v[44:47]
    ds_read_b64_tr_b16 a[132:133], v233 offset:43168
    v_pk_mul_f32 v[248:249], v[248:249], v[206:207]
    v_cvt_pk_bf16_f32 v174, v246, v247
    v_cvt_pk_bf16_f32 v175, v248, v249
    buffer_store_dwordx4 v[172:175], v228, s[32:35], s53 offen sc1
    v_pk_mul_f32 v[234:235], v[12:13], s[60:61]
    v_mfma_f32_16x16x32_bf16 v[100:103], a[148:151], a[100:103], v[100:103]
    ds_read_b64_tr_b16 a[134:135], v233 offset:46752
    v_pk_mul_f32 v[236:237], v[14:15], s[60:61]
    v_pk_mul_f32 v[40:41], v[12:13], v[40:41]
    v_pk_mul_f32 v[42:43], v[14:15], v[42:43]
    v_exp_f32 v234, v234
    v_exp_f32 v235, v235
    v_mfma_f32_16x16x32_bf16 v[156:159], a[148:151], a[104:107], v[156:159]
    v_exp_f32 v236, v236
    v_exp_f32 v237, v237
    v_pk_add_f32 v[234:235], v[234:235], 1.0 op_sel_hi:[1,0]
    v_pk_add_f32 v[236:237], v[236:237], 1.0 op_sel_hi:[1,0]
    v_rcp_f32 v234, v234
    v_mfma_f32_16x16x32_bf16 v[212:215], a[148:151], a[108:111], v[212:215]
    v_rcp_f32 v235, v235
    v_rcp_f32 v236, v236
    v_rcp_f32 v237, v237
    v_pk_mul_f32 v[234:235], v[234:235], v[40:41]
    v_pk_mul_f32 v[236:237], v[236:237], v[42:43]
    s_waitcnt lgkmcnt(6)
    v_mfma_f32_16x16x32_bf16 v[16:19], a[152:155], a[112:115], v[16:19]
    ds_read_b64_tr_b16 a[136:137], v233 offset:36000
    v_cvt_pk_bf16_f32 v12, v234, v235
    v_cvt_pk_bf16_f32 v13, v236, v237
    v_pk_mul_f32 v[238:239], v[68:69], s[60:61]
    v_pk_mul_f32 v[240:241], v[70:71], s[60:61]
    v_pk_mul_f32 v[96:97], v[68:69], v[96:97]
    v_mfma_f32_16x16x32_bf16 v[72:75], a[152:155], a[116:119], v[72:75]
    ds_read_b64_tr_b16 a[138:139], v233 offset:39584
    v_pk_mul_f32 v[98:99], v[70:71], v[98:99]
    v_exp_f32 v238, v238
    v_exp_f32 v239, v239
    v_exp_f32 v240, v240
    v_exp_f32 v241, v241
    v_mfma_f32_16x16x32_bf16 v[128:131], a[152:155], a[120:123], v[128:131]
    v_pk_add_f32 v[238:239], v[238:239], 1.0 op_sel_hi:[1,0]
    v_pk_add_f32 v[240:241], v[240:241], 1.0 op_sel_hi:[1,0]
    v_rcp_f32 v238, v238
    v_rcp_f32 v239, v239
    v_rcp_f32 v240, v240
    v_mfma_f32_16x16x32_bf16 v[184:187], a[152:155], a[124:127], v[184:187]
    v_rcp_f32 v241, v241
    v_pk_mul_f32 v[238:239], v[238:239], v[96:97]
    v_pk_mul_f32 v[240:241], v[240:241], v[98:99]
    v_cvt_pk_bf16_f32 v68, v238, v239
    v_cvt_pk_bf16_f32 v69, v240, v241
    s_waitcnt lgkmcnt(6)
    v_mfma_f32_16x16x32_bf16 v[44:47], a[156:159], a[112:115], v[44:47]
    ds_read_b64_tr_b16 a[140:141], v233 offset:50336
    v_pk_mul_f32 v[242:243], v[124:125], s[60:61]
    v_pk_mul_f32 v[244:245], v[126:127], s[60:61]
    v_pk_mul_f32 v[152:153], v[124:125], v[152:153]
    v_pk_mul_f32 v[154:155], v[126:127], v[154:155]
    v_exp_f32 v242, v242
    v_mfma_f32_16x16x32_bf16 v[100:103], a[156:159], a[116:119], v[100:103]
    ds_read_b64_tr_b16 a[142:143], v233 offset:53920
    v_exp_f32 v243, v243
    v_exp_f32 v244, v244
    v_exp_f32 v245, v245
    v_pk_add_f32 v[242:243], v[242:243], 1.0 op_sel_hi:[1,0]
    v_pk_add_f32 v[244:245], v[244:245], 1.0 op_sel_hi:[1,0]
    v_mfma_f32_16x16x32_bf16 v[156:159], a[156:159], a[120:123], v[156:159]
    v_rcp_f32 v242, v242
    v_rcp_f32 v243, v243
    v_rcp_f32 v244, v244
    v_rcp_f32 v245, v245
    v_pk_mul_f32 v[242:243], v[242:243], v[152:153]
    v_mfma_f32_16x16x32_bf16 v[212:215], a[156:159], a[124:127], v[212:215]
    v_pk_mul_f32 v[244:245], v[244:245], v[154:155]
    v_cvt_pk_bf16_f32 v124, v242, v243
    v_cvt_pk_bf16_f32 v125, v244, v245
    v_pk_mul_f32 v[246:247], v[180:181], s[60:61]
    v_pk_mul_f32 v[248:249], v[182:183], s[60:61]
    s_waitcnt lgkmcnt(6)
    v_mfma_f32_16x16x32_bf16 v[20:23], a[128:131], a[96:99], v[20:23]
    ds_read_b64_tr_b16 a[144:145], v233 offset:28864
    v_pk_mul_f32 v[208:209], v[180:181], v[208:209]
    v_pk_mul_f32 v[210:211], v[182:183], v[210:211]
    v_exp_f32 v246, v246
    v_exp_f32 v247, v247
    v_exp_f32 v248, v248
    v_mfma_f32_16x16x32_bf16 v[76:79], a[128:131], a[100:103], v[76:79]
    ds_read_b64_tr_b16 a[146:147], v233 offset:32448
    v_exp_f32 v249, v249
    v_pk_add_f32 v[246:247], v[246:247], 1.0 op_sel_hi:[1,0]
    v_pk_add_f32 v[248:249], v[248:249], 1.0 op_sel_hi:[1,0]
    v_rcp_f32 v246, v246
    v_rcp_f32 v247, v247
    v_mfma_f32_16x16x32_bf16 v[132:135], a[128:131], a[104:107], v[132:135]
    v_rcp_f32 v248, v248
    v_rcp_f32 v249, v249
    v_pk_mul_f32 v[246:247], v[246:247], v[208:209]
    v_pk_mul_f32 v[248:249], v[248:249], v[210:211]
    v_cvt_pk_bf16_f32 v180, v246, v247
    v_mfma_f32_16x16x32_bf16 v[188:191], a[128:131], a[108:111], v[188:191]
    v_cvt_pk_bf16_f32 v181, v248, v249
    v_pk_mul_f32 v[234:235], v[16:17], s[60:61]
    v_pk_mul_f32 v[236:237], v[18:19], s[60:61]
    v_pk_mul_f32 v[44:45], v[16:17], v[44:45]
    v_pk_mul_f32 v[46:47], v[18:19], v[46:47]
    s_waitcnt lgkmcnt(6)
    v_mfma_f32_16x16x32_bf16 v[48:51], a[132:135], a[96:99], v[48:51]
    ds_read_b64_tr_b16 a[148:149], v233 offset:43200
    v_exp_f32 v234, v234
    v_exp_f32 v235, v235
    v_exp_f32 v236, v236
    v_exp_f32 v237, v237
    v_pk_add_f32 v[234:235], v[234:235], 1.0 op_sel_hi:[1,0]
    v_mfma_f32_16x16x32_bf16 v[104:107], a[132:135], a[100:103], v[104:107]
    ds_read_b64_tr_b16 a[150:151], v233 offset:46784
    v_pk_add_f32 v[236:237], v[236:237], 1.0 op_sel_hi:[1,0]
    v_rcp_f32 v234, v234
    v_rcp_f32 v235, v235
    v_rcp_f32 v236, v236
    v_rcp_f32 v237, v237
    v_mfma_f32_16x16x32_bf16 v[160:163], a[132:135], a[104:107], v[160:163]
    v_pk_mul_f32 v[234:235], v[234:235], v[44:45]
    v_pk_mul_f32 v[236:237], v[236:237], v[46:47]
    v_cvt_pk_bf16_f32 v14, v234, v235
    v_cvt_pk_bf16_f32 v15, v236, v237
    buffer_store_dwordx4 v[12:15], v225, s[32:35], s54 offen sc1
    v_mfma_f32_16x16x32_bf16 v[216:219], a[132:135], a[108:111], v[216:219]
    v_pk_mul_f32 v[238:239], v[72:73], s[60:61]
    v_pk_mul_f32 v[240:241], v[74:75], s[60:61]
    v_pk_mul_f32 v[100:101], v[72:73], v[100:101]
    v_pk_mul_f32 v[102:103], v[74:75], v[102:103]
    v_exp_f32 v238, v238
    s_waitcnt lgkmcnt(6)
    v_mfma_f32_16x16x32_bf16 v[20:23], a[136:139], a[112:115], v[20:23]
    ds_read_b64_tr_b16 a[152:153], v233 offset:36032
    v_exp_f32 v239, v239
    v_exp_f32 v240, v240
    v_exp_f32 v241, v241
    v_pk_add_f32 v[238:239], v[238:239], 1.0 op_sel_hi:[1,0]
    v_pk_add_f32 v[240:241], v[240:241], 1.0 op_sel_hi:[1,0]
    v_mfma_f32_16x16x32_bf16 v[76:79], a[136:139], a[116:119], v[76:79]
    ds_read_b64_tr_b16 a[154:155], v233 offset:39616
    v_rcp_f32 v238, v238
    v_rcp_f32 v239, v239
    v_rcp_f32 v240, v240
    v_rcp_f32 v241, v241
    v_pk_mul_f32 v[238:239], v[238:239], v[100:101]
    v_mfma_f32_16x16x32_bf16 v[132:135], a[136:139], a[120:123], v[132:135]
    v_pk_mul_f32 v[240:241], v[240:241], v[102:103]
    v_cvt_pk_bf16_f32 v70, v238, v239
    v_cvt_pk_bf16_f32 v71, v240, v241
    buffer_store_dwordx4 v[68:71], v226, s[32:35], s54 offen sc1
    v_pk_mul_f32 v[242:243], v[128:129], s[60:61]
    v_mfma_f32_16x16x32_bf16 v[188:191], a[136:139], a[124:127], v[188:191]
    v_pk_mul_f32 v[244:245], v[130:131], s[60:61]
    v_pk_mul_f32 v[156:157], v[128:129], v[156:157]
    v_pk_mul_f32 v[158:159], v[130:131], v[158:159]
    v_exp_f32 v242, v242
    v_exp_f32 v243, v243
    s_waitcnt lgkmcnt(6)
    v_mfma_f32_16x16x32_bf16 v[48:51], a[140:143], a[112:115], v[48:51]
    ds_read_b64_tr_b16 a[156:157], v233 offset:50368
    v_exp_f32 v244, v244
    v_exp_f32 v245, v245
    v_pk_add_f32 v[242:243], v[242:243], 1.0 op_sel_hi:[1,0]
    v_pk_add_f32 v[244:245], v[244:245], 1.0 op_sel_hi:[1,0]
    v_rcp_f32 v242, v242
    v_mfma_f32_16x16x32_bf16 v[104:107], a[140:143], a[116:119], v[104:107]
    ds_read_b64_tr_b16 a[158:159], v233 offset:53952
    v_rcp_f32 v243, v243
    v_rcp_f32 v244, v244
    v_rcp_f32 v245, v245
    v_pk_mul_f32 v[242:243], v[242:243], v[156:157]
    v_pk_mul_f32 v[244:245], v[244:245], v[158:159]
    v_mfma_f32_16x16x32_bf16 v[160:163], a[140:143], a[120:123], v[160:163]
    v_cvt_pk_bf16_f32 v126, v242, v243
    v_cvt_pk_bf16_f32 v127, v244, v245
    buffer_store_dwordx4 v[124:127], v227, s[32:35], s54 offen sc1
    v_pk_mul_f32 v[246:247], v[184:185], s[60:61]
    v_pk_mul_f32 v[248:249], v[186:187], s[60:61]
    v_mfma_f32_16x16x32_bf16 v[216:219], a[140:143], a[124:127], v[216:219]
    v_pk_mul_f32 v[212:213], v[184:185], v[212:213]
    v_pk_mul_f32 v[214:215], v[186:187], v[214:215]
    v_exp_f32 v246, v246
    v_exp_f32 v247, v247
    v_exp_f32 v248, v248
    s_waitcnt lgkmcnt(6)
    v_mfma_f32_16x16x32_bf16 v[24:27], a[144:147], a[96:99], v[24:27]
    v_exp_f32 v249, v249
    v_pk_add_f32 v[246:247], v[246:247], 1.0 op_sel_hi:[1,0]
    v_pk_add_f32 v[248:249], v[248:249], 1.0 op_sel_hi:[1,0]
    v_rcp_f32 v246, v246
    v_rcp_f32 v247, v247
    v_mfma_f32_16x16x32_bf16 v[80:83], a[144:147], a[100:103], v[80:83]
    v_rcp_f32 v248, v248
    v_rcp_f32 v249, v249
    v_pk_mul_f32 v[246:247], v[246:247], v[212:213]
    v_pk_mul_f32 v[248:249], v[248:249], v[214:215]
    v_cvt_pk_bf16_f32 v182, v246, v247
    v_mfma_f32_16x16x32_bf16 v[136:139], a[144:147], a[104:107], v[136:139]
    v_cvt_pk_bf16_f32 v183, v248, v249
    buffer_store_dwordx4 v[180:183], v228, s[32:35], s54 offen sc1
    v_pk_mul_f32 v[234:235], v[20:21], s[60:61]
    v_pk_mul_f32 v[236:237], v[22:23], s[60:61]
    v_pk_mul_f32 v[48:49], v[20:21], v[48:49]
    v_mfma_f32_16x16x32_bf16 v[192:195], a[144:147], a[108:111], v[192:195]
    v_pk_mul_f32 v[50:51], v[22:23], v[50:51]
    v_exp_f32 v234, v234
    v_exp_f32 v235, v235
    v_exp_f32 v236, v236
    v_exp_f32 v237, v237
    s_waitcnt lgkmcnt(4)
    v_mfma_f32_16x16x32_bf16 v[52:55], a[148:151], a[96:99], v[52:55]
    v_pk_add_f32 v[234:235], v[234:235], 1.0 op_sel_hi:[1,0]
    v_pk_add_f32 v[236:237], v[236:237], 1.0 op_sel_hi:[1,0]
    v_rcp_f32 v234, v234
    v_rcp_f32 v235, v235
    v_rcp_f32 v236, v236
    v_mfma_f32_16x16x32_bf16 v[108:111], a[148:151], a[100:103], v[108:111]
    v_rcp_f32 v237, v237
    v_pk_mul_f32 v[234:235], v[234:235], v[48:49]
    v_pk_mul_f32 v[236:237], v[236:237], v[50:51]
    v_cvt_pk_bf16_f32 v20, v234, v235
    v_cvt_pk_bf16_f32 v21, v236, v237
    v_mfma_f32_16x16x32_bf16 v[164:167], a[148:151], a[104:107], v[164:167]
    v_pk_mul_f32 v[238:239], v[76:77], s[60:61]
    v_pk_mul_f32 v[240:241], v[78:79], s[60:61]
    v_pk_mul_f32 v[104:105], v[76:77], v[104:105]
    v_pk_mul_f32 v[106:107], v[78:79], v[106:107]
    v_exp_f32 v238, v238
    v_mfma_f32_16x16x32_bf16 v[220:223], a[148:151], a[108:111], v[220:223]
    v_exp_f32 v239, v239
    v_exp_f32 v240, v240
    v_exp_f32 v241, v241
    v_pk_add_f32 v[238:239], v[238:239], 1.0 op_sel_hi:[1,0]
    v_pk_add_f32 v[240:241], v[240:241], 1.0 op_sel_hi:[1,0]
    s_waitcnt lgkmcnt(2)
    v_mfma_f32_16x16x32_bf16 v[24:27], a[152:155], a[112:115], v[24:27]
    v_rcp_f32 v238, v238
    v_rcp_f32 v239, v239
    v_rcp_f32 v240, v240
    v_rcp_f32 v241, v241
    v_pk_mul_f32 v[238:239], v[238:239], v[104:105]
    v_mfma_f32_16x16x32_bf16 v[80:83], a[152:155], a[116:119], v[80:83]
    v_pk_mul_f32 v[240:241], v[240:241], v[106:107]
    v_cvt_pk_bf16_f32 v76, v238, v239
    v_cvt_pk_bf16_f32 v77, v240, v241
    v_pk_mul_f32 v[242:243], v[132:133], s[60:61]
    v_pk_mul_f32 v[244:245], v[134:135], s[60:61]
    v_mfma_f32_16x16x32_bf16 v[136:139], a[152:155], a[120:123], v[136:139]
    v_pk_mul_f32 v[160:161], v[132:133], v[160:161]
    v_pk_mul_f32 v[162:163], v[134:135], v[162:163]
    v_exp_f32 v242, v242
    v_exp_f32 v243, v243
    v_exp_f32 v244, v244
    v_mfma_f32_16x16x32_bf16 v[192:195], a[152:155], a[124:127], v[192:195]
    v_exp_f32 v245, v245
    v_pk_add_f32 v[242:243], v[242:243], 1.0 op_sel_hi:[1,0]
    v_pk_add_f32 v[244:245], v[244:245], 1.0 op_sel_hi:[1,0]
    v_rcp_f32 v242, v242
    v_rcp_f32 v243, v243
    s_waitcnt lgkmcnt(0)
    v_mfma_f32_16x16x32_bf16 v[52:55], a[156:159], a[112:115], v[52:55]
    v_rcp_f32 v244, v244
    v_rcp_f32 v245, v245
    v_pk_mul_f32 v[242:243], v[242:243], v[160:161]
    v_pk_mul_f32 v[244:245], v[244:245], v[162:163]
    v_cvt_pk_bf16_f32 v132, v242, v243
    v_mfma_f32_16x16x32_bf16 v[108:111], a[156:159], a[116:119], v[108:111]
    v_cvt_pk_bf16_f32 v133, v244, v245
    v_pk_mul_f32 v[246:247], v[188:189], s[60:61]
    v_pk_mul_f32 v[248:249], v[190:191], s[60:61]
    v_pk_mul_f32 v[216:217], v[188:189], v[216:217]
    v_pk_mul_f32 v[218:219], v[190:191], v[218:219]
    v_mfma_f32_16x16x32_bf16 v[164:167], a[156:159], a[120:123], v[164:167]
    v_exp_f32 v246, v246
    v_exp_f32 v247, v247
    v_exp_f32 v248, v248
    v_exp_f32 v249, v249
    v_pk_add_f32 v[246:247], v[246:247], 1.0 op_sel_hi:[1,0]
    v_mfma_f32_16x16x32_bf16 v[220:223], a[156:159], a[124:127], v[220:223]
    v_pk_add_f32 v[248:249], v[248:249], 1.0 op_sel_hi:[1,0]
    v_rcp_f32 v246, v246
    v_rcp_f32 v247, v247
    v_rcp_f32 v248, v248
    v_rcp_f32 v249, v249
    s_nop 7
    v_pk_mul_f32 v[246:247], v[246:247], v[216:217]
    v_pk_mul_f32 v[248:249], v[248:249], v[218:219]
    v_cvt_pk_bf16_f32 v188, v246, v247
    v_cvt_pk_bf16_f32 v189, v248, v249
    v_pk_mul_f32 v[234:235], v[24:25], s[60:61]
    v_pk_mul_f32 v[236:237], v[26:27], s[60:61]
    v_pk_mul_f32 v[52:53], v[24:25], v[52:53]
    v_pk_mul_f32 v[54:55], v[26:27], v[54:55]
    v_exp_f32 v234, v234
    v_exp_f32 v235, v235
    v_exp_f32 v236, v236
    v_exp_f32 v237, v237
    v_pk_add_f32 v[234:235], v[234:235], 1.0 op_sel_hi:[1,0]
    v_pk_add_f32 v[236:237], v[236:237], 1.0 op_sel_hi:[1,0]
    v_rcp_f32 v234, v234
    v_rcp_f32 v235, v235
    v_rcp_f32 v236, v236
    v_rcp_f32 v237, v237
    v_pk_mul_f32 v[234:235], v[234:235], v[52:53]
    v_pk_mul_f32 v[236:237], v[236:237], v[54:55]
    v_cvt_pk_bf16_f32 v22, v234, v235
    v_cvt_pk_bf16_f32 v23, v236, v237
    buffer_store_dwordx4 v[20:23], v225, s[32:35], s55 offen sc1
    v_pk_mul_f32 v[238:239], v[80:81], s[60:61]
    v_pk_mul_f32 v[240:241], v[82:83], s[60:61]
    v_pk_mul_f32 v[108:109], v[80:81], v[108:109]
    v_pk_mul_f32 v[110:111], v[82:83], v[110:111]
    v_exp_f32 v238, v238
    v_exp_f32 v239, v239
    v_exp_f32 v240, v240
    v_exp_f32 v241, v241
    v_pk_add_f32 v[238:239], v[238:239], 1.0 op_sel_hi:[1,0]
    v_pk_add_f32 v[240:241], v[240:241], 1.0 op_sel_hi:[1,0]
    v_rcp_f32 v238, v238
    v_rcp_f32 v239, v239
    v_rcp_f32 v240, v240
    v_rcp_f32 v241, v241
    v_pk_mul_f32 v[238:239], v[238:239], v[108:109]
    v_pk_mul_f32 v[240:241], v[240:241], v[110:111]
    v_cvt_pk_bf16_f32 v78, v238, v239
    v_cvt_pk_bf16_f32 v79, v240, v241
    buffer_store_dwordx4 v[76:79], v226, s[32:35], s55 offen sc1
    v_pk_mul_f32 v[242:243], v[136:137], s[60:61]
    v_pk_mul_f32 v[244:245], v[138:139], s[60:61]
    v_pk_mul_f32 v[164:165], v[136:137], v[164:165]
    v_pk_mul_f32 v[166:167], v[138:139], v[166:167]
    v_exp_f32 v242, v242
    v_exp_f32 v243, v243
    v_exp_f32 v244, v244
    v_exp_f32 v245, v245
    v_pk_add_f32 v[242:243], v[242:243], 1.0 op_sel_hi:[1,0]
    v_pk_add_f32 v[244:245], v[244:245], 1.0 op_sel_hi:[1,0]
    v_rcp_f32 v242, v242
    v_rcp_f32 v243, v243
    v_rcp_f32 v244, v244
    v_rcp_f32 v245, v245
    v_pk_mul_f32 v[242:243], v[242:243], v[164:165]
    v_pk_mul_f32 v[244:245], v[244:245], v[166:167]
    v_cvt_pk_bf16_f32 v134, v242, v243
    v_cvt_pk_bf16_f32 v135, v244, v245
    buffer_store_dwordx4 v[132:135], v227, s[32:35], s55 offen sc1
    v_pk_mul_f32 v[246:247], v[192:193], s[60:61]
    v_pk_mul_f32 v[248:249], v[194:195], s[60:61]
    v_pk_mul_f32 v[220:221], v[192:193], v[220:221]
    v_pk_mul_f32 v[222:223], v[194:195], v[222:223]
    v_exp_f32 v246, v246
    v_exp_f32 v247, v247
    v_exp_f32 v248, v248
    v_exp_f32 v249, v249
    v_pk_add_f32 v[246:247], v[246:247], 1.0 op_sel_hi:[1,0]
    v_pk_add_f32 v[248:249], v[248:249], 1.0 op_sel_hi:[1,0]
    v_rcp_f32 v246, v246
    v_rcp_f32 v247, v247
    v_rcp_f32 v248, v248
    v_rcp_f32 v249, v249
    v_pk_mul_f32 v[246:247], v[246:247], v[220:221]
    v_pk_mul_f32 v[248:249], v[248:249], v[222:223]
    v_cvt_pk_bf16_f32 v190, v246, v247
    v_cvt_pk_bf16_f32 v191, v248, v249
    buffer_store_dwordx4 v[188:191], v228, s[32:35], s55 offen sc1
L_gu_stored:
    s_lshl_b32 s51, s37, 1
    s_lshr_b32 s42, s38, 4
    s_add_u32 s51, s51, s42
    s_add_u32 s51, s51, 192
    s_waitcnt vmcnt(0)
    s_barrier
    s_cmp_lg_u32 s94, 0
    s_cbranch_scc1 L_gu_nosig
    s_add_u32 s88, s4, 0x60000
    s_addc_u32 s89, s5, 0
    s_mov_b32 s90, 0x6800
    s_mov_b32 s91, 0x20000
    s_lshl_b32 s92, s51, 7
    v_mov_b32 v252, s92
    v_mov_b32 v253, 1
    s_mov_b64 s[92:93], exec
    s_mov_b64 exec, 1
    buffer_atomic_add v253, v252, s[88:91], 0 offen
    s_mov_b64 exec, s[92:93]
L_gu_nosig:
    s_mov_b64 exec, -1
    v_mbcnt_lo_u32_b32 v0, -1, 0
    v_mbcnt_hi_u32_b32 v0, -1, v0
    v_add_u32 v0, s94, v0
    s_load_dwordx2 s[4:5], s[0:1], 104
    s_load_dwordx2 s[6:7], s[0:1], 64
    s_load_dwordx2 s[8:9], s[0:1], 88
    v_mov_b32 v210, v0
    v_lshrrev_b32 v211, 6, v0
    s_nop 0
    v_readfirstlane_b32 s36, v211
    s_and_b32 s42, s2, 3
    s_lshl_b32 s42, s42, 2
    s_bfe_u32 s60, s2, 0x20003
    s_add_u32 s37, s42, s60
    s_lshr_b32 s38, s2, 5
    s_bfe_u32 s49, s2, 0x10002
    s_lshl_b32 s42, s60, 0
    s_add_u32 s62, s38, s42
    v_and_b32 v212, 63, v210
    v_lshlrev_b32 v192, 4, v212
    v_lshrrev_b32 v213, 4, v212
    v_and_b32 v214, 15, v212
    s_lshl_b32 s42, s36, 4
    v_add_u32 v215, s42, v213
    v_lshlrev_b32 v215, 11, v215
    v_add_u32 v216, 0, v213
    v_lshlrev_b32 v216, 1, v216
    v_xor_b32 v216, v216, v214
    s_lshl_b32 s42, s49, 3
    v_xor_b32 v216, s42, v216
    v_lshl_add_u32 v216, v216, 4, v215
    v_add_u32 v193, 0, v216
    v_add_u32 v195, 14336, v216
    v_add_u32 v216, 4, v213
    v_lshlrev_b32 v216, 1, v216
    v_xor_b32 v216, v216, v214
    s_lshl_b32 s42, s49, 3
    v_xor_b32 v216, s42, v216
    v_lshl_add_u32 v216, v216, 4, v215
    v_add_u32 v194, 7168, v216
    v_add_u32 v196, 21504, v216
    s_lshl_b32 s44, s36, 12
    s_add_u32 s45, s44, 16384
    s_add_u32 s46, s44, 32768
    s_add_u32 s47, s44, 49152
    s_waitcnt lgkmcnt(0)
    s_lshl_b32 s42, s37, 3
    s_lshl_b32 s43, s36, 1
    s_add_u32 s42, s42, s43
    s_mul_i32 s42, s42, 114688
    s_mul_i32 s43, s49, 57344
    s_add_u32 s42, s42, s43
    s_add_u32 s42, s42, 0x1000000
    s_add_u32 s12, s4, s42
    s_addc_u32 s13, s5, 0
    s_mov_b32 s14, 0xe000
    s_mov_b32 s15, 0x20000
    s_add_u32 s42, s42, 114688
    s_add_u32 s16, s4, s42
    s_addc_u32 s17, s5, 0
    s_mov_b32 s18, 0xe000
    s_mov_b32 s19, 0x20000
    s_mul_i32 s42, s49, 3670016
    s_lshl_b32 s43, s38, 8
    s_add_u32 s42, s42, s43
    s_add_u32 s20, s6, s42
    s_addc_u32 s21, s7, 0
    s_mov_b32 s22, 0x0
    s_mov_b32 s23, 0x20000
    s_sub_u32 s22, 3670016, s43
    s_mov_b32 s63, 0
    s_mov_b32 s65, s63
    s_add_u32 s64, s63, s62
    s_and_b32 s64, s64, 3
    s_andn2_b32 s67, s63, 3
    s_or_b32 s64, s64, s67
    s_add_u32 s63, s63, 1
    s_lshl_b32 s39, s64, 11
    s_lshl_b32 s40, s64, 17
    s_mov_b32 m0, s44
    s_nop 0
    buffer_load_dwordx4 v193, s[20:23], s40 offen offset:0 lds
    buffer_load_dwordx4 v194, s[20:23], s40 offen offset:1024 lds
    buffer_load_dwordx4 v195, s[20:23], s40 offen offset:2048 lds
    buffer_load_dwordx4 v196, s[20:23], s40 offen offset:3072 lds
    s_add_u32 s64, s63, s62
    s_and_b32 s64, s64, 3
    s_andn2_b32 s67, s63, 3
    s_or_b32 s64, s64, s67
    s_add_u32 s63, s63, 1
    s_lshl_b32 s39, s64, 11
    s_lshl_b32 s40, s64, 17
    s_mov_b32 m0, s45
    s_nop 0
    buffer_load_dwordx4 v193, s[20:23], s40 offen offset:0 lds
    buffer_load_dwordx4 v194, s[20:23], s40 offen offset:1024 lds
    buffer_load_dwordx4 v195, s[20:23], s40 offen offset:2048 lds
    buffer_load_dwordx4 v196, s[20:23], s40 offen offset:3072 lds
    s_and_b32 s50, s37, 14
    s_add_u32 s50, s50, s49
    s_add_u32 s50, s50, 192
    s_cmp_lg_u32 s94, 0
    s_cbranch_scc1 L_down_wgo
    s_add_u32 s88, s4, 0x60000
    s_addc_u32 s89, s5, 0
    s_mov_b32 s90, 0x6800
    s_mov_b32 s91, 0x20000
    s_lshl_b32 s92, s50, 7
    v_mov_b32 v252, s92
    s_mov_b64 s[92:93], exec
    s_mov_b64 exec, 1
    s_mov_b32 s3, 0x40000
L_down_wpoll:
    buffer_load_dword v253, v252, s[88:91], 0 offen sc1
    s_waitcnt vmcnt(0)
    v_cmp_ne_u32 vcc, 16, v253
    s_cbranch_vccz L_down_wdone
    s_sleep 1
    s_sub_u32 s3, s3, 1
    s_cmp_lg_u32 s3, 0
    s_cbranch_scc1 L_down_wpoll
L_down_wdone:
    s_mov_b64 exec, s[92:93]
L_down_wgo:
    s_barrier
    v_mov_b32 v252, 0x7f000000
    s_mov_b32 s63, s65
    s_add_u32 s64, s63, s62
    s_and_b32 s64, s64, 3
    s_andn2_b32 s67, s63, 3
    s_or_b32 s64, s64, s67
    s_add_u32 s63, s63, 1
    s_lshl_b32 s39, s64, 11
    s_lshl_b32 s40, s64, 17
    buffer_load_dwordx4 v[128:131], v192, s[12:15], s39 offen offset:0 sc1
    buffer_load_dwordx4 v[132:135], v192, s[16:19], s39 offen offset:0 sc1
    buffer_load_dwordx4 v[136:139], v192, s[12:15], s39 offen offset:1024 sc1
    buffer_load_dwordx4 v[140:143], v192, s[16:19], s39 offen offset:1024 sc1
    s_add_u32 s64, s63, s62
    s_and_b32 s64, s64, 3
    s_andn2_b32 s67, s63, 3
    s_or_b32 s64, s64, s67
    s_add_u32 s63, s63, 1
    s_lshl_b32 s39, s64, 11
    s_lshl_b32 s40, s64, 17
    buffer_load_dwordx4 v[144:147], v192, s[12:15], s39 offen offset:0 sc1
    buffer_load_dwordx4 v[148:151], v192, s[16:19], s39 offen offset:0 sc1
    buffer_load_dwordx4 v[152:155], v192, s[12:15], s39 offen offset:1024 sc1
    buffer_load_dwordx4 v[156:159], v192, s[16:19], s39 offen offset:1024 sc1
    s_add_u32 s64, s63, s62
    s_and_b32 s64, s64, 3
    s_andn2_b32 s67, s63, 3
    s_or_b32 s64, s64, s67
    s_add_u32 s63, s63, 1
    s_lshl_b32 s39, s64, 11
    s_lshl_b32 s40, s64, 17
    v_lshrrev_b32 v213, 2, v212
    v_lshlrev_b32 v214, 8, v213
    v_and_b32 v215, 3, v212
    v_lshl_add_u32 v214, v215, 3, v214
    v_and_b32 v215, 7, v213
    v_lshl_add_u32 v200, v215, 5, v214
    v_xor_b32 v201, 32, v200
    v_xor_b32 v202, 64, v200
    v_xor_b32 v203, 96, v200
    v_xor_b32 v204, 128, v200
    v_xor_b32 v205, 160, v200
    v_xor_b32 v206, 192, v200
    v_xor_b32 v207, 224, v200
    s_lshl_b32 s51, s38, 1
    s_add_u32 s51, s51, s49
    s_add_u32 s24, s4, 0x500000
    s_addc_u32 s25, s5, 0
    s_mov_b32 s26, 0x400000
    s_mov_b32 s27, 0x20000
    s_mov_b32 s28, s8
    s_mov_b32 s29, s9
    s_mov_b32 s30, 0x400000
    s_mov_b32 s31, 0x20000
    s_add_u32 s32, s4, 0x20000
    s_addc_u32 s33, s5, 0
    s_mov_b32 s34, 0xc000
    s_mov_b32 s35, 0x20000
    s_lshl_b32 s42, s37, 7
    s_lshl_b32 s43, s36, 5
    s_add_u32 s42, s42, s43
    v_and_b32 v213, 15, v212
    v_add_u32 v213, s42, v213
    v_lshlrev_b32 v213, 11, v213
    s_lshl_b32 s42, s51, 7
    v_add_u32 v213, s42, v213
    v_lshrrev_b32 v214, 4, v212
    v_lshl_add_u32 v215, v214, 4, v213
    s_lshl_b32 s42, s51, 8
    s_add_u32 s42, s42, 20480
    v_lshlrev_b32 v216, 4, v214
    v_add_u32 v216, s42, v216
    v_and_b32 v217, 1, v214
    v_lshlrev_b32 v217, 5, v217
    v_lshrrev_b32 v218, 1, v214
    v_lshl_add_u32 v217, v218, 4, v217
    v_add_u32 v208, v217, v213
    s_mov_b32 s48, 0x8000
    s_mov_b32 s52, 24576
    buffer_load_dwordx4 a[0:3], v215, s[24:27], 0 offen offset:0 sc1
    buffer_load_dwordx4 a[4:7], v215, s[24:27], 0 offen offset:64 sc1
    buffer_load_dwordx4 a[8:11], v215, s[24:27], s48 offen offset:0 sc1
    buffer_load_dwordx4 a[12:15], v215, s[24:27], s48 offen offset:64 sc1
    buffer_load_dwordx4 a[16:19], v216, s[32:35], 0 offen offset:0 sc1
    buffer_load_dwordx4 a[32:35], v216, s[32:35], s52 offen offset:0 sc1
    buffer_load_dwordx4 a[20:23], v216, s[32:35], 0 offen offset:64 sc1
    buffer_load_dwordx4 a[36:39], v216, s[32:35], s52 offen offset:64 sc1
    buffer_load_dwordx4 a[24:27], v216, s[32:35], 0 offen offset:128 sc1
    buffer_load_dwordx4 a[40:43], v216, s[32:35], s52 offen offset:128 sc1
    buffer_load_dwordx4 a[28:31], v216, s[32:35], 0 offen offset:192 sc1
    buffer_load_dwordx4 a[44:47], v216, s[32:35], s52 offen offset:192 sc1
    v_mov_b32 v0, 0
    v_mov_b32 v1, 0
    v_mov_b32 v2, 0
    v_mov_b32 v3, 0
    v_mov_b32 v4, 0
    v_mov_b32 v5, 0
    v_mov_b32 v6, 0
    v_mov_b32 v7, 0
    v_mov_b32 v8, 0
    v_mov_b32 v9, 0
    v_mov_b32 v10, 0
    v_mov_b32 v11, 0
    v_mov_b32 v12, 0
    v_mov_b32 v13, 0
    v_mov_b32 v14, 0
    v_mov_b32 v15, 0
    v_mov_b32 v16, 0
    v_mov_b32 v17, 0
    v_mov_b32 v18, 0
    v_mov_b32 v19, 0
    v_mov_b32 v20, 0
    v_mov_b32 v21, 0
    v_mov_b32 v22, 0
    v_mov_b32 v23, 0
    v_mov_b32 v24, 0
    v_mov_b32 v25, 0
    v_mov_b32 v26, 0
    v_mov_b32 v27, 0
    v_mov_b32 v28, 0
    v_mov_b32 v29, 0
    v_mov_b32 v30, 0
    v_mov_b32 v31, 0
    v_mov_b32 v32, 0
    v_mov_b32 v33, 0
    v_mov_b32 v34, 0
    v_mov_b32 v35, 0
    v_mov_b32 v36, 0
    v_mov_b32 v37, 0
    v_mov_b32 v38, 0
    v_mov_b32 v39, 0
    v_mov_b32 v40, 0
    v_mov_b32 v41, 0
    v_mov_b32 v42, 0
    v_mov_b32 v43, 0
    v_mov_b32 v44, 0
    v_mov_b32 v45, 0
    v_mov_b32 v46, 0
    v_mov_b32 v47, 0
    v_mov_b32 v48, 0
    v_mov_b32 v49, 0
    v_mov_b32 v50, 0
    v_mov_b32 v51, 0
    v_mov_b32 v52, 0
    v_mov_b32 v53, 0
    v_mov_b32 v54, 0
    v_mov_b32 v55, 0
    v_mov_b32 v56, 0
    v_mov_b32 v57, 0
    v_mov_b32 v58, 0
    v_mov_b32 v59, 0
    v_mov_b32 v60, 0
    v_mov_b32 v61, 0
    v_mov_b32 v62, 0
    v_mov_b32 v63, 0
    s_waitcnt vmcnt(24)
    s_barrier
    ds_read_b64_tr_b16 v[64:65], v200 offset:0
    ds_read_b64_tr_b16 v[66:67], v200 offset:4096
    ds_read_b64_tr_b16 v[68:69], v201 offset:0
    ds_read_b64_tr_b16 v[70:71], v201 offset:4096
    ds_read_b64_tr_b16 v[72:73], v202 offset:0
    ds_read_b64_tr_b16 v[74:75], v202 offset:4096
    ds_read_b64_tr_b16 v[76:77], v203 offset:0
    ds_read_b64_tr_b16 v[78:79], v203 offset:4096
    ds_read_b64_tr_b16 v[80:81], v204 offset:0
    ds_read_b64_tr_b16 v[82:83], v204 offset:4096
    ds_read_b64_tr_b16 v[84:85], v205 offset:0
    ds_read_b64_tr_b16 v[86:87], v205 offset:4096
    ds_read_b64_tr_b16 v[88:89], v206 offset:0
    ds_read_b64_tr_b16 v[90:91], v206 offset:4096
    ds_read_b64_tr_b16 v[92:93], v207 offset:0
    ds_read_b64_tr_b16 v[94:95], v207 offset:4096
    s_mov_b32 s41, 7
L_down_loop:
    s_waitcnt vmcnt(18)
    s_waitcnt lgkmcnt(12)
    v_mfma_f32_16x16x32_bf16 v[0:3], v[64:67], v[128:131], v[0:3]
    ds_read_b64_tr_b16 v[96:97], v200 offset:8192
    ds_read_b64_tr_b16 v[98:99], v200 offset:12288
    v_mfma_f32_16x16x32_bf16 v[32:35], v[64:67], v[132:135], v[32:35]
    s_mov_b32 m0, s46
    s_nop 0
    buffer_load_dwordx4 v193, s[20:23], s40 offen offset:0 lds
    v_mfma_f32_16x16x32_bf16 v[4:7], v[68:71], v[128:131], v[4:7]
    ds_read_b64_tr_b16 v[100:101], v201 offset:8192
    ds_read_b64_tr_b16 v[102:103], v201 offset:12288
    v_mfma_f32_16x16x32_bf16 v[36:39], v[68:71], v[132:135], v[36:39]
    s_waitcnt lgkmcnt(12)
    v_mfma_f32_16x16x32_bf16 v[8:11], v[72:75], v[128:131], v[8:11]
    ds_read_b64_tr_b16 v[104:105], v202 offset:8192
    ds_read_b64_tr_b16 v[106:107], v202 offset:12288
    v_mfma_f32_16x16x32_bf16 v[40:43], v[72:75], v[132:135], v[40:43]
    buffer_load_dwordx4 v[160:163], v192, s[12:15], s39 offen offset:0 sc1
    v_mfma_f32_16x16x32_bf16 v[12:15], v[76:79], v[128:131], v[12:15]
    ds_read_b64_tr_b16 v[108:109], v203 offset:8192
    ds_read_b64_tr_b16 v[110:111], v203 offset:12288
    v_mfma_f32_16x16x32_bf16 v[44:47], v[76:79], v[132:135], v[44:47]
    s_waitcnt lgkmcnt(12)
    v_mfma_f32_16x16x32_bf16 v[16:19], v[80:83], v[128:131], v[16:19]
    ds_read_b64_tr_b16 v[112:113], v204 offset:8192
    ds_read_b64_tr_b16 v[114:115], v204 offset:12288
    v_mfma_f32_16x16x32_bf16 v[48:51], v[80:83], v[132:135], v[48:51]
    buffer_load_dwordx4 v194, s[20:23], s40 offen offset:1024 lds
    v_mfma_f32_16x16x32_bf16 v[20:23], v[84:87], v[128:131], v[20:23]
    ds_read_b64_tr_b16 v[116:117], v205 offset:8192
    ds_read_b64_tr_b16 v[118:119], v205 offset:12288
    v_mfma_f32_16x16x32_bf16 v[52:55], v[84:87], v[132:135], v[52:55]
    s_waitcnt lgkmcnt(12)
    v_mfma_f32_16x16x32_bf16 v[24:27], v[88:91], v[128:131], v[24:27]
    ds_read_b64_tr_b16 v[120:121], v206 offset:8192
    ds_read_b64_tr_b16 v[122:123], v206 offset:12288
    v_mfma_f32_16x16x32_bf16 v[56:59], v[88:91], v[132:135], v[56:59]
    buffer_load_dwordx4 v[164:167], v192, s[16:19], s39 offen offset:0 sc1
    v_mfma_f32_16x16x32_bf16 v[28:31], v[92:95], v[128:131], v[28:31]
    ds_read_b64_tr_b16 v[124:125], v207 offset:8192
    ds_read_b64_tr_b16 v[126:127], v207 offset:12288
    v_mfma_f32_16x16x32_bf16 v[60:63], v[92:95], v[132:135], v[60:63]
    s_waitcnt vmcnt(12)
    s_waitcnt vmcnt(5)
    s_barrier
    s_waitcnt lgkmcnt(12)
    v_mfma_f32_16x16x32_bf16 v[0:3], v[96:99], v[136:139], v[0:3]
    ds_read_b64_tr_b16 v[64:65], v200 offset:16384
    ds_read_b64_tr_b16 v[66:67], v200 offset:20480
    v_mfma_f32_16x16x32_bf16 v[32:35], v[96:99], v[140:143], v[32:35]
    buffer_load_dwordx4 v195, s[20:23], s40 offen offset:2048 lds
    v_mfma_f32_16x16x32_bf16 v[4:7], v[100:103], v[136:139], v[4:7]
    ds_read_b64_tr_b16 v[68:69], v201 offset:16384
    ds_read_b64_tr_b16 v[70:71], v201 offset:20480
    v_mfma_f32_16x16x32_bf16 v[36:39], v[100:103], v[140:143], v[36:39]
    s_waitcnt lgkmcnt(12)
    s_add_u32 s64, s63, s62
    v_mfma_f32_16x16x32_bf16 v[8:11], v[104:107], v[136:139], v[8:11]
    ds_read_b64_tr_b16 v[72:73], v202 offset:16384
    ds_read_b64_tr_b16 v[74:75], v202 offset:20480
    v_mfma_f32_16x16x32_bf16 v[40:43], v[104:107], v[140:143], v[40:43]
    buffer_load_dwordx4 v[168:171], v192, s[12:15], s39 offen offset:1024 sc1
    v_mfma_f32_16x16x32_bf16 v[12:15], v[108:111], v[136:139], v[12:15]
    ds_read_b64_tr_b16 v[76:77], v203 offset:16384
    ds_read_b64_tr_b16 v[78:79], v203 offset:20480
    v_mfma_f32_16x16x32_bf16 v[44:47], v[108:111], v[140:143], v[44:47]
    s_waitcnt lgkmcnt(12)
    s_and_b32 s64, s64, 3
    v_mfma_f32_16x16x32_bf16 v[16:19], v[112:115], v[136:139], v[16:19]
    ds_read_b64_tr_b16 v[80:81], v204 offset:16384
    ds_read_b64_tr_b16 v[82:83], v204 offset:20480
    v_mfma_f32_16x16x32_bf16 v[48:51], v[112:115], v[140:143], v[48:51]
    buffer_load_dwordx4 v196, s[20:23], s40 offen offset:3072 lds
    v_mfma_f32_16x16x32_bf16 v[20:23], v[116:119], v[136:139], v[20:23]
    ds_read_b64_tr_b16 v[84:85], v205 offset:16384
    ds_read_b64_tr_b16 v[86:87], v205 offset:20480
    v_mfma_f32_16x16x32_bf16 v[52:55], v[116:119], v[140:143], v[52:55]
    s_waitcnt lgkmcnt(12)
    s_andn2_b32 s67, s63, 3
    v_mfma_f32_16x16x32_bf16 v[24:27], v[120:123], v[136:139], v[24:27]
    ds_read_b64_tr_b16 v[88:89], v206 offset:16384
    ds_read_b64_tr_b16 v[90:91], v206 offset:20480
    v_mfma_f32_16x16x32_bf16 v[56:59], v[120:123], v[140:143], v[56:59]
    buffer_load_dwordx4 v[172:175], v192, s[16:19], s39 offen offset:1024 sc1
    v_mfma_f32_16x16x32_bf16 v[28:31], v[124:127], v[136:139], v[28:31]
    ds_read_b64_tr_b16 v[92:93], v207 offset:16384
    ds_read_b64_tr_b16 v[94:95], v207 offset:20480
    v_mfma_f32_16x16x32_bf16 v[60:63], v[124:127], v[140:143], v[60:63]
    s_or_b32 s64, s64, s67
    s_add_u32 s63, s63, 1
    s_lshl_b32 s39, s64, 11
    s_lshl_b32 s40, s64, 17
    s_waitcnt vmcnt(22)
    s_waitcnt lgkmcnt(12)
    v_mfma_f32_16x16x32_bf16 v[0:3], v[64:67], v[144:147], v[0:3]
    ds_read_b64_tr_b16 v[96:97], v200 offset:24576
    ds_read_b64_tr_b16 v[98:99], v200 offset:28672
    v_mfma_f32_16x16x32_bf16 v[32:35], v[64:67], v[148:151], v[32:35]
    s_mov_b32 m0, s47
    s_nop 0
    buffer_load_dwordx4 v193, s[20:23], s40 offen offset:0 lds
    v_mfma_f32_16x16x32_bf16 v[4:7], v[68:71], v[144:147], v[4:7]
    ds_read_b64_tr_b16 v[100:101], v201 offset:24576
    ds_read_b64_tr_b16 v[102:103], v201 offset:28672
    v_mfma_f32_16x16x32_bf16 v[36:39], v[68:71], v[148:151], v[36:39]
    s_waitcnt lgkmcnt(12)
    v_mfma_f32_16x16x32_bf16 v[8:11], v[72:75], v[144:147], v[8:11]
    ds_read_b64_tr_b16 v[104:105], v202 offset:24576
    ds_read_b64_tr_b16 v[106:107], v202 offset:28672
    v_mfma_f32_16x16x32_bf16 v[40:43], v[72:75], v[148:151], v[40:43]
    buffer_load_dwordx4 v[176:179], v192, s[12:15], s39 offen offset:0 sc1
    v_mfma_f32_16x16x32_bf16 v[12:15], v[76:79], v[144:147], v[12:15]
    ds_read_b64_tr_b16 v[108:109], v203 offset:24576
    ds_read_b64_tr_b16 v[110:111], v203 offset:28672
    v_mfma_f32_16x16x32_bf16 v[44:47], v[76:79], v[148:151], v[44:47]
    s_waitcnt lgkmcnt(12)
    v_mfma_f32_16x16x32_bf16 v[16:19], v[80:83], v[144:147], v[16:19]
    ds_read_b64_tr_b16 v[112:113], v204 offset:24576
    ds_read_b64_tr_b16 v[114:115], v204 offset:28672
    v_mfma_f32_16x16x32_bf16 v[48:51], v[80:83], v[148:151], v[48:51]
    buffer_load_dwordx4 v194, s[20:23], s40 offen offset:1024 lds
    v_mfma_f32_16x16x32_bf16 v[20:23], v[84:87], v[144:147], v[20:23]
    ds_read_b64_tr_b16 v[116:117], v205 offset:24576
    ds_read_b64_tr_b16 v[118:119], v205 offset:28672
    v_mfma_f32_16x16x32_bf16 v[52:55], v[84:87], v[148:151], v[52:55]
    s_waitcnt lgkmcnt(12)
    v_mfma_f32_16x16x32_bf16 v[24:27], v[88:91], v[144:147], v[24:27]
    ds_read_b64_tr_b16 v[120:121], v206 offset:24576
    ds_read_b64_tr_b16 v[122:123], v206 offset:28672
    v_mfma_f32_16x16x32_bf16 v[56:59], v[88:91], v[148:151], v[56:59]
    buffer_load_dwordx4 v[180:183], v192, s[16:19], s39 offen offset:0 sc1
    v_mfma_f32_16x16x32_bf16 v[28:31], v[92:95], v[144:147], v[28:31]
    ds_read_b64_tr_b16 v[124:125], v207 offset:24576
    ds_read_b64_tr_b16 v[126:127], v207 offset:28672
    v_mfma_f32_16x16x32_bf16 v[60:63], v[92:95], v[148:151], v[60:63]
    s_waitcnt vmcnt(12)
    s_waitcnt vmcnt(5)
    s_barrier
    s_waitcnt lgkmcnt(12)
    v_mfma_f32_16x16x32_bf16 v[0:3], v[96:99], v[152:155], v[0:3]
    ds_read_b64_tr_b16 v[64:65], v200 offset:32768
    ds_read_b64_tr_b16 v[66:67], v200 offset:36864
    v_mfma_f32_16x16x32_bf16 v[32:35], v[96:99], v[156:159], v[32:35]
    buffer_load_dwordx4 v195, s[20:23], s40 offen offset:2048 lds
    v_mfma_f32_16x16x32_bf16 v[4:7], v[100:103], v[152:155], v[4:7]
    ds_read_b64_tr_b16 v[68:69], v201 offset:32768
    ds_read_b64_tr_b16 v[70:71], v201 offset:36864
    v_mfma_f32_16x16x32_bf16 v[36:39], v[100:103], v[156:159], v[36:39]
    s_waitcnt lgkmcnt(12)
    s_add_u32 s64, s63, s62
    v_mfma_f32_16x16x32_bf16 v[8:11], v[104:107], v[152:155], v[8:11]
    ds_read_b64_tr_b16 v[72:73], v202 offset:32768
    ds_read_b64_tr_b16 v[74:75], v202 offset:36864
    v_mfma_f32_16x16x32_bf16 v[40:43], v[104:107], v[156:159], v[40:43]
    buffer_load_dwordx4 v[184:187], v192, s[12:15], s39 offen offset:1024 sc1
    v_mfma_f32_16x16x32_bf16 v[12:15], v[108:111], v[152:155], v[12:15]
    ds_read_b64_tr_b16 v[76:77], v203 offset:32768
    ds_read_b64_tr_b16 v[78:79], v203 offset:36864
    v_mfma_f32_16x16x32_bf16 v[44:47], v[108:111], v[156:159], v[44:47]
    s_waitcnt lgkmcnt(12)
    s_and_b32 s64, s64, 3
    v_mfma_f32_16x16x32_bf16 v[16:19], v[112:115], v[152:155], v[16:19]
    ds_read_b64_tr_b16 v[80:81], v204 offset:32768
    ds_read_b64_tr_b16 v[82:83], v204 offset:36864
    v_mfma_f32_16x16x32_bf16 v[48:51], v[112:115], v[156:159], v[48:51]
    buffer_load_dwordx4 v196, s[20:23], s40 offen offset:3072 lds
    v_mfma_f32_16x16x32_bf16 v[20:23], v[116:119], v[152:155], v[20:23]
    ds_read_b64_tr_b16 v[84:85], v205 offset:32768
    ds_read_b64_tr_b16 v[86:87], v205 offset:36864
    v_mfma_f32_16x16x32_bf16 v[52:55], v[116:119], v[156:159], v[52:55]
    s_waitcnt lgkmcnt(12)
    s_andn2_b32 s67, s63, 3
    v_mfma_f32_16x16x32_bf16 v[24:27], v[120:123], v[152:155], v[24:27]
    ds_read_b64_tr_b16 v[88:89], v206 offset:32768
    ds_read_b64_tr_b16 v[90:91], v206 offset:36864
    v_mfma_f32_16x16x32_bf16 v[56:59], v[120:123], v[156:159], v[56:59]
    buffer_load_dwordx4 v[188:191], v192, s[16:19], s39 offen offset:1024 sc1
    v_mfma_f32_16x16x32_bf16 v[28:31], v[124:127], v[152:155], v[28:31]
    ds_read_b64_tr_b16 v[92:93], v207 offset:32768
    ds_read_b64_tr_b16 v[94:95], v207 offset:36864
    v_mfma_f32_16x16x32_bf16 v[60:63], v[124:127], v[156:159], v[60:63]
    s_or_b32 s64, s64, s67
    s_add_u32 s63, s63, 1
    s_lshl_b32 s39, s64, 11
    s_lshl_b32 s40, s64, 17
    s_waitcnt lgkmcnt(12)
    v_mfma_f32_16x16x32_bf16 v[0:3], v[64:67], v[160:163], v[0:3]
    ds_read_b64_tr_b16 v[96:97], v200 offset:40960
    ds_read_b64_tr_b16 v[98:99], v200 offset:45056
    v_mfma_f32_16x16x32_bf16 v[32:35], v[64:67], v[164:167], v[32:35]
    s_mov_b32 m0, s44
    s_nop 0
    buffer_load_dwordx4 v193, s[20:23], s40 offen offset:0 lds
    v_mfma_f32_16x16x32_bf16 v[4:7], v[68:71], v[160:163], v[4:7]
    ds_read_b64_tr_b16 v[100:101], v201 offset:40960
    ds_read_b64_tr_b16 v[102:103], v201 offset:45056
    v_mfma_f32_16x16x32_bf16 v[36:39], v[68:71], v[164:167], v[36:39]
    s_waitcnt lgkmcnt(12)
    v_mfma_f32_16x16x32_bf16 v[8:11], v[72:75], v[160:163], v[8:11]
    ds_read_b64_tr_b16 v[104:105], v202 offset:40960
    ds_read_b64_tr_b16 v[106:107], v202 offset:45056
    v_mfma_f32_16x16x32_bf16 v[40:43], v[72:75], v[164:167], v[40:43]
    buffer_load_dwordx4 v[128:131], v192, s[12:15], s39 offen offset:0 sc1
    v_mfma_f32_16x16x32_bf16 v[12:15], v[76:79], v[160:163], v[12:15]
    ds_read_b64_tr_b16 v[108:109], v203 offset:40960
    ds_read_b64_tr_b16 v[110:111], v203 offset:45056
    v_mfma_f32_16x16x32_bf16 v[44:47], v[76:79], v[164:167], v[44:47]
    s_waitcnt lgkmcnt(12)
    v_mfma_f32_16x16x32_bf16 v[16:19], v[80:83], v[160:163], v[16:19]
    ds_read_b64_tr_b16 v[112:113], v204 offset:40960
    ds_read_b64_tr_b16 v[114:115], v204 offset:45056
    v_mfma_f32_16x16x32_bf16 v[48:51], v[80:83], v[164:167], v[48:51]
    buffer_load_dwordx4 v194, s[20:23], s40 offen offset:1024 lds
    v_mfma_f32_16x16x32_bf16 v[20:23], v[84:87], v[160:163], v[20:23]
    ds_read_b64_tr_b16 v[116:117], v205 offset:40960
    ds_read_b64_tr_b16 v[118:119], v205 offset:45056
    v_mfma_f32_16x16x32_bf16 v[52:55], v[84:87], v[164:167], v[52:55]
    s_waitcnt lgkmcnt(12)
    v_mfma_f32_16x16x32_bf16 v[24:27], v[88:91], v[160:163], v[24:27]
    ds_read_b64_tr_b16 v[120:121], v206 offset:40960
    ds_read_b64_tr_b16 v[122:123], v206 offset:45056
    v_mfma_f32_16x16x32_bf16 v[56:59], v[88:91], v[164:167], v[56:59]
    buffer_load_dwordx4 v[132:135], v192, s[16:19], s39 offen offset:0 sc1
    v_mfma_f32_16x16x32_bf16 v[28:31], v[92:95], v[160:163], v[28:31]
    ds_read_b64_tr_b16 v[124:125], v207 offset:40960
    ds_read_b64_tr_b16 v[126:127], v207 offset:45056
    v_mfma_f32_16x16x32_bf16 v[60:63], v[92:95], v[164:167], v[60:63]
    s_waitcnt vmcnt(12)
    s_waitcnt vmcnt(5)
    s_barrier
    s_waitcnt lgkmcnt(12)
    v_mfma_f32_16x16x32_bf16 v[0:3], v[96:99], v[168:171], v[0:3]
    ds_read_b64_tr_b16 v[64:65], v200 offset:49152
    ds_read_b64_tr_b16 v[66:67], v200 offset:53248
    v_mfma_f32_16x16x32_bf16 v[32:35], v[96:99], v[172:175], v[32:35]
    buffer_load_dwordx4 v195, s[20:23], s40 offen offset:2048 lds
    v_mfma_f32_16x16x32_bf16 v[4:7], v[100:103], v[168:171], v[4:7]
    ds_read_b64_tr_b16 v[68:69], v201 offset:49152
    ds_read_b64_tr_b16 v[70:71], v201 offset:53248
    v_mfma_f32_16x16x32_bf16 v[36:39], v[100:103], v[172:175], v[36:39]
    s_waitcnt lgkmcnt(12)
    s_add_u32 s64, s63, s62
    v_mfma_f32_16x16x32_bf16 v[8:11], v[104:107], v[168:171], v[8:11]
    ds_read_b64_tr_b16 v[72:73], v202 offset:49152
    ds_read_b64_tr_b16 v[74:75], v202 offset:53248
    v_mfma_f32_16x16x32_bf16 v[40:43], v[104:107], v[172:175], v[40:43]
    buffer_load_dwordx4 v[136:139], v192, s[12:15], s39 offen offset:1024 sc1
    v_mfma_f32_16x16x32_bf16 v[12:15], v[108:111], v[168:171], v[12:15]
    ds_read_b64_tr_b16 v[76:77], v203 offset:49152
    ds_read_b64_tr_b16 v[78:79], v203 offset:53248
    v_mfma_f32_16x16x32_bf16 v[44:47], v[108:111], v[172:175], v[44:47]
    s_waitcnt lgkmcnt(12)
    s_and_b32 s64, s64, 3
    v_mfma_f32_16x16x32_bf16 v[16:19], v[112:115], v[168:171], v[16:19]
    ds_read_b64_tr_b16 v[80:81], v204 offset:49152
    ds_read_b64_tr_b16 v[82:83], v204 offset:53248
    v_mfma_f32_16x16x32_bf16 v[48:51], v[112:115], v[172:175], v[48:51]
    buffer_load_dwordx4 v196, s[20:23], s40 offen offset:3072 lds
    v_mfma_f32_16x16x32_bf16 v[20:23], v[116:119], v[168:171], v[20:23]
    ds_read_b64_tr_b16 v[84:85], v205 offset:49152
    ds_read_b64_tr_b16 v[86:87], v205 offset:53248
    v_mfma_f32_16x16x32_bf16 v[52:55], v[116:119], v[172:175], v[52:55]
    s_waitcnt lgkmcnt(12)
    s_andn2_b32 s67, s63, 3
    v_mfma_f32_16x16x32_bf16 v[24:27], v[120:123], v[168:171], v[24:27]
    ds_read_b64_tr_b16 v[88:89], v206 offset:49152
    ds_read_b64_tr_b16 v[90:91], v206 offset:53248
    v_mfma_f32_16x16x32_bf16 v[56:59], v[120:123], v[172:175], v[56:59]
    buffer_load_dwordx4 v[140:143], v192, s[16:19], s39 offen offset:1024 sc1
    v_mfma_f32_16x16x32_bf16 v[28:31], v[124:127], v[168:171], v[28:31]
    ds_read_b64_tr_b16 v[92:93], v207 offset:49152
    ds_read_b64_tr_b16 v[94:95], v207 offset:53248
    v_mfma_f32_16x16x32_bf16 v[60:63], v[124:127], v[172:175], v[60:63]
    s_or_b32 s64, s64, s67
    s_add_u32 s63, s63, 1
    s_lshl_b32 s39, s64, 11
    s_lshl_b32 s40, s64, 17
    s_waitcnt lgkmcnt(12)
    v_mfma_f32_16x16x32_bf16 v[0:3], v[64:67], v[176:179], v[0:3]
    ds_read_b64_tr_b16 v[96:97], v200 offset:57344
    ds_read_b64_tr_b16 v[98:99], v200 offset:61440
    v_mfma_f32_16x16x32_bf16 v[32:35], v[64:67], v[180:183], v[32:35]
    s_mov_b32 m0, s45
    s_nop 0
    buffer_load_dwordx4 v193, s[20:23], s40 offen offset:0 lds
    v_mfma_f32_16x16x32_bf16 v[4:7], v[68:71], v[176:179], v[4:7]
    ds_read_b64_tr_b16 v[100:101], v201 offset:57344
    ds_read_b64_tr_b16 v[102:103], v201 offset:61440
    v_mfma_f32_16x16x32_bf16 v[36:39], v[68:71], v[180:183], v[36:39]
    s_waitcnt lgkmcnt(12)
    v_mfma_f32_16x16x32_bf16 v[8:11], v[72:75], v[176:179], v[8:11]
    ds_read_b64_tr_b16 v[104:105], v202 offset:57344
    ds_read_b64_tr_b16 v[106:107], v202 offset:61440
    v_mfma_f32_16x16x32_bf16 v[40:43], v[72:75], v[180:183], v[40:43]
    buffer_load_dwordx4 v[144:147], v192, s[12:15], s39 offen offset:0 sc1
    v_mfma_f32_16x16x32_bf16 v[12:15], v[76:79], v[176:179], v[12:15]
    ds_read_b64_tr_b16 v[108:109], v203 offset:57344
    ds_read_b64_tr_b16 v[110:111], v203 offset:61440
    v_mfma_f32_16x16x32_bf16 v[44:47], v[76:79], v[180:183], v[44:47]
    s_waitcnt lgkmcnt(12)
    v_mfma_f32_16x16x32_bf16 v[16:19], v[80:83], v[176:179], v[16:19]
    ds_read_b64_tr_b16 v[112:113], v204 offset:57344
    ds_read_b64_tr_b16 v[114:115], v204 offset:61440
    v_mfma_f32_16x16x32_bf16 v[48:51], v[80:83], v[180:183], v[48:51]
    buffer_load_dwordx4 v194, s[20:23], s40 offen offset:1024 lds
    v_mfma_f32_16x16x32_bf16 v[20:23], v[84:87], v[176:179], v[20:23]
    ds_read_b64_tr_b16 v[116:117], v205 offset:57344
    ds_read_b64_tr_b16 v[118:119], v205 offset:61440
    v_mfma_f32_16x16x32_bf16 v[52:55], v[84:87], v[180:183], v[52:55]
    s_waitcnt lgkmcnt(12)
    v_mfma_f32_16x16x32_bf16 v[24:27], v[88:91], v[176:179], v[24:27]
    ds_read_b64_tr_b16 v[120:121], v206 offset:57344
    ds_read_b64_tr_b16 v[122:123], v206 offset:61440
    v_mfma_f32_16x16x32_bf16 v[56:59], v[88:91], v[180:183], v[56:59]
    buffer_load_dwordx4 v[148:151], v192, s[16:19], s39 offen offset:0 sc1
    v_mfma_f32_16x16x32_bf16 v[28:31], v[92:95], v[176:179], v[28:31]
    ds_read_b64_tr_b16 v[124:125], v207 offset:57344
    ds_read_b64_tr_b16 v[126:127], v207 offset:61440
    v_mfma_f32_16x16x32_bf16 v[60:63], v[92:95], v[180:183], v[60:63]
    s_waitcnt vmcnt(12)
    s_waitcnt vmcnt(5)
    s_barrier
    s_waitcnt lgkmcnt(12)
    v_mfma_f32_16x16x32_bf16 v[0:3], v[96:99], v[184:187], v[0:3]
    ds_read_b64_tr_b16 v[64:65], v200 offset:0
    ds_read_b64_tr_b16 v[66:67], v200 offset:4096
    v_mfma_f32_16x16x32_bf16 v[32:35], v[96:99], v[188:191], v[32:35]
    buffer_load_dwordx4 v195, s[20:23], s40 offen offset:2048 lds
    v_mfma_f32_16x16x32_bf16 v[4:7], v[100:103], v[184:187], v[4:7]
    ds_read_b64_tr_b16 v[68:69], v201 offset:0
    ds_read_b64_tr_b16 v[70:71], v201 offset:4096
    v_mfma_f32_16x16x32_bf16 v[36:39], v[100:103], v[188:191], v[36:39]
    s_waitcnt lgkmcnt(12)
    s_add_u32 s64, s63, s62
    v_mfma_f32_16x16x32_bf16 v[8:11], v[104:107], v[184:187], v[8:11]
    ds_read_b64_tr_b16 v[72:73], v202 offset:0
    ds_read_b64_tr_b16 v[74:75], v202 offset:4096
    v_mfma_f32_16x16x32_bf16 v[40:43], v[104:107], v[188:191], v[40:43]
    buffer_load_dwordx4 v[152:155], v192, s[12:15], s39 offen offset:1024 sc1
    v_mfma_f32_16x16x32_bf16 v[12:15], v[108:111], v[184:187], v[12:15]
    ds_read_b64_tr_b16 v[76:77], v203 offset:0
    ds_read_b64_tr_b16 v[78:79], v203 offset:4096
    v_mfma_f32_16x16x32_bf16 v[44:47], v[108:111], v[188:191], v[44:47]
    s_waitcnt lgkmcnt(12)
    s_and_b32 s64, s64, 3
    v_mfma_f32_16x16x32_bf16 v[16:19], v[112:115], v[184:187], v[16:19]
    ds_read_b64_tr_b16 v[80:81], v204 offset:0
    ds_read_b64_tr_b16 v[82:83], v204 offset:4096
    v_mfma_f32_16x16x32_bf16 v[48:51], v[112:115], v[188:191], v[48:51]
    buffer_load_dwordx4 v196, s[20:23], s40 offen offset:3072 lds
    v_mfma_f32_16x16x32_bf16 v[20:23], v[116:119], v[184:187], v[20:23]
    ds_read_b64_tr_b16 v[84:85], v205 offset:0
    ds_read_b64_tr_b16 v[86:87], v205 offset:4096
    v_mfma_f32_16x16x32_bf16 v[52:55], v[116:119], v[188:191], v[52:55]
    s_waitcnt lgkmcnt(12)
    s_andn2_b32 s67, s63, 3
    v_mfma_f32_16x16x32_bf16 v[24:27], v[120:123], v[184:187], v[24:27]
    ds_read_b64_tr_b16 v[88:89], v206 offset:0
    ds_read_b64_tr_b16 v[90:91], v206 offset:4096
    v_mfma_f32_16x16x32_bf16 v[56:59], v[120:123], v[188:191], v[56:59]
    buffer_load_dwordx4 v[156:159], v192, s[16:19], s39 offen offset:1024 sc1
    v_mfma_f32_16x16x32_bf16 v[28:31], v[124:127], v[184:187], v[28:31]
    ds_read_b64_tr_b16 v[92:93], v207 offset:0
    ds_read_b64_tr_b16 v[94:95], v207 offset:4096
    v_mfma_f32_16x16x32_bf16 v[60:63], v[124:127], v[188:191], v[60:63]
    s_or_b32 s64, s64, s67
    s_add_u32 s63, s63, 1
    s_lshl_b32 s39, s64, 11
    s_lshl_b32 s40, s64, 17
    s_sub_u32 s41, s41, 1
    s_cmp_lg_u32 s41, 0
    s_cbranch_scc1 L_down_loop
    s_waitcnt lgkmcnt(0)
    s_nop 7
    s_lshl_b32 s42, s37, 3
    s_add_u32 s53, s42, s38
    s_lshl_b32 s42, s53, 15
    s_add_u32 s42, s42, 0x3800000
    s_add_u32 s16, s4, s42
    s_addc_u32 s17, s5, 0
    s_mov_b32 s18, 0x8000
    s_mov_b32 s19, 0x20000
    s_lshl_b32 s42, s49, 14
    s_lshl_b32 s43, s36, 12
    s_add_u32 s42, s42, s43
    s_xor_b32 s43, s42, 16384
    v_cvt_pk_bf16_f32 v64, v16, v17
    v_cvt_pk_bf16_f32 v65, v18, v19
    v_cvt_pk_bf16_f32 v66, v20, v21
    v_cvt_pk_bf16_f32 v67, v22, v23
    buffer_store_dwordx4 v[64:67], v192, s[16:19], s42 offen offset:0 sc1
    v_cvt_pk_bf16_f32 v68, v24, v25
    v_cvt_pk_bf16_f32 v69, v26, v27
    v_cvt_pk_bf16_f32 v70, v28, v29
    v_cvt_pk_bf16_f32 v71, v30, v31
    buffer_store_dwordx4 v[68:71], v192, s[16:19], s42 offen offset:1024 sc1
    v_cvt_pk_bf16_f32 v72, v48, v49
    v_cvt_pk_bf16_f32 v73, v50, v51
    v_cvt_pk_bf16_f32 v74, v52, v53
    v_cvt_pk_bf16_f32 v75, v54, v55
    buffer_store_dwordx4 v[72:75], v192, s[16:19], s42 offen offset:2048 sc1
    v_cvt_pk_bf16_f32 v76, v56, v57
    v_cvt_pk_bf16_f32 v77, v58, v59
    v_cvt_pk_bf16_f32 v78, v60, v61
    v_cvt_pk_bf16_f32 v79, v62, v63
    buffer_store_dwordx4 v[76:79], v192, s[16:19], s42 offen offset:3072 sc1
    s_waitcnt vmcnt(4)
    v_accvgpr_read_b32 v96, a16
    v_accvgpr_read_b32 v128, a32
    v_accvgpr_read_b32 v97, a17
    v_accvgpr_read_b32 v129, a33
    v_accvgpr_read_b32 v98, a18
    v_accvgpr_read_b32 v130, a34
    v_accvgpr_read_b32 v99, a19
    v_accvgpr_read_b32 v131, a35
    v_accvgpr_read_b32 v100, a20
    v_accvgpr_read_b32 v132, a36
    v_accvgpr_read_b32 v101, a21
    v_accvgpr_read_b32 v133, a37
    v_accvgpr_read_b32 v102, a22
    v_accvgpr_read_b32 v134, a38
    v_accvgpr_read_b32 v103, a23
    v_accvgpr_read_b32 v135, a39
    v_accvgpr_read_b32 v104, a24
    v_accvgpr_read_b32 v136, a40
    v_accvgpr_read_b32 v105, a25
    v_accvgpr_read_b32 v137, a41
    v_accvgpr_read_b32 v106, a26
    v_accvgpr_read_b32 v138, a42
    v_accvgpr_read_b32 v107, a27
    v_accvgpr_read_b32 v139, a43
    v_accvgpr_read_b32 v108, a28
    v_accvgpr_read_b32 v140, a44
    v_accvgpr_read_b32 v109, a29
    v_accvgpr_read_b32 v141, a45
    v_accvgpr_read_b32 v110, a30
    v_accvgpr_read_b32 v142, a46
    v_accvgpr_read_b32 v111, a31
    v_accvgpr_read_b32 v143, a47
    v_add_f32 v96, v96, v128
    v_add_f32 v97, v97, v129
    v_add_f32 v98, v98, v130
    v_add_f32 v99, v99, v131
    v_add_f32 v100, v100, v132
    v_add_f32 v101, v101, v133
    v_add_f32 v102, v102, v134
    v_add_f32 v103, v103, v135
    v_add_f32 v104, v104, v136
    v_add_f32 v105, v105, v137
    v_add_f32 v106, v106, v138
    v_add_f32 v107, v107, v139
    v_add_f32 v108, v108, v140
    v_add_f32 v109, v109, v141
    v_add_f32 v110, v110, v142
    v_add_f32 v111, v111, v143
    v_cvt_pk_bf16_f32 v144, v96, v97
    v_lshlrev_b32 v96, 16, v144
    v_and_b32 v97, 0xffff0000, v144
    v_cvt_pk_bf16_f32 v145, v98, v99
    v_lshlrev_b32 v98, 16, v145
    v_and_b32 v99, 0xffff0000, v145
    v_cvt_pk_bf16_f32 v144, v100, v101
    v_lshlrev_b32 v100, 16, v144
    v_and_b32 v101, 0xffff0000, v144
    v_cvt_pk_bf16_f32 v145, v102, v103
    v_lshlrev_b32 v102, 16, v145
    v_and_b32 v103, 0xffff0000, v145
    v_cvt_pk_bf16_f32 v144, v104, v105
    v_lshlrev_b32 v104, 16, v144
    v_and_b32 v105, 0xffff0000, v144
    v_cvt_pk_bf16_f32 v145, v106, v107
    v_lshlrev_b32 v106, 16, v145
    v_and_b32 v107, 0xffff0000, v145
    v_cvt_pk_bf16_f32 v144, v108, v109
    v_lshlrev_b32 v108, 16, v144
    v_and_b32 v109, 0xffff0000, v144
    v_cvt_pk_bf16_f32 v145, v110, v111
    v_lshlrev_b32 v110, 16, v145
    v_and_b32 v111, 0xffff0000, v145
    v_accvgpr_read_b32 v112, a0
    v_accvgpr_read_b32 v113, a1
    v_accvgpr_read_b32 v114, a2
    v_accvgpr_read_b32 v115, a3
    v_accvgpr_read_b32 v116, a4
    v_accvgpr_read_b32 v117, a5
    v_accvgpr_read_b32 v118, a6
    v_accvgpr_read_b32 v119, a7
    v_accvgpr_read_b32 v120, a8
    v_accvgpr_read_b32 v121, a9
    v_accvgpr_read_b32 v122, a10
    v_accvgpr_read_b32 v123, a11
    v_accvgpr_read_b32 v124, a12
    v_accvgpr_read_b32 v125, a13
    v_accvgpr_read_b32 v126, a14
    v_accvgpr_read_b32 v127, a15
    s_add_u32 s54, s53, 64
    s_waitcnt vmcnt(0)
    s_barrier
    s_cmp_lg_u32 s94, 0
    s_cbranch_scc1 L_down_x_nosig
    s_add_u32 s88, s4, 0x60000
    s_addc_u32 s89, s5, 0
    s_mov_b32 s90, 0x6800
    s_mov_b32 s91, 0x20000
    s_lshl_b32 s92, s54, 7
    v_mov_b32 v252, s92
    v_mov_b32 v253, 1
    s_mov_b64 s[92:93], exec
    s_mov_b64 exec, 1
    buffer_atomic_add v253, v252, s[88:91], 0 offen
    s_mov_b64 exec, s[92:93]
L_down_x_nosig:
    s_cmp_lg_u32 s94, 0
    s_cbranch_scc1 L_down_x_wgo
    s_add_u32 s88, s4, 0x60000
    s_addc_u32 s89, s5, 0
    s_mov_b32 s90, 0x6800
    s_mov_b32 s91, 0x20000
    s_lshl_b32 s92, s54, 7
    v_mov_b32 v252, s92
    s_mov_b64 s[92:93], exec
    s_mov_b64 exec, 1
    s_mov_b32 s3, 0x40000
L_down_x_wpoll:
    buffer_load_dword v253, v252, s[88:91], 0 offen sc1
    s_waitcnt vmcnt(0)
    v_cmp_ne_u32 vcc, 2, v253
    s_cbranch_vccz L_down_x_wdone
    s_sleep 1
    s_sub_u32 s3, s3, 1
    s_cmp_lg_u32 s3, 0
    s_cbranch_scc1 L_down_x_wpoll
L_down_x_wdone:
    s_mov_b64 exec, s[92:93]
L_down_x_wgo:
    s_barrier
    v_mov_b32 v252, 0x7f000000
    buffer_load_dwordx4 v[128:131], v192, s[16:19], s43 offen offset:0 sc1
    buffer_load_dwordx4 v[132:135], v192, s[16:19], s43 offen offset:1024 sc1
    buffer_load_dwordx4 v[136:139], v192, s[16:19], s43 offen offset:2048 sc1
    buffer_load_dwordx4 v[140:143], v192, s[16:19], s43 offen offset:3072 sc1
    s_waitcnt vmcnt(3)
    v_lshlrev_b32 v144, 16, v128
    v_and_b32 v145, 0xffff0000, v128
    v_lshlrev_b32 v146, 16, v129
    v_and_b32 v147, 0xffff0000, v129
    v_add_f32 v144, v144, v0
    v_add_f32 v145, v145, v1
    v_add_f32 v146, v146, v2
    v_add_f32 v147, v147, v3
    v_cvt_pk_bf16_f32 v152, v144, v145
    v_lshlrev_b32 v144, 16, v152
    v_and_b32 v145, 0xffff0000, v152
    v_cvt_pk_bf16_f32 v153, v146, v147
    v_lshlrev_b32 v146, 16, v153
    v_and_b32 v147, 0xffff0000, v153
    v_mul_f32 v144, v144, v96
    v_mul_f32 v145, v145, v97
    v_mul_f32 v146, v146, v98
    v_mul_f32 v147, v147, v99
    v_cvt_pk_bf16_f32 v152, v144, v145
    v_lshlrev_b32 v144, 16, v152
    v_and_b32 v145, 0xffff0000, v152
    v_cvt_pk_bf16_f32 v153, v146, v147
    v_lshlrev_b32 v146, 16, v153
    v_and_b32 v147, 0xffff0000, v153
    v_lshlrev_b32 v148, 16, v112
    v_and_b32 v149, 0xffff0000, v112
    v_lshlrev_b32 v150, 16, v113
    v_and_b32 v151, 0xffff0000, v113
    v_add_f32 v144, v144, v148
    v_add_f32 v145, v145, v149
    v_add_f32 v146, v146, v150
    v_add_f32 v147, v147, v151
    v_cvt_pk_bf16_f32 v112, v144, v145
    v_cvt_pk_bf16_f32 v113, v146, v147
    v_lshlrev_b32 v156, 16, v130
    v_and_b32 v157, 0xffff0000, v130
    v_lshlrev_b32 v158, 16, v131
    v_and_b32 v159, 0xffff0000, v131
    v_add_f32 v156, v156, v4
    v_add_f32 v157, v157, v5
    v_add_f32 v158, v158, v6
    v_add_f32 v159, v159, v7
    v_cvt_pk_bf16_f32 v164, v156, v157
    v_lshlrev_b32 v156, 16, v164
    v_and_b32 v157, 0xffff0000, v164
    v_cvt_pk_bf16_f32 v165, v158, v159
    v_lshlrev_b32 v158, 16, v165
    v_and_b32 v159, 0xffff0000, v165
    v_mul_f32 v156, v156, v100
    v_mul_f32 v157, v157, v101
    v_mul_f32 v158, v158, v102
    v_mul_f32 v159, v159, v103
    v_cvt_pk_bf16_f32 v164, v156, v157
    v_lshlrev_b32 v156, 16, v164
    v_and_b32 v157, 0xffff0000, v164
    v_cvt_pk_bf16_f32 v165, v158, v159
    v_lshlrev_b32 v158, 16, v165
    v_and_b32 v159, 0xffff0000, v165
    v_lshlrev_b32 v160, 16, v114
    v_and_b32 v161, 0xffff0000, v114
    v_lshlrev_b32 v162, 16, v115
    v_and_b32 v163, 0xffff0000, v115
    v_add_f32 v156, v156, v160
    v_add_f32 v157, v157, v161
    v_add_f32 v158, v158, v162
    v_add_f32 v159, v159, v163
    v_cvt_pk_bf16_f32 v114, v156, v157
    v_cvt_pk_bf16_f32 v115, v158, v159
    s_nop 0
    v_permlane16_swap_b32 v112, v114
    v_permlane16_swap_b32 v113, v115
    buffer_store_dwordx4 v[112:115], v208, s[28:31], 0 offen offset:0 sc1
    s_waitcnt vmcnt(3)
    v_lshlrev_b32 v144, 16, v132
    v_and_b32 v145, 0xffff0000, v132
    v_lshlrev_b32 v146, 16, v133
    v_and_b32 v147, 0xffff0000, v133
    v_add_f32 v144, v144, v8
    v_add_f32 v145, v145, v9
    v_add_f32 v146, v146, v10
    v_add_f32 v147, v147, v11
    v_cvt_pk_bf16_f32 v152, v144, v145
    v_lshlrev_b32 v144, 16, v152
    v_and_b32 v145, 0xffff0000, v152
    v_cvt_pk_bf16_f32 v153, v146, v147
    v_lshlrev_b32 v146, 16, v153
    v_and_b32 v147, 0xffff0000, v153
    v_mul_f32 v144, v144, v104
    v_mul_f32 v145, v145, v105
    v_mul_f32 v146, v146, v106
    v_mul_f32 v147, v147, v107
    v_cvt_pk_bf16_f32 v152, v144, v145
    v_lshlrev_b32 v144, 16, v152
    v_and_b32 v145, 0xffff0000, v152
    v_cvt_pk_bf16_f32 v153, v146, v147
    v_lshlrev_b32 v146, 16, v153
    v_and_b32 v147, 0xffff0000, v153
    v_lshlrev_b32 v148, 16, v116
    v_and_b32 v149, 0xffff0000, v116
    v_lshlrev_b32 v150, 16, v117
    v_and_b32 v151, 0xffff0000, v117
    v_add_f32 v144, v144, v148
    v_add_f32 v145, v145, v149
    v_add_f32 v146, v146, v150
    v_add_f32 v147, v147, v151
    v_cvt_pk_bf16_f32 v116, v144, v145
    v_cvt_pk_bf16_f32 v117, v146, v147
    v_lshlrev_b32 v156, 16, v134
    v_and_b32 v157, 0xffff0000, v134
    v_lshlrev_b32 v158, 16, v135
    v_and_b32 v159, 0xffff0000, v135
    v_add_f32 v156, v156, v12
    v_add_f32 v157, v157, v13
    v_add_f32 v158, v158, v14
    v_add_f32 v159, v159, v15
    v_cvt_pk_bf16_f32 v164, v156, v157
    v_lshlrev_b32 v156, 16, v164
    v_and_b32 v157, 0xffff0000, v164
    v_cvt_pk_bf16_f32 v165, v158, v159
    v_lshlrev_b32 v158, 16, v165
    v_and_b32 v159, 0xffff0000, v165
    v_mul_f32 v156, v156, v108
    v_mul_f32 v157, v157, v109
    v_mul_f32 v158, v158, v110
    v_mul_f32 v159, v159, v111
    v_cvt_pk_bf16_f32 v164, v156, v157
    v_lshlrev_b32 v156, 16, v164
    v_and_b32 v157, 0xffff0000, v164
    v_cvt_pk_bf16_f32 v165, v158, v159
    v_lshlrev_b32 v158, 16, v165
    v_and_b32 v159, 0xffff0000, v165
    v_lshlrev_b32 v160, 16, v118
    v_and_b32 v161, 0xffff0000, v118
    v_lshlrev_b32 v162, 16, v119
    v_and_b32 v163, 0xffff0000, v119
    v_add_f32 v156, v156, v160
    v_add_f32 v157, v157, v161
    v_add_f32 v158, v158, v162
    v_add_f32 v159, v159, v163
    v_cvt_pk_bf16_f32 v118, v156, v157
    v_cvt_pk_bf16_f32 v119, v158, v159
    s_nop 0
    v_permlane16_swap_b32 v116, v118
    v_permlane16_swap_b32 v117, v119
    buffer_store_dwordx4 v[116:119], v208, s[28:31], 0 offen offset:64 sc1
    s_waitcnt vmcnt(3)
    v_lshlrev_b32 v144, 16, v136
    v_and_b32 v145, 0xffff0000, v136
    v_lshlrev_b32 v146, 16, v137
    v_and_b32 v147, 0xffff0000, v137
    v_add_f32 v144, v144, v32
    v_add_f32 v145, v145, v33
    v_add_f32 v146, v146, v34
    v_add_f32 v147, v147, v35
    v_cvt_pk_bf16_f32 v152, v144, v145
    v_lshlrev_b32 v144, 16, v152
    v_and_b32 v145, 0xffff0000, v152
    v_cvt_pk_bf16_f32 v153, v146, v147
    v_lshlrev_b32 v146, 16, v153
    v_and_b32 v147, 0xffff0000, v153
    v_mul_f32 v144, v144, v96
    v_mul_f32 v145, v145, v97
    v_mul_f32 v146, v146, v98
    v_mul_f32 v147, v147, v99
    v_cvt_pk_bf16_f32 v152, v144, v145
    v_lshlrev_b32 v144, 16, v152
    v_and_b32 v145, 0xffff0000, v152
    v_cvt_pk_bf16_f32 v153, v146, v147
    v_lshlrev_b32 v146, 16, v153
    v_and_b32 v147, 0xffff0000, v153
    v_lshlrev_b32 v148, 16, v120
    v_and_b32 v149, 0xffff0000, v120
    v_lshlrev_b32 v150, 16, v121
    v_and_b32 v151, 0xffff0000, v121
    v_add_f32 v144, v144, v148
    v_add_f32 v145, v145, v149
    v_add_f32 v146, v146, v150
    v_add_f32 v147, v147, v151
    v_cvt_pk_bf16_f32 v120, v144, v145
    v_cvt_pk_bf16_f32 v121, v146, v147
    v_lshlrev_b32 v156, 16, v138
    v_and_b32 v157, 0xffff0000, v138
    v_lshlrev_b32 v158, 16, v139
    v_and_b32 v159, 0xffff0000, v139
    v_add_f32 v156, v156, v36
    v_add_f32 v157, v157, v37
    v_add_f32 v158, v158, v38
    v_add_f32 v159, v159, v39
    v_cvt_pk_bf16_f32 v164, v156, v157
    v_lshlrev_b32 v156, 16, v164
    v_and_b32 v157, 0xffff0000, v164
    v_cvt_pk_bf16_f32 v165, v158, v159
    v_lshlrev_b32 v158, 16, v165
    v_and_b32 v159, 0xffff0000, v165
    v_mul_f32 v156, v156, v100
    v_mul_f32 v157, v157, v101
    v_mul_f32 v158, v158, v102
    v_mul_f32 v159, v159, v103
    v_cvt_pk_bf16_f32 v164, v156, v157
    v_lshlrev_b32 v156, 16, v164
    v_and_b32 v157, 0xffff0000, v164
    v_cvt_pk_bf16_f32 v165, v158, v159
    v_lshlrev_b32 v158, 16, v165
    v_and_b32 v159, 0xffff0000, v165
    v_lshlrev_b32 v160, 16, v122
    v_and_b32 v161, 0xffff0000, v122
    v_lshlrev_b32 v162, 16, v123
    v_and_b32 v163, 0xffff0000, v123
    v_add_f32 v156, v156, v160
    v_add_f32 v157, v157, v161
    v_add_f32 v158, v158, v162
    v_add_f32 v159, v159, v163
    v_cvt_pk_bf16_f32 v122, v156, v157
    v_cvt_pk_bf16_f32 v123, v158, v159
    s_nop 0
    v_permlane16_swap_b32 v120, v122
    v_permlane16_swap_b32 v121, v123
    buffer_store_dwordx4 v[120:123], v208, s[28:31], s48 offen offset:0 sc1
    s_waitcnt vmcnt(3)
    v_lshlrev_b32 v144, 16, v140
    v_and_b32 v145, 0xffff0000, v140
    v_lshlrev_b32 v146, 16, v141
    v_and_b32 v147, 0xffff0000, v141
    v_add_f32 v144, v144, v40
    v_add_f32 v145, v145, v41
    v_add_f32 v146, v146, v42
    v_add_f32 v147, v147, v43
    v_cvt_pk_bf16_f32 v152, v144, v145
    v_lshlrev_b32 v144, 16, v152
    v_and_b32 v145, 0xffff0000, v152
    v_cvt_pk_bf16_f32 v153, v146, v147
    v_lshlrev_b32 v146, 16, v153
    v_and_b32 v147, 0xffff0000, v153
    v_mul_f32 v144, v144, v104
    v_mul_f32 v145, v145, v105
    v_mul_f32 v146, v146, v106
    v_mul_f32 v147, v147, v107
    v_cvt_pk_bf16_f32 v152, v144, v145
    v_lshlrev_b32 v144, 16, v152
    v_and_b32 v145, 0xffff0000, v152
    v_cvt_pk_bf16_f32 v153, v146, v147
    v_lshlrev_b32 v146, 16, v153
    v_and_b32 v147, 0xffff0000, v153
    v_lshlrev_b32 v148, 16, v124
    v_and_b32 v149, 0xffff0000, v124
    v_lshlrev_b32 v150, 16, v125
    v_and_b32 v151, 0xffff0000, v125
    v_add_f32 v144, v144, v148
    v_add_f32 v145, v145, v149
    v_add_f32 v146, v146, v150
    v_add_f32 v147, v147, v151
    v_cvt_pk_bf16_f32 v124, v144, v145
    v_cvt_pk_bf16_f32 v125, v146, v147
    v_lshlrev_b32 v156, 16, v142
    v_and_b32 v157, 0xffff0000, v142
    v_lshlrev_b32 v158, 16, v143
    v_and_b32 v159, 0xffff0000, v143
    v_add_f32 v156, v156, v44
    v_add_f32 v157, v157, v45
    v_add_f32 v158, v158, v46
    v_add_f32 v159, v159, v47
    v_cvt_pk_bf16_f32 v164, v156, v157
    v_lshlrev_b32 v156, 16, v164
    v_and_b32 v157, 0xffff0000, v164
    v_cvt_pk_bf16_f32 v165, v158, v159
    v_lshlrev_b32 v158, 16, v165
    v_and_b32 v159, 0xffff0000, v165
    v_mul_f32 v156, v156, v108
    v_mul_f32 v157, v157, v109
    v_mul_f32 v158, v158, v110
    v_mul_f32 v159, v159, v111
    v_cvt_pk_bf16_f32 v164, v156, v157
    v_lshlrev_b32 v156, 16, v164
    v_and_b32 v157, 0xffff0000, v164
    v_cvt_pk_bf16_f32 v165, v158, v159
    v_lshlrev_b32 v158, 16, v165
    v_and_b32 v159, 0xffff0000, v165
    v_lshlrev_b32 v160, 16, v126
    v_and_b32 v161, 0xffff0000, v126
    v_lshlrev_b32 v162, 16, v127
    v_and_b32 v163, 0xffff0000, v127
    v_add_f32 v156, v156, v160
    v_add_f32 v157, v157, v161
    v_add_f32 v158, v158, v162
    v_add_f32 v159, v159, v163
    v_cvt_pk_bf16_f32 v126, v156, v157
    v_cvt_pk_bf16_f32 v127, v158, v159
    s_nop 0
    v_permlane16_swap_b32 v124, v126
    v_permlane16_swap_b32 v125, v127
    buffer_store_dwordx4 v[124:127], v208, s[28:31], s48 offen offset:64 sc1
L_main_done:
    s_endpgm
L_attn_r0_0:
    s_call_b64 s[58:59], L_attn_rare0_0
    s_branch L_attn_r0_0_back
L_attn_r0_1:
    s_call_b64 s[58:59], L_attn_rare0_1
    s_branch L_attn_r0_1_back
L_attn_r1_0:
    s_call_b64 s[58:59], L_attn_rare1_0
    s_branch L_attn_r1_0_back
L_attn_r1_1:
    s_call_b64 s[58:59], L_attn_rare1_1
    s_branch L_attn_r1_1_back
L_attn_r2_0:
    s_call_b64 s[58:59], L_attn_rare0_0
    s_branch L_attn_r2_0_back
L_attn_r2_1:
    s_call_b64 s[58:59], L_attn_rare0_1
    s_branch L_attn_r2_1_back
L_attn_r3_0:
    s_call_b64 s[58:59], L_attn_rare1_0
    s_branch L_attn_r3_0_back
L_attn_r3_1:
    s_call_b64 s[58:59], L_attn_rare1_1
    s_branch L_attn_r3_1_back
L_attn_r4_0:
    s_call_b64 s[58:59], L_attn_rare0_0
    s_branch L_attn_r4_0_back
L_attn_r4_1:
    s_call_b64 s[58:59], L_attn_rare0_1
    s_branch L_attn_r4_1_back
L_attn_r5_0:
    s_call_b64 s[58:59], L_attn_rare1_0
    s_branch L_attn_r5_0_back
L_attn_r5_1:
    s_call_b64 s[58:59], L_attn_rare1_1
    s_branch L_attn_r5_1_back
L_attn_r6_0:
    s_call_b64 s[58:59], L_attn_rare0_0
    s_branch L_attn_r6_0_back
L_attn_r6_1:
    s_call_b64 s[58:59], L_attn_rare0_1
    s_branch L_attn_r6_1_back
L_attn_r7_0:
    s_call_b64 s[58:59], L_attn_rare1_0
    s_branch L_attn_r7_0_back
L_attn_r7_1:
    s_call_b64 s[58:59], L_attn_rare1_1
    s_branch L_attn_r7_1_back
L_attn_rare0_0:
    s_nop 15
    v_max3_f32 v188, v0, v1, v2
    v_max3_f32 v188, v188, v3, v4
    v_max3_f32 v188, v188, v5, v6
    v_max_f32 v188, v188, v7
    v_mov_b32 v189, v188
    s_nop 1
    v_permlane16_swap_b32 v188, v189
    v_max_f32 v188, v188, v189
    v_mov_b32 v189, v188
    s_nop 1
    v_permlane32_swap_b32 v188, v189
    v_max_f32 v188, v188, v189
    v_add_f32 v188, 0x42cc0000, v188
    v_max_f32 v188, 0, v188
    v_sub_f32 v0, v0, v188
    v_sub_f32 v1, v1, v188
    v_sub_f32 v2, v2, v188
    v_sub_f32 v3, v3, v188
    v_sub_f32 v4, v4, v188
    v_sub_f32 v5, v5, v188
    v_sub_f32 v6, v6, v188
    v_sub_f32 v7, v7, v188
    v_sub_f32 v32, v32, v188
    v_sub_f32 v33, v33, v188
    v_sub_f32 v34, v34, v188
    v_sub_f32 v35, v35, v188
    v_sub_f32 v36, v36, v188
    v_sub_f32 v37, v37, v188
    v_sub_f32 v38, v38, v188
    v_sub_f32 v39, v39, v188
    v_sub_f32 v96, v96, v188
    v_sub_f32 v97, v97, v188
    v_sub_f32 v98, v98, v188
    v_sub_f32 v99, v99, v188
    v_sub_f32 v189, 0, v188
    v_exp_f32 v189, v189
    s_nop 0
    v_mul_f32 v116, v116, v189
    v_accvgpr_read_b32 v176, a0
    v_mul_f32 v176, v176, v189
    v_accvgpr_write_b32 a0, v176
    v_accvgpr_read_b32 v177, a1
    v_mul_f32 v177, v177, v189
    v_accvgpr_write_b32 a1, v177
    v_accvgpr_read_b32 v178, a2
    v_mul_f32 v178, v178, v189
    v_accvgpr_write_b32 a2, v178
    v_accvgpr_read_b32 v179, a3
    v_mul_f32 v179, v179, v189
    v_accvgpr_write_b32 a3, v179
    v_accvgpr_read_b32 v176, a4
    v_mul_f32 v176, v176, v189
    v_accvgpr_write_b32 a4, v176
    v_accvgpr_read_b32 v177, a5
    v_mul_f32 v177, v177, v189
    v_accvgpr_write_b32 a5, v177
    v_accvgpr_read_b32 v178, a6
    v_mul_f32 v178, v178, v189
    v_accvgpr_write_b32 a6, v178
    v_accvgpr_read_b32 v179, a7
    v_mul_f32 v179, v179, v189
    v_accvgpr_write_b32 a7, v179
    v_accvgpr_read_b32 v176, a8
    v_mul_f32 v176, v176, v189
    v_accvgpr_write_b32 a8, v176
    v_accvgpr_read_b32 v177, a9
    v_mul_f32 v177, v177, v189
    v_accvgpr_write_b32 a9, v177
    v_accvgpr_read_b32 v178, a10
    v_mul_f32 v178, v178, v189
    v_accvgpr_write_b32 a10, v178
    v_accvgpr_read_b32 v179, a11
    v_mul_f32 v179, v179, v189
    v_accvgpr_write_b32 a11, v179
    v_accvgpr_read_b32 v176, a12
    v_mul_f32 v176, v176, v189
    v_accvgpr_write_b32 a12, v176
    v_accvgpr_read_b32 v177, a13
    v_mul_f32 v177, v177, v189
    v_accvgpr_write_b32 a13, v177
    v_accvgpr_read_b32 v178, a14
    v_mul_f32 v178, v178, v189
    v_accvgpr_write_b32 a14, v178
    v_accvgpr_read_b32 v179, a15
    v_mul_f32 v179, v179, v189
    v_accvgpr_write_b32 a15, v179
    v_accvgpr_read_b32 v176, a16
    v_mul_f32 v176, v176, v189
    v_accvgpr_write_b32 a16, v176
    v_accvgpr_read_b32 v177, a17
    v_mul_f32 v177, v177, v189
    v_accvgpr_write_b32 a17, v177
    v_accvgpr_read_b32 v178, a18
    v_mul_f32 v178, v178, v189
    v_accvgpr_write_b32 a18, v178
    v_accvgpr_read_b32 v179, a19
    v_mul_f32 v179, v179, v189
    v_accvgpr_write_b32 a19, v179
    v_accvgpr_read_b32 v176, a20
    v_mul_f32 v176, v176, v189
    v_accvgpr_write_b32 a20, v176
    v_accvgpr_read_b32 v177, a21
    v_mul_f32 v177, v177, v189
    v_accvgpr_write_b32 a21, v177
    v_accvgpr_read_b32 v178, a22
    v_mul_f32 v178, v178, v189
    v_accvgpr_write_b32 a22, v178
    v_accvgpr_read_b32 v179, a23
    v_mul_f32 v179, v179, v189
    v_accvgpr_write_b32 a23, v179
    v_accvgpr_read_b32 v176, a24
    v_mul_f32 v176, v176, v189
    v_accvgpr_write_b32 a24, v176
    v_accvgpr_read_b32 v177, a25
    v_mul_f32 v177, v177, v189
    v_accvgpr_write_b32 a25, v177
    v_accvgpr_read_b32 v178, a26
    v_mul_f32 v178, v178, v189
    v_accvgpr_write_b32 a26, v178
    v_accvgpr_read_b32 v179, a27
    v_mul_f32 v179, v179, v189
    v_accvgpr_write_b32 a27, v179
    v_accvgpr_read_b32 v176, a28
    v_mul_f32 v176, v176, v189
    v_accvgpr_write_b32 a28, v176
    v_accvgpr_read_b32 v177, a29
    v_mul_f32 v177, v177, v189
    v_accvgpr_write_b32 a29, v177
    v_accvgpr_read_b32 v178, a30
    v_mul_f32 v178, v178, v189
    v_accvgpr_write_b32 a30, v178
    v_accvgpr_read_b32 v179, a31
    v_mul_f32 v179, v179, v189
    v_accvgpr_write_b32 a31, v179
    v_exp_f32 v180, v0
    v_exp_f32 v181, v1
    s_nop 0
    v_add_f32 v112, v180, v181
    v_cvt_pk_bf16_f32 v64, v180, v181
    v_exp_f32 v182, v2
    v_exp_f32 v183, v3
    s_nop 0
    v_add_f32 v112, v112, v182
    v_add_f32 v112, v112, v183
    v_cvt_pk_bf16_f32 v65, v182, v183
    v_exp_f32 v180, v4
    v_exp_f32 v181, v5
    s_nop 0
    v_add_f32 v112, v112, v180
    v_add_f32 v112, v112, v181
    v_cvt_pk_bf16_f32 v66, v180, v181
    v_exp_f32 v182, v6
    v_exp_f32 v183, v7
    s_nop 0
    v_add_f32 v112, v112, v182
    v_add_f32 v112, v112, v183
    v_cvt_pk_bf16_f32 v67, v182, v183
    v_max3_f32 v188, v8, v9, v10
    v_max3_f32 v188, v188, v11, v12
    v_max3_f32 v188, v188, v13, v14
    v_max_f32 v188, v188, v15
    v_mov_b32 v189, v188
    s_nop 1
    v_permlane16_swap_b32 v188, v189
    v_max_f32 v188, v188, v189
    v_mov_b32 v189, v188
    s_nop 1
    v_permlane32_swap_b32 v188, v189
    v_max_f32 v188, v188, v189
    v_add_f32 v188, 0x42cc0000, v188
    v_max_f32 v188, 0, v188
    v_sub_f32 v8, v8, v188
    v_sub_f32 v9, v9, v188
    v_sub_f32 v10, v10, v188
    v_sub_f32 v11, v11, v188
    v_sub_f32 v12, v12, v188
    v_sub_f32 v13, v13, v188
    v_sub_f32 v14, v14, v188
    v_sub_f32 v15, v15, v188
    v_sub_f32 v40, v40, v188
    v_sub_f32 v41, v41, v188
    v_sub_f32 v42, v42, v188
    v_sub_f32 v43, v43, v188
    v_sub_f32 v44, v44, v188
    v_sub_f32 v45, v45, v188
    v_sub_f32 v46, v46, v188
    v_sub_f32 v47, v47, v188
    v_sub_f32 v100, v100, v188
    v_sub_f32 v101, v101, v188
    v_sub_f32 v102, v102, v188
    v_sub_f32 v103, v103, v188
    v_sub_f32 v189, 0, v188
    v_exp_f32 v189, v189
    s_nop 0
    v_mul_f32 v117, v117, v189
    v_accvgpr_read_b32 v176, a32
    v_mul_f32 v176, v176, v189
    v_accvgpr_write_b32 a32, v176
    v_accvgpr_read_b32 v177, a33
    v_mul_f32 v177, v177, v189
    v_accvgpr_write_b32 a33, v177
    v_accvgpr_read_b32 v178, a34
    v_mul_f32 v178, v178, v189
    v_accvgpr_write_b32 a34, v178
    v_accvgpr_read_b32 v179, a35
    v_mul_f32 v179, v179, v189
    v_accvgpr_write_b32 a35, v179
    v_accvgpr_read_b32 v176, a36
    v_mul_f32 v176, v176, v189
    v_accvgpr_write_b32 a36, v176
    v_accvgpr_read_b32 v177, a37
    v_mul_f32 v177, v177, v189
    v_accvgpr_write_b32 a37, v177
    v_accvgpr_read_b32 v178, a38
    v_mul_f32 v178, v178, v189
    v_accvgpr_write_b32 a38, v178
    v_accvgpr_read_b32 v179, a39
    v_mul_f32 v179, v179, v189
    v_accvgpr_write_b32 a39, v179
    v_accvgpr_read_b32 v176, a40
    v_mul_f32 v176, v176, v189
    v_accvgpr_write_b32 a40, v176
    v_accvgpr_read_b32 v177, a41
    v_mul_f32 v177, v177, v189
    v_accvgpr_write_b32 a41, v177
    v_accvgpr_read_b32 v178, a42
    v_mul_f32 v178, v178, v189
    v_accvgpr_write_b32 a42, v178
    v_accvgpr_read_b32 v179, a43
    v_mul_f32 v179, v179, v189
    v_accvgpr_write_b32 a43, v179
    v_accvgpr_read_b32 v176, a44
    v_mul_f32 v176, v176, v189
    v_accvgpr_write_b32 a44, v176
    v_accvgpr_read_b32 v177, a45
    v_mul_f32 v177, v177, v189
    v_accvgpr_write_b32 a45, v177
    v_accvgpr_read_b32 v178, a46
    v_mul_f32 v178, v178, v189
    v_accvgpr_write_b32 a46, v178
    v_accvgpr_read_b32 v179, a47
    v_mul_f32 v179, v179, v189
    v_accvgpr_write_b32 a47, v179
    v_accvgpr_read_b32 v176, a48
    v_mul_f32 v176, v176, v189
    v_accvgpr_write_b32 a48, v176
    v_accvgpr_read_b32 v177, a49
    v_mul_f32 v177, v177, v189
    v_accvgpr_write_b32 a49, v177
    v_accvgpr_read_b32 v178, a50
    v_mul_f32 v178, v178, v189
    v_accvgpr_write_b32 a50, v178
    v_accvgpr_read_b32 v179, a51
    v_mul_f32 v179, v179, v189
    v_accvgpr_write_b32 a51, v179
    v_accvgpr_read_b32 v176, a52
    v_mul_f32 v176, v176, v189
    v_accvgpr_write_b32 a52, v176
    v_accvgpr_read_b32 v177, a53
    v_mul_f32 v177, v177, v189
    v_accvgpr_write_b32 a53, v177
    v_accvgpr_read_b32 v178, a54
    v_mul_f32 v178, v178, v189
    v_accvgpr_write_b32 a54, v178
    v_accvgpr_read_b32 v179, a55
    v_mul_f32 v179, v179, v189
    v_accvgpr_write_b32 a55, v179
    v_accvgpr_read_b32 v176, a56
    v_mul_f32 v176, v176, v189
    v_accvgpr_write_b32 a56, v176
    v_accvgpr_read_b32 v177, a57
    v_mul_f32 v177, v177, v189
    v_accvgpr_write_b32 a57, v177
    v_accvgpr_read_b32 v178, a58
    v_mul_f32 v178, v178, v189
    v_accvgpr_write_b32 a58, v178
    v_accvgpr_read_b32 v179, a59
    v_mul_f32 v179, v179, v189
    v_accvgpr_write_b32 a59, v179
    v_accvgpr_read_b32 v176, a60
    v_mul_f32 v176, v176, v189
    v_accvgpr_write_b32 a60, v176
    v_accvgpr_read_b32 v177, a61
    v_mul_f32 v177, v177, v189
    v_accvgpr_write_b32 a61, v177
    v_accvgpr_read_b32 v178, a62
    v_mul_f32 v178, v178, v189
    v_accvgpr_write_b32 a62, v178
    v_accvgpr_read_b32 v179, a63
    v_mul_f32 v179, v179, v189
    v_accvgpr_write_b32 a63, v179
    v_exp_f32 v180, v8
    v_exp_f32 v181, v9
    s_nop 0
    v_add_f32 v113, v180, v181
    v_cvt_pk_bf16_f32 v68, v180, v181
    v_exp_f32 v182, v10
    v_exp_f32 v183, v11
    s_nop 0
    v_add_f32 v113, v113, v182
    v_add_f32 v113, v113, v183
    v_cvt_pk_bf16_f32 v69, v182, v183
    v_exp_f32 v180, v12
    v_exp_f32 v181, v13
    s_nop 0
    v_add_f32 v113, v113, v180
    v_add_f32 v113, v113, v181
    v_cvt_pk_bf16_f32 v70, v180, v181
    v_exp_f32 v182, v14
    v_exp_f32 v183, v15
    s_nop 0
    v_add_f32 v113, v113, v182
    v_add_f32 v113, v113, v183
    v_cvt_pk_bf16_f32 v71, v182, v183
    s_nop 7
    s_setpc_b64 s[58:59]
L_attn_rare0_1:
    s_nop 15
    v_max3_f32 v188, v16, v17, v18
    v_max3_f32 v188, v188, v19, v20
    v_max3_f32 v188, v188, v21, v22
    v_max_f32 v188, v188, v23
    v_mov_b32 v189, v188
    s_nop 1
    v_permlane16_swap_b32 v188, v189
    v_max_f32 v188, v188, v189
    v_mov_b32 v189, v188
    s_nop 1
    v_permlane32_swap_b32 v188, v189
    v_max_f32 v188, v188, v189
    v_add_f32 v188, 0x42cc0000, v188
    v_max_f32 v188, 0, v188
    v_sub_f32 v16, v16, v188
    v_sub_f32 v17, v17, v188
    v_sub_f32 v18, v18, v188
    v_sub_f32 v19, v19, v188
    v_sub_f32 v20, v20, v188
    v_sub_f32 v21, v21, v188
    v_sub_f32 v22, v22, v188
    v_sub_f32 v23, v23, v188
    v_sub_f32 v48, v48, v188
    v_sub_f32 v49, v49, v188
    v_sub_f32 v50, v50, v188
    v_sub_f32 v51, v51, v188
    v_sub_f32 v52, v52, v188
    v_sub_f32 v53, v53, v188
    v_sub_f32 v54, v54, v188
    v_sub_f32 v55, v55, v188
    v_sub_f32 v104, v104, v188
    v_sub_f32 v105, v105, v188
    v_sub_f32 v106, v106, v188
    v_sub_f32 v107, v107, v188
    v_sub_f32 v189, 0, v188
    v_exp_f32 v189, v189
    s_nop 0
    v_mul_f32 v118, v118, v189
    v_accvgpr_read_b32 v176, a64
    v_mul_f32 v176, v176, v189
    v_accvgpr_write_b32 a64, v176
    v_accvgpr_read_b32 v177, a65
    v_mul_f32 v177, v177, v189
    v_accvgpr_write_b32 a65, v177
    v_accvgpr_read_b32 v178, a66
    v_mul_f32 v178, v178, v189
    v_accvgpr_write_b32 a66, v178
    v_accvgpr_read_b32 v179, a67
    v_mul_f32 v179, v179, v189
    v_accvgpr_write_b32 a67, v179
    v_accvgpr_read_b32 v176, a68
    v_mul_f32 v176, v176, v189
    v_accvgpr_write_b32 a68, v176
    v_accvgpr_read_b32 v177, a69
    v_mul_f32 v177, v177, v189
    v_accvgpr_write_b32 a69, v177
    v_accvgpr_read_b32 v178, a70
    v_mul_f32 v178, v178, v189
    v_accvgpr_write_b32 a70, v178
    v_accvgpr_read_b32 v179, a71
    v_mul_f32 v179, v179, v189
    v_accvgpr_write_b32 a71, v179
    v_accvgpr_read_b32 v176, a72
    v_mul_f32 v176, v176, v189
    v_accvgpr_write_b32 a72, v176
    v_accvgpr_read_b32 v177, a73
    v_mul_f32 v177, v177, v189
    v_accvgpr_write_b32 a73, v177
    v_accvgpr_read_b32 v178, a74
    v_mul_f32 v178, v178, v189
    v_accvgpr_write_b32 a74, v178
    v_accvgpr_read_b32 v179, a75
    v_mul_f32 v179, v179, v189
    v_accvgpr_write_b32 a75, v179
    v_accvgpr_read_b32 v176, a76
    v_mul_f32 v176, v176, v189
    v_accvgpr_write_b32 a76, v176
    v_accvgpr_read_b32 v177, a77
    v_mul_f32 v177, v177, v189
    v_accvgpr_write_b32 a77, v177
    v_accvgpr_read_b32 v178, a78
    v_mul_f32 v178, v178, v189
    v_accvgpr_write_b32 a78, v178
    v_accvgpr_read_b32 v179, a79
    v_mul_f32 v179, v179, v189
    v_accvgpr_write_b32 a79, v179
    v_accvgpr_read_b32 v176, a80
    v_mul_f32 v176, v176, v189
    v_accvgpr_write_b32 a80, v176
    v_accvgpr_read_b32 v177, a81
    v_mul_f32 v177, v177, v189
    v_accvgpr_write_b32 a81, v177
    v_accvgpr_read_b32 v178, a82
    v_mul_f32 v178, v178, v189
    v_accvgpr_write_b32 a82, v178
    v_accvgpr_read_b32 v179, a83
    v_mul_f32 v179, v179, v189
    v_accvgpr_write_b32 a83, v179
    v_accvgpr_read_b32 v176, a84
    v_mul_f32 v176, v176, v189
    v_accvgpr_write_b32 a84, v176
    v_accvgpr_read_b32 v177, a85
    v_mul_f32 v177, v177, v189
    v_accvgpr_write_b32 a85, v177
    v_accvgpr_read_b32 v178, a86
    v_mul_f32 v178, v178, v189
    v_accvgpr_write_b32 a86, v178
    v_accvgpr_read_b32 v179, a87
    v_mul_f32 v179, v179, v189
    v_accvgpr_write_b32 a87, v179
    v_accvgpr_read_b32 v176, a88
    v_mul_f32 v176, v176, v189
    v_accvgpr_write_b32 a88, v176
    v_accvgpr_read_b32 v177, a89
    v_mul_f32 v177, v177, v189
    v_accvgpr_write_b32 a89, v177
    v_accvgpr_read_b32 v178, a90
    v_mul_f32 v178, v178, v189
    v_accvgpr_write_b32 a90, v178
    v_accvgpr_read_b32 v179, a91
    v_mul_f32 v179, v179, v189
    v_accvgpr_write_b32 a91, v179
    v_accvgpr_read_b32 v176, a92
    v_mul_f32 v176, v176, v189
    v_accvgpr_write_b32 a92, v176
    v_accvgpr_read_b32 v177, a93
    v_mul_f32 v177, v177, v189
    v_accvgpr_write_b32 a93, v177
    v_accvgpr_read_b32 v178, a94
    v_mul_f32 v178, v178, v189
    v_accvgpr_write_b32 a94, v178
    v_accvgpr_read_b32 v179, a95
    v_mul_f32 v179, v179, v189
    v_accvgpr_write_b32 a95, v179
    v_exp_f32 v180, v16
    v_exp_f32 v181, v17
    s_nop 0
    v_add_f32 v114, v180, v181
    v_cvt_pk_bf16_f32 v72, v180, v181
    v_exp_f32 v182, v18
    v_exp_f32 v183, v19
    s_nop 0
    v_add_f32 v114, v114, v182
    v_add_f32 v114, v114, v183
    v_cvt_pk_bf16_f32 v73, v182, v183
    v_exp_f32 v180, v20
    v_exp_f32 v181, v21
    s_nop 0
    v_add_f32 v114, v114, v180
    v_add_f32 v114, v114, v181
    v_cvt_pk_bf16_f32 v74, v180, v181
    v_exp_f32 v182, v22
    v_exp_f32 v183, v23
    s_nop 0
    v_add_f32 v114, v114, v182
    v_add_f32 v114, v114, v183
    v_cvt_pk_bf16_f32 v75, v182, v183
    v_max3_f32 v188, v24, v25, v26
    v_max3_f32 v188, v188, v27, v28
    v_max3_f32 v188, v188, v29, v30
    v_max_f32 v188, v188, v31
    v_mov_b32 v189, v188
    s_nop 1
    v_permlane16_swap_b32 v188, v189
    v_max_f32 v188, v188, v189
    v_mov_b32 v189, v188
    s_nop 1
    v_permlane32_swap_b32 v188, v189
    v_max_f32 v188, v188, v189
    v_add_f32 v188, 0x42cc0000, v188
    v_max_f32 v188, 0, v188
    v_sub_f32 v24, v24, v188
    v_sub_f32 v25, v25, v188
    v_sub_f32 v26, v26, v188
    v_sub_f32 v27, v27, v188
    v_sub_f32 v28, v28, v188
    v_sub_f32 v29, v29, v188
    v_sub_f32 v30, v30, v188
    v_sub_f32 v31, v31, v188
    v_sub_f32 v56, v56, v188
    v_sub_f32 v57, v57, v188
    v_sub_f32 v58, v58, v188
    v_sub_f32 v59, v59, v188
    v_sub_f32 v60, v60, v188
    v_sub_f32 v61, v61, v188
    v_sub_f32 v62, v62, v188
    v_sub_f32 v63, v63, v188
    v_sub_f32 v108, v108, v188
    v_sub_f32 v109, v109, v188
    v_sub_f32 v110, v110, v188
    v_sub_f32 v111, v111, v188
    v_sub_f32 v189, 0, v188
    v_exp_f32 v189, v189
    s_nop 0
    v_mul_f32 v119, v119, v189
    v_accvgpr_read_b32 v176, a96
    v_mul_f32 v176, v176, v189
    v_accvgpr_write_b32 a96, v176
    v_accvgpr_read_b32 v177, a97
    v_mul_f32 v177, v177, v189
    v_accvgpr_write_b32 a97, v177
    v_accvgpr_read_b32 v178, a98
    v_mul_f32 v178, v178, v189
    v_accvgpr_write_b32 a98, v178
    v_accvgpr_read_b32 v179, a99
    v_mul_f32 v179, v179, v189
    v_accvgpr_write_b32 a99, v179
    v_accvgpr_read_b32 v176, a100
    v_mul_f32 v176, v176, v189
    v_accvgpr_write_b32 a100, v176
    v_accvgpr_read_b32 v177, a101
    v_mul_f32 v177, v177, v189
    v_accvgpr_write_b32 a101, v177
    v_accvgpr_read_b32 v178, a102
    v_mul_f32 v178, v178, v189
    v_accvgpr_write_b32 a102, v178
    v_accvgpr_read_b32 v179, a103
    v_mul_f32 v179, v179, v189
    v_accvgpr_write_b32 a103, v179
    v_accvgpr_read_b32 v176, a104
    v_mul_f32 v176, v176, v189
    v_accvgpr_write_b32 a104, v176
    v_accvgpr_read_b32 v177, a105
    v_mul_f32 v177, v177, v189
    v_accvgpr_write_b32 a105, v177
    v_accvgpr_read_b32 v178, a106
    v_mul_f32 v178, v178, v189
    v_accvgpr_write_b32 a106, v178
    v_accvgpr_read_b32 v179, a107
    v_mul_f32 v179, v179, v189
    v_accvgpr_write_b32 a107, v179
    v_accvgpr_read_b32 v176, a108
    v_mul_f32 v176, v176, v189
    v_accvgpr_write_b32 a108, v176
    v_accvgpr_read_b32 v177, a109
    v_mul_f32 v177, v177, v189
    v_accvgpr_write_b32 a109, v177
    v_accvgpr_read_b32 v178, a110
    v_mul_f32 v178, v178, v189
    v_accvgpr_write_b32 a110, v178
    v_accvgpr_read_b32 v179, a111
    v_mul_f32 v179, v179, v189
    v_accvgpr_write_b32 a111, v179
    v_accvgpr_read_b32 v176, a112
    v_mul_f32 v176, v176, v189
    v_accvgpr_write_b32 a112, v176
    v_accvgpr_read_b32 v177, a113
    v_mul_f32 v177, v177, v189
    v_accvgpr_write_b32 a113, v177
    v_accvgpr_read_b32 v178, a114
    v_mul_f32 v178, v178, v189
    v_accvgpr_write_b32 a114, v178
    v_accvgpr_read_b32 v179, a115
    v_mul_f32 v179, v179, v189
    v_accvgpr_write_b32 a115, v179
    v_accvgpr_read_b32 v176, a116
    v_mul_f32 v176, v176, v189
    v_accvgpr_write_b32 a116, v176
    v_accvgpr_read_b32 v177, a117
    v_mul_f32 v177, v177, v189
    v_accvgpr_write_b32 a117, v177
    v_accvgpr_read_b32 v178, a118
    v_mul_f32 v178, v178, v189
    v_accvgpr_write_b32 a118, v178
    v_accvgpr_read_b32 v179, a119
    v_mul_f32 v179, v179, v189
    v_accvgpr_write_b32 a119, v179
    v_accvgpr_read_b32 v176, a120
    v_mul_f32 v176, v176, v189
    v_accvgpr_write_b32 a120, v176
    v_accvgpr_read_b32 v177, a121
    v_mul_f32 v177, v177, v189
    v_accvgpr_write_b32 a121, v177
    v_accvgpr_read_b32 v178, a122
    v_mul_f32 v178, v178, v189
    v_accvgpr_write_b32 a122, v178
    v_accvgpr_read_b32 v179, a123
    v_mul_f32 v179, v179, v189
    v_accvgpr_write_b32 a123, v179
    v_accvgpr_read_b32 v176, a124
    v_mul_f32 v176, v176, v189
    v_accvgpr_write_b32 a124, v176
    v_accvgpr_read_b32 v177, a125
    v_mul_f32 v177, v177, v189
    v_accvgpr_write_b32 a125, v177
    v_accvgpr_read_b32 v178, a126
    v_mul_f32 v178, v178, v189
    v_accvgpr_write_b32 a126, v178
    v_accvgpr_read_b32 v179, a127
    v_mul_f32 v179, v179, v189
    v_accvgpr_write_b32 a127, v179
    v_exp_f32 v180, v24
    v_exp_f32 v181, v25
    s_nop 0
    v_add_f32 v115, v180, v181
    v_cvt_pk_bf16_f32 v76, v180, v181
    v_exp_f32 v182, v26
    v_exp_f32 v183, v27
    s_nop 0
    v_add_f32 v115, v115, v182
    v_add_f32 v115, v115, v183
    v_cvt_pk_bf16_f32 v77, v182, v183
    v_exp_f32 v180, v28
    v_exp_f32 v181, v29
    s_nop 0
    v_add_f32 v115, v115, v180
    v_add_f32 v115, v115, v181
    v_cvt_pk_bf16_f32 v78, v180, v181
    v_exp_f32 v182, v30
    v_exp_f32 v183, v31
    s_nop 0
    v_add_f32 v115, v115, v182
    v_add_f32 v115, v115, v183
    v_cvt_pk_bf16_f32 v79, v182, v183
    s_nop 7
    s_setpc_b64 s[58:59]
L_attn_rare1_0:
    s_nop 15
    v_max3_f32 v188, v32, v33, v34
    v_max3_f32 v188, v188, v35, v36
    v_max3_f32 v188, v188, v37, v38
    v_max_f32 v188, v188, v39
    v_mov_b32 v189, v188
    s_nop 1
    v_permlane16_swap_b32 v188, v189
    v_max_f32 v188, v188, v189
    v_mov_b32 v189, v188
    s_nop 1
    v_permlane32_swap_b32 v188, v189
    v_max_f32 v188, v188, v189
    v_add_f32 v188, 0x42cc0000, v188
    v_max_f32 v188, 0, v188
    v_sub_f32 v32, v32, v188
    v_sub_f32 v33, v33, v188
    v_sub_f32 v34, v34, v188
    v_sub_f32 v35, v35, v188
    v_sub_f32 v36, v36, v188
    v_sub_f32 v37, v37, v188
    v_sub_f32 v38, v38, v188
    v_sub_f32 v39, v39, v188
    v_sub_f32 v0, v0, v188
    v_sub_f32 v1, v1, v188
    v_sub_f32 v2, v2, v188
    v_sub_f32 v3, v3, v188
    v_sub_f32 v4, v4, v188
    v_sub_f32 v5, v5, v188
    v_sub_f32 v6, v6, v188
    v_sub_f32 v7, v7, v188
    v_sub_f32 v96, v96, v188
    v_sub_f32 v97, v97, v188
    v_sub_f32 v98, v98, v188
    v_sub_f32 v99, v99, v188
    v_sub_f32 v189, 0, v188
    v_exp_f32 v189, v189
    s_nop 0
    v_mul_f32 v116, v116, v189
    v_accvgpr_read_b32 v176, a0
    v_mul_f32 v176, v176, v189
    v_accvgpr_write_b32 a0, v176
    v_accvgpr_read_b32 v177, a1
    v_mul_f32 v177, v177, v189
    v_accvgpr_write_b32 a1, v177
    v_accvgpr_read_b32 v178, a2
    v_mul_f32 v178, v178, v189
    v_accvgpr_write_b32 a2, v178
    v_accvgpr_read_b32 v179, a3
    v_mul_f32 v179, v179, v189
    v_accvgpr_write_b32 a3, v179
    v_accvgpr_read_b32 v176, a4
    v_mul_f32 v176, v176, v189
    v_accvgpr_write_b32 a4, v176
    v_accvgpr_read_b32 v177, a5
    v_mul_f32 v177, v177, v189
    v_accvgpr_write_b32 a5, v177
    v_accvgpr_read_b32 v178, a6
    v_mul_f32 v178, v178, v189
    v_accvgpr_write_b32 a6, v178
    v_accvgpr_read_b32 v179, a7
    v_mul_f32 v179, v179, v189
    v_accvgpr_write_b32 a7, v179
    v_accvgpr_read_b32 v176, a8
    v_mul_f32 v176, v176, v189
    v_accvgpr_write_b32 a8, v176
    v_accvgpr_read_b32 v177, a9
    v_mul_f32 v177, v177, v189
    v_accvgpr_write_b32 a9, v177
    v_accvgpr_read_b32 v178, a10
    v_mul_f32 v178, v178, v189
    v_accvgpr_write_b32 a10, v178
    v_accvgpr_read_b32 v179, a11
    v_mul_f32 v179, v179, v189
    v_accvgpr_write_b32 a11, v179
    v_accvgpr_read_b32 v176, a12
    v_mul_f32 v176, v176, v189
    v_accvgpr_write_b32 a12, v176
    v_accvgpr_read_b32 v177, a13
    v_mul_f32 v177, v177, v189
    v_accvgpr_write_b32 a13, v177
    v_accvgpr_read_b32 v178, a14
    v_mul_f32 v178, v178, v189
    v_accvgpr_write_b32 a14, v178
    v_accvgpr_read_b32 v179, a15
    v_mul_f32 v179, v179, v189
    v_accvgpr_write_b32 a15, v179
    v_accvgpr_read_b32 v176, a16
    v_mul_f32 v176, v176, v189
    v_accvgpr_write_b32 a16, v176
    v_accvgpr_read_b32 v177, a17
    v_mul_f32 v177, v177, v189
    v_accvgpr_write_b32 a17, v177
    v_accvgpr_read_b32 v178, a18
    v_mul_f32 v178, v178, v189
    v_accvgpr_write_b32 a18, v178
    v_accvgpr_read_b32 v179, a19
    v_mul_f32 v179, v179, v189
    v_accvgpr_write_b32 a19, v179
    v_accvgpr_read_b32 v176, a20
    v_mul_f32 v176, v176, v189
    v_accvgpr_write_b32 a20, v176
    v_accvgpr_read_b32 v177, a21
    v_mul_f32 v177, v177, v189
    v_accvgpr_write_b32 a21, v177
    v_accvgpr_read_b32 v178, a22
    v_mul_f32 v178, v178, v189
    v_accvgpr_write_b32 a22, v178
    v_accvgpr_read_b32 v179, a23
    v_mul_f32 v179, v179, v189
    v_accvgpr_write_b32 a23, v179
    v_accvgpr_read_b32 v176, a24
    v_mul_f32 v176, v176, v189
    v_accvgpr_write_b32 a24, v176
    v_accvgpr_read_b32 v177, a25
    v_mul_f32 v177, v177, v189
    v_accvgpr_write_b32 a25, v177
    v_accvgpr_read_b32 v178, a26
    v_mul_f32 v178, v178, v189
    v_accvgpr_write_b32 a26, v178
    v_accvgpr_read_b32 v179, a27
    v_mul_f32 v179, v179, v189
    v_accvgpr_write_b32 a27, v179
    v_accvgpr_read_b32 v176, a28
    v_mul_f32 v176, v176, v189
    v_accvgpr_write_b32 a28, v176
    v_accvgpr_read_b32 v177, a29
    v_mul_f32 v177, v177, v189
    v_accvgpr_write_b32 a29, v177
    v_accvgpr_read_b32 v178, a30
    v_mul_f32 v178, v178, v189
    v_accvgpr_write_b32 a30, v178
    v_accvgpr_read_b32 v179, a31
    v_mul_f32 v179, v179, v189
    v_accvgpr_write_b32 a31, v179
    v_exp_f32 v180, v32
    v_exp_f32 v181, v33
    s_nop 0
    v_add_f32 v112, v180, v181
    v_cvt_pk_bf16_f32 v80, v180, v181
    v_exp_f32 v182, v34
    v_exp_f32 v183, v35
    s_nop 0
    v_add_f32 v112, v112, v182
    v_add_f32 v112, v112, v183
    v_cvt_pk_bf16_f32 v81, v182, v183
    v_exp_f32 v180, v36
    v_exp_f32 v181, v37
    s_nop 0
    v_add_f32 v112, v112, v180
    v_add_f32 v112, v112, v181
    v_cvt_pk_bf16_f32 v82, v180, v181
    v_exp_f32 v182, v38
    v_exp_f32 v183, v39
    s_nop 0
    v_add_f32 v112, v112, v182
    v_add_f32 v112, v112, v183
    v_cvt_pk_bf16_f32 v83, v182, v183
    v_max3_f32 v188, v40, v41, v42
    v_max3_f32 v188, v188, v43, v44
    v_max3_f32 v188, v188, v45, v46
    v_max_f32 v188, v188, v47
    v_mov_b32 v189, v188
    s_nop 1
    v_permlane16_swap_b32 v188, v189
    v_max_f32 v188, v188, v189
    v_mov_b32 v189, v188
    s_nop 1
    v_permlane32_swap_b32 v188, v189
    v_max_f32 v188, v188, v189
    v_add_f32 v188, 0x42cc0000, v188
    v_max_f32 v188, 0, v188
    v_sub_f32 v40, v40, v188
    v_sub_f32 v41, v41, v188
    v_sub_f32 v42, v42, v188
    v_sub_f32 v43, v43, v188
    v_sub_f32 v44, v44, v188
    v_sub_f32 v45, v45, v188
    v_sub_f32 v46, v46, v188
    v_sub_f32 v47, v47, v188
    v_sub_f32 v8, v8, v188
    v_sub_f32 v9, v9, v188
    v_sub_f32 v10, v10, v188
    v_sub_f32 v11, v11, v188
    v_sub_f32 v12, v12, v188
    v_sub_f32 v13, v13, v188
    v_sub_f32 v14, v14, v188
    v_sub_f32 v15, v15, v188
    v_sub_f32 v100, v100, v188
    v_sub_f32 v101, v101, v188
    v_sub_f32 v102, v102, v188
    v_sub_f32 v103, v103, v188
    v_sub_f32 v189, 0, v188
    v_exp_f32 v189, v189
    s_nop 0
    v_mul_f32 v117, v117, v189
    v_accvgpr_read_b32 v176, a32
    v_mul_f32 v176, v176, v189
    v_accvgpr_write_b32 a32, v176
    v_accvgpr_read_b32 v177, a33
    v_mul_f32 v177, v177, v189
    v_accvgpr_write_b32 a33, v177
    v_accvgpr_read_b32 v178, a34
    v_mul_f32 v178, v178, v189
    v_accvgpr_write_b32 a34, v178
    v_accvgpr_read_b32 v179, a35
    v_mul_f32 v179, v179, v189
    v_accvgpr_write_b32 a35, v179
    v_accvgpr_read_b32 v176, a36
    v_mul_f32 v176, v176, v189
    v_accvgpr_write_b32 a36, v176
    v_accvgpr_read_b32 v177, a37
    v_mul_f32 v177, v177, v189
    v_accvgpr_write_b32 a37, v177
    v_accvgpr_read_b32 v178, a38
    v_mul_f32 v178, v178, v189
    v_accvgpr_write_b32 a38, v178
    v_accvgpr_read_b32 v179, a39
    v_mul_f32 v179, v179, v189
    v_accvgpr_write_b32 a39, v179
    v_accvgpr_read_b32 v176, a40
    v_mul_f32 v176, v176, v189
    v_accvgpr_write_b32 a40, v176
    v_accvgpr_read_b32 v177, a41
    v_mul_f32 v177, v177, v189
    v_accvgpr_write_b32 a41, v177
    v_accvgpr_read_b32 v178, a42
    v_mul_f32 v178, v178, v189
    v_accvgpr_write_b32 a42, v178
    v_accvgpr_read_b32 v179, a43
    v_mul_f32 v179, v179, v189
    v_accvgpr_write_b32 a43, v179
    v_accvgpr_read_b32 v176, a44
    v_mul_f32 v176, v176, v189
    v_accvgpr_write_b32 a44, v176
    v_accvgpr_read_b32 v177, a45
    v_mul_f32 v177, v177, v189
    v_accvgpr_write_b32 a45, v177
    v_accvgpr_read_b32 v178, a46
    v_mul_f32 v178, v178, v189
    v_accvgpr_write_b32 a46, v178
    v_accvgpr_read_b32 v179, a47
    v_mul_f32 v179, v179, v189
    v_accvgpr_write_b32 a47, v179
    v_accvgpr_read_b32 v176, a48
    v_mul_f32 v176, v176, v189
    v_accvgpr_write_b32 a48, v176
    v_accvgpr_read_b32 v177, a49
    v_mul_f32 v177, v177, v189
    v_accvgpr_write_b32 a49, v177
    v_accvgpr_read_b32 v178, a50
    v_mul_f32 v178, v178, v189
    v_accvgpr_write_b32 a50, v178
    v_accvgpr_read_b32 v179, a51
    v_mul_f32 v179, v179, v189
    v_accvgpr_write_b32 a51, v179
    v_accvgpr_read_b32 v176, a52
    v_mul_f32 v176, v176, v189
    v_accvgpr_write_b32 a52, v176
    v_accvgpr_read_b32 v177, a53
    v_mul_f32 v177, v177, v189
    v_accvgpr_write_b32 a53, v177
    v_accvgpr_read_b32 v178, a54
    v_mul_f32 v178, v178, v189
    v_accvgpr_write_b32 a54, v178
    v_accvgpr_read_b32 v179, a55
    v_mul_f32 v179, v179, v189
    v_accvgpr_write_b32 a55, v179
    v_accvgpr_read_b32 v176, a56
    v_mul_f32 v176, v176, v189
    v_accvgpr_write_b32 a56, v176
    v_accvgpr_read_b32 v177, a57
    v_mul_f32 v177, v177, v189
    v_accvgpr_write_b32 a57, v177
    v_accvgpr_read_b32 v178, a58
    v_mul_f32 v178, v178, v189
    v_accvgpr_write_b32 a58, v178
    v_accvgpr_read_b32 v179, a59
    v_mul_f32 v179, v179, v189
    v_accvgpr_write_b32 a59, v179
    v_accvgpr_read_b32 v176, a60
    v_mul_f32 v176, v176, v189
    v_accvgpr_write_b32 a60, v176
    v_accvgpr_read_b32 v177, a61
    v_mul_f32 v177, v177, v189
    v_accvgpr_write_b32 a61, v177
    v_accvgpr_read_b32 v178, a62
    v_mul_f32 v178, v178, v189
    v_accvgpr_write_b32 a62, v178
    v_accvgpr_read_b32 v179, a63
    v_mul_f32 v179, v179, v189
    v_accvgpr_write_b32 a63, v179
    v_exp_f32 v180, v40
    v_exp_f32 v181, v41
    s_nop 0
    v_add_f32 v113, v180, v181
    v_cvt_pk_bf16_f32 v84, v180, v181
    v_exp_f32 v182, v42
    v_exp_f32 v183, v43
    s_nop 0
    v_add_f32 v113, v113, v182
    v_add_f32 v113, v113, v183
    v_cvt_pk_bf16_f32 v85, v182, v183
    v_exp_f32 v180, v44
    v_exp_f32 v181, v45
    s_nop 0
    v_add_f32 v113, v113, v180
    v_add_f32 v113, v113, v181
    v_cvt_pk_bf16_f32 v86, v180, v181
    v_exp_f32 v182, v46
    v_exp_f32 v183, v47
    s_nop 0
    v_add_f32 v113, v113, v182
    v_add_f32 v113, v113, v183
    v_cvt_pk_bf16_f32 v87, v182, v183
    s_nop 7
    s_setpc_b64 s[58:59]
L_attn_rare1_1:
    s_nop 15
    v_max3_f32 v188, v48, v49, v50
    v_max3_f32 v188, v188, v51, v52
    v_max3_f32 v188, v188, v53, v54
    v_max_f32 v188, v188, v55
    v_mov_b32 v189, v188
    s_nop 1
    v_permlane16_swap_b32 v188, v189
    v_max_f32 v188, v188, v189
    v_mov_b32 v189, v188
    s_nop 1
    v_permlane32_swap_b32 v188, v189
    v_max_f32 v188, v188, v189
    v_add_f32 v188, 0x42cc0000, v188
    v_max_f32 v188, 0, v188
    v_sub_f32 v48, v48, v188
    v_sub_f32 v49, v49, v188
    v_sub_f32 v50, v50, v188
    v_sub_f32 v51, v51, v188
    v_sub_f32 v52, v52, v188
    v_sub_f32 v53, v53, v188
    v_sub_f32 v54, v54, v188
    v_sub_f32 v55, v55, v188
    v_sub_f32 v16, v16, v188
    v_sub_f32 v17, v17, v188
    v_sub_f32 v18, v18, v188
    v_sub_f32 v19, v19, v188
    v_sub_f32 v20, v20, v188
    v_sub_f32 v21, v21, v188
    v_sub_f32 v22, v22, v188
    v_sub_f32 v23, v23, v188
    v_sub_f32 v104, v104, v188
    v_sub_f32 v105, v105, v188
    v_sub_f32 v106, v106, v188
    v_sub_f32 v107, v107, v188
    v_sub_f32 v189, 0, v188
    v_exp_f32 v189, v189
    s_nop 0
    v_mul_f32 v118, v118, v189
    v_accvgpr_read_b32 v176, a64
    v_mul_f32 v176, v176, v189
    v_accvgpr_write_b32 a64, v176
    v_accvgpr_read_b32 v177, a65
    v_mul_f32 v177, v177, v189
    v_accvgpr_write_b32 a65, v177
    v_accvgpr_read_b32 v178, a66
    v_mul_f32 v178, v178, v189
    v_accvgpr_write_b32 a66, v178
    v_accvgpr_read_b32 v179, a67
    v_mul_f32 v179, v179, v189
    v_accvgpr_write_b32 a67, v179
    v_accvgpr_read_b32 v176, a68
    v_mul_f32 v176, v176, v189
    v_accvgpr_write_b32 a68, v176
    v_accvgpr_read_b32 v177, a69
    v_mul_f32 v177, v177, v189
    v_accvgpr_write_b32 a69, v177
    v_accvgpr_read_b32 v178, a70
    v_mul_f32 v178, v178, v189
    v_accvgpr_write_b32 a70, v178
    v_accvgpr_read_b32 v179, a71
    v_mul_f32 v179, v179, v189
    v_accvgpr_write_b32 a71, v179
    v_accvgpr_read_b32 v176, a72
    v_mul_f32 v176, v176, v189
    v_accvgpr_write_b32 a72, v176
    v_accvgpr_read_b32 v177, a73
    v_mul_f32 v177, v177, v189
    v_accvgpr_write_b32 a73, v177
    v_accvgpr_read_b32 v178, a74
    v_mul_f32 v178, v178, v189
    v_accvgpr_write_b32 a74, v178
    v_accvgpr_read_b32 v179, a75
    v_mul_f32 v179, v179, v189
    v_accvgpr_write_b32 a75, v179
    v_accvgpr_read_b32 v176, a76
    v_mul_f32 v176, v176, v189
    v_accvgpr_write_b32 a76, v176
    v_accvgpr_read_b32 v177, a77
    v_mul_f32 v177, v177, v189
    v_accvgpr_write_b32 a77, v177
    v_accvgpr_read_b32 v178, a78
    v_mul_f32 v178, v178, v189
    v_accvgpr_write_b32 a78, v178
    v_accvgpr_read_b32 v179, a79
    v_mul_f32 v179, v179, v189
    v_accvgpr_write_b32 a79, v179
    v_accvgpr_read_b32 v176, a80
    v_mul_f32 v176, v176, v189
    v_accvgpr_write_b32 a80, v176
    v_accvgpr_read_b32 v177, a81
    v_mul_f32 v177, v177, v189
    v_accvgpr_write_b32 a81, v177
    v_accvgpr_read_b32 v178, a82
    v_mul_f32 v178, v178, v189
    v_accvgpr_write_b32 a82, v178
    v_accvgpr_read_b32 v179, a83
    v_mul_f32 v179, v179, v189
    v_accvgpr_write_b32 a83, v179
    v_accvgpr_read_b32 v176, a84
    v_mul_f32 v176, v176, v189
    v_accvgpr_write_b32 a84, v176
    v_accvgpr_read_b32 v177, a85
    v_mul_f32 v177, v177, v189
    v_accvgpr_write_b32 a85, v177
    v_accvgpr_read_b32 v178, a86
    v_mul_f32 v178, v178, v189
    v_accvgpr_write_b32 a86, v178
    v_accvgpr_read_b32 v179, a87
    v_mul_f32 v179, v179, v189
    v_accvgpr_write_b32 a87, v179
    v_accvgpr_read_b32 v176, a88
    v_mul_f32 v176, v176, v189
    v_accvgpr_write_b32 a88, v176
    v_accvgpr_read_b32 v177, a89
    v_mul_f32 v177, v177, v189
    v_accvgpr_write_b32 a89, v177
    v_accvgpr_read_b32 v178, a90
    v_mul_f32 v178, v178, v189
    v_accvgpr_write_b32 a90, v178
    v_accvgpr_read_b32 v179, a91
    v_mul_f32 v179, v179, v189
    v_accvgpr_write_b32 a91, v179
    v_accvgpr_read_b32 v176, a92
    v_mul_f32 v176, v176, v189
    v_accvgpr_write_b32 a92, v176
    v_accvgpr_read_b32 v177, a93
    v_mul_f32 v177, v177, v189
    v_accvgpr_write_b32 a93, v177
    v_accvgpr_read_b32 v178, a94
    v_mul_f32 v178, v178, v189
    v_accvgpr_write_b32 a94, v178
    v_accvgpr_read_b32 v179, a95
    v_mul_f32 v179, v179, v189
    v_accvgpr_write_b32 a95, v179
    v_exp_f32 v180, v48
    v_exp_f32 v181, v49
    s_nop 0
    v_add_f32 v114, v180, v181
    v_cvt_pk_bf16_f32 v88, v180, v181
    v_exp_f32 v182, v50
    v_exp_f32 v183, v51
    s_nop 0
    v_add_f32 v114, v114, v182
    v_add_f32 v114, v114, v183
    v_cvt_pk_bf16_f32 v89, v182, v183
    v_exp_f32 v180, v52
    v_exp_f32 v181, v53
    s_nop 0
    v_add_f32 v114, v114, v180
    v_add_f32 v114, v114, v181
    v_cvt_pk_bf16_f32 v90, v180, v181
    v_exp_f32 v182, v54
    v_exp_f32 v183, v55
    s_nop 0
    v_add_f32 v114, v114, v182
    v_add_f32 v114, v114, v183
    v_cvt_pk_bf16_f32 v91, v182, v183
    v_max3_f32 v188, v56, v57, v58
    v_max3_f32 v188, v188, v59, v60
    v_max3_f32 v188, v188, v61, v62
    v_max_f32 v188, v188, v63
    v_mov_b32 v189, v188
    s_nop 1
    v_permlane16_swap_b32 v188, v189
    v_max_f32 v188, v188, v189
    v_mov_b32 v189, v188
    s_nop 1
    v_permlane32_swap_b32 v188, v189
    v_max_f32 v188, v188, v189
    v_add_f32 v188, 0x42cc0000, v188
    v_max_f32 v188, 0, v188
    v_sub_f32 v56, v56, v188
    v_sub_f32 v57, v57, v188
    v_sub_f32 v58, v58, v188
    v_sub_f32 v59, v59, v188
    v_sub_f32 v60, v60, v188
    v_sub_f32 v61, v61, v188
    v_sub_f32 v62, v62, v188
    v_sub_f32 v63, v63, v188
    v_sub_f32 v24, v24, v188
    v_sub_f32 v25, v25, v188
    v_sub_f32 v26, v26, v188
    v_sub_f32 v27, v27, v188
    v_sub_f32 v28, v28, v188
    v_sub_f32 v29, v29, v188
    v_sub_f32 v30, v30, v188
    v_sub_f32 v31, v31, v188
    v_sub_f32 v108, v108, v188
    v_sub_f32 v109, v109, v188
    v_sub_f32 v110, v110, v188
    v_sub_f32 v111, v111, v188
    v_sub_f32 v189, 0, v188
    v_exp_f32 v189, v189
    s_nop 0
    v_mul_f32 v119, v119, v189
    v_accvgpr_read_b32 v176, a96
    v_mul_f32 v176, v176, v189
    v_accvgpr_write_b32 a96, v176
    v_accvgpr_read_b32 v177, a97
    v_mul_f32 v177, v177, v189
    v_accvgpr_write_b32 a97, v177
    v_accvgpr_read_b32 v178, a98
    v_mul_f32 v178, v178, v189
    v_accvgpr_write_b32 a98, v178
    v_accvgpr_read_b32 v179, a99
    v_mul_f32 v179, v179, v189
    v_accvgpr_write_b32 a99, v179
    v_accvgpr_read_b32 v176, a100
    v_mul_f32 v176, v176, v189
    v_accvgpr_write_b32 a100, v176
    v_accvgpr_read_b32 v177, a101
    v_mul_f32 v177, v177, v189
    v_accvgpr_write_b32 a101, v177
    v_accvgpr_read_b32 v178, a102
    v_mul_f32 v178, v178, v189
    v_accvgpr_write_b32 a102, v178
    v_accvgpr_read_b32 v179, a103
    v_mul_f32 v179, v179, v189
    v_accvgpr_write_b32 a103, v179
    v_accvgpr_read_b32 v176, a104
    v_mul_f32 v176, v176, v189
    v_accvgpr_write_b32 a104, v176
    v_accvgpr_read_b32 v177, a105
    v_mul_f32 v177, v177, v189
    v_accvgpr_write_b32 a105, v177
    v_accvgpr_read_b32 v178, a106
    v_mul_f32 v178, v178, v189
    v_accvgpr_write_b32 a106, v178
    v_accvgpr_read_b32 v179, a107
    v_mul_f32 v179, v179, v189
    v_accvgpr_write_b32 a107, v179
    v_accvgpr_read_b32 v176, a108
    v_mul_f32 v176, v176, v189
    v_accvgpr_write_b32 a108, v176
    v_accvgpr_read_b32 v177, a109
    v_mul_f32 v177, v177, v189
    v_accvgpr_write_b32 a109, v177
    v_accvgpr_read_b32 v178, a110
    v_mul_f32 v178, v178, v189
    v_accvgpr_write_b32 a110, v178
    v_accvgpr_read_b32 v179, a111
    v_mul_f32 v179, v179, v189
    v_accvgpr_write_b32 a111, v179
    v_accvgpr_read_b32 v176, a112
    v_mul_f32 v176, v176, v189
    v_accvgpr_write_b32 a112, v176
    v_accvgpr_read_b32 v177, a113
    v_mul_f32 v177, v177, v189
    v_accvgpr_write_b32 a113, v177
    v_accvgpr_read_b32 v178, a114
    v_mul_f32 v178, v178, v189
    v_accvgpr_write_b32 a114, v178
    v_accvgpr_read_b32 v179, a115
    v_mul_f32 v179, v179, v189
    v_accvgpr_write_b32 a115, v179
    v_accvgpr_read_b32 v176, a116
    v_mul_f32 v176, v176, v189
    v_accvgpr_write_b32 a116, v176
    v_accvgpr_read_b32 v177, a117
    v_mul_f32 v177, v177, v189
    v_accvgpr_write_b32 a117, v177
    v_accvgpr_read_b32 v178, a118
    v_mul_f32 v178, v178, v189
    v_accvgpr_write_b32 a118, v178
    v_accvgpr_read_b32 v179, a119
    v_mul_f32 v179, v179, v189
    v_accvgpr_write_b32 a119, v179
    v_accvgpr_read_b32 v176, a120
    v_mul_f32 v176, v176, v189
    v_accvgpr_write_b32 a120, v176
    v_accvgpr_read_b32 v177, a121
    v_mul_f32 v177, v177, v189
    v_accvgpr_write_b32 a121, v177
    v_accvgpr_read_b32 v178, a122
    v_mul_f32 v178, v178, v189
    v_accvgpr_write_b32 a122, v178
    v_accvgpr_read_b32 v179, a123
    v_mul_f32 v179, v179, v189
    v_accvgpr_write_b32 a123, v179
    v_accvgpr_read_b32 v176, a124
    v_mul_f32 v176, v176, v189
    v_accvgpr_write_b32 a124, v176
    v_accvgpr_read_b32 v177, a125
    v_mul_f32 v177, v177, v189
    v_accvgpr_write_b32 a125, v177
    v_accvgpr_read_b32 v178, a126
    v_mul_f32 v178, v178, v189
    v_accvgpr_write_b32 a126, v178
    v_accvgpr_read_b32 v179, a127
    v_mul_f32 v179, v179, v189
    v_accvgpr_write_b32 a127, v179
    v_exp_f32 v180, v56
    v_exp_f32 v181, v57
    s_nop 0
    v_add_f32 v115, v180, v181
    v_cvt_pk_bf16_f32 v92, v180, v181
    v_exp_f32 v182, v58
    v_exp_f32 v183, v59
    s_nop 0
    v_add_f32 v115, v115, v182
    v_add_f32 v115, v115, v183
    v_cvt_pk_bf16_f32 v93, v182, v183
    v_exp_f32 v180, v60
    v_exp_f32 v181, v61
    s_nop 0
    v_add_f32 v115, v115, v180
    v_add_f32 v115, v115, v181
    v_cvt_pk_bf16_f32 v94, v180, v181
    v_exp_f32 v182, v62
    v_exp_f32 v183, v63
    s_nop 0
    v_add_f32 v115, v115, v182
    v_add_f32 v115, v115, v183
    v_cvt_pk_bf16_f32 v95, v182, v183
    s_nop 7
    s_setpc_b64 s[58:59]
.section .rodata,"a"
.p2align 6
.amdhsa_kernel main_kernel
  .amdhsa_next_free_vgpr 512
  .amdhsa_next_free_sgpr 102
  .amdhsa_accum_offset 256
  .amdhsa_group_segment_fixed_size 0
  .amdhsa_kernarg_size 112
  .amdhsa_user_sgpr_count 2
  .amdhsa_user_sgpr_kernarg_segment_ptr 1
  .amdhsa_system_sgpr_workgroup_id_x 1
  .amdhsa_float_denorm_mode_32 3
.end_amdhsa_kernel
.text
.text
.p2align 2
L_code_end:
    s_endpgm
```
